```python
import torch

def _softmax(x, axis=-1):
    return torch.softmax(x, dim=axis)
def _gelu(x):
    return torch.nn.functional.gelu(x, approximate="tanh")
def _silu(x):
    return torch.nn.functional.silu(x)
def _sigmoid(x):
    return torch.sigmoid(x)
def _layernorm(x, axis=-1, eps=1e-5):
    m = x.mean(dim=axis, keepdim=True)
    v = x.var(dim=axis, keepdim=True, unbiased=False)
    return (x - m) / torch.sqrt(v + eps)
def _scatter_add(tgt, idx, src, axis=0):
    return tgt.clone().index_add_(axis, idx, src)
def _segment_sum(src, seg, n):
    out = torch.zeros((n,) + src.shape[1:], dtype=src.dtype)
    return out.index_add_(0, seg, src)
def _pad(x, pw):
    flat = tuple(v for pair in reversed(pw) for v in pair)
    return torch.nn.functional.pad(x, flat)

kernel_name = 'standalone__mha_block_cached__near_ridge'

def setup_inputs():

    _w = (lambda a: (lambda t: t.to(torch.bfloat16) if t.is_floating_point() else t)(torch.as_tensor(a)))
    B, Sq, D = 32, 192, 512
    H, Sk, Dh = 32, 512, 128
    return {
        "x": _w((lambda *s: torch.randn(*s, dtype=torch.bfloat16) * 0.8)(B, Sq, D)),
        "k_cache": _w((lambda *s: torch.randn(*s, dtype=torch.bfloat16) * 0.8)(B, H, Sk, Dh)),
        "v_cache": _w((lambda *s: torch.randn(*s, dtype=torch.bfloat16) * 0.05)(B, H, Sk, Dh)),
        "wq": _w((lambda *s: torch.randn(*s, dtype=torch.bfloat16) * 0.8)(D, H * Dh) * (D ** -0.5)),
        "wo": _w((lambda *s: torch.randn(*s, dtype=torch.bfloat16) * 0.05)(H * Dh, D) * ((H * Dh) ** -0.5)),
    }

def reference(x, k_cache, v_cache, wq, wo):
    B, Sq, D = x.shape
    H, Dh = 32, 128
    q = (lambda x, *d: x.permute(*d))((x @ wq).reshape(B, Sq, H, Dh), 0, 2, 1, 3)
    scores = torch.einsum("bhqd,bhkd->bhqk", q, k_cache) * (Dh ** -0.5)
    p = _softmax(scores, axis=-1)
    o = torch.einsum("bhqk,bhkd->bhqd", p, v_cache)
    return (lambda x, *d: x.permute(*d))(o, 0, 2, 1, 3).reshape(B, Sq, H * Dh) @ wo
```

```asm
; @launch grid=(256,1,1) block=(256,1,1) lds=163840
.amdgcn_target "amdgcn-amd-amdhsa--gfx950"
.text
.globl standalone__mha_block_cached__near_ridge_kernel
.p2align 8
.type standalone__mha_block_cached__near_ridge_kernel,@function
standalone__mha_block_cached__near_ridge_kernel:
s_cmp_lt_u32 s2, 256
s_cbranch_scc1 L_go
s_endpgm
L_go:
s_load_dwordx16 s[68:83], s[0:1], 0
v_lshrrev_b32 v1, 6, v0
v_and_b32 v252, 63, v0
s_and_b32 s4, s2, 7
v_readfirstlane_b32 s63, v1
s_lshr_b32 s5, s2, 3
s_mov_b32 s99, s5
s_lshr_b32 s6, s4, 0
s_lshl_b32 s6, s6, 2
s_lshr_b32 s7, s5, 3
s_add_u32 s64, s6, s7
s_and_b32 s6, s4, 0
s_lshl_b32 s6, s6, 3
s_and_b32 s7, s5, 7
s_add_u32 s65, s6, s7
s_lshl_b32 s60, s63, 12
v_lshrrev_b32 v5, 4, v252
v_and_b32 v6, 15, v252
s_lshl_b32 s6, s63, 4
v_add_u32 v1, s6, v5
s_lshl_b32 s6, s63, 2
v_or_b32 v2, s6, v5
v_xor_b32 v2, v2, v6
v_lshlrev_b32 v2, 4, v2
v_lshl_add_u32 v247, v1, 10, v2
v_lshl_add_u32 v244, v1, 8, v2
v_lshrrev_b32 v7, 5, v252
v_bfe_u32 v2, v252, 3, 2
v_lshl_add_u32 v7, v7, 3, v2
s_lshl_b32 s6, s63, 5
v_add_u32 v7, s6, v7
v_and_b32 v3, 7, v252
v_lshlrev_b32 v4, 1, v5
v_xor_b32 v3, v3, v4
v_lshlrev_b32 v3, 4, v3
s_mov_b32 s53, 3072
s_mov_b32 s54, 6144
s_mov_b32 s55, 9216
s_mov_b32 s50, 130048
s_mov_b32 s51, 30720
s_mov_b32 s52, 160768
s_lshr_b32 s4, s64, 2
s_lshl_b32 s5, s4, 2
s_bfe_u32 s3, s5, 0x10002
s_and_b32 s5, s5, 3
s_mov_b32 s98, s5
s_lshl_b32 s49, s5, 8
s_lshl_b32 s3, s3, 7
s_or_b32 s49, s49, s3
s_lshr_b32 s3, s3, 1
v_xor_b32 v7, s3, v7
v_lshl_add_u32 v246, v7, 13, v3
s_lshl_b32 s47, s5, 17
s_mov_b32 s48, s47
s_mov_b32 s5, s65
s_mul_i32 s3, s5, 43
s_lshr_b32 s3, s3, 7
s_mul_i32 s3, s3, 3
s_sub_u32 s5, s5, s3
s_add_u32 s46, s4, 3
s_add_u32 s43, s4, s5
s_cmp_eq_u32 s5, 2
s_cselect_b32 s3, -2, 1
s_add_u32 s44, s43, s3
s_cmp_eq_u32 s5, 0
s_cselect_b32 s3, 2, -1
s_add_u32 s45, s43, s3
s_and_b32 s43, s43, 3
s_lshl_b32 s43, s43, 20
s_and_b32 s44, s44, 3
s_lshl_b32 s44, s44, 20
s_and_b32 s45, s45, 3
s_lshl_b32 s45, s45, 20
s_and_b32 s46, s46, 3
s_lshl_b32 s46, s46, 20
s_mul_i32 s7, s64, 196608
s_mov_b32 s22, 196608
s_mov_b32 s23, 0x20000
s_mov_b32 s19, 0x20000
s_lshl_b32 s4, s65, 10
s_sub_u32 s18, 0x400000, s4
s_waitcnt lgkmcnt(0)
s_add_u32 s20, s68, s7
s_addc_u32 s21, s69, 0
s_add_u32 s16, s74, s4
s_addc_u32 s17, s75, 0
s_add_u32 m0, s60, 147456
s_lshr_b32 s56, s43, 12
s_add_u32 s57, s56, s53
s_add_u32 s58, s56, s54
s_add_u32 s59, s56, s55
buffer_load_dwordx4 v247, s[20:23], s56 offen offset:0 lds
buffer_load_dwordx4 v247, s[20:23], s57 offen offset:1024 lds
buffer_load_dwordx4 v247, s[20:23], s58 offen offset:2048 lds
buffer_load_dwordx4 v247, s[20:23], s59 offen offset:3072 lds
s_add_u32 m0, s60, 131072
s_lshr_b32 s56, s43, 12
s_add_u32 s56, s56, 65536
s_add_u32 s57, s56, s53
s_add_u32 s58, s56, s54
s_add_u32 s59, s56, s55
buffer_load_dwordx4 v247, s[20:23], s56 offen offset:0 lds
buffer_load_dwordx4 v247, s[20:23], s57 offen offset:1024 lds
buffer_load_dwordx4 v247, s[20:23], s58 offen offset:2048 lds
buffer_load_dwordx4 v247, s[20:23], s59 offen offset:3072 lds
s_add_u32 m0, s60, 0
s_lshr_b32 s56, s43, 12
s_add_u32 s56, s56, 131072
s_add_u32 s57, s56, s53
s_add_u32 s58, s56, s54
s_add_u32 s59, s56, s55
buffer_load_dwordx4 v247, s[20:23], s56 offen offset:0 lds
buffer_load_dwordx4 v247, s[20:23], s57 offen offset:1024 lds
buffer_load_dwordx4 v247, s[20:23], s58 offen offset:2048 lds
buffer_load_dwordx4 v247, s[20:23], s59 offen offset:3072 lds
s_add_u32 m0, s60, 114688
s_add_u32 s56, s49, s43
s_add_u32 s57, s56, s50
s_add_u32 s58, s56, s51
s_add_u32 s59, s56, s52
buffer_load_dwordx4 v246, s[16:19], s56 offen offset:0 lds
buffer_load_dwordx4 v246, s[16:19], s57 offen offset:1024 lds
buffer_load_dwordx4 v246, s[16:19], s58 offen offset:2048 lds
buffer_load_dwordx4 v246, s[16:19], s59 offen offset:3072 lds
s_lshl_b32 s3, s64, 22
s_lshl_b32 s7, s65, 19
s_add_u32 s3, s3, s7
s_add_u32 s8, s70, s3
s_addc_u32 s9, s71, 0
s_mov_b32 s10, 0x80000
s_mov_b32 s11, 0x20000
s_add_u32 s12, s72, s3
s_addc_u32 s13, s73, 0
s_mov_b32 s14, 0x80000
s_mov_b32 s15, 0x20000
s_getpc_b64 s[88:89]
L_pc:
s_add_u32 s88, s88, standalone__mha_block_cached__near_ridge_kernel-L_pc
s_addc_u32 s89, s89, -1
s_mov_b32 s90, L_g3-standalone__mha_block_cached__near_ridge_kernel
s_mov_b32 s91, 0x20000
s_lshl_b32 s5, s99, 2
s_add_u32 s5, s5, s63
s_and_b32 s5, s5, 127
s_lshl_b32 s5, s5, 13
v_mbcnt_lo_u32_b32 v254, -1, 0
v_mbcnt_hi_u32_b32 v254, -1, v254
v_lshlrev_b32 v254, 7, v254
buffer_load_dword v255, v254, s[88:91], s5 offen
v_lshrrev_b32 v7, 3, v252
v_add_u32 v7, s6, v7
v_lshl_add_u32 v253, v7, 10, v3
s_and_b32 s6, s63, 1
s_lshl_b32 s6, s6, 2
v_or_b32 v2, s6, v5
v_lshlrev_b32 v2, 1, v2
v_xor_b32 v2, v2, v6
v_lshlrev_b32 v1, 8, v1
v_lshl_add_u32 v245, v2, 4, v1
s_mov_b32 s24, s82
s_mov_b32 s25, s83
s_mov_b32 s26, 0x3200000
s_mov_b32 s27, 0x20000
v_lshrrev_b32 v1, 3, v252
v_and_b32 v2, 7, v252
v_lshlrev_b32 v1, 8, v1
v_lshl_add_u32 v8, v2, 2, v1
s_lshl_b32 s6, s64, 11
s_add_u32 s6, s6, 0x3040000
s_or_b32 s7, s65, s63
s_cmp_eq_u32 s7, 0
s_cselect_b32 s100, s6, 0x40000000
v_mov_b32 v9, 0
buffer_store_dword v9, v8, s[24:27], s100 offen sc1
s_mov_b32 s62, 0x3e0293ee
s_mov_b32 s66, 0x30800000
s_mov_b32 s67, 0x4e800000
s_mov_b32 s61, 0
s_lshl_b32 s36, s63, 10
s_mov_b32 s28, s78
s_mov_b32 s29, s79
s_mov_b32 s30, 0x600000
s_mov_b32 s31, 0x20000
s_mov_b32 s32, s80
s_mov_b32 s33, s81
s_mov_b32 s34, 0x100
s_mov_b32 s35, 0x20000
v_lshrrev_b32 v1, 2, v6
v_and_b32 v2, 3, v6
v_lshl_add_u32 v3, v1, 4, v2
v_lshlrev_b32 v3, 8, v3
s_and_b32 s3, s49, 128
v_add_u32 v4, 0, v5
v_xor_b32 v4, v4, v6
v_lshl_add_u32 v236, v4, 4, v3
v_xor_b32 v236, s3, v236
s_and_b32 s3, s49, 128
v_add_u32 v4, 4, v5
v_xor_b32 v4, v4, v6
v_lshl_add_u32 v237, v4, 4, v3
v_xor_b32 v237, s3, v237
s_and_b32 s3, s49, 128
v_add_u32 v4, 8, v5
v_xor_b32 v4, v4, v6
v_lshl_add_u32 v238, v4, 4, v3
v_xor_b32 v238, s3, v238
s_and_b32 s3, s49, 128
v_add_u32 v4, 12, v5
v_xor_b32 v4, v4, v6
v_lshl_add_u32 v239, v4, 4, v3
v_xor_b32 v239, s3, v239
v_lshl_add_u32 v3, v5, 4, v1
v_lshlrev_b32 v3, 8, v3
v_and_b32 v4, 1, v5
v_lshl_add_u32 v7, v4, 2, v1
v_lshl_add_u32 v3, v7, 5, v3
v_lshl_add_u32 v3, v2, 3, v3
v_add_u32 v240, 0, v3
v_lshl_add_u32 v3, v5, 2, v1
v_lshlrev_b32 v3, 7, v3
v_lshrrev_b32 v7, 1, v1
v_lshl_add_u32 v7, v4, 1, v7
v_lshlrev_b32 v7, 1, v7
v_xor_b32 v7, v7, v2
v_lshl_add_u32 v7, v7, 4, v3
v_add_u32 v241, 98304, v7
v_mov_b32 v3, 0x3f803f80
v_cmp_eq_u32 vcc, 0, v2
s_nop 1
v_cndmask_b32 v3, 0, v3, vcc
v_accvgpr_write_b32 a252, v3
v_accvgpr_write_b32 a253, v3
v_accvgpr_write_b32 a254, v3
v_accvgpr_write_b32 a255, v3
v_add_u32 v192, s36, v236
v_add_u32 v196, 0x10000, v192
v_add_u32 v200, 0x20000, v192
v_add_u32 v236, 98304, v236
v_add_u32 v193, s36, v237
v_add_u32 v197, 0x10000, v193
v_add_u32 v201, 0x20000, v193
v_add_u32 v237, 98304, v237
v_add_u32 v194, s36, v238
v_add_u32 v198, 0x10000, v194
v_add_u32 v202, 0x20000, v194
v_add_u32 v238, 98304, v238
v_add_u32 v195, s36, v239
v_add_u32 v199, 0x10000, v195
v_add_u32 v203, 0x20000, v195
v_add_u32 v239, 98304, v239
s_add_u32 s36, s36, 0xffff8000
s_add_u32 m0, s60, 16384
s_lshr_b32 s56, s44, 12
s_add_u32 s57, s56, s53
s_add_u32 s58, s56, s54
s_add_u32 s59, s56, s55
buffer_load_dwordx4 v247, s[20:23], s56 offen offset:0 lds
buffer_load_dwordx4 v247, s[20:23], s57 offen offset:1024 lds
buffer_load_dwordx4 v247, s[20:23], s58 offen offset:2048 lds
buffer_load_dwordx4 v247, s[20:23], s59 offen offset:3072 lds
s_add_u32 m0, s60, 98304
s_lshr_b32 s56, s44, 12
s_add_u32 s56, s56, 65536
s_add_u32 s57, s56, s53
s_add_u32 s58, s56, s54
s_add_u32 s59, s56, s55
buffer_load_dwordx4 v247, s[20:23], s56 offen offset:0 lds
buffer_load_dwordx4 v247, s[20:23], s57 offen offset:1024 lds
buffer_load_dwordx4 v247, s[20:23], s58 offen offset:2048 lds
buffer_load_dwordx4 v247, s[20:23], s59 offen offset:3072 lds
s_add_u32 m0, s60, 65536
s_lshr_b32 s56, s44, 12
s_add_u32 s56, s56, 131072
s_add_u32 s57, s56, s53
s_add_u32 s58, s56, s54
s_add_u32 s59, s56, s55
buffer_load_dwordx4 v247, s[20:23], s56 offen offset:0 lds
buffer_load_dwordx4 v247, s[20:23], s57 offen offset:1024 lds
buffer_load_dwordx4 v247, s[20:23], s58 offen offset:2048 lds
buffer_load_dwordx4 v247, s[20:23], s59 offen offset:3072 lds
s_add_u32 m0, s60, 49152
s_add_u32 s56, s49, s44
s_add_u32 s57, s56, s50
s_add_u32 s58, s56, s51
s_add_u32 s59, s56, s52
buffer_load_dwordx4 v246, s[16:19], s56 offen offset:0 lds
buffer_load_dwordx4 v246, s[16:19], s57 offen offset:1024 lds
buffer_load_dwordx4 v246, s[16:19], s58 offen offset:2048 lds
buffer_load_dwordx4 v246, s[16:19], s59 offen offset:3072 lds
s_lshl_b32 s6, s65, 19
s_add_u32 s80, s76, s6
s_addc_u32 s81, s77, 0
s_mov_b32 s74, 0
s_lshl_b32 s93, s98, 17
s_add_u32 s95, s93, 0x20000
s_and_b32 s95, s95, 0x7ffff
s_xor_b32 s96, s93, 0x40000
s_xor_b32 s97, s95, 0x40000
s_getreg_b32 s37, hwreg(HW_REG_XCC_ID, 0, 3)
s_lshr_b32 s38, s64, 2
s_and_b32 s38, s38, 7
s_lshl_b32 s38, s38, 7
s_lshl_b32 s37, s37, 2
s_lshl_b32 s37, 1, s37
s_add_u32 s40, s38, 128
s_and_b32 s40, s40, 0x3ff
s_add_u32 s41, s38, 256
s_and_b32 s41, s41, 0x3ff
s_add_u32 s42, s38, 384
s_and_b32 s42, s42, 0x3ff
s_lshr_b32 s87, s46, 12
s_lshr_b32 s88, s46, 12
s_add_u32 s88, s88, 65536
s_lshr_b32 s89, s46, 12
s_add_u32 s89, s89, 131072
s_mul_i32 s6, s64, 1576960
s_mov_b32 s75, s6
s_add_u32 s6, s6, 4096
s_mul_i32 s7, s63, 49152
s_add_u32 s68, s6, s7
s_lshl_b32 s7, s65, 10
s_add_u32 s68, s68, s7
s_mul_i32 s7, s65, 3
s_add_u32 s7, s7, s63
s_lshl_b32 s4, s7, 13
s_add_u32 s69, s6, s4
s_lshl_b32 s70, s64, 11
s_add_u32 s70, s70, 0x303ff00
s_lshr_b32 s4, s7, 1
s_mul_i32 s5, s4, 11
s_lshr_b32 s5, s5, 5
s_mul_i32 s3, s5, 3
s_sub_u32 s4, s4, s3
s_lshl_b32 s4, s4, 6
s_lshl_b32 s5, s5, 2
s_add_u32 s4, s4, s5
s_mul_i32 s5, s64, 192
s_add_u32 s4, s4, s5
s_lshl_b32 s4, s4, 10
s_and_b32 s5, s7, 1
s_lshl_b32 s5, s5, 6
s_add_u32 s71, s4, s5
s_mov_b32 s39, s38
s_cmp_eq_u32 s63, 3
s_cselect_b32 s69, 0x40000000, s69
s_cselect_b32 s71, 0x40000000, s71
v_bfe_u32 v3, v252, 3, 2
v_and_b32 v2, 3, v252
v_lshlrev_b32 v248, 5, v3
v_lshl_add_u32 v248, v2, 3, v248
v_lshlrev_b32 v3, 1, v3
v_xor_b32 v2, v2, v3
v_lshlrev_b32 v2, 4, v2
v_sub_u32 v248, v248, v2
s_waitcnt vmcnt(18)
s_barrier
ds_read_b128 a[0:3], v200 offset:16384
ds_read_b128 a[12:15], v201 offset:16384
ds_read_b128 a[24:27], v202 offset:16384
ds_read_b128 a[36:39], v203 offset:16384
ds_read_b128 a[4:7], v200 offset:0
ds_read_b128 a[16:19], v201 offset:0
ds_read_b128 a[28:31], v202 offset:0
ds_read_b128 a[40:43], v203 offset:0
ds_read_b128 a[8:11], v192 offset:0
ds_read_b128 a[20:23], v193 offset:0
ds_read_b128 a[32:35], v194 offset:0
ds_read_b128 a[44:47], v195 offset:0
ds_read_b64_tr_b16 v[204:205], v241 offset:16384
ds_read_b64_tr_b16 v[206:207], v241 offset:18432
ds_read_b64_tr_b16 v[208:209], v241 offset:20480
ds_read_b64_tr_b16 v[210:211], v241 offset:22528
ds_read_b64_tr_b16 v[212:213], v241 offset:24576
ds_read_b64_tr_b16 v[214:215], v241 offset:26624
ds_read_b64_tr_b16 v[216:217], v241 offset:28672
ds_read_b64_tr_b16 v[218:219], v241 offset:30720
s_waitcnt lgkmcnt(0)
s_barrier
s_nop 0
v_mfma_f32_16x16x32_bf16 v[0:3], v[204:207], a[0:3], 0
s_add_u32 m0, s60, 81920
ds_read_b64_tr_b16 v[220:221], v241 offset:16392
v_mfma_f32_16x16x32_bf16 v[0:3], v[208:211], a[12:15], v[0:3]
s_nop 0
ds_read_b64_tr_b16 v[222:223], v241 offset:18440
v_mfma_f32_16x16x32_bf16 v[0:3], v[212:215], a[24:27], v[0:3]
s_lshr_b32 s56, s45, 12
ds_read_b64_tr_b16 v[224:225], v241 offset:20488
v_mfma_f32_16x16x32_bf16 v[0:3], v[216:219], a[36:39], v[0:3]
s_add_u32 s57, s56, s53
ds_read_b64_tr_b16 v[226:227], v241 offset:22536
v_xor_b32 v242, 64, v241
v_mfma_f32_16x16x32_bf16 v[4:7], v[204:207], a[4:7], 0
s_add_u32 s58, s56, s54
buffer_load_dwordx4 v247, s[20:23], s56 offen offset:0 lds
v_mfma_f32_16x16x32_bf16 v[4:7], v[208:211], a[16:19], v[4:7]
s_add_u32 s59, s56, s55
ds_read_b64_tr_b16 v[228:229], v241 offset:24584
v_mfma_f32_16x16x32_bf16 v[4:7], v[212:215], a[28:31], v[4:7]
buffer_load_dwordx4 v247, s[20:23], s57 offen offset:1024 lds
v_mfma_f32_16x16x32_bf16 v[4:7], v[216:219], a[40:43], v[4:7]
ds_read_b64_tr_b16 v[230:231], v241 offset:26632
v_mfma_f32_16x16x32_bf16 v[8:11], v[204:207], a[8:11], 0
ds_read_b64_tr_b16 v[232:233], v241 offset:28680
buffer_load_dwordx4 v247, s[20:23], s58 offen offset:2048 lds
v_mfma_f32_16x16x32_bf16 v[8:11], v[208:211], a[20:23], v[8:11]
ds_read_b64_tr_b16 v[234:235], v241 offset:30728
v_mfma_f32_16x16x32_bf16 v[8:11], v[212:215], a[32:35], v[8:11]
s_waitcnt lgkmcnt(4)
buffer_load_dwordx4 v247, s[20:23], s59 offen offset:3072 lds
v_mfma_f32_16x16x32_bf16 v[8:11], v[216:219], a[44:47], v[8:11]
s_add_u32 m0, s60, 32768
ds_read_b64_tr_b16 v[204:205], v242 offset:16384
v_mfma_f32_16x16x32_bf16 v[12:15], v[220:223], a[0:3], 0
s_lshr_b32 s56, s45, 12
ds_read_b64_tr_b16 v[206:207], v242 offset:18432
v_mfma_f32_16x16x32_bf16 v[12:15], v[224:227], a[12:15], v[12:15]
s_waitcnt lgkmcnt(2)
s_add_u32 s56, s56, 65536
buffer_load_dwordx4 v247, s[20:23], s56 offen offset:0 lds
v_mfma_f32_16x16x32_bf16 v[12:15], v[228:231], a[24:27], v[12:15]
s_add_u32 s57, s56, s53
ds_read_b64_tr_b16 v[208:209], v242 offset:20480
v_mfma_f32_16x16x32_bf16 v[12:15], v[232:235], a[36:39], v[12:15]
s_add_u32 s58, s56, s54
ds_read_b64_tr_b16 v[210:211], v242 offset:22528
buffer_load_dwordx4 v247, s[20:23], s57 offen offset:1024 lds
v_mfma_f32_16x16x32_bf16 v[16:19], v[220:223], a[4:7], 0
s_add_u32 s59, s56, s55
ds_read_b64_tr_b16 v[212:213], v242 offset:24576
v_mfma_f32_16x16x32_bf16 v[16:19], v[224:227], a[16:19], v[16:19]
buffer_load_dwordx4 v247, s[20:23], s58 offen offset:2048 lds
v_mfma_f32_16x16x32_bf16 v[16:19], v[228:231], a[28:31], v[16:19]
ds_read_b64_tr_b16 v[214:215], v242 offset:26624
v_mfma_f32_16x16x32_bf16 v[16:19], v[232:235], a[40:43], v[16:19]
ds_read_b64_tr_b16 v[216:217], v242 offset:28672
buffer_load_dwordx4 v247, s[20:23], s59 offen offset:3072 lds
v_mfma_f32_16x16x32_bf16 v[20:23], v[220:223], a[8:11], 0
s_add_u32 m0, s60, 147456
ds_read_b64_tr_b16 v[218:219], v242 offset:30720
v_add_u32 v241, 0xffff4000, v241
v_mfma_f32_16x16x32_bf16 v[20:23], v[224:227], a[20:23], v[20:23]
s_lshr_b32 s56, s45, 12
v_mfma_f32_16x16x32_bf16 v[20:23], v[228:231], a[32:35], v[20:23]
s_add_u32 s56, s56, 131072
buffer_load_dwordx4 v247, s[20:23], s56 offen offset:0 lds
v_mfma_f32_16x16x32_bf16 v[20:23], v[232:235], a[44:47], v[20:23]
s_waitcnt lgkmcnt(4)
ds_read_b64_tr_b16 v[220:221], v242 offset:16392
v_mfma_f32_16x16x32_bf16 v[24:27], v[204:207], a[0:3], 0
s_add_u32 s57, s56, s53
buffer_load_dwordx4 v247, s[20:23], s57 offen offset:1024 lds
v_mfma_f32_16x16x32_bf16 v[24:27], v[208:211], a[12:15], v[24:27]
s_waitcnt lgkmcnt(1)
ds_read_b64_tr_b16 v[222:223], v242 offset:18440
v_mfma_f32_16x16x32_bf16 v[24:27], v[212:215], a[24:27], v[24:27]
s_add_u32 s58, s56, s54
ds_read_b64_tr_b16 v[224:225], v242 offset:20488
buffer_load_dwordx4 v247, s[20:23], s58 offen offset:2048 lds
v_mfma_f32_16x16x32_bf16 v[24:27], v[216:219], a[36:39], v[24:27]
s_add_u32 s59, s56, s55
ds_read_b64_tr_b16 v[226:227], v242 offset:22536
v_mfma_f32_16x16x32_bf16 v[28:31], v[204:207], a[4:7], 0
buffer_load_dwordx4 v247, s[20:23], s59 offen offset:3072 lds
v_mfma_f32_16x16x32_bf16 v[28:31], v[208:211], a[16:19], v[28:31]
s_add_u32 m0, s60, 131072
ds_read_b64_tr_b16 v[228:229], v242 offset:24584
v_mfma_f32_16x16x32_bf16 v[28:31], v[212:215], a[28:31], v[28:31]
s_add_u32 s56, s49, s45
ds_read_b64_tr_b16 v[230:231], v242 offset:26632
v_mfma_f32_16x16x32_bf16 v[28:31], v[216:219], a[40:43], v[28:31]
s_add_u32 s57, s56, s50
ds_read_b64_tr_b16 v[232:233], v242 offset:28680
buffer_load_dwordx4 v246, s[16:19], s56 offen offset:0 lds
v_mfma_f32_16x16x32_bf16 v[32:35], v[204:207], a[8:11], 0
s_add_u32 s58, s56, s51
ds_read_b64_tr_b16 v[234:235], v242 offset:30728
v_mfma_f32_16x16x32_bf16 v[32:35], v[208:211], a[20:23], v[32:35]
s_add_u32 s59, s56, s52
buffer_load_dwordx4 v246, s[16:19], s57 offen offset:1024 lds
v_mfma_f32_16x16x32_bf16 v[32:35], v[212:215], a[32:35], v[32:35]
s_waitcnt lgkmcnt(4)
v_mfma_f32_16x16x32_bf16 v[32:35], v[216:219], a[44:47], v[32:35]
buffer_load_dwordx4 v246, s[16:19], s58 offen offset:2048 lds
v_mfma_f32_16x16x32_bf16 v[36:39], v[220:223], a[0:3], 0
s_waitcnt vmcnt(15) lgkmcnt(0)
v_mfma_f32_16x16x32_bf16 v[36:39], v[224:227], a[12:15], v[36:39]
s_barrier
buffer_load_dwordx4 v246, s[16:19], s59 offen offset:3072 lds
v_mfma_f32_16x16x32_bf16 v[36:39], v[228:231], a[24:27], v[36:39]
s_add_u32 m0, s60, 0
ds_read_b64_tr_b16 v[204:205], v241 offset:0
ds_read_b64_tr_b16 v[206:207], v241 offset:2048
v_mfma_f32_16x16x32_bf16 v[36:39], v[232:235], a[36:39], v[36:39]
s_add_u32 s56, s49, s43
ds_read_b64_tr_b16 v[208:209], v241 offset:4096
ds_read_b64_tr_b16 v[210:211], v241 offset:6144
v_mfma_f32_16x16x32_bf16 v[40:43], v[220:223], a[4:7], 0
s_xor_b32 s56, s56, 128
ds_read_b64_tr_b16 v[212:213], v241 offset:8192
ds_read_b64_tr_b16 v[214:215], v241 offset:10240
buffer_load_dwordx4 v246, s[16:19], s56 offen offset:0 lds
v_mfma_f32_16x16x32_bf16 v[40:43], v[224:227], a[16:19], v[40:43]
s_add_u32 s57, s56, s50
ds_read_b64_tr_b16 v[216:217], v241 offset:12288
ds_read_b64_tr_b16 v[218:219], v241 offset:14336
v_mfma_f32_16x16x32_bf16 v[40:43], v[228:231], a[28:31], v[40:43]
s_add_u32 s58, s56, s51
buffer_load_dwordx4 v246, s[16:19], s57 offen offset:1024 lds
v_mfma_f32_16x16x32_bf16 v[40:43], v[232:235], a[40:43], v[40:43]
s_add_u32 s59, s56, s52
ds_read_b128 a[48:51], v192 offset:16384
v_mfma_f32_16x16x32_bf16 v[44:47], v[220:223], a[8:11], 0
ds_read_b128 a[60:63], v193 offset:16384
buffer_load_dwordx4 v246, s[16:19], s58 offen offset:2048 lds
v_mfma_f32_16x16x32_bf16 v[44:47], v[224:227], a[20:23], v[44:47]
ds_read_b128 a[72:75], v194 offset:16384
v_mfma_f32_16x16x32_bf16 v[44:47], v[228:231], a[32:35], v[44:47]
s_waitcnt lgkmcnt(7)
ds_read_b128 a[84:87], v195 offset:16384
buffer_load_dwordx4 v246, s[16:19], s59 offen offset:3072 lds
v_mfma_f32_16x16x32_bf16 v[44:47], v[232:235], a[44:47], v[44:47]
s_waitcnt lgkmcnt(0)
ds_read_b128 a[52:55], v196 offset:32768
v_mfma_f32_16x16x32_bf16 v[0:3], v[204:207], a[48:51], v[0:3]
s_add_u32 m0, s60, 114688
ds_read_b128 a[64:67], v197 offset:32768
ds_read_b64_tr_b16 v[220:221], v241 offset:8
v_mfma_f32_16x16x32_bf16 v[0:3], v[208:211], a[60:63], v[0:3]
s_waitcnt lgkmcnt(7)
s_lshr_b32 s56, s46, 12
ds_read_b128 a[76:79], v198 offset:32768
ds_read_b64_tr_b16 v[222:223], v241 offset:2056
buffer_load_dwordx4 v247, s[20:23], s56 offen offset:0 lds
v_mfma_f32_16x16x32_bf16 v[0:3], v[212:215], a[72:75], v[0:3]
s_add_u32 s57, s56, s53
ds_read_b128 a[88:91], v199 offset:32768
ds_read_b64_tr_b16 v[224:225], v241 offset:4104
v_mfma_f32_16x16x32_bf16 v[0:3], v[216:219], a[84:87], v[0:3]
s_waitcnt lgkmcnt(1)
ds_read_b128 a[56:59], v196 offset:0
ds_read_b64_tr_b16 v[226:227], v241 offset:6152
buffer_load_dwordx4 v247, s[20:23], s57 offen offset:1024 lds
v_mfma_f32_16x16x32_bf16 v[4:7], v[204:207], a[52:55], v[4:7]
s_add_u32 s58, s56, s54
ds_read_b128 a[68:71], v197 offset:0
v_xor_b32 v242, 64, v241
v_mfma_f32_16x16x32_bf16 v[4:7], v[208:211], a[64:67], v[4:7]
s_add_u32 s59, s56, s55
ds_read_b128 a[80:83], v198 offset:0
ds_read_b64_tr_b16 v[228:229], v241 offset:8200
buffer_load_dwordx4 v247, s[20:23], s58 offen offset:2048 lds
v_mfma_f32_16x16x32_bf16 v[4:7], v[212:215], a[76:79], v[4:7]
ds_read_b128 a[92:95], v199 offset:0
ds_read_b64_tr_b16 v[230:231], v241 offset:10248
v_mfma_f32_16x16x32_bf16 v[4:7], v[216:219], a[88:91], v[4:7]
s_waitcnt lgkmcnt(1)
ds_read_b64_tr_b16 v[232:233], v241 offset:12296
buffer_load_dwordx4 v247, s[20:23], s59 offen offset:3072 lds
v_mfma_f32_16x16x32_bf16 v[8:11], v[204:207], a[56:59], v[8:11]
s_add_u32 m0, s60, 16384
ds_read_b64_tr_b16 v[234:235], v241 offset:14344
v_mfma_f32_16x16x32_bf16 v[8:11], v[208:211], a[68:71], v[8:11]
s_waitcnt lgkmcnt(3)
v_mfma_f32_16x16x32_bf16 v[8:11], v[212:215], a[80:83], v[8:11]
s_barrier
v_mfma_f32_16x16x32_bf16 v[8:11], v[216:219], a[92:95], v[8:11]
s_waitcnt lgkmcnt(7)
ds_read_b64_tr_b16 v[204:205], v242 offset:0
v_mfma_f32_16x16x32_bf16 v[12:15], v[220:223], a[48:51], v[12:15]
s_lshr_b32 s56, s46, 12
ds_read_b64_tr_b16 v[206:207], v242 offset:2048
v_mfma_f32_16x16x32_bf16 v[12:15], v[224:227], a[60:63], v[12:15]
s_waitcnt lgkmcnt(2)
ds_read_b64_tr_b16 v[208:209], v242 offset:4096
v_mfma_f32_16x16x32_bf16 v[12:15], v[228:231], a[72:75], v[12:15]
s_add_u32 s56, s56, 65536
buffer_load_dwordx4 v247, s[20:23], s56 offen offset:0 lds
v_mfma_f32_16x16x32_bf16 v[12:15], v[232:235], a[84:87], v[12:15]
s_add_u32 s57, s56, s53
ds_read_b64_tr_b16 v[210:211], v242 offset:6144
v_mfma_f32_16x16x32_bf16 v[16:19], v[220:223], a[52:55], v[16:19]
s_add_u32 s58, s56, s54
buffer_load_dwordx4 v247, s[20:23], s57 offen offset:1024 lds
v_mfma_f32_16x16x32_bf16 v[16:19], v[224:227], a[64:67], v[16:19]
s_add_u32 s59, s56, s55
ds_read_b64_tr_b16 v[212:213], v242 offset:8192
v_mfma_f32_16x16x32_bf16 v[16:19], v[228:231], a[76:79], v[16:19]
ds_read_b64_tr_b16 v[214:215], v242 offset:10240
buffer_load_dwordx4 v247, s[20:23], s58 offen offset:2048 lds
v_mfma_f32_16x16x32_bf16 v[16:19], v[232:235], a[88:91], v[16:19]
ds_read_b64_tr_b16 v[216:217], v242 offset:12288
v_mfma_f32_16x16x32_bf16 v[20:23], v[220:223], a[56:59], v[20:23]
ds_read_b64_tr_b16 v[218:219], v242 offset:14336
buffer_load_dwordx4 v247, s[20:23], s59 offen offset:3072 lds
v_mfma_f32_16x16x32_bf16 v[20:23], v[224:227], a[68:71], v[20:23]
s_add_u32 m0, s60, 98304
v_add_u32 v241, 0xc000, v241
v_mfma_f32_16x16x32_bf16 v[20:23], v[228:231], a[80:83], v[20:23]
s_waitcnt lgkmcnt(4)
v_mfma_f32_16x16x32_bf16 v[20:23], v[232:235], a[92:95], v[20:23]
s_lshr_b32 s56, s46, 12
s_add_u32 s56, s56, 131072
buffer_load_dwordx4 v247, s[20:23], s56 offen offset:0 lds
v_mfma_f32_16x16x32_bf16 v[24:27], v[204:207], a[48:51], v[24:27]
s_add_u32 s57, s56, s53
ds_read_b64_tr_b16 v[220:221], v242 offset:8
v_mfma_f32_16x16x32_bf16 v[24:27], v[208:211], a[60:63], v[24:27]
s_waitcnt lgkmcnt(1)
ds_read_b64_tr_b16 v[222:223], v242 offset:2056
buffer_load_dwordx4 v247, s[20:23], s57 offen offset:1024 lds
v_mfma_f32_16x16x32_bf16 v[24:27], v[212:215], a[72:75], v[24:27]
s_add_u32 s58, s56, s54
ds_read_b64_tr_b16 v[224:225], v242 offset:4104
v_mfma_f32_16x16x32_bf16 v[24:27], v[216:219], a[84:87], v[24:27]
s_add_u32 s59, s56, s55
ds_read_b64_tr_b16 v[226:227], v242 offset:6152
buffer_load_dwordx4 v247, s[20:23], s58 offen offset:2048 lds
v_mfma_f32_16x16x32_bf16 v[28:31], v[204:207], a[52:55], v[28:31]
ds_read_b64_tr_b16 v[228:229], v242 offset:8200
v_mfma_f32_16x16x32_bf16 v[28:31], v[208:211], a[64:67], v[28:31]
buffer_load_dwordx4 v247, s[20:23], s59 offen offset:3072 lds
v_mfma_f32_16x16x32_bf16 v[28:31], v[212:215], a[76:79], v[28:31]
s_add_u32 m0, s60, 65536
ds_read_b64_tr_b16 v[230:231], v242 offset:10248
v_mfma_f32_16x16x32_bf16 v[28:31], v[216:219], a[88:91], v[28:31]
s_add_u32 s56, s49, s46
ds_read_b64_tr_b16 v[232:233], v242 offset:12296
v_mfma_f32_16x16x32_bf16 v[32:35], v[204:207], a[56:59], v[32:35]
s_add_u32 s57, s56, s50
ds_read_b64_tr_b16 v[234:235], v242 offset:14344
buffer_load_dwordx4 v246, s[16:19], s56 offen offset:0 lds
v_mfma_f32_16x16x32_bf16 v[32:35], v[208:211], a[68:71], v[32:35]
s_add_u32 s58, s56, s51
v_mfma_f32_16x16x32_bf16 v[32:35], v[212:215], a[80:83], v[32:35]
s_waitcnt lgkmcnt(4)
buffer_load_dwordx4 v246, s[16:19], s57 offen offset:1024 lds
v_mfma_f32_16x16x32_bf16 v[32:35], v[216:219], a[92:95], v[32:35]
s_add_u32 s59, s56, s52
v_mfma_f32_16x16x32_bf16 v[36:39], v[220:223], a[48:51], v[36:39]
s_waitcnt vmcnt(18) lgkmcnt(0)
buffer_load_dwordx4 v246, s[16:19], s58 offen offset:2048 lds
v_mfma_f32_16x16x32_bf16 v[36:39], v[224:227], a[60:63], v[36:39]
s_barrier
ds_read_b64_tr_b16 v[204:205], v241 offset:32768
v_mfma_f32_16x16x32_bf16 v[36:39], v[228:231], a[72:75], v[36:39]
ds_read_b64_tr_b16 v[206:207], v241 offset:34816
buffer_load_dwordx4 v246, s[16:19], s59 offen offset:3072 lds
v_mfma_f32_16x16x32_bf16 v[36:39], v[232:235], a[84:87], v[36:39]
s_add_u32 m0, s60, 49152
ds_read_b64_tr_b16 v[208:209], v241 offset:36864
ds_read_b64_tr_b16 v[210:211], v241 offset:38912
v_mfma_f32_16x16x32_bf16 v[40:43], v[220:223], a[52:55], v[40:43]
s_add_u32 s56, s49, s46
ds_read_b64_tr_b16 v[212:213], v241 offset:40960
ds_read_b64_tr_b16 v[214:215], v241 offset:43008
v_mfma_f32_16x16x32_bf16 v[40:43], v[224:227], a[64:67], v[40:43]
s_xor_b32 s56, s56, 128
ds_read_b64_tr_b16 v[216:217], v241 offset:45056
ds_read_b64_tr_b16 v[218:219], v241 offset:47104
buffer_load_dwordx4 v246, s[16:19], s56 offen offset:0 lds
v_mfma_f32_16x16x32_bf16 v[40:43], v[228:231], a[76:79], v[40:43]
s_add_u32 s57, s56, s50
ds_read_b128 a[96:99], v196 offset:16384
v_mfma_f32_16x16x32_bf16 v[40:43], v[232:235], a[88:91], v[40:43]
s_add_u32 s58, s56, s51
buffer_load_dwordx4 v246, s[16:19], s57 offen offset:1024 lds
v_mfma_f32_16x16x32_bf16 v[44:47], v[220:223], a[56:59], v[44:47]
s_add_u32 s59, s56, s52
ds_read_b128 a[108:111], v197 offset:16384
v_mfma_f32_16x16x32_bf16 v[44:47], v[224:227], a[68:71], v[44:47]
ds_read_b128 a[120:123], v198 offset:16384
buffer_load_dwordx4 v246, s[16:19], s58 offen offset:2048 lds
v_mfma_f32_16x16x32_bf16 v[44:47], v[228:231], a[80:83], v[44:47]
s_waitcnt lgkmcnt(7)
ds_read_b128 a[132:135], v199 offset:16384
v_mfma_f32_16x16x32_bf16 v[44:47], v[232:235], a[92:95], v[44:47]
s_waitcnt lgkmcnt(0)
ds_read_b128 a[100:103], v192 offset:32768
buffer_load_dwordx4 v246, s[16:19], s59 offen offset:3072 lds
v_mfma_f32_16x16x32_bf16 v[0:3], v[204:207], a[96:99], v[0:3]
s_add_u32 s56, s49, s44
ds_read_b128 a[112:115], v193 offset:32768
ds_read_b64_tr_b16 v[220:221], v241 offset:32776
v_mfma_f32_16x16x32_bf16 v[0:3], v[208:211], a[108:111], v[0:3]
s_waitcnt lgkmcnt(7)
ds_read_b128 a[124:127], v194 offset:32768
ds_read_b64_tr_b16 v[222:223], v241 offset:34824
v_mfma_f32_16x16x32_bf16 v[0:3], v[212:215], a[120:123], v[0:3]
s_xor_b32 s56, s56, 128
ds_read_b128 a[136:139], v195 offset:32768
ds_read_b64_tr_b16 v[224:225], v241 offset:36872
v_mfma_f32_16x16x32_bf16 v[0:3], v[216:219], a[132:135], v[0:3]
s_waitcnt lgkmcnt(1)
ds_read_b128 a[104:107], v200 offset:16384
ds_read_b64_tr_b16 v[226:227], v241 offset:38920
v_mfma_f32_16x16x32_bf16 v[4:7], v[204:207], a[100:103], v[4:7]
s_add_u32 m0, s60, 81920
ds_read_b128 a[116:119], v201 offset:16384
v_xor_b32 v242, 64, v241
v_mfma_f32_16x16x32_bf16 v[4:7], v[208:211], a[112:115], v[4:7]
s_add_u32 s57, s56, s50
ds_read_b128 a[128:131], v202 offset:16384
ds_read_b64_tr_b16 v[228:229], v241 offset:40968
v_mfma_f32_16x16x32_bf16 v[4:7], v[212:215], a[124:127], v[4:7]
s_add_u32 s58, s56, s51
ds_read_b128 a[140:143], v203 offset:16384
ds_read_b64_tr_b16 v[230:231], v241 offset:43016
v_mfma_f32_16x16x32_bf16 v[4:7], v[216:219], a[136:139], v[4:7]
s_waitcnt lgkmcnt(1)
ds_read_b64_tr_b16 v[232:233], v241 offset:45064
v_mfma_f32_16x16x32_bf16 v[8:11], v[204:207], a[104:107], v[8:11]
s_add_u32 s59, s56, s52
ds_read_b64_tr_b16 v[234:235], v241 offset:47112
v_mfma_f32_16x16x32_bf16 v[8:11], v[208:211], a[116:119], v[8:11]
s_waitcnt lgkmcnt(3)
v_mfma_f32_16x16x32_bf16 v[8:11], v[212:215], a[128:131], v[8:11]
s_barrier
buffer_load_dwordx4 v246, s[16:19], s56 offen offset:0 lds
v_mfma_f32_16x16x32_bf16 v[8:11], v[216:219], a[140:143], v[8:11]
s_waitcnt lgkmcnt(7)
ds_read_b64_tr_b16 v[204:205], v242 offset:32768
v_mfma_f32_16x16x32_bf16 v[12:15], v[220:223], a[96:99], v[12:15]
ds_read_b64_tr_b16 v[206:207], v242 offset:34816
v_mfma_f32_16x16x32_bf16 v[12:15], v[224:227], a[108:111], v[12:15]
s_waitcnt lgkmcnt(2)
ds_read_b64_tr_b16 v[208:209], v242 offset:36864
v_mfma_f32_16x16x32_bf16 v[12:15], v[228:231], a[120:123], v[12:15]
ds_read_b64_tr_b16 v[210:211], v242 offset:38912
v_mfma_f32_16x16x32_bf16 v[12:15], v[232:235], a[132:135], v[12:15]
buffer_load_dwordx4 v246, s[16:19], s57 offen offset:1024 lds
v_mfma_f32_16x16x32_bf16 v[16:19], v[220:223], a[100:103], v[16:19]
ds_read_b64_tr_b16 v[212:213], v242 offset:40960
v_mfma_f32_16x16x32_bf16 v[16:19], v[224:227], a[112:115], v[16:19]
ds_read_b64_tr_b16 v[214:215], v242 offset:43008
v_mfma_f32_16x16x32_bf16 v[16:19], v[228:231], a[124:127], v[16:19]
buffer_load_dwordx4 v246, s[16:19], s58 offen offset:2048 lds
v_mfma_f32_16x16x32_bf16 v[16:19], v[232:235], a[136:139], v[16:19]
ds_read_b64_tr_b16 v[216:217], v242 offset:45056
v_mfma_f32_16x16x32_bf16 v[20:23], v[220:223], a[104:107], v[20:23]
ds_read_b64_tr_b16 v[218:219], v242 offset:47104
buffer_load_dwordx4 v246, s[16:19], s59 offen offset:3072 lds
v_mfma_f32_16x16x32_bf16 v[20:23], v[224:227], a[116:119], v[20:23]
s_add_u32 m0, s60, 32768
v_add_u32 v241, 0xfffe8000, v241
v_mfma_f32_16x16x32_bf16 v[20:23], v[228:231], a[128:131], v[20:23]
s_waitcnt lgkmcnt(4)
v_mfma_f32_16x16x32_bf16 v[20:23], v[232:235], a[140:143], v[20:23]
s_add_u32 s56, s49, s45
s_xor_b32 s56, s56, 128
buffer_load_dwordx4 v246, s[16:19], s56 offen offset:0 lds
v_mfma_f32_16x16x32_bf16 v[24:27], v[204:207], a[96:99], v[24:27]
s_add_u32 s57, s56, s50
ds_read_b64_tr_b16 v[220:221], v242 offset:32776
v_mfma_f32_16x16x32_bf16 v[24:27], v[208:211], a[108:111], v[24:27]
s_waitcnt lgkmcnt(1)
ds_read_b64_tr_b16 v[222:223], v242 offset:34824
buffer_load_dwordx4 v246, s[16:19], s57 offen offset:1024 lds
v_mfma_f32_16x16x32_bf16 v[24:27], v[212:215], a[120:123], v[24:27]
s_add_u32 s58, s56, s51
ds_read_b64_tr_b16 v[224:225], v242 offset:36872
v_mfma_f32_16x16x32_bf16 v[24:27], v[216:219], a[132:135], v[24:27]
s_add_u32 s59, s56, s52
ds_read_b64_tr_b16 v[226:227], v242 offset:38920
buffer_load_dwordx4 v246, s[16:19], s58 offen offset:2048 lds
v_mfma_f32_16x16x32_bf16 v[28:31], v[204:207], a[100:103], v[28:31]
ds_read_b64_tr_b16 v[228:229], v242 offset:40968
v_mfma_f32_16x16x32_bf16 v[28:31], v[208:211], a[112:115], v[28:31]
buffer_load_dwordx4 v246, s[16:19], s59 offen offset:3072 lds
v_mfma_f32_16x16x32_bf16 v[28:31], v[212:215], a[124:127], v[28:31]
s_add_u32 m0, s60, 147456
ds_read_b64_tr_b16 v[230:231], v242 offset:43016
v_mfma_f32_16x16x32_bf16 v[28:31], v[216:219], a[136:139], v[28:31]
s_add_u32 s49, s49, 256
ds_read_b64_tr_b16 v[232:233], v242 offset:45064
v_mfma_f32_16x16x32_bf16 v[32:35], v[204:207], a[104:107], v[32:35]
s_and_b32 s49, s49, 0x3ff
ds_read_b64_tr_b16 v[234:235], v242 offset:47112
buffer_load_dwordx4 v244, s[8:11], s47 offen offset:0 nt lds
v_mfma_f32_16x16x32_bf16 v[32:35], v[208:211], a[116:119], v[32:35]
s_add_u32 s86, s49, s43
v_mfma_f32_16x16x32_bf16 v[32:35], v[212:215], a[128:131], v[32:35]
s_waitcnt lgkmcnt(4)
v_mfma_f32_16x16x32_bf16 v[32:35], v[216:219], a[140:143], v[32:35]
s_add_u32 s90, s49, s44
v_mfma_f32_16x16x32_bf16 v[36:39], v[220:223], a[96:99], v[36:39]
s_waitcnt vmcnt(29) lgkmcnt(0)
buffer_load_dwordx4 v244, s[8:11], s47 offen offset:1024 nt lds
v_mfma_f32_16x16x32_bf16 v[36:39], v[224:227], a[108:111], v[36:39]
s_barrier
ds_read_b64_tr_b16 v[204:205], v241 offset:0
v_mfma_f32_16x16x32_bf16 v[36:39], v[228:231], a[120:123], v[36:39]
s_add_u32 s91, s49, s45
ds_read_b64_tr_b16 v[206:207], v241 offset:2048
v_mfma_f32_16x16x32_bf16 v[36:39], v[232:235], a[132:135], v[36:39]
ds_read_b64_tr_b16 v[208:209], v241 offset:4096
v_mfma_f32_16x16x32_bf16 v[40:43], v[220:223], a[100:103], v[40:43]
ds_read_b64_tr_b16 v[210:211], v241 offset:6144
v_mfma_f32_16x16x32_bf16 v[40:43], v[224:227], a[112:115], v[40:43]
ds_read_b64_tr_b16 v[212:213], v241 offset:8192
v_mfma_f32_16x16x32_bf16 v[40:43], v[228:231], a[124:127], v[40:43]
ds_read_b64_tr_b16 v[214:215], v241 offset:10240
v_mfma_f32_16x16x32_bf16 v[40:43], v[232:235], a[136:139], v[40:43]
buffer_load_dwordx4 v244, s[8:11], s47 offen offset:2048 nt lds
v_mfma_f32_16x16x32_bf16 v[44:47], v[220:223], a[104:107], v[44:47]
ds_read_b64_tr_b16 v[216:217], v241 offset:12288
v_mfma_f32_16x16x32_bf16 v[44:47], v[224:227], a[116:119], v[44:47]
ds_read_b64_tr_b16 v[218:219], v241 offset:14336
v_mfma_f32_16x16x32_bf16 v[44:47], v[228:231], a[128:131], v[44:47]
s_waitcnt lgkmcnt(4)
v_mfma_f32_16x16x32_bf16 v[44:47], v[232:235], a[140:143], v[44:47]
ds_read_b64_tr_b16 v[220:221], v241 offset:8
v_mfma_f32_16x16x32_bf16 v[48:51], v[204:207], a[0:3], 0
ds_read_b64_tr_b16 v[222:223], v241 offset:2056
v_mfma_f32_16x16x32_bf16 v[48:51], v[208:211], a[12:15], v[48:51]
s_waitcnt lgkmcnt(2)
ds_read_b64_tr_b16 v[224:225], v241 offset:4104
v_mfma_f32_16x16x32_bf16 v[48:51], v[212:215], a[24:27], v[48:51]
buffer_load_dwordx4 v244, s[8:11], s47 offen offset:3072 nt lds
v_mfma_f32_16x16x32_bf16 v[48:51], v[216:219], a[36:39], v[48:51]
s_add_u32 s47, s47, 0x4000
ds_read_b64_tr_b16 v[226:227], v241 offset:6152
v_xor_b32 v242, 64, v241
v_mfma_f32_16x16x32_bf16 v[52:55], v[204:207], a[4:7], 0
s_add_u32 m0, s60, 131072
ds_read_b64_tr_b16 v[228:229], v241 offset:8200
v_mfma_f32_16x16x32_bf16 v[52:55], v[208:211], a[16:19], v[52:55]
ds_read_b64_tr_b16 v[230:231], v241 offset:10248
v_mfma_f32_16x16x32_bf16 v[52:55], v[212:215], a[28:31], v[52:55]
ds_read_b64_tr_b16 v[232:233], v241 offset:12296
v_mfma_f32_16x16x32_bf16 v[52:55], v[216:219], a[40:43], v[52:55]
ds_read_b64_tr_b16 v[234:235], v241 offset:14344
v_mfma_f32_16x16x32_bf16 v[56:59], v[204:207], a[8:11], 0
buffer_load_dwordx4 v244, s[8:11], s47 offen offset:0 nt lds
v_mfma_f32_16x16x32_bf16 v[56:59], v[208:211], a[20:23], v[56:59]
v_mfma_f32_16x16x32_bf16 v[56:59], v[212:215], a[32:35], v[56:59]
s_waitcnt lgkmcnt(4)
v_mfma_f32_16x16x32_bf16 v[56:59], v[216:219], a[44:47], v[56:59]
ds_read_b64_tr_b16 v[204:205], v242 offset:0
v_mfma_f32_16x16x32_bf16 v[60:63], v[220:223], a[0:3], 0
ds_read_b64_tr_b16 v[206:207], v242 offset:2048
v_mfma_f32_16x16x32_bf16 v[60:63], v[224:227], a[12:15], v[60:63]
s_waitcnt lgkmcnt(2)
ds_read_b64_tr_b16 v[208:209], v242 offset:4096
v_mfma_f32_16x16x32_bf16 v[60:63], v[228:231], a[24:27], v[60:63]
ds_read_b64_tr_b16 v[210:211], v242 offset:6144
v_mfma_f32_16x16x32_bf16 v[60:63], v[232:235], a[36:39], v[60:63]
ds_read_b64_tr_b16 v[212:213], v242 offset:8192
v_mfma_f32_16x16x32_bf16 v[64:67], v[220:223], a[4:7], 0
buffer_load_dwordx4 v244, s[8:11], s47 offen offset:1024 nt lds
v_mfma_f32_16x16x32_bf16 v[64:67], v[224:227], a[16:19], v[64:67]
ds_read_b64_tr_b16 v[214:215], v242 offset:10240
v_mfma_f32_16x16x32_bf16 v[64:67], v[228:231], a[28:31], v[64:67]
ds_read_b64_tr_b16 v[216:217], v242 offset:12288
v_mfma_f32_16x16x32_bf16 v[64:67], v[232:235], a[40:43], v[64:67]
ds_read_b64_tr_b16 v[218:219], v242 offset:14336
v_mfma_f32_16x16x32_bf16 v[68:71], v[220:223], a[8:11], 0
buffer_load_dwordx4 v244, s[8:11], s47 offen offset:2048 nt lds
v_mfma_f32_16x16x32_bf16 v[68:71], v[224:227], a[20:23], v[68:71]
v_add_u32 v241, 0x10000, v241
v_mfma_f32_16x16x32_bf16 v[68:71], v[228:231], a[32:35], v[68:71]
s_waitcnt lgkmcnt(4)
v_mfma_f32_16x16x32_bf16 v[68:71], v[232:235], a[44:47], v[68:71]
ds_read_b64_tr_b16 v[220:221], v242 offset:8
v_mfma_f32_16x16x32_bf16 v[72:75], v[204:207], a[0:3], 0
ds_read_b64_tr_b16 v[222:223], v242 offset:2056
v_mfma_f32_16x16x32_bf16 v[72:75], v[208:211], a[12:15], v[72:75]
s_waitcnt lgkmcnt(2)
ds_read_b64_tr_b16 v[224:225], v242 offset:4104
v_mfma_f32_16x16x32_bf16 v[72:75], v[212:215], a[24:27], v[72:75]
ds_read_b64_tr_b16 v[226:227], v242 offset:6152
v_mfma_f32_16x16x32_bf16 v[72:75], v[216:219], a[36:39], v[72:75]
ds_read_b64_tr_b16 v[228:229], v242 offset:8200
v_mfma_f32_16x16x32_bf16 v[76:79], v[204:207], a[4:7], 0
buffer_load_dwordx4 v244, s[8:11], s47 offen offset:3072 nt lds
v_mfma_f32_16x16x32_bf16 v[76:79], v[208:211], a[16:19], v[76:79]
s_add_u32 s47, s47, 0x4000
ds_read_b64_tr_b16 v[230:231], v242 offset:10248
v_mfma_f32_16x16x32_bf16 v[76:79], v[212:215], a[28:31], v[76:79]
ds_read_b64_tr_b16 v[232:233], v242 offset:12296
v_mfma_f32_16x16x32_bf16 v[76:79], v[216:219], a[40:43], v[76:79]
s_add_u32 m0, s60, 0
ds_read_b64_tr_b16 v[234:235], v242 offset:14344
v_mfma_f32_16x16x32_bf16 v[80:83], v[204:207], a[8:11], 0
v_mfma_f32_16x16x32_bf16 v[80:83], v[208:211], a[20:23], v[80:83]
v_mfma_f32_16x16x32_bf16 v[80:83], v[212:215], a[32:35], v[80:83]
s_waitcnt lgkmcnt(4)
v_mfma_f32_16x16x32_bf16 v[80:83], v[216:219], a[44:47], v[80:83]
v_mfma_f32_16x16x32_bf16 v[84:87], v[220:223], a[0:3], 0
s_waitcnt vmcnt(20) lgkmcnt(0)
v_mfma_f32_16x16x32_bf16 v[84:87], v[224:227], a[12:15], v[84:87]
s_barrier
ds_read_b64_tr_b16 v[204:205], v241 offset:0
v_mfma_f32_16x16x32_bf16 v[84:87], v[228:231], a[24:27], v[84:87]
ds_read_b64_tr_b16 v[206:207], v241 offset:2048
v_mfma_f32_16x16x32_bf16 v[84:87], v[232:235], a[36:39], v[84:87]
ds_read_b64_tr_b16 v[208:209], v241 offset:4096
ds_read_b64_tr_b16 v[210:211], v241 offset:6144
v_mfma_f32_16x16x32_bf16 v[88:91], v[220:223], a[4:7], 0
ds_read_b64_tr_b16 v[212:213], v241 offset:8192
ds_read_b64_tr_b16 v[214:215], v241 offset:10240
v_mfma_f32_16x16x32_bf16 v[88:91], v[224:227], a[16:19], v[88:91]
ds_read_b64_tr_b16 v[216:217], v241 offset:12288
ds_read_b64_tr_b16 v[218:219], v241 offset:14336
buffer_load_dwordx4 v245, s[12:15], s48 offen offset:0 nt lds
v_mfma_f32_16x16x32_bf16 v[88:91], v[228:231], a[28:31], v[88:91]
ds_read_b128 v[96:99], v196 offset:49152
v_mfma_f32_16x16x32_bf16 v[88:91], v[232:235], a[40:43], v[88:91]
ds_read_b128 v[108:111], v197 offset:49152
v_mfma_f32_16x16x32_bf16 v[92:95], v[220:223], a[8:11], 0
ds_read_b128 v[120:123], v198 offset:49152
v_mfma_f32_16x16x32_bf16 v[92:95], v[224:227], a[20:23], v[92:95]
ds_read_b128 v[132:135], v199 offset:49152
v_mfma_f32_16x16x32_bf16 v[92:95], v[228:231], a[32:35], v[92:95]
s_waitcnt lgkmcnt(8)
ds_read_b128 v[100:103], v192 offset:16384
v_mfma_f32_16x16x32_bf16 v[92:95], v[232:235], a[44:47], v[92:95]
s_waitcnt lgkmcnt(1)
buffer_load_dwordx4 v245, s[12:15], s48 offen offset:1024 nt lds
v_mfma_f32_16x16x32_bf16 v[0:3], v[204:207], v[96:99], v[0:3]
ds_read_b128 v[112:115], v193 offset:16384
ds_read_b64_tr_b16 v[220:221], v241 offset:8
v_mfma_f32_16x16x32_bf16 v[0:3], v[208:211], v[108:111], v[0:3]
s_waitcnt lgkmcnt(7)
ds_read_b128 v[124:127], v194 offset:16384
ds_read_b64_tr_b16 v[222:223], v241 offset:2056
v_mfma_f32_16x16x32_bf16 v[0:3], v[212:215], v[120:123], v[0:3]
ds_read_b128 v[136:139], v195 offset:16384
ds_read_b64_tr_b16 v[224:225], v241 offset:4104
v_mfma_f32_16x16x32_bf16 v[0:3], v[216:219], v[132:135], v[0:3]
s_waitcnt lgkmcnt(1)
ds_read_b128 v[104:107], v196 offset:32768
ds_read_b64_tr_b16 v[226:227], v241 offset:6152
v_mfma_f32_16x16x32_bf16 v[4:7], v[204:207], v[100:103], v[4:7]
ds_read_b128 v[116:119], v197 offset:32768
v_xor_b32 v242, 64, v241
v_mfma_f32_16x16x32_bf16 v[4:7], v[208:211], v[112:115], v[4:7]
ds_read_b128 v[128:131], v198 offset:32768
ds_read_b64_tr_b16 v[228:229], v241 offset:8200
buffer_load_dwordx4 v245, s[12:15], s48 offen offset:2048 nt lds
v_mfma_f32_16x16x32_bf16 v[4:7], v[212:215], v[124:127], v[4:7]
ds_read_b128 v[140:143], v199 offset:32768
ds_read_b64_tr_b16 v[230:231], v241 offset:10248
v_mfma_f32_16x16x32_bf16 v[4:7], v[216:219], v[136:139], v[4:7]
s_waitcnt lgkmcnt(1)
ds_read_b64_tr_b16 v[232:233], v241 offset:12296
v_mfma_f32_16x16x32_bf16 v[8:11], v[204:207], v[104:107], v[8:11]
ds_read_b64_tr_b16 v[234:235], v241 offset:14344
v_mfma_f32_16x16x32_bf16 v[8:11], v[208:211], v[116:119], v[8:11]
s_waitcnt lgkmcnt(3)
buffer_load_dwordx4 v245, s[12:15], s48 offen offset:3072 nt lds
v_mfma_f32_16x16x32_bf16 v[8:11], v[212:215], v[128:131], v[8:11]
s_barrier
v_mfma_f32_16x16x32_bf16 v[8:11], v[216:219], v[140:143], v[8:11]
s_waitcnt lgkmcnt(7)
ds_read_b64_tr_b16 v[204:205], v242 offset:0
v_mfma_f32_16x16x32_bf16 v[12:15], v[220:223], v[96:99], v[12:15]
s_add_u32 s48, s48, 0x4000
ds_read_b64_tr_b16 v[206:207], v242 offset:2048
v_mfma_f32_16x16x32_bf16 v[12:15], v[224:227], v[108:111], v[12:15]
s_waitcnt lgkmcnt(2)
ds_read_b64_tr_b16 v[208:209], v242 offset:4096
v_mfma_f32_16x16x32_bf16 v[12:15], v[228:231], v[120:123], v[12:15]
s_add_u32 m0, s60, 114688
ds_read_b64_tr_b16 v[210:211], v242 offset:6144
v_mfma_f32_16x16x32_bf16 v[12:15], v[232:235], v[132:135], v[12:15]
ds_read_b64_tr_b16 v[212:213], v242 offset:8192
v_mfma_f32_16x16x32_bf16 v[16:19], v[220:223], v[100:103], v[16:19]
ds_read_b64_tr_b16 v[214:215], v242 offset:10240
v_mfma_f32_16x16x32_bf16 v[16:19], v[224:227], v[112:115], v[16:19]
ds_read_b64_tr_b16 v[216:217], v242 offset:12288
v_mfma_f32_16x16x32_bf16 v[16:19], v[228:231], v[124:127], v[16:19]
buffer_load_dwordx4 v244, s[8:11], s47 offen offset:0 nt lds
v_mfma_f32_16x16x32_bf16 v[16:19], v[232:235], v[136:139], v[16:19]
ds_read_b64_tr_b16 v[218:219], v242 offset:14336
v_mfma_f32_16x16x32_bf16 v[20:23], v[220:223], v[104:107], v[20:23]
v_add_u32 v241, 0xffffc000, v241
v_mfma_f32_16x16x32_bf16 v[20:23], v[224:227], v[116:119], v[20:23]
v_mfma_f32_16x16x32_bf16 v[20:23], v[228:231], v[128:131], v[20:23]
s_waitcnt lgkmcnt(4)
buffer_load_dwordx4 v244, s[8:11], s47 offen offset:1024 nt lds
v_mfma_f32_16x16x32_bf16 v[20:23], v[232:235], v[140:143], v[20:23]
ds_read_b64_tr_b16 v[220:221], v242 offset:8
v_mfma_f32_16x16x32_bf16 v[24:27], v[204:207], v[96:99], v[24:27]
ds_read_b64_tr_b16 v[222:223], v242 offset:2056
v_mfma_f32_16x16x32_bf16 v[24:27], v[208:211], v[108:111], v[24:27]
s_waitcnt lgkmcnt(2)
ds_read_b64_tr_b16 v[224:225], v242 offset:4104
v_mfma_f32_16x16x32_bf16 v[24:27], v[212:215], v[120:123], v[24:27]
ds_read_b64_tr_b16 v[226:227], v242 offset:6152
v_mfma_f32_16x16x32_bf16 v[24:27], v[216:219], v[132:135], v[24:27]
ds_read_b64_tr_b16 v[228:229], v242 offset:8200
v_mfma_f32_16x16x32_bf16 v[28:31], v[204:207], v[100:103], v[28:31]
ds_read_b64_tr_b16 v[230:231], v242 offset:10248
v_mfma_f32_16x16x32_bf16 v[28:31], v[208:211], v[112:115], v[28:31]
ds_read_b64_tr_b16 v[232:233], v242 offset:12296
v_mfma_f32_16x16x32_bf16 v[28:31], v[212:215], v[124:127], v[28:31]
ds_read_b64_tr_b16 v[234:235], v242 offset:14344
v_mfma_f32_16x16x32_bf16 v[28:31], v[216:219], v[136:139], v[28:31]
buffer_load_dwordx4 v244, s[8:11], s47 offen offset:2048 nt lds
v_mfma_f32_16x16x32_bf16 v[32:35], v[204:207], v[104:107], v[32:35]
v_mfma_f32_16x16x32_bf16 v[32:35], v[208:211], v[116:119], v[32:35]
v_mfma_f32_16x16x32_bf16 v[32:35], v[212:215], v[128:131], v[32:35]
s_waitcnt lgkmcnt(4)
v_mfma_f32_16x16x32_bf16 v[32:35], v[216:219], v[140:143], v[32:35]
buffer_load_dwordx4 v244, s[8:11], s47 offen offset:3072 nt lds
v_mfma_f32_16x16x32_bf16 v[36:39], v[220:223], v[96:99], v[36:39]
s_waitcnt vmcnt(24) lgkmcnt(0)
v_mfma_f32_16x16x32_bf16 v[36:39], v[224:227], v[108:111], v[36:39]
s_barrier
ds_read_b64_tr_b16 v[204:205], v241 offset:0
v_mfma_f32_16x16x32_bf16 v[36:39], v[228:231], v[120:123], v[36:39]
s_add_u32 s47, s47, 0x4000
ds_read_b64_tr_b16 v[206:207], v241 offset:2048
v_mfma_f32_16x16x32_bf16 v[36:39], v[232:235], v[132:135], v[36:39]
s_add_u32 m0, s60, 16384
ds_read_b64_tr_b16 v[208:209], v241 offset:4096
v_mfma_f32_16x16x32_bf16 v[40:43], v[220:223], v[100:103], v[40:43]
ds_read_b64_tr_b16 v[210:211], v241 offset:6144
v_mfma_f32_16x16x32_bf16 v[40:43], v[224:227], v[112:115], v[40:43]
ds_read_b64_tr_b16 v[212:213], v241 offset:8192
v_mfma_f32_16x16x32_bf16 v[40:43], v[228:231], v[124:127], v[40:43]
ds_read_b64_tr_b16 v[214:215], v241 offset:10240
v_mfma_f32_16x16x32_bf16 v[40:43], v[232:235], v[136:139], v[40:43]
ds_read_b64_tr_b16 v[216:217], v241 offset:12288
v_mfma_f32_16x16x32_bf16 v[44:47], v[220:223], v[104:107], v[44:47]
buffer_load_dwordx4 v245, s[12:15], s48 offen offset:0 nt lds
v_mfma_f32_16x16x32_bf16 v[44:47], v[224:227], v[116:119], v[44:47]
ds_read_b64_tr_b16 v[218:219], v241 offset:14336
v_mfma_f32_16x16x32_bf16 v[44:47], v[228:231], v[128:131], v[44:47]
s_waitcnt lgkmcnt(4)
v_mfma_f32_16x16x32_bf16 v[44:47], v[232:235], v[140:143], v[44:47]
ds_read_b64_tr_b16 v[220:221], v241 offset:8
v_mfma_f32_16x16x32_bf16 v[48:51], v[204:207], v[96:99], v[48:51]
ds_read_b64_tr_b16 v[222:223], v241 offset:2056
v_mfma_f32_16x16x32_bf16 v[48:51], v[208:211], v[108:111], v[48:51]
s_waitcnt lgkmcnt(2)
ds_read_b64_tr_b16 v[224:225], v241 offset:4104
v_mfma_f32_16x16x32_bf16 v[48:51], v[212:215], v[120:123], v[48:51]
ds_read_b64_tr_b16 v[226:227], v241 offset:6152
v_mfma_f32_16x16x32_bf16 v[48:51], v[216:219], v[132:135], v[48:51]
ds_read_b64_tr_b16 v[228:229], v241 offset:8200
v_xor_b32 v242, 64, v241
v_mfma_f32_16x16x32_bf16 v[52:55], v[204:207], v[100:103], v[52:55]
buffer_load_dwordx4 v245, s[12:15], s48 offen offset:1024 nt lds
v_mfma_f32_16x16x32_bf16 v[52:55], v[208:211], v[112:115], v[52:55]
ds_read_b64_tr_b16 v[230:231], v241 offset:10248
v_mfma_f32_16x16x32_bf16 v[52:55], v[212:215], v[124:127], v[52:55]
ds_read_b64_tr_b16 v[232:233], v241 offset:12296
v_mfma_f32_16x16x32_bf16 v[52:55], v[216:219], v[136:139], v[52:55]
ds_read_b64_tr_b16 v[234:235], v241 offset:14344
v_mfma_f32_16x16x32_bf16 v[56:59], v[204:207], v[104:107], v[56:59]
buffer_load_dwordx4 v245, s[12:15], s48 offen offset:2048 nt lds
v_mfma_f32_16x16x32_bf16 v[56:59], v[208:211], v[116:119], v[56:59]
v_mfma_f32_16x16x32_bf16 v[56:59], v[212:215], v[128:131], v[56:59]
s_waitcnt lgkmcnt(4)
v_mfma_f32_16x16x32_bf16 v[56:59], v[216:219], v[140:143], v[56:59]
ds_read_b64_tr_b16 v[204:205], v242 offset:0
v_mfma_f32_16x16x32_bf16 v[60:63], v[220:223], v[96:99], v[60:63]
ds_read_b64_tr_b16 v[206:207], v242 offset:2048
v_mfma_f32_16x16x32_bf16 v[60:63], v[224:227], v[108:111], v[60:63]
s_waitcnt lgkmcnt(2)
ds_read_b64_tr_b16 v[208:209], v242 offset:4096
v_mfma_f32_16x16x32_bf16 v[60:63], v[228:231], v[120:123], v[60:63]
ds_read_b64_tr_b16 v[210:211], v242 offset:6144
v_mfma_f32_16x16x32_bf16 v[60:63], v[232:235], v[132:135], v[60:63]
ds_read_b64_tr_b16 v[212:213], v242 offset:8192
v_mfma_f32_16x16x32_bf16 v[64:67], v[220:223], v[100:103], v[64:67]
buffer_load_dwordx4 v245, s[12:15], s48 offen offset:3072 nt lds
v_mfma_f32_16x16x32_bf16 v[64:67], v[224:227], v[112:115], v[64:67]
s_add_u32 s48, s48, 0x4000
ds_read_b64_tr_b16 v[214:215], v242 offset:10240
v_mfma_f32_16x16x32_bf16 v[64:67], v[228:231], v[124:127], v[64:67]
s_add_u32 m0, s60, 98304
ds_read_b64_tr_b16 v[216:217], v242 offset:12288
v_mfma_f32_16x16x32_bf16 v[64:67], v[232:235], v[136:139], v[64:67]
ds_read_b64_tr_b16 v[218:219], v242 offset:14336
v_mfma_f32_16x16x32_bf16 v[68:71], v[220:223], v[104:107], v[68:71]
v_add_u32 v241, 0xffffc000, v241
v_mfma_f32_16x16x32_bf16 v[68:71], v[224:227], v[116:119], v[68:71]
v_mfma_f32_16x16x32_bf16 v[68:71], v[228:231], v[128:131], v[68:71]
s_waitcnt lgkmcnt(4)
buffer_load_dwordx4 v244, s[8:11], s47 offen offset:0 nt lds
v_mfma_f32_16x16x32_bf16 v[68:71], v[232:235], v[140:143], v[68:71]
ds_read_b64_tr_b16 v[220:221], v242 offset:8
v_mfma_f32_16x16x32_bf16 v[72:75], v[204:207], v[96:99], v[72:75]
ds_read_b64_tr_b16 v[222:223], v242 offset:2056
v_mfma_f32_16x16x32_bf16 v[72:75], v[208:211], v[108:111], v[72:75]
s_waitcnt lgkmcnt(2)
ds_read_b64_tr_b16 v[224:225], v242 offset:4104
v_mfma_f32_16x16x32_bf16 v[72:75], v[212:215], v[120:123], v[72:75]
ds_read_b64_tr_b16 v[226:227], v242 offset:6152
v_mfma_f32_16x16x32_bf16 v[72:75], v[216:219], v[132:135], v[72:75]
ds_read_b64_tr_b16 v[228:229], v242 offset:8200
v_mfma_f32_16x16x32_bf16 v[76:79], v[204:207], v[100:103], v[76:79]
ds_read_b64_tr_b16 v[230:231], v242 offset:10248
v_mfma_f32_16x16x32_bf16 v[76:79], v[208:211], v[112:115], v[76:79]
ds_read_b64_tr_b16 v[232:233], v242 offset:12296
v_mfma_f32_16x16x32_bf16 v[76:79], v[212:215], v[124:127], v[76:79]
buffer_load_dwordx4 v244, s[8:11], s47 offen offset:1024 nt lds
v_mfma_f32_16x16x32_bf16 v[76:79], v[216:219], v[136:139], v[76:79]
ds_read_b64_tr_b16 v[234:235], v242 offset:14344
v_mfma_f32_16x16x32_bf16 v[80:83], v[204:207], v[104:107], v[80:83]
v_mfma_f32_16x16x32_bf16 v[80:83], v[208:211], v[116:119], v[80:83]
v_mfma_f32_16x16x32_bf16 v[80:83], v[212:215], v[128:131], v[80:83]
s_waitcnt lgkmcnt(4)
buffer_load_dwordx4 v244, s[8:11], s47 offen offset:2048 nt lds
v_mfma_f32_16x16x32_bf16 v[80:83], v[216:219], v[140:143], v[80:83]
v_mfma_f32_16x16x32_bf16 v[84:87], v[220:223], v[96:99], v[84:87]
s_waitcnt vmcnt(27) lgkmcnt(0)
v_mfma_f32_16x16x32_bf16 v[84:87], v[224:227], v[108:111], v[84:87]
s_barrier
ds_read_b64_tr_b16 v[204:205], v241 offset:49152
v_mfma_f32_16x16x32_bf16 v[84:87], v[228:231], v[120:123], v[84:87]
ds_read_b64_tr_b16 v[206:207], v241 offset:51200
v_mfma_f32_16x16x32_bf16 v[84:87], v[232:235], v[132:135], v[84:87]
ds_read_b64_tr_b16 v[208:209], v241 offset:53248
v_mfma_f32_16x16x32_bf16 v[88:91], v[220:223], v[100:103], v[88:91]
ds_read_b64_tr_b16 v[210:211], v241 offset:55296
v_mfma_f32_16x16x32_bf16 v[88:91], v[224:227], v[112:115], v[88:91]
ds_read_b64_tr_b16 v[212:213], v241 offset:57344
v_mfma_f32_16x16x32_bf16 v[88:91], v[228:231], v[124:127], v[88:91]
ds_read_b64_tr_b16 v[214:215], v241 offset:59392
v_mfma_f32_16x16x32_bf16 v[88:91], v[232:235], v[136:139], v[88:91]
buffer_load_dwordx4 v244, s[8:11], s47 offen offset:3072 nt lds
v_mfma_f32_16x16x32_bf16 v[92:95], v[220:223], v[104:107], v[92:95]
s_add_u32 s47, s47, 0x4000
ds_read_b64_tr_b16 v[216:217], v241 offset:61440
v_mfma_f32_16x16x32_bf16 v[92:95], v[224:227], v[116:119], v[92:95]
ds_read_b64_tr_b16 v[218:219], v241 offset:63488
v_mfma_f32_16x16x32_bf16 v[92:95], v[228:231], v[128:131], v[92:95]
v_mfma_f32_16x16x32_bf16 v[92:95], v[232:235], v[140:143], v[92:95]
s_waitcnt vmcnt(63)
s_lshl_b32 s6, s64, 2
s_cmp_eq_u32 s63, 0
s_cselect_b32 s6, s6, 0x40000000
v_mov_b32 v255, 0x40000000
v_writelane_b32 v255, 0, 0
v_mov_b32 v254, s37
buffer_atomic_add v254, v255, s[32:35], s6 offen sc1
s_branch L_R2
L_loop:
s_waitcnt lgkmcnt(4)
v_mfma_f32_16x16x32_bf16 v[0:3], v[204:207], a[0:3], 0
ds_read_b64_tr_b16 v[220:221], v241 offset:49160
v_add_u32 v192, s36, v236
v_mfma_f32_16x16x32_bf16 v[0:3], v[208:211], a[12:15], v[0:3]
s_waitcnt lgkmcnt(1)
ds_read_b64_tr_b16 v[222:223], v241 offset:51208
v_add_u32 v193, s36, v237
v_mfma_f32_16x16x32_bf16 v[0:3], v[212:215], a[24:27], v[0:3]
ds_read_b64_tr_b16 v[224:225], v241 offset:53256
v_add_u32 v194, s36, v238
v_mfma_f32_16x16x32_bf16 v[0:3], v[216:219], a[36:39], v[0:3]
ds_read_b64_tr_b16 v[226:227], v241 offset:55304
v_add_u32 v195, s36, v239
v_mfma_f32_16x16x32_bf16 v[4:7], v[204:207], a[4:7], 0
ds_read_b64_tr_b16 v[228:229], v241 offset:57352
v_mul_f32 v11, v251, v11
v_mfma_f32_16x16x32_bf16 v[4:7], v[208:211], a[16:19], v[4:7]
s_add_u32 m0, s60, 0
ds_read_b64_tr_b16 v[230:231], v241 offset:59400
v_cvt_pk_bf16_f32 v152, v8, v9
v_mfma_f32_16x16x32_bf16 v[4:7], v[212:215], a[28:31], v[4:7]
ds_read_b64_tr_b16 v[232:233], v241 offset:61448
v_cvt_pk_bf16_f32 v153, v10, v11
v_mfma_f32_16x16x32_bf16 v[4:7], v[216:219], a[40:43], v[4:7]
ds_read_b128 v[96:99], v192 offset:16384
v_xor_b32 v242, 64, v241
v_mfma_f32_16x16x32_bf16 v[8:11], v[204:207], a[8:11], 0
ds_read_b64_tr_b16 v[234:235], v241 offset:63496
v_mul_f32 v20, v251, v20
v_mfma_f32_16x16x32_bf16 v[8:11], v[208:211], a[20:23], v[8:11]
ds_read_b128 v[108:111], v193 offset:16384
v_mul_f32 v21, v251, v21
v_mfma_f32_16x16x32_bf16 v[8:11], v[212:215], a[32:35], v[8:11]
s_waitcnt lgkmcnt(6)
ds_read_b128 v[120:123], v194 offset:16384
v_mul_f32 v22, v251, v22
v_mfma_f32_16x16x32_bf16 v[8:11], v[216:219], a[44:47], v[8:11]
ds_read_b64_tr_b16 v[204:205], v242 offset:49152
v_mul_f32 v23, v251, v23
v_mfma_f32_16x16x32_bf16 v[12:15], v[220:223], a[0:3], 0
ds_read_b64_tr_b16 v[206:207], v242 offset:51200
v_cvt_pk_bf16_f32 v154, v20, v21
v_mfma_f32_16x16x32_bf16 v[12:15], v[224:227], a[12:15], v[12:15]
s_waitcnt lgkmcnt(4)
ds_read_b64_tr_b16 v[208:209], v242 offset:53248
v_cvt_pk_bf16_f32 v155, v22, v23
v_mfma_f32_16x16x32_bf16 v[12:15], v[228:231], a[24:27], v[12:15]
ds_read_b128 v[132:135], v195 offset:16384
v_mul_f32 v24, v249, v24
v_mfma_f32_16x16x32_bf16 v[12:15], v[232:235], a[36:39], v[12:15]
ds_read_b64_tr_b16 v[210:211], v242 offset:55296
buffer_load_dwordx4 v245, s[12:15], s48 offen offset:1024 nt lds
v_mfma_f32_16x16x32_bf16 v[16:19], v[220:223], a[4:7], 0
ds_read_b128 v[100:103], v192 offset:49152
v_mul_f32 v25, v249, v25
v_mfma_f32_16x16x32_bf16 v[16:19], v[224:227], a[16:19], v[16:19]
ds_read_b64_tr_b16 v[212:213], v242 offset:57344
v_mul_f32 v26, v249, v26
v_mfma_f32_16x16x32_bf16 v[16:19], v[228:231], a[28:31], v[16:19]
ds_read_b64_tr_b16 v[214:215], v242 offset:59392
v_mul_f32 v27, v249, v27
v_mfma_f32_16x16x32_bf16 v[16:19], v[232:235], a[40:43], v[16:19]
ds_read_b128 v[112:115], v193 offset:49152
ds_read_b64_tr_b16 v[216:217], v242 offset:61440
v_mfma_f32_16x16x32_bf16 v[20:23], v[220:223], a[8:11], 0
ds_read_b64_tr_b16 v[218:219], v242 offset:63488
v_cvt_pk_bf16_f32 v156, v24, v25
v_mfma_f32_16x16x32_bf16 v[20:23], v[224:227], a[20:23], v[20:23]
ds_read_b128 v[124:127], v194 offset:49152
v_cvt_pk_bf16_f32 v157, v26, v27
v_mfma_f32_16x16x32_bf16 v[20:23], v[228:231], a[32:35], v[20:23]
s_waitcnt lgkmcnt(7)
ds_read_b128 v[136:139], v195 offset:49152
v_mul_f32 v28, v250, v28
v_mfma_f32_16x16x32_bf16 v[20:23], v[232:235], a[44:47], v[20:23]
ds_read_b64_tr_b16 v[220:221], v242 offset:49160
v_mul_f32 v29, v250, v29
v_mfma_f32_16x16x32_bf16 v[24:27], v[204:207], a[0:3], 0
ds_read_b128 v[104:107], v192 offset:0
v_mul_f32 v30, v250, v30
v_mfma_f32_16x16x32_bf16 v[24:27], v[208:211], a[12:15], v[24:27]
s_waitcnt lgkmcnt(4)
ds_read_b64_tr_b16 v[222:223], v242 offset:51208
v_mul_f32 v31, v250, v31
v_mfma_f32_16x16x32_bf16 v[24:27], v[212:215], a[24:27], v[24:27]
s_add_u32 s56, s49, s43
ds_read_b64_tr_b16 v[224:225], v242 offset:53256
v_cvt_pk_bf16_f32 v160, v28, v29
v_mfma_f32_16x16x32_bf16 v[24:27], v[216:219], a[36:39], v[24:27]
s_xor_b32 s56, s56, 128
ds_read_b128 v[116:119], v193 offset:0
ds_read_b64_tr_b16 v[226:227], v242 offset:55304
v_cvt_pk_bf16_f32 v161, v30, v31
v_mfma_f32_16x16x32_bf16 v[28:31], v[204:207], a[4:7], 0
s_add_u32 s57, s56, s50
v_mul_f32 v32, v251, v32
v_mul_f32 v33, v251, v33
v_mfma_f32_16x16x32_bf16 v[28:31], v[208:211], a[16:19], v[28:31]
s_add_u32 s58, s56, s51
ds_read_b128 v[128:131], v194 offset:0
ds_read_b64_tr_b16 v[228:229], v242 offset:57352
v_mfma_f32_16x16x32_bf16 v[28:31], v[212:215], a[28:31], v[28:31]
s_add_u32 s59, s56, s52
ds_read_b64_tr_b16 v[230:231], v242 offset:59400
v_mul_f32 v34, v251, v34
v_mfma_f32_16x16x32_bf16 v[28:31], v[216:219], a[40:43], v[28:31]
ds_read_b128 v[140:143], v195 offset:0
ds_read_b64_tr_b16 v[232:233], v242 offset:61448
v_mul_f32 v35, v251, v35
v_cvt_pk_bf16_f32 v164, v32, v33
v_cvt_pk_bf16_f32 v165, v34, v35
v_mfma_f32_16x16x32_bf16 v[32:35], v[204:207], a[8:11], 0
ds_read_b64_tr_b16 v[234:235], v242 offset:63496
v_mul_f32 v36, v249, v36
v_mfma_f32_16x16x32_bf16 v[32:35], v[208:211], a[20:23], v[32:35]
buffer_load_dwordx4 v245, s[12:15], s48 offen offset:2048 nt lds
v_mfma_f32_16x16x32_bf16 v[32:35], v[212:215], a[32:35], v[32:35]
s_waitcnt lgkmcnt(6)
v_mul_f32 v37, v249, v37
v_mul_f32 v38, v249, v38
v_mfma_f32_16x16x32_bf16 v[32:35], v[216:219], a[44:47], v[32:35]
s_add_u32 m0, s60, 32768
v_mul_f32 v39, v249, v39
v_cvt_pk_bf16_f32 v158, v36, v37
v_cvt_pk_bf16_f32 v159, v38, v39
v_mfma_f32_16x16x32_bf16 v[36:39], v[220:223], a[0:3], 0
s_waitcnt vmcnt(12) lgkmcnt(0)
v_mul_f32 v40, v250, v40
v_mul_f32 v41, v250, v41
v_mfma_f32_16x16x32_bf16 v[36:39], v[224:227], a[12:15], v[36:39]
s_barrier
ds_read_b64_tr_b16 v[204:205], v241 offset:16384
v_mul_f32 v42, v250, v42
v_mfma_f32_16x16x32_bf16 v[36:39], v[228:231], a[24:27], v[36:39]
ds_read_b64_tr_b16 v[206:207], v241 offset:18432
v_mul_f32 v43, v250, v43
v_mfma_f32_16x16x32_bf16 v[36:39], v[232:235], a[36:39], v[36:39]
v_cvt_pk_bf16_f32 v162, v40, v41
v_cvt_pk_bf16_f32 v163, v42, v43
v_mfma_f32_16x16x32_bf16 v[40:43], v[220:223], a[4:7], 0
ds_read_b64_tr_b16 v[208:209], v241 offset:20480
v_mul_f32 v44, v251, v44
v_mfma_f32_16x16x32_bf16 v[40:43], v[224:227], a[16:19], v[40:43]
ds_read_b64_tr_b16 v[210:211], v241 offset:22528
v_mul_f32 v45, v251, v45
v_mfma_f32_16x16x32_bf16 v[40:43], v[228:231], a[28:31], v[40:43]
buffer_load_dwordx4 v246, s[16:19], s56 offen offset:0 lds
v_mfma_f32_16x16x32_bf16 v[40:43], v[232:235], a[40:43], v[40:43]
ds_read_b64_tr_b16 v[212:213], v241 offset:24576
v_mul_f32 v46, v251, v46
v_mul_f32 v47, v251, v47
v_cvt_pk_bf16_f32 v166, v44, v45
v_cvt_pk_bf16_f32 v167, v46, v47
v_mfma_f32_16x16x32_bf16 v[44:47], v[220:223], a[8:11], 0
ds_read_b64_tr_b16 v[214:215], v241 offset:26624
v_mul_f32 v48, v249, v48
v_mfma_f32_16x16x32_bf16 v[44:47], v[224:227], a[20:23], v[44:47]
ds_read_b64_tr_b16 v[216:217], v241 offset:28672
v_mul_f32 v49, v249, v49
v_mfma_f32_16x16x32_bf16 v[44:47], v[228:231], a[32:35], v[44:47]
s_waitcnt lgkmcnt(3)
ds_read_b64_tr_b16 v[218:219], v241 offset:30720
v_mul_f32 v50, v249, v50
v_mfma_f32_16x16x32_bf16 v[44:47], v[232:235], a[44:47], v[44:47]
ds_read_b64_tr_b16 v[220:221], v241 offset:16392
v_mul_f32 v51, v249, v51
v_mfma_f32_16x16x32_bf16 v[0:3], v[204:207], a[48:51], v[0:3]
ds_read_b64_tr_b16 v[222:223], v241 offset:18440
v_cvt_pk_bf16_f32 v168, v48, v49
v_mfma_f32_16x16x32_bf16 v[0:3], v[208:211], a[60:63], v[0:3]
s_waitcnt lgkmcnt(2)
buffer_load_dwordx4 v246, s[16:19], s57 offen offset:1024 lds
v_mfma_f32_16x16x32_bf16 v[0:3], v[212:215], a[72:75], v[0:3]
s_add_u32 m0, s60, 0
ds_read_b64_tr_b16 v[224:225], v241 offset:20488
v_cvt_pk_bf16_f32 v169, v50, v51
v_mfma_f32_16x16x32_bf16 v[0:3], v[216:219], a[84:87], v[0:3]
ds_read_b64_tr_b16 v[226:227], v241 offset:22536
v_xor_b32 v242, 64, v241
v_mfma_f32_16x16x32_bf16 v[4:7], v[204:207], a[52:55], v[4:7]
buffer_load_dwordx4 v245, s[12:15], s48 offen offset:3072 nt lds
v_mfma_f32_16x16x32_bf16 v[4:7], v[208:211], a[64:67], v[4:7]
s_add_u32 m0, s60, 32768
ds_read_b64_tr_b16 v[228:229], v241 offset:24584
v_mul_f32 v52, v250, v52
v_mfma_f32_16x16x32_bf16 v[4:7], v[212:215], a[76:79], v[4:7]
s_add_u32 s48, s48, 0x4000
ds_read_b64_tr_b16 v[230:231], v241 offset:26632
v_mul_f32 v53, v250, v53
v_mfma_f32_16x16x32_bf16 v[4:7], v[216:219], a[88:91], v[4:7]
ds_read_b64_tr_b16 v[232:233], v241 offset:28680
v_mul_f32 v54, v250, v54
v_mfma_f32_16x16x32_bf16 v[8:11], v[204:207], a[56:59], v[8:11]
ds_read_b64_tr_b16 v[234:235], v241 offset:30728
buffer_load_dwordx4 v246, s[16:19], s58 offen offset:2048 lds
v_mfma_f32_16x16x32_bf16 v[8:11], v[208:211], a[68:71], v[8:11]
v_mul_f32 v55, v250, v55
v_cvt_pk_bf16_f32 v172, v52, v53
v_mfma_f32_16x16x32_bf16 v[8:11], v[212:215], a[80:83], v[8:11]
s_waitcnt lgkmcnt(4)
v_cvt_pk_bf16_f32 v173, v54, v55
v_mul_f32 v56, v251, v56
v_mfma_f32_16x16x32_bf16 v[8:11], v[216:219], a[92:95], v[8:11]
ds_read_b64_tr_b16 v[204:205], v242 offset:16384
v_mul_f32 v57, v251, v57
v_mfma_f32_16x16x32_bf16 v[12:15], v[220:223], a[48:51], v[12:15]
ds_read_b64_tr_b16 v[206:207], v242 offset:18432
v_mul_f32 v58, v251, v58
v_mfma_f32_16x16x32_bf16 v[12:15], v[224:227], a[60:63], v[12:15]
s_waitcnt lgkmcnt(2)
ds_read_b64_tr_b16 v[208:209], v242 offset:20480
v_mul_f32 v59, v251, v59
v_mfma_f32_16x16x32_bf16 v[12:15], v[228:231], a[72:75], v[12:15]
ds_read_b64_tr_b16 v[210:211], v242 offset:22528
v_cvt_pk_bf16_f32 v176, v56, v57
v_mfma_f32_16x16x32_bf16 v[12:15], v[232:235], a[84:87], v[12:15]
buffer_load_dwordx4 v246, s[16:19], s59 offen offset:3072 lds
v_mfma_f32_16x16x32_bf16 v[16:19], v[220:223], a[52:55], v[16:19]
s_add_u32 m0, s60, 114688
ds_read_b64_tr_b16 v[212:213], v242 offset:24576
v_cvt_pk_bf16_f32 v177, v58, v59
v_mfma_f32_16x16x32_bf16 v[16:19], v[224:227], a[64:67], v[16:19]
ds_read_b64_tr_b16 v[214:215], v242 offset:26624
v_mul_f32 v60, v249, v60
v_mfma_f32_16x16x32_bf16 v[16:19], v[228:231], a[76:79], v[16:19]
s_add_u32 s56, s49, s46
ds_read_b64_tr_b16 v[216:217], v242 offset:28672
v_mul_f32 v61, v249, v61
v_mfma_f32_16x16x32_bf16 v[16:19], v[232:235], a[88:91], v[16:19]
s_add_u32 s57, s56, s50
ds_read_b64_tr_b16 v[218:219], v242 offset:30720
v_mul_f32 v62, v249, v62
v_mfma_f32_16x16x32_bf16 v[20:23], v[220:223], a[56:59], v[20:23]
s_add_u32 s58, s56, s51
buffer_load_dwordx4 v244, s[8:11], s47 offen offset:0 nt lds
v_mfma_f32_16x16x32_bf16 v[20:23], v[224:227], a[68:71], v[20:23]
s_add_u32 s59, s56, s52
v_add_u32 v241, 0xc000, v241
v_mul_f32 v63, v249, v63
v_mfma_f32_16x16x32_bf16 v[20:23], v[228:231], a[80:83], v[20:23]
s_waitcnt lgkmcnt(4)
v_cvt_pk_bf16_f32 v170, v60, v61
v_cvt_pk_bf16_f32 v171, v62, v63
v_mfma_f32_16x16x32_bf16 v[20:23], v[232:235], a[92:95], v[20:23]
ds_read_b64_tr_b16 v[220:221], v242 offset:16392
v_mul_f32 v64, v250, v64
v_mfma_f32_16x16x32_bf16 v[24:27], v[204:207], a[48:51], v[24:27]
s_add_u32 m0, s60, 49152
ds_read_b64_tr_b16 v[222:223], v242 offset:18440
v_mul_f32 v65, v250, v65
v_mfma_f32_16x16x32_bf16 v[24:27], v[208:211], a[60:63], v[24:27]
s_waitcnt lgkmcnt(2)
ds_read_b64_tr_b16 v[224:225], v242 offset:20488
v_mul_f32 v66, v250, v66
v_mfma_f32_16x16x32_bf16 v[24:27], v[212:215], a[72:75], v[24:27]
ds_read_b64_tr_b16 v[226:227], v242 offset:22536
v_mul_f32 v67, v250, v67
v_mfma_f32_16x16x32_bf16 v[24:27], v[216:219], a[84:87], v[24:27]
ds_read_b64_tr_b16 v[228:229], v242 offset:24584
v_cvt_pk_bf16_f32 v174, v64, v65
v_mfma_f32_16x16x32_bf16 v[28:31], v[204:207], a[52:55], v[28:31]
ds_read_b64_tr_b16 v[230:231], v242 offset:26632
v_cvt_pk_bf16_f32 v175, v66, v67
v_mfma_f32_16x16x32_bf16 v[28:31], v[208:211], a[64:67], v[28:31]
ds_read_b64_tr_b16 v[232:233], v242 offset:28680
v_mul_f32 v68, v251, v68
v_mfma_f32_16x16x32_bf16 v[28:31], v[212:215], a[76:79], v[28:31]
ds_read_b64_tr_b16 v[234:235], v242 offset:30728
v_mul_f32 v69, v251, v69
v_mfma_f32_16x16x32_bf16 v[28:31], v[216:219], a[88:91], v[28:31]
buffer_load_dwordx4 v246, s[16:19], s56 offen offset:0 lds
v_mfma_f32_16x16x32_bf16 v[32:35], v[204:207], a[56:59], v[32:35]
v_mul_f32 v70, v251, v70
v_mul_f32 v71, v251, v71
v_mfma_f32_16x16x32_bf16 v[32:35], v[208:211], a[68:71], v[32:35]
v_cvt_pk_bf16_f32 v178, v68, v69
v_cvt_pk_bf16_f32 v179, v70, v71
v_mfma_f32_16x16x32_bf16 v[32:35], v[212:215], a[80:83], v[32:35]
s_waitcnt lgkmcnt(4)
v_mul_f32 v72, v249, v72
v_mul_f32 v73, v249, v73
v_mfma_f32_16x16x32_bf16 v[32:35], v[216:219], a[92:95], v[32:35]
v_mul_f32 v74, v249, v74
v_mul_f32 v75, v249, v75
v_mfma_f32_16x16x32_bf16 v[36:39], v[220:223], a[48:51], v[36:39]
s_waitcnt vmcnt(11) lgkmcnt(0)
v_cvt_pk_bf16_f32 v180, v72, v73
v_cvt_pk_bf16_f32 v181, v74, v75
v_mfma_f32_16x16x32_bf16 v[36:39], v[224:227], a[60:63], v[36:39]
s_barrier
ds_read_b64_tr_b16 v[204:205], v241 offset:49152
v_mul_f32 v76, v250, v76
v_mfma_f32_16x16x32_bf16 v[36:39], v[228:231], a[72:75], v[36:39]
ds_read_b64_tr_b16 v[206:207], v241 offset:51200
v_mul_f32 v77, v250, v77
v_mfma_f32_16x16x32_bf16 v[36:39], v[232:235], a[84:87], v[36:39]
ds_read_b64_tr_b16 v[208:209], v241 offset:53248
v_mul_f32 v78, v250, v78
v_mfma_f32_16x16x32_bf16 v[40:43], v[220:223], a[52:55], v[40:43]
buffer_load_dwordx4 v246, s[16:19], s57 offen offset:1024 lds
v_mfma_f32_16x16x32_bf16 v[40:43], v[224:227], a[64:67], v[40:43]
s_add_u32 m0, s60, 114688
ds_read_b64_tr_b16 v[210:211], v241 offset:55296
v_mul_f32 v79, v250, v79
v_mfma_f32_16x16x32_bf16 v[40:43], v[228:231], a[76:79], v[40:43]
buffer_load_dwordx4 v244, s[8:11], s47 offen offset:1024 nt lds
v_mfma_f32_16x16x32_bf16 v[40:43], v[232:235], a[88:91], v[40:43]
s_add_u32 m0, s60, 49152
ds_read_b64_tr_b16 v[212:213], v241 offset:57344
v_cvt_pk_bf16_f32 v184, v76, v77
v_mfma_f32_16x16x32_bf16 v[44:47], v[220:223], a[56:59], v[44:47]
ds_read_b64_tr_b16 v[214:215], v241 offset:59392
v_cvt_pk_bf16_f32 v185, v78, v79
v_mfma_f32_16x16x32_bf16 v[44:47], v[224:227], a[68:71], v[44:47]
ds_read_b64_tr_b16 v[216:217], v241 offset:61440
v_mul_f32 v80, v251, v80
v_mfma_f32_16x16x32_bf16 v[44:47], v[228:231], a[80:83], v[44:47]
s_waitcnt lgkmcnt(3)
ds_read_b64_tr_b16 v[218:219], v241 offset:63488
v_mul_f32 v81, v251, v81
v_mfma_f32_16x16x32_bf16 v[44:47], v[232:235], a[92:95], v[44:47]
ds_read_b64_tr_b16 v[220:221], v241 offset:49160
v_mul_f32 v82, v251, v82
v_mfma_f32_16x16x32_bf16 v[0:3], v[204:207], a[96:99], v[0:3]
buffer_load_dwordx4 v246, s[16:19], s58 offen offset:2048 lds
v_mfma_f32_16x16x32_bf16 v[0:3], v[208:211], a[108:111], v[0:3]
s_waitcnt lgkmcnt(1)
ds_read_b64_tr_b16 v[222:223], v241 offset:51208
v_mul_f32 v83, v251, v83
v_mfma_f32_16x16x32_bf16 v[0:3], v[212:215], a[120:123], v[0:3]
ds_read_b64_tr_b16 v[224:225], v241 offset:53256
v_cvt_pk_bf16_f32 v188, v80, v81
v_mfma_f32_16x16x32_bf16 v[0:3], v[216:219], a[132:135], v[0:3]
ds_read_b64_tr_b16 v[226:227], v241 offset:55304
v_xor_b32 v242, 64, v241
v_mfma_f32_16x16x32_bf16 v[4:7], v[204:207], a[100:103], v[4:7]
ds_read_b64_tr_b16 v[228:229], v241 offset:57352
v_cvt_pk_bf16_f32 v189, v82, v83
v_mfma_f32_16x16x32_bf16 v[4:7], v[208:211], a[112:115], v[4:7]
ds_read_b64_tr_b16 v[230:231], v241 offset:59400
v_mul_f32 v84, v249, v84
v_mfma_f32_16x16x32_bf16 v[4:7], v[212:215], a[124:127], v[4:7]
ds_read_b64_tr_b16 v[232:233], v241 offset:61448
v_mul_f32 v85, v249, v85
v_mfma_f32_16x16x32_bf16 v[4:7], v[216:219], a[136:139], v[4:7]
buffer_load_dwordx4 v246, s[16:19], s59 offen offset:3072 lds
v_mfma_f32_16x16x32_bf16 v[8:11], v[204:207], a[104:107], v[8:11]
s_add_u32 m0, s60, 114688
ds_read_b64_tr_b16 v[234:235], v241 offset:63496
v_mul_f32 v86, v249, v86
v_mfma_f32_16x16x32_bf16 v[8:11], v[208:211], a[116:119], v[8:11]
s_add_u32 s56, s49, s46
v_mul_f32 v87, v249, v87
v_cvt_pk_bf16_f32 v182, v84, v85
v_mfma_f32_16x16x32_bf16 v[8:11], v[212:215], a[128:131], v[8:11]
s_waitcnt lgkmcnt(4)
v_cvt_pk_bf16_f32 v183, v86, v87
v_mul_f32 v88, v250, v88
v_mfma_f32_16x16x32_bf16 v[8:11], v[216:219], a[140:143], v[8:11]
s_xor_b32 s56, s56, 128
ds_read_b64_tr_b16 v[204:205], v242 offset:49152
v_mul_f32 v89, v250, v89
v_mfma_f32_16x16x32_bf16 v[12:15], v[220:223], a[96:99], v[12:15]
s_add_u32 s57, s56, s50
ds_read_b64_tr_b16 v[206:207], v242 offset:51200
v_mul_f32 v90, v250, v90
v_mfma_f32_16x16x32_bf16 v[12:15], v[224:227], a[108:111], v[12:15]
s_waitcnt lgkmcnt(2)
buffer_load_dwordx4 v244, s[8:11], s47 offen offset:2048 nt lds
v_mfma_f32_16x16x32_bf16 v[12:15], v[228:231], a[120:123], v[12:15]
s_add_u32 m0, s60, 65536
ds_read_b64_tr_b16 v[208:209], v242 offset:53248
v_mul_f32 v91, v250, v91
v_mfma_f32_16x16x32_bf16 v[12:15], v[232:235], a[132:135], v[12:15]
s_add_u32 s58, s56, s51
ds_read_b64_tr_b16 v[210:211], v242 offset:55296
v_cvt_pk_bf16_f32 v186, v88, v89
v_mfma_f32_16x16x32_bf16 v[16:19], v[220:223], a[100:103], v[16:19]
s_add_u32 s59, s56, s52
ds_read_b64_tr_b16 v[212:213], v242 offset:57344
v_cvt_pk_bf16_f32 v187, v90, v91
v_mfma_f32_16x16x32_bf16 v[16:19], v[224:227], a[112:115], v[16:19]
ds_read_b64_tr_b16 v[214:215], v242 offset:59392
v_mul_f32 v92, v251, v92
v_mfma_f32_16x16x32_bf16 v[16:19], v[228:231], a[124:127], v[16:19]
ds_read_b64_tr_b16 v[216:217], v242 offset:61440
v_mul_f32 v93, v251, v93
v_mfma_f32_16x16x32_bf16 v[16:19], v[232:235], a[136:139], v[16:19]
ds_read_b64_tr_b16 v[218:219], v242 offset:63488
v_mul_f32 v94, v251, v94
v_mfma_f32_16x16x32_bf16 v[20:23], v[220:223], a[104:107], v[20:23]
buffer_load_dwordx4 v246, s[16:19], s56 offen offset:0 lds
v_mfma_f32_16x16x32_bf16 v[20:23], v[224:227], a[116:119], v[20:23]
v_add_u32 v241, 0xffffc000, v241
v_mul_f32 v95, v251, v95
v_mfma_f32_16x16x32_bf16 v[20:23], v[228:231], a[128:131], v[20:23]
s_waitcnt lgkmcnt(4)
v_cvt_pk_bf16_f32 v190, v92, v93
v_cvt_pk_bf16_f32 v191, v94, v95
v_mfma_f32_16x16x32_bf16 v[20:23], v[232:235], a[140:143], v[20:23]
ds_read_b64_tr_b16 v[220:221], v242 offset:49160
v_mfma_f32_16x16x32_bf16 v[24:27], v[204:207], a[96:99], v[24:27]
ds_read_b64_tr_b16 v[222:223], v242 offset:51208
v_mfma_f32_16x16x32_bf16 v[24:27], v[208:211], a[108:111], v[24:27]
s_waitcnt lgkmcnt(2)
ds_read_b64_tr_b16 v[224:225], v242 offset:53256
v_mfma_f32_16x16x32_bf16 v[24:27], v[212:215], a[120:123], v[24:27]
ds_read_b64_tr_b16 v[226:227], v242 offset:55304
v_mfma_f32_16x16x32_bf16 v[24:27], v[216:219], a[132:135], v[24:27]
buffer_load_dwordx4 v246, s[16:19], s57 offen offset:1024 lds
v_mfma_f32_16x16x32_bf16 v[28:31], v[204:207], a[100:103], v[28:31]
s_add_u32 m0, s60, 114688
ds_read_b64_tr_b16 v[228:229], v242 offset:57352
v_mfma_f32_16x16x32_bf16 v[28:31], v[208:211], a[112:115], v[28:31]
ds_read_b64_tr_b16 v[230:231], v242 offset:59400
v_mfma_f32_16x16x32_bf16 v[28:31], v[212:215], a[124:127], v[28:31]
ds_read_b64_tr_b16 v[232:233], v242 offset:61448
v_mfma_f32_16x16x32_bf16 v[28:31], v[216:219], a[136:139], v[28:31]
buffer_load_dwordx4 v244, s[8:11], s47 offen offset:3072 nt lds
v_mfma_f32_16x16x32_bf16 v[32:35], v[204:207], a[104:107], v[32:35]
s_add_u32 m0, s60, 65536
ds_read_b64_tr_b16 v[234:235], v242 offset:63496
v_mfma_f32_16x16x32_bf16 v[32:35], v[208:211], a[116:119], v[32:35]
s_add_u32 s47, s47, 0x4000
v_mfma_f32_16x16x32_bf16 v[32:35], v[212:215], a[128:131], v[32:35]
s_waitcnt lgkmcnt(4)
buffer_load_dwordx4 v246, s[16:19], s58 offen offset:2048 lds
v_mfma_f32_16x16x32_bf16 v[32:35], v[216:219], a[140:143], v[32:35]
v_mfma_f32_16x16x32_bf16 v[36:39], v[220:223], a[96:99], v[36:39]
s_waitcnt vmcnt(11) lgkmcnt(0)
v_mfma_f32_16x16x32_bf16 v[36:39], v[224:227], a[108:111], v[36:39]
s_barrier
ds_read_b64_tr_b16 v[204:205], v241 offset:0
v_mfma_f32_16x16x32_bf16 v[36:39], v[228:231], a[120:123], v[36:39]
ds_read_b64_tr_b16 v[206:207], v241 offset:2048
v_mfma_f32_16x16x32_bf16 v[36:39], v[232:235], a[132:135], v[36:39]
ds_read_b64_tr_b16 v[208:209], v241 offset:4096
v_mfma_f32_16x16x32_bf16 v[40:43], v[220:223], a[100:103], v[40:43]
ds_read_b64_tr_b16 v[210:211], v241 offset:6144
v_mfma_f32_16x16x32_bf16 v[40:43], v[224:227], a[112:115], v[40:43]
buffer_load_dwordx4 v246, s[16:19], s59 offen offset:3072 lds
v_mfma_f32_16x16x32_bf16 v[40:43], v[228:231], a[124:127], v[40:43]
s_add_u32 m0, s60, 16384
ds_read_b64_tr_b16 v[212:213], v241 offset:8192
v_mfma_f32_16x16x32_bf16 v[40:43], v[232:235], a[136:139], v[40:43]
ds_read_b64_tr_b16 v[214:215], v241 offset:10240
v_mfma_f32_16x16x32_bf16 v[44:47], v[220:223], a[104:107], v[44:47]
ds_read_b64_tr_b16 v[216:217], v241 offset:12288
v_mfma_f32_16x16x32_bf16 v[44:47], v[224:227], a[116:119], v[44:47]
ds_read_b64_tr_b16 v[218:219], v241 offset:14336
v_mfma_f32_16x16x32_bf16 v[44:47], v[228:231], a[128:131], v[44:47]
s_waitcnt lgkmcnt(4)
buffer_load_dwordx4 v245, s[12:15], s48 offen offset:0 nt lds
v_mfma_f32_16x16x32_bf16 v[44:47], v[232:235], a[140:143], v[44:47]
ds_read_b64_tr_b16 v[220:221], v241 offset:8
v_mfma_f32_16x16x32_bf16 v[48:51], v[204:207], a[0:3], 0
ds_read_b64_tr_b16 v[222:223], v241 offset:2056
v_mfma_f32_16x16x32_bf16 v[48:51], v[208:211], a[12:15], v[48:51]
s_waitcnt lgkmcnt(2)
ds_read_b64_tr_b16 v[224:225], v241 offset:4104
v_mfma_f32_16x16x32_bf16 v[48:51], v[212:215], a[24:27], v[48:51]
ds_read_b64_tr_b16 v[226:227], v241 offset:6152
v_mfma_f32_16x16x32_bf16 v[48:51], v[216:219], a[36:39], v[48:51]
ds_read_b64_tr_b16 v[228:229], v241 offset:8200
v_xor_b32 v242, 64, v241
v_mfma_f32_16x16x32_bf16 v[52:55], v[204:207], a[4:7], 0
ds_read_b64_tr_b16 v[230:231], v241 offset:10248
v_mfma_f32_16x16x32_bf16 v[52:55], v[208:211], a[16:19], v[52:55]
ds_read_b64_tr_b16 v[232:233], v241 offset:12296
v_mfma_f32_16x16x32_bf16 v[52:55], v[212:215], a[28:31], v[52:55]
s_add_u32 s56, s49, s44
ds_read_b64_tr_b16 v[234:235], v241 offset:14344
v_mfma_f32_16x16x32_bf16 v[52:55], v[216:219], a[40:43], v[52:55]
s_xor_b32 s56, s56, 128
v_mfma_f32_16x16x32_bf16 v[56:59], v[204:207], a[8:11], 0
s_add_u32 s57, s56, s50
v_mfma_f32_16x16x32_bf16 v[56:59], v[208:211], a[20:23], v[56:59]
s_add_u32 s58, s56, s51
v_mfma_f32_16x16x32_bf16 v[56:59], v[212:215], a[32:35], v[56:59]
s_waitcnt lgkmcnt(4)
v_mfma_f32_16x16x32_bf16 v[56:59], v[216:219], a[44:47], v[56:59]
s_add_u32 s59, s56, s52
ds_read_b64_tr_b16 v[204:205], v242 offset:0
v_mfma_f32_16x16x32_bf16 v[60:63], v[220:223], a[0:3], 0
ds_read_b64_tr_b16 v[206:207], v242 offset:2048
v_mfma_f32_16x16x32_bf16 v[60:63], v[224:227], a[12:15], v[60:63]
s_waitcnt lgkmcnt(2)
ds_read_b64_tr_b16 v[208:209], v242 offset:4096
v_mfma_f32_16x16x32_bf16 v[60:63], v[228:231], a[24:27], v[60:63]
ds_read_b64_tr_b16 v[210:211], v242 offset:6144
v_mfma_f32_16x16x32_bf16 v[60:63], v[232:235], a[36:39], v[60:63]
ds_read_b64_tr_b16 v[212:213], v242 offset:8192
v_mfma_f32_16x16x32_bf16 v[64:67], v[220:223], a[4:7], 0
ds_read_b64_tr_b16 v[214:215], v242 offset:10240
v_mfma_f32_16x16x32_bf16 v[64:67], v[224:227], a[16:19], v[64:67]
ds_read_b64_tr_b16 v[216:217], v242 offset:12288
v_mfma_f32_16x16x32_bf16 v[64:67], v[228:231], a[28:31], v[64:67]
buffer_load_dwordx4 v245, s[12:15], s48 offen offset:1024 nt lds
v_mfma_f32_16x16x32_bf16 v[64:67], v[232:235], a[40:43], v[64:67]
s_add_u32 m0, s60, 81920
ds_read_b64_tr_b16 v[218:219], v242 offset:14336
v_mfma_f32_16x16x32_bf16 v[68:71], v[220:223], a[8:11], 0
v_mfma_f32_16x16x32_bf16 v[68:71], v[224:227], a[20:23], v[68:71]
v_mfma_f32_16x16x32_bf16 v[68:71], v[228:231], a[32:35], v[68:71]
s_waitcnt lgkmcnt(4)
buffer_load_dwordx4 v246, s[16:19], s56 offen offset:0 lds
v_mfma_f32_16x16x32_bf16 v[68:71], v[232:235], a[44:47], v[68:71]
ds_read_b64_tr_b16 v[220:221], v242 offset:8
v_mfma_f32_16x16x32_bf16 v[72:75], v[204:207], a[0:3], 0
ds_read_b64_tr_b16 v[222:223], v242 offset:2056
v_mfma_f32_16x16x32_bf16 v[72:75], v[208:211], a[12:15], v[72:75]
s_waitcnt lgkmcnt(2)
ds_read_b64_tr_b16 v[224:225], v242 offset:4104
v_mfma_f32_16x16x32_bf16 v[72:75], v[212:215], a[24:27], v[72:75]
ds_read_b64_tr_b16 v[226:227], v242 offset:6152
v_mfma_f32_16x16x32_bf16 v[72:75], v[216:219], a[36:39], v[72:75]
ds_read_b64_tr_b16 v[228:229], v242 offset:8200
v_mfma_f32_16x16x32_bf16 v[76:79], v[204:207], a[4:7], 0
buffer_load_dwordx4 v246, s[16:19], s57 offen offset:1024 lds
v_mfma_f32_16x16x32_bf16 v[76:79], v[208:211], a[16:19], v[76:79]
ds_read_b64_tr_b16 v[230:231], v242 offset:10248
v_mfma_f32_16x16x32_bf16 v[76:79], v[212:215], a[28:31], v[76:79]
ds_read_b64_tr_b16 v[232:233], v242 offset:12296
v_mfma_f32_16x16x32_bf16 v[76:79], v[216:219], a[40:43], v[76:79]
ds_read_b64_tr_b16 v[234:235], v242 offset:14344
v_mfma_f32_16x16x32_bf16 v[80:83], v[204:207], a[8:11], 0
buffer_load_dwordx4 v246, s[16:19], s58 offen offset:2048 lds
v_mfma_f32_16x16x32_bf16 v[80:83], v[208:211], a[20:23], v[80:83]
s_add_u32 m0, s60, 16384
v_mfma_f32_16x16x32_bf16 v[80:83], v[212:215], a[32:35], v[80:83]
s_waitcnt lgkmcnt(4)
v_mfma_f32_16x16x32_bf16 v[80:83], v[216:219], a[44:47], v[80:83]
v_mfma_f32_16x16x32_bf16 v[84:87], v[220:223], a[0:3], 0
s_waitcnt vmcnt(11) lgkmcnt(0)
buffer_load_dwordx4 v245, s[12:15], s48 offen offset:2048 nt lds
v_mfma_f32_16x16x32_bf16 v[84:87], v[224:227], a[12:15], v[84:87]
s_barrier
ds_read_b64_tr_b16 v[204:205], v241 offset:16384
v_mfma_f32_16x16x32_bf16 v[84:87], v[228:231], a[24:27], v[84:87]
s_add_u32 m0, s60, 81920
ds_read_b64_tr_b16 v[206:207], v241 offset:18432
v_mfma_f32_16x16x32_bf16 v[84:87], v[232:235], a[36:39], v[84:87]
ds_read_b64_tr_b16 v[208:209], v241 offset:20480
v_mfma_f32_16x16x32_bf16 v[88:91], v[220:223], a[4:7], 0
ds_read_b64_tr_b16 v[210:211], v241 offset:22528
v_mfma_f32_16x16x32_bf16 v[88:91], v[224:227], a[16:19], v[88:91]
ds_read_b64_tr_b16 v[212:213], v241 offset:24576
v_mfma_f32_16x16x32_bf16 v[88:91], v[228:231], a[28:31], v[88:91]
buffer_load_dwordx4 v246, s[16:19], s59 offen offset:3072 lds
v_mfma_f32_16x16x32_bf16 v[88:91], v[232:235], a[40:43], v[88:91]
s_add_u32 m0, s60, 32768
ds_read_b64_tr_b16 v[214:215], v241 offset:26624
v_mfma_f32_16x16x32_bf16 v[92:95], v[220:223], a[8:11], 0
s_add_u32 s56, s49, s45
ds_read_b64_tr_b16 v[216:217], v241 offset:28672
v_mfma_f32_16x16x32_bf16 v[92:95], v[224:227], a[20:23], v[92:95]
s_xor_b32 s56, s56, 128
ds_read_b64_tr_b16 v[218:219], v241 offset:30720
v_mfma_f32_16x16x32_bf16 v[92:95], v[228:231], a[32:35], v[92:95]
s_waitcnt lgkmcnt(4)
buffer_load_dwordx4 v246, s[16:19], s56 offen offset:0 lds
v_mfma_f32_16x16x32_bf16 v[92:95], v[232:235], a[44:47], v[92:95]
s_add_u32 s57, s56, s50
ds_read_b64_tr_b16 v[220:221], v241 offset:16392
v_mfma_f32_16x16x32_bf16 v[0:3], v[204:207], v[96:99], v[0:3]
s_add_u32 s58, s56, s51
ds_read_b64_tr_b16 v[222:223], v241 offset:18440
v_mfma_f32_16x16x32_bf16 v[0:3], v[208:211], v[108:111], v[0:3]
s_waitcnt lgkmcnt(2)
ds_read_b64_tr_b16 v[224:225], v241 offset:20488
v_mfma_f32_16x16x32_bf16 v[0:3], v[212:215], v[120:123], v[0:3]
s_add_u32 s59, s56, s52
ds_read_b64_tr_b16 v[226:227], v241 offset:22536
v_mfma_f32_16x16x32_bf16 v[0:3], v[216:219], v[132:135], v[0:3]
ds_read_b64_tr_b16 v[228:229], v241 offset:24584
v_xor_b32 v242, 64, v241
v_mfma_f32_16x16x32_bf16 v[4:7], v[204:207], v[100:103], v[4:7]
buffer_load_dwordx4 v246, s[16:19], s57 offen offset:1024 lds
v_mfma_f32_16x16x32_bf16 v[4:7], v[208:211], v[112:115], v[4:7]
s_add_u32 m0, s60, 16384
ds_read_b64_tr_b16 v[230:231], v241 offset:26632
v_mfma_f32_16x16x32_bf16 v[4:7], v[212:215], v[124:127], v[4:7]
ds_read_b64_tr_b16 v[232:233], v241 offset:28680
v_mfma_f32_16x16x32_bf16 v[4:7], v[216:219], v[136:139], v[4:7]
ds_read_b64_tr_b16 v[234:235], v241 offset:30728
v_mfma_f32_16x16x32_bf16 v[8:11], v[204:207], v[104:107], v[8:11]
buffer_load_dwordx4 v245, s[12:15], s48 offen offset:3072 nt lds
v_mfma_f32_16x16x32_bf16 v[8:11], v[208:211], v[116:119], v[8:11]
s_add_u32 m0, s60, 32768
v_mfma_f32_16x16x32_bf16 v[8:11], v[212:215], v[128:131], v[8:11]
s_waitcnt lgkmcnt(4)
v_mfma_f32_16x16x32_bf16 v[8:11], v[216:219], v[140:143], v[8:11]
s_add_u32 s48, s48, 0x4000
ds_read_b64_tr_b16 v[204:205], v242 offset:16384
v_mfma_f32_16x16x32_bf16 v[12:15], v[220:223], v[96:99], v[12:15]
buffer_load_dwordx4 v246, s[16:19], s58 offen offset:2048 lds
v_mfma_f32_16x16x32_bf16 v[12:15], v[224:227], v[108:111], v[12:15]
s_waitcnt lgkmcnt(1)
ds_read_b64_tr_b16 v[206:207], v242 offset:18432
v_mfma_f32_16x16x32_bf16 v[12:15], v[228:231], v[120:123], v[12:15]
ds_read_b64_tr_b16 v[208:209], v242 offset:20480
v_mfma_f32_16x16x32_bf16 v[12:15], v[232:235], v[132:135], v[12:15]
ds_read_b64_tr_b16 v[210:211], v242 offset:22528
v_mfma_f32_16x16x32_bf16 v[16:19], v[220:223], v[100:103], v[16:19]
ds_read_b64_tr_b16 v[212:213], v242 offset:24576
v_mfma_f32_16x16x32_bf16 v[16:19], v[224:227], v[112:115], v[16:19]
ds_read_b64_tr_b16 v[214:215], v242 offset:26624
v_mfma_f32_16x16x32_bf16 v[16:19], v[228:231], v[124:127], v[16:19]
ds_read_b64_tr_b16 v[216:217], v242 offset:28672
v_mfma_f32_16x16x32_bf16 v[16:19], v[232:235], v[136:139], v[16:19]
buffer_load_dwordx4 v246, s[16:19], s59 offen offset:3072 lds
v_mfma_f32_16x16x32_bf16 v[20:23], v[220:223], v[104:107], v[20:23]
s_add_u32 m0, s60, 98304
ds_read_b64_tr_b16 v[218:219], v242 offset:30720
v_mfma_f32_16x16x32_bf16 v[20:23], v[224:227], v[116:119], v[20:23]
v_mfma_f32_16x16x32_bf16 v[20:23], v[228:231], v[128:131], v[20:23]
s_waitcnt lgkmcnt(4)
v_mfma_f32_16x16x32_bf16 v[20:23], v[232:235], v[140:143], v[20:23]
ds_read_b64_tr_b16 v[220:221], v242 offset:16392
v_mfma_f32_16x16x32_bf16 v[24:27], v[204:207], v[96:99], v[24:27]
ds_read_b64_tr_b16 v[222:223], v242 offset:18440
v_mfma_f32_16x16x32_bf16 v[24:27], v[208:211], v[108:111], v[24:27]
s_waitcnt lgkmcnt(2)
ds_read_b64_tr_b16 v[224:225], v242 offset:20488
v_mfma_f32_16x16x32_bf16 v[24:27], v[212:215], v[120:123], v[24:27]
ds_read_b64_tr_b16 v[226:227], v242 offset:22536
v_mfma_f32_16x16x32_bf16 v[24:27], v[216:219], v[132:135], v[24:27]
ds_read_b64_tr_b16 v[228:229], v242 offset:24584
v_mfma_f32_16x16x32_bf16 v[28:31], v[204:207], v[100:103], v[28:31]
buffer_load_dwordx4 v244, s[8:11], s47 offen offset:0 nt lds
v_mfma_f32_16x16x32_bf16 v[28:31], v[208:211], v[112:115], v[28:31]
ds_read_b64_tr_b16 v[230:231], v242 offset:26632
v_mfma_f32_16x16x32_bf16 v[28:31], v[212:215], v[124:127], v[28:31]
ds_read_b64_tr_b16 v[232:233], v242 offset:28680
v_mfma_f32_16x16x32_bf16 v[28:31], v[216:219], v[136:139], v[28:31]
ds_read_b64_tr_b16 v[234:235], v242 offset:30728
v_mfma_f32_16x16x32_bf16 v[32:35], v[204:207], v[104:107], v[32:35]
v_mfma_f32_16x16x32_bf16 v[32:35], v[208:211], v[116:119], v[32:35]
v_mfma_f32_16x16x32_bf16 v[32:35], v[212:215], v[128:131], v[32:35]
s_waitcnt lgkmcnt(4)
v_mfma_f32_16x16x32_bf16 v[32:35], v[216:219], v[140:143], v[32:35]
v_mfma_f32_16x16x32_bf16 v[36:39], v[220:223], v[96:99], v[36:39]
s_waitcnt vmcnt(13) lgkmcnt(0)
v_mfma_f32_16x16x32_bf16 v[36:39], v[224:227], v[108:111], v[36:39]
s_barrier
ds_read_b64_tr_b16 v[204:205], v241 offset:32768
v_mfma_f32_16x16x32_bf16 v[36:39], v[228:231], v[120:123], v[36:39]
ds_read_b64_tr_b16 v[206:207], v241 offset:34816
v_mfma_f32_16x16x32_bf16 v[36:39], v[232:235], v[132:135], v[36:39]
ds_read_b64_tr_b16 v[208:209], v241 offset:36864
v_mfma_f32_16x16x32_bf16 v[40:43], v[220:223], v[100:103], v[40:43]
ds_read_b64_tr_b16 v[210:211], v241 offset:38912
v_mfma_f32_16x16x32_bf16 v[40:43], v[224:227], v[112:115], v[40:43]
ds_read_b64_tr_b16 v[212:213], v241 offset:40960
v_mfma_f32_16x16x32_bf16 v[40:43], v[228:231], v[124:127], v[40:43]
ds_read_b64_tr_b16 v[214:215], v241 offset:43008
v_mfma_f32_16x16x32_bf16 v[40:43], v[232:235], v[136:139], v[40:43]
ds_read_b64_tr_b16 v[216:217], v241 offset:45056
v_mfma_f32_16x16x32_bf16 v[44:47], v[220:223], v[104:107], v[44:47]
ds_read_b64_tr_b16 v[218:219], v241 offset:47104
v_mfma_f32_16x16x32_bf16 v[44:47], v[224:227], v[116:119], v[44:47]
v_mfma_f32_16x16x32_bf16 v[44:47], v[228:231], v[128:131], v[44:47]
v_mfma_f32_16x16x32_bf16 v[44:47], v[232:235], v[140:143], v[44:47]
s_cmp_eq_u32 s61, 2
s_cbranch_scc1 L_v2
s_cmp_eq_u32 s61, 3
s_cbranch_scc1 L_v3
s_waitcnt lgkmcnt(4)
v_mfma_f32_16x16x32_bf16 v[48:51], v[204:207], v[96:99], v[48:51]
s_add_u32 m0, s60, 98304
ds_read_b64_tr_b16 v[220:221], v241 offset:32776
v_accvgpr_write_b32 a144, v144
v_mfma_f32_16x16x32_bf16 v[48:51], v[208:211], v[108:111], v[48:51]
s_waitcnt lgkmcnt(1)
ds_read_b64_tr_b16 v[222:223], v241 offset:34824
v_accvgpr_write_b32 a145, v145
v_mfma_f32_16x16x32_bf16 v[48:51], v[212:215], v[120:123], v[48:51]
s_add_u32 s49, s49, 256
ds_read_b64_tr_b16 v[224:225], v241 offset:36872
v_accvgpr_write_b32 a146, v146
v_mfma_f32_16x16x32_bf16 v[48:51], v[216:219], v[132:135], v[48:51]
s_and_b32 s49, s49, 0x3ff
ds_read_b64_tr_b16 v[226:227], v241 offset:38920
v_xor_b32 v242, 64, v241
v_mfma_f32_16x16x32_bf16 v[52:55], v[204:207], v[100:103], v[52:55]
s_add_u32 s86, s49, s43
ds_read_b64_tr_b16 v[228:229], v241 offset:40968
v_accvgpr_write_b32 a147, v147
v_mfma_f32_16x16x32_bf16 v[52:55], v[208:211], v[112:115], v[52:55]
s_add_u32 s90, s49, s44
buffer_load_dwordx4 v244, s[8:11], s47 offen offset:1024 nt lds
v_mfma_f32_16x16x32_bf16 v[52:55], v[212:215], v[124:127], v[52:55]
s_add_u32 s91, s49, s45
ds_read_b64_tr_b16 v[230:231], v241 offset:43016
v_accvgpr_write_b32 a148, v148
v_mfma_f32_16x16x32_bf16 v[52:55], v[216:219], v[136:139], v[52:55]
ds_read_b64_tr_b16 v[232:233], v241 offset:45064
v_accvgpr_write_b32 a149, v149
v_mfma_f32_16x16x32_bf16 v[56:59], v[204:207], v[104:107], v[56:59]
ds_read_b64_tr_b16 v[234:235], v241 offset:47112
v_accvgpr_write_b32 a150, v150
v_mfma_f32_16x16x32_bf16 v[56:59], v[208:211], v[116:119], v[56:59]
v_accvgpr_write_b32 a151, v151
v_accvgpr_write_b32 a152, v152
v_mfma_f32_16x16x32_bf16 v[56:59], v[212:215], v[128:131], v[56:59]
s_waitcnt lgkmcnt(4)
v_accvgpr_write_b32 a153, v153
v_accvgpr_write_b32 a154, v154
v_mfma_f32_16x16x32_bf16 v[56:59], v[216:219], v[140:143], v[56:59]
ds_read_b64_tr_b16 v[204:205], v242 offset:32768
v_accvgpr_write_b32 a155, v155
v_mfma_f32_16x16x32_bf16 v[60:63], v[220:223], v[96:99], v[60:63]
ds_read_b64_tr_b16 v[206:207], v242 offset:34816
v_accvgpr_write_b32 a156, v156
v_mfma_f32_16x16x32_bf16 v[60:63], v[224:227], v[108:111], v[60:63]
s_waitcnt lgkmcnt(2)
ds_read_b64_tr_b16 v[208:209], v242 offset:36864
v_accvgpr_write_b32 a157, v157
v_mfma_f32_16x16x32_bf16 v[60:63], v[228:231], v[120:123], v[60:63]
ds_read_b64_tr_b16 v[210:211], v242 offset:38912
v_accvgpr_write_b32 a158, v158
v_mfma_f32_16x16x32_bf16 v[60:63], v[232:235], v[132:135], v[60:63]
ds_read_b64_tr_b16 v[212:213], v242 offset:40960
v_accvgpr_write_b32 a159, v159
v_mfma_f32_16x16x32_bf16 v[64:67], v[220:223], v[100:103], v[64:67]
ds_read_b64_tr_b16 v[214:215], v242 offset:43008
v_accvgpr_write_b32 a160, v160
v_mfma_f32_16x16x32_bf16 v[64:67], v[224:227], v[112:115], v[64:67]
ds_read_b64_tr_b16 v[216:217], v242 offset:45056
v_accvgpr_write_b32 a161, v161
v_mfma_f32_16x16x32_bf16 v[64:67], v[228:231], v[124:127], v[64:67]
buffer_load_dwordx4 v244, s[8:11], s47 offen offset:2048 nt lds
v_mfma_f32_16x16x32_bf16 v[64:67], v[232:235], v[136:139], v[64:67]
ds_read_b64_tr_b16 v[218:219], v242 offset:47104
v_accvgpr_write_b32 a162, v162
v_mfma_f32_16x16x32_bf16 v[68:71], v[220:223], v[104:107], v[68:71]
v_accvgpr_write_b32 a163, v163
v_accvgpr_write_b32 a164, v164
v_mfma_f32_16x16x32_bf16 v[68:71], v[224:227], v[116:119], v[68:71]
v_accvgpr_write_b32 a165, v165
v_accvgpr_write_b32 a166, v166
v_mfma_f32_16x16x32_bf16 v[68:71], v[228:231], v[128:131], v[68:71]
s_waitcnt lgkmcnt(4)
v_accvgpr_write_b32 a167, v167
v_accvgpr_write_b32 a168, v168
v_mfma_f32_16x16x32_bf16 v[68:71], v[232:235], v[140:143], v[68:71]
ds_read_b64_tr_b16 v[220:221], v242 offset:32776
v_accvgpr_write_b32 a169, v169
v_mfma_f32_16x16x32_bf16 v[72:75], v[204:207], v[96:99], v[72:75]
ds_read_b64_tr_b16 v[222:223], v242 offset:34824
v_accvgpr_write_b32 a170, v170
v_mfma_f32_16x16x32_bf16 v[72:75], v[208:211], v[108:111], v[72:75]
s_waitcnt lgkmcnt(2)
ds_read_b64_tr_b16 v[224:225], v242 offset:36872
v_accvgpr_write_b32 a171, v171
v_mfma_f32_16x16x32_bf16 v[72:75], v[212:215], v[120:123], v[72:75]
ds_read_b64_tr_b16 v[226:227], v242 offset:38920
v_accvgpr_write_b32 a172, v172
v_mfma_f32_16x16x32_bf16 v[72:75], v[216:219], v[132:135], v[72:75]
ds_read_b64_tr_b16 v[228:229], v242 offset:40968
v_accvgpr_write_b32 a173, v173
v_mfma_f32_16x16x32_bf16 v[76:79], v[204:207], v[100:103], v[76:79]
ds_read_b64_tr_b16 v[230:231], v242 offset:43016
v_accvgpr_write_b32 a174, v174
v_mfma_f32_16x16x32_bf16 v[76:79], v[208:211], v[112:115], v[76:79]
ds_read_b64_tr_b16 v[232:233], v242 offset:45064
v_accvgpr_write_b32 a175, v175
v_mfma_f32_16x16x32_bf16 v[76:79], v[212:215], v[124:127], v[76:79]
ds_read_b64_tr_b16 v[234:235], v242 offset:47112
v_accvgpr_write_b32 a176, v176
v_mfma_f32_16x16x32_bf16 v[76:79], v[216:219], v[136:139], v[76:79]
v_accvgpr_write_b32 a177, v177
v_accvgpr_write_b32 a178, v178
v_mfma_f32_16x16x32_bf16 v[80:83], v[204:207], v[104:107], v[80:83]
v_accvgpr_write_b32 a179, v179
v_accvgpr_write_b32 a180, v180
v_mfma_f32_16x16x32_bf16 v[80:83], v[208:211], v[116:119], v[80:83]
buffer_load_dwordx4 v244, s[8:11], s47 offen offset:3072 nt lds
v_mfma_f32_16x16x32_bf16 v[80:83], v[212:215], v[128:131], v[80:83]
s_waitcnt lgkmcnt(4)
v_accvgpr_write_b32 a181, v181
v_accvgpr_write_b32 a182, v182
v_mfma_f32_16x16x32_bf16 v[80:83], v[216:219], v[140:143], v[80:83]
s_add_u32 s47, s47, 0x4000
v_accvgpr_write_b32 a183, v183
v_accvgpr_write_b32 a184, v184
v_mfma_f32_16x16x32_bf16 v[84:87], v[220:223], v[96:99], v[84:87]
s_waitcnt vmcnt(9) lgkmcnt(0)
v_accvgpr_write_b32 a185, v185
v_accvgpr_write_b32 a186, v186
v_mfma_f32_16x16x32_bf16 v[84:87], v[224:227], v[108:111], v[84:87]
s_barrier
ds_read_b64_tr_b16 v[204:205], v241 offset:49152
v_accvgpr_write_b32 a187, v187
v_mfma_f32_16x16x32_bf16 v[84:87], v[228:231], v[120:123], v[84:87]
ds_read_b64_tr_b16 v[206:207], v241 offset:51200
v_accvgpr_write_b32 a188, v188
v_mfma_f32_16x16x32_bf16 v[84:87], v[232:235], v[132:135], v[84:87]
ds_read_b64_tr_b16 v[208:209], v241 offset:53248
v_accvgpr_write_b32 a189, v189
v_mfma_f32_16x16x32_bf16 v[88:91], v[220:223], v[100:103], v[88:91]
ds_read_b64_tr_b16 v[210:211], v241 offset:55296
v_accvgpr_write_b32 a190, v190
v_mfma_f32_16x16x32_bf16 v[88:91], v[224:227], v[112:115], v[88:91]
ds_read_b64_tr_b16 v[212:213], v241 offset:57344
v_accvgpr_write_b32 a191, v191
v_mfma_f32_16x16x32_bf16 v[88:91], v[228:231], v[124:127], v[88:91]
ds_read_b64_tr_b16 v[214:215], v241 offset:59392
v_mfma_f32_16x16x32_bf16 v[88:91], v[232:235], v[136:139], v[88:91]
ds_read_b64_tr_b16 v[216:217], v241 offset:61440
v_mfma_f32_16x16x32_bf16 v[92:95], v[220:223], v[104:107], v[92:95]
ds_read_b64_tr_b16 v[218:219], v241 offset:63488
v_mfma_f32_16x16x32_bf16 v[92:95], v[224:227], v[116:119], v[92:95]
v_mfma_f32_16x16x32_bf16 v[92:95], v[228:231], v[128:131], v[92:95]
v_mfma_f32_16x16x32_bf16 v[92:95], v[232:235], v[140:143], v[92:95]
s_branch L_R2
L_v2:
s_waitcnt lgkmcnt(4)
v_mfma_f32_16x16x32_bf16 v[48:51], v[204:207], v[96:99], v[48:51]
s_add_u32 m0, s60, 98304
ds_read_b64_tr_b16 v[220:221], v241 offset:32776
v_accvgpr_write_b32 a192, v144
v_mfma_f32_16x16x32_bf16 v[48:51], v[208:211], v[108:111], v[48:51]
s_waitcnt lgkmcnt(1)
ds_read_b64_tr_b16 v[222:223], v241 offset:34824
v_accvgpr_write_b32 a193, v145
v_mfma_f32_16x16x32_bf16 v[48:51], v[212:215], v[120:123], v[48:51]
s_add_u32 s49, s49, 256
ds_read_b64_tr_b16 v[224:225], v241 offset:36872
v_accvgpr_write_b32 a194, v146
v_mfma_f32_16x16x32_bf16 v[48:51], v[216:219], v[132:135], v[48:51]
s_and_b32 s49, s49, 0x3ff
ds_read_b64_tr_b16 v[226:227], v241 offset:38920
v_xor_b32 v242, 64, v241
v_mfma_f32_16x16x32_bf16 v[52:55], v[204:207], v[100:103], v[52:55]
s_add_u32 s86, s49, s43
ds_read_b64_tr_b16 v[228:229], v241 offset:40968
v_accvgpr_write_b32 a195, v147
v_mfma_f32_16x16x32_bf16 v[52:55], v[208:211], v[112:115], v[52:55]
s_add_u32 s90, s49, s44
buffer_load_dwordx4 v244, s[8:11], s47 offen offset:1024 nt lds
v_mfma_f32_16x16x32_bf16 v[52:55], v[212:215], v[124:127], v[52:55]
s_add_u32 s91, s49, s45
ds_read_b64_tr_b16 v[230:231], v241 offset:43016
v_accvgpr_write_b32 a196, v148
v_mfma_f32_16x16x32_bf16 v[52:55], v[216:219], v[136:139], v[52:55]
s_lshl_b32 s100, s64, 2
ds_read_b64_tr_b16 v[232:233], v241 offset:45064
v_accvgpr_write_b32 a197, v149
v_mfma_f32_16x16x32_bf16 v[56:59], v[204:207], v[104:107], v[56:59]
ds_read_b64_tr_b16 v[234:235], v241 offset:47112
v_accvgpr_write_b32 a198, v150
v_mfma_f32_16x16x32_bf16 v[56:59], v[208:211], v[116:119], v[56:59]
v_accvgpr_write_b32 a199, v151
v_accvgpr_write_b32 a200, v152
v_mfma_f32_16x16x32_bf16 v[56:59], v[212:215], v[128:131], v[56:59]
s_waitcnt lgkmcnt(4)
v_accvgpr_write_b32 a201, v153
v_accvgpr_write_b32 a202, v154
v_mfma_f32_16x16x32_bf16 v[56:59], v[216:219], v[140:143], v[56:59]
ds_read_b64_tr_b16 v[204:205], v242 offset:32768
v_accvgpr_write_b32 a203, v155
v_mfma_f32_16x16x32_bf16 v[60:63], v[220:223], v[96:99], v[60:63]
ds_read_b64_tr_b16 v[206:207], v242 offset:34816
v_accvgpr_write_b32 a204, v156
v_mfma_f32_16x16x32_bf16 v[60:63], v[224:227], v[108:111], v[60:63]
s_waitcnt lgkmcnt(2)
ds_read_b64_tr_b16 v[208:209], v242 offset:36864
v_accvgpr_write_b32 a205, v157
v_mfma_f32_16x16x32_bf16 v[60:63], v[228:231], v[120:123], v[60:63]
ds_read_b64_tr_b16 v[210:211], v242 offset:38912
v_accvgpr_write_b32 a206, v158
v_mfma_f32_16x16x32_bf16 v[60:63], v[232:235], v[132:135], v[60:63]
ds_read_b64_tr_b16 v[212:213], v242 offset:40960
v_accvgpr_write_b32 a207, v159
v_mfma_f32_16x16x32_bf16 v[64:67], v[220:223], v[100:103], v[64:67]
ds_read_b64_tr_b16 v[214:215], v242 offset:43008
v_accvgpr_write_b32 a208, v160
v_mfma_f32_16x16x32_bf16 v[64:67], v[224:227], v[112:115], v[64:67]
ds_read_b64_tr_b16 v[216:217], v242 offset:45056
v_accvgpr_write_b32 a209, v161
v_mfma_f32_16x16x32_bf16 v[64:67], v[228:231], v[124:127], v[64:67]
buffer_load_dwordx4 v244, s[8:11], s47 offen offset:2048 nt lds
v_mfma_f32_16x16x32_bf16 v[64:67], v[232:235], v[136:139], v[64:67]
ds_read_b64_tr_b16 v[218:219], v242 offset:47104
v_accvgpr_write_b32 a210, v162
v_mfma_f32_16x16x32_bf16 v[68:71], v[220:223], v[104:107], v[68:71]
v_accvgpr_write_b32 a211, v163
v_accvgpr_write_b32 a212, v164
v_mfma_f32_16x16x32_bf16 v[68:71], v[224:227], v[116:119], v[68:71]
v_accvgpr_write_b32 a213, v165
v_accvgpr_write_b32 a214, v166
v_mfma_f32_16x16x32_bf16 v[68:71], v[228:231], v[128:131], v[68:71]
s_waitcnt lgkmcnt(4)
v_accvgpr_write_b32 a215, v167
v_accvgpr_write_b32 a216, v168
v_mfma_f32_16x16x32_bf16 v[68:71], v[232:235], v[140:143], v[68:71]
ds_read_b64_tr_b16 v[220:221], v242 offset:32776
v_accvgpr_write_b32 a217, v169
v_mfma_f32_16x16x32_bf16 v[72:75], v[204:207], v[96:99], v[72:75]
ds_read_b64_tr_b16 v[222:223], v242 offset:34824
v_accvgpr_write_b32 a218, v170
v_mfma_f32_16x16x32_bf16 v[72:75], v[208:211], v[108:111], v[72:75]
s_waitcnt lgkmcnt(2)
ds_read_b64_tr_b16 v[224:225], v242 offset:36872
v_accvgpr_write_b32 a219, v171
v_mfma_f32_16x16x32_bf16 v[72:75], v[212:215], v[120:123], v[72:75]
ds_read_b64_tr_b16 v[226:227], v242 offset:38920
v_accvgpr_write_b32 a220, v172
v_mfma_f32_16x16x32_bf16 v[72:75], v[216:219], v[132:135], v[72:75]
ds_read_b64_tr_b16 v[228:229], v242 offset:40968
v_accvgpr_write_b32 a221, v173
v_mfma_f32_16x16x32_bf16 v[76:79], v[204:207], v[100:103], v[76:79]
ds_read_b64_tr_b16 v[230:231], v242 offset:43016
v_accvgpr_write_b32 a222, v174
v_mfma_f32_16x16x32_bf16 v[76:79], v[208:211], v[112:115], v[76:79]
ds_read_b64_tr_b16 v[232:233], v242 offset:45064
v_accvgpr_write_b32 a223, v175
v_mfma_f32_16x16x32_bf16 v[76:79], v[212:215], v[124:127], v[76:79]
ds_read_b64_tr_b16 v[234:235], v242 offset:47112
v_accvgpr_write_b32 a224, v176
v_mfma_f32_16x16x32_bf16 v[76:79], v[216:219], v[136:139], v[76:79]
v_accvgpr_write_b32 a225, v177
v_accvgpr_write_b32 a226, v178
v_mfma_f32_16x16x32_bf16 v[80:83], v[204:207], v[104:107], v[80:83]
v_accvgpr_write_b32 a227, v179
v_accvgpr_write_b32 a228, v180
v_mfma_f32_16x16x32_bf16 v[80:83], v[208:211], v[116:119], v[80:83]
buffer_load_dwordx4 v244, s[8:11], s47 offen offset:3072 nt lds
v_mfma_f32_16x16x32_bf16 v[80:83], v[212:215], v[128:131], v[80:83]
s_waitcnt lgkmcnt(4)
v_accvgpr_write_b32 a229, v181
v_accvgpr_write_b32 a230, v182
v_mfma_f32_16x16x32_bf16 v[80:83], v[216:219], v[140:143], v[80:83]
s_add_u32 s47, s47, 0x4000
v_accvgpr_write_b32 a231, v183
v_accvgpr_write_b32 a232, v184
v_mfma_f32_16x16x32_bf16 v[84:87], v[220:223], v[96:99], v[84:87]
s_waitcnt vmcnt(9) lgkmcnt(0)
v_accvgpr_write_b32 a233, v185
v_accvgpr_write_b32 a234, v186
v_mfma_f32_16x16x32_bf16 v[84:87], v[224:227], v[108:111], v[84:87]
s_barrier
ds_read_b64_tr_b16 v[204:205], v241 offset:49152
v_accvgpr_write_b32 a235, v187
v_mfma_f32_16x16x32_bf16 v[84:87], v[228:231], v[120:123], v[84:87]
ds_read_b64_tr_b16 v[206:207], v241 offset:51200
v_accvgpr_write_b32 a236, v188
v_mfma_f32_16x16x32_bf16 v[84:87], v[232:235], v[132:135], v[84:87]
ds_read_b64_tr_b16 v[208:209], v241 offset:53248
v_accvgpr_write_b32 a237, v189
v_mfma_f32_16x16x32_bf16 v[88:91], v[220:223], v[100:103], v[88:91]
ds_read_b64_tr_b16 v[210:211], v241 offset:55296
v_accvgpr_write_b32 a238, v190
v_mfma_f32_16x16x32_bf16 v[88:91], v[224:227], v[112:115], v[88:91]
ds_read_b64_tr_b16 v[212:213], v241 offset:57344
v_accvgpr_write_b32 a239, v191
v_mfma_f32_16x16x32_bf16 v[88:91], v[228:231], v[124:127], v[88:91]
ds_read_b64_tr_b16 v[214:215], v241 offset:59392
v_mfma_f32_16x16x32_bf16 v[88:91], v[232:235], v[136:139], v[88:91]
ds_read_b64_tr_b16 v[216:217], v241 offset:61440
v_mfma_f32_16x16x32_bf16 v[92:95], v[220:223], v[104:107], v[92:95]
buffer_load_dword v252, off, s[32:35], s100 sc1
v_mfma_f32_16x16x32_bf16 v[92:95], v[224:227], v[116:119], v[92:95]
ds_read_b64_tr_b16 v[218:219], v241 offset:63488
v_mfma_f32_16x16x32_bf16 v[92:95], v[228:231], v[128:131], v[92:95]
v_mfma_f32_16x16x32_bf16 v[92:95], v[232:235], v[140:143], v[92:95]
s_branch L_R2
L_v3:
s_waitcnt lgkmcnt(4)
v_mfma_f32_16x16x32_bf16 v[48:51], v[204:207], v[96:99], v[48:51]
s_add_u32 m0, s60, 98304
ds_read_b64_tr_b16 v[220:221], v241 offset:32776
v_accvgpr_write_b32 a0, v144
v_mfma_f32_16x16x32_bf16 v[48:51], v[208:211], v[108:111], v[48:51]
s_waitcnt lgkmcnt(1)
ds_read_b64_tr_b16 v[222:223], v241 offset:34824
v_accvgpr_write_b32 a1, v145
v_mfma_f32_16x16x32_bf16 v[48:51], v[212:215], v[120:123], v[48:51]
s_mov_b32 s16, s80
ds_read_b64_tr_b16 v[224:225], v241 offset:36872
v_accvgpr_write_b32 a2, v146
v_mfma_f32_16x16x32_bf16 v[48:51], v[216:219], v[132:135], v[48:51]
s_mov_b32 s17, s81
ds_read_b64_tr_b16 v[226:227], v241 offset:38920
v_xor_b32 v242, 64, v241
v_mfma_f32_16x16x32_bf16 v[52:55], v[204:207], v[100:103], v[52:55]
s_mov_b32 s18, 0x80000
ds_read_b64_tr_b16 v[228:229], v241 offset:40968
v_accvgpr_write_b32 a3, v147
v_mfma_f32_16x16x32_bf16 v[52:55], v[208:211], v[112:115], v[52:55]
s_mov_b32 s20, s80
buffer_load_dwordx4 v244, s[8:11], s47 offen offset:1024 nt lds
v_mfma_f32_16x16x32_bf16 v[52:55], v[212:215], v[124:127], v[52:55]
s_mov_b32 s21, s81
ds_read_b64_tr_b16 v[230:231], v241 offset:43016
v_accvgpr_write_b32 a4, v148
v_mfma_f32_16x16x32_bf16 v[52:55], v[216:219], v[136:139], v[52:55]
s_mov_b32 s22, 0x80000
ds_read_b64_tr_b16 v[232:233], v241 offset:45064
v_accvgpr_write_b32 a5, v149
v_mfma_f32_16x16x32_bf16 v[56:59], v[204:207], v[104:107], v[56:59]
s_mov_b32 s74, 1
ds_read_b64_tr_b16 v[234:235], v241 offset:47112
v_accvgpr_write_b32 a6, v150
v_mfma_f32_16x16x32_bf16 v[56:59], v[208:211], v[116:119], v[56:59]
s_mov_b32 s50, 7168
v_accvgpr_write_b32 a7, v151
v_accvgpr_write_b32 a8, v152
v_mfma_f32_16x16x32_bf16 v[56:59], v[212:215], v[128:131], v[56:59]
s_waitcnt lgkmcnt(4)
v_accvgpr_write_b32 a9, v153
v_accvgpr_write_b32 a10, v154
v_mfma_f32_16x16x32_bf16 v[56:59], v[216:219], v[140:143], v[56:59]
s_mov_b32 s53, 7168
ds_read_b64_tr_b16 v[204:205], v242 offset:32768
v_accvgpr_write_b32 a11, v155
v_mfma_f32_16x16x32_bf16 v[60:63], v[220:223], v[96:99], v[60:63]
s_mov_b32 s51, 14336
ds_read_b64_tr_b16 v[206:207], v242 offset:34816
v_accvgpr_write_b32 a12, v156
v_mfma_f32_16x16x32_bf16 v[60:63], v[224:227], v[108:111], v[60:63]
s_waitcnt lgkmcnt(2)
ds_read_b64_tr_b16 v[208:209], v242 offset:36864
v_accvgpr_write_b32 a13, v157
v_mfma_f32_16x16x32_bf16 v[60:63], v[228:231], v[120:123], v[60:63]
s_mov_b32 s54, 14336
ds_read_b64_tr_b16 v[210:211], v242 offset:38912
v_accvgpr_write_b32 a14, v158
v_mfma_f32_16x16x32_bf16 v[60:63], v[232:235], v[132:135], v[60:63]
s_mov_b32 s52, 21504
ds_read_b64_tr_b16 v[212:213], v242 offset:40960
v_accvgpr_write_b32 a15, v159
v_mfma_f32_16x16x32_bf16 v[64:67], v[220:223], v[100:103], v[64:67]
s_mov_b32 s55, 21504
ds_read_b64_tr_b16 v[214:215], v242 offset:43008
v_accvgpr_write_b32 a16, v160
v_mfma_f32_16x16x32_bf16 v[64:67], v[224:227], v[112:115], v[64:67]
s_add_u32 s86, s38, s93
ds_read_b64_tr_b16 v[216:217], v242 offset:45056
v_accvgpr_write_b32 a17, v161
v_mfma_f32_16x16x32_bf16 v[64:67], v[228:231], v[124:127], v[64:67]
s_add_u32 s87, s38, s95
buffer_load_dwordx4 v244, s[8:11], s47 offen offset:2048 nt lds
v_mfma_f32_16x16x32_bf16 v[64:67], v[232:235], v[136:139], v[64:67]
s_add_u32 s88, s38, s96
ds_read_b64_tr_b16 v[218:219], v242 offset:47104
v_accvgpr_write_b32 a18, v162
v_mfma_f32_16x16x32_bf16 v[68:71], v[220:223], v[104:107], v[68:71]
s_add_u32 s89, s38, s97
v_accvgpr_write_b32 a19, v163
v_accvgpr_write_b32 a20, v164
v_mfma_f32_16x16x32_bf16 v[68:71], v[224:227], v[116:119], v[68:71]
s_add_u32 s90, s40, s93
v_accvgpr_write_b32 a21, v165
v_accvgpr_write_b32 a22, v166
v_mfma_f32_16x16x32_bf16 v[68:71], v[228:231], v[128:131], v[68:71]
s_waitcnt lgkmcnt(4)
v_accvgpr_write_b32 a23, v167
v_accvgpr_write_b32 a24, v168
v_mfma_f32_16x16x32_bf16 v[68:71], v[232:235], v[140:143], v[68:71]
s_add_u32 s91, s40, s95
ds_read_b64_tr_b16 v[220:221], v242 offset:32776
v_accvgpr_write_b32 a25, v169
v_mfma_f32_16x16x32_bf16 v[72:75], v[204:207], v[96:99], v[72:75]
ds_read_b64_tr_b16 v[222:223], v242 offset:34824
v_accvgpr_write_b32 a26, v170
v_mfma_f32_16x16x32_bf16 v[72:75], v[208:211], v[108:111], v[72:75]
s_waitcnt lgkmcnt(2)
ds_read_b64_tr_b16 v[224:225], v242 offset:36872
v_accvgpr_write_b32 a27, v171
v_mfma_f32_16x16x32_bf16 v[72:75], v[212:215], v[120:123], v[72:75]
ds_read_b64_tr_b16 v[226:227], v242 offset:38920
v_accvgpr_write_b32 a28, v172
v_mfma_f32_16x16x32_bf16 v[72:75], v[216:219], v[132:135], v[72:75]
ds_read_b64_tr_b16 v[228:229], v242 offset:40968
v_accvgpr_write_b32 a29, v173
v_mfma_f32_16x16x32_bf16 v[76:79], v[204:207], v[100:103], v[76:79]
ds_read_b64_tr_b16 v[230:231], v242 offset:43016
v_accvgpr_write_b32 a30, v174
v_mfma_f32_16x16x32_bf16 v[76:79], v[208:211], v[112:115], v[76:79]
ds_read_b64_tr_b16 v[232:233], v242 offset:45064
v_accvgpr_write_b32 a31, v175
v_mfma_f32_16x16x32_bf16 v[76:79], v[212:215], v[124:127], v[76:79]
ds_read_b64_tr_b16 v[234:235], v242 offset:47112
v_accvgpr_write_b32 a32, v176
v_mfma_f32_16x16x32_bf16 v[76:79], v[216:219], v[136:139], v[76:79]
v_accvgpr_write_b32 a33, v177
v_accvgpr_write_b32 a34, v178
v_mfma_f32_16x16x32_bf16 v[80:83], v[204:207], v[104:107], v[80:83]
v_accvgpr_write_b32 a35, v179
v_accvgpr_write_b32 a36, v180
v_mfma_f32_16x16x32_bf16 v[80:83], v[208:211], v[116:119], v[80:83]
buffer_load_dwordx4 v244, s[8:11], s47 offen offset:3072 nt lds
v_mfma_f32_16x16x32_bf16 v[80:83], v[212:215], v[128:131], v[80:83]
s_waitcnt lgkmcnt(4)
v_accvgpr_write_b32 a37, v181
v_accvgpr_write_b32 a38, v182
v_mfma_f32_16x16x32_bf16 v[80:83], v[216:219], v[140:143], v[80:83]
s_add_u32 s47, s47, 0x4000
v_accvgpr_write_b32 a39, v183
v_accvgpr_write_b32 a40, v184
v_mfma_f32_16x16x32_bf16 v[84:87], v[220:223], v[96:99], v[84:87]
s_waitcnt vmcnt(9) lgkmcnt(0)
v_accvgpr_write_b32 a41, v185
v_accvgpr_write_b32 a42, v186
v_mfma_f32_16x16x32_bf16 v[84:87], v[224:227], v[108:111], v[84:87]
s_barrier
ds_read_b64_tr_b16 v[204:205], v241 offset:49152
v_accvgpr_write_b32 a43, v187
v_mfma_f32_16x16x32_bf16 v[84:87], v[228:231], v[120:123], v[84:87]
ds_read_b64_tr_b16 v[206:207], v241 offset:51200
v_accvgpr_write_b32 a44, v188
v_mfma_f32_16x16x32_bf16 v[84:87], v[232:235], v[132:135], v[84:87]
ds_read_b64_tr_b16 v[208:209], v241 offset:53248
v_accvgpr_write_b32 a45, v189
v_mfma_f32_16x16x32_bf16 v[88:91], v[220:223], v[100:103], v[88:91]
ds_read_b64_tr_b16 v[210:211], v241 offset:55296
v_accvgpr_write_b32 a46, v190
v_mfma_f32_16x16x32_bf16 v[88:91], v[224:227], v[112:115], v[88:91]
ds_read_b64_tr_b16 v[212:213], v241 offset:57344
v_accvgpr_write_b32 a47, v191
v_mfma_f32_16x16x32_bf16 v[88:91], v[228:231], v[124:127], v[88:91]
ds_read_b64_tr_b16 v[214:215], v241 offset:59392
v_mov_b32 v246, v253
v_mfma_f32_16x16x32_bf16 v[88:91], v[232:235], v[136:139], v[88:91]
ds_read_b64_tr_b16 v[216:217], v241 offset:61440
v_mov_b32 v247, v253
v_mfma_f32_16x16x32_bf16 v[92:95], v[220:223], v[104:107], v[92:95]
ds_read_b64_tr_b16 v[218:219], v241 offset:63488
v_mfma_f32_16x16x32_bf16 v[92:95], v[224:227], v[116:119], v[92:95]
v_mfma_f32_16x16x32_bf16 v[92:95], v[228:231], v[128:131], v[92:95]
v_mfma_f32_16x16x32_bf16 v[92:95], v[232:235], v[140:143], v[92:95]
s_waitcnt vmcnt(63)
s_mov_b32 s3, 0
L_chkD:
v_readfirstlane_b32 s4, v252
s_nop 3
s_lshr_b32 s5, s4, 4
s_and_b32 s5, s5, 0x0f0f0f0f
s_and_b32 s7, s4, 0x0f0f0f0f
s_add_u32 s5, s5, s7
s_mul_i32 s5, s5, 0x01010101
s_lshr_b32 s5, s5, 24
s_cmp_lg_u32 s5, 8
s_cbranch_scc1 L_spinD
L_backD:
s_lshl_b32 s5, s37, 3
s_cmp_eq_u32 s4, s5
s_cselect_b32 s72, 1, 7
s_getpc_b64 s[76:77]
L_pc2:
s_add_u32 s76, s76, L_g3-L_pc2
s_addc_u32 s77, s77, 0
s_mov_b32 s78, L_codeend-L_g3
s_mov_b32 s79, 0x20000
s_lshl_b32 s5, s99, 2
s_add_u32 s5, s5, s63
s_and_b32 s5, s5, 15
s_lshl_b32 s5, s5, 13
v_mbcnt_lo_u32_b32 v254, -1, 0
v_mbcnt_hi_u32_b32 v254, -1, v254
v_lshlrev_b32 v254, 7, v254
buffer_load_dword v255, v254, s[76:79], s5 offen
s_cmp_eq_u32 s72, 1
s_cselect_b32 s4, 256, 0x40000000
v_lshlrev_b32 v254, 1, v254
v_and_b32 v254, 0x700, v254
s_add_u32 s4, s4, s70
buffer_load_dword v255, v254, s[24:27], s4 offen sc1
L_R2:
s_waitcnt lgkmcnt(4)
v_mfma_f32_16x16x32_bf16 v[48:51], v[204:207], a[48:51], v[48:51]
s_add_u32 m0, s60, 49152
ds_read_b64_tr_b16 v[220:221], v241 offset:49160
v_mul_f32 v0, s62, v0
v_mfma_f32_16x16x32_bf16 v[48:51], v[208:211], a[60:63], v[48:51]
s_waitcnt lgkmcnt(1)
ds_read_b64_tr_b16 v[222:223], v241 offset:51208
v_mul_f32 v1, s62, v1
v_mfma_f32_16x16x32_bf16 v[48:51], v[212:215], a[72:75], v[48:51]
ds_read_b64_tr_b16 v[224:225], v241 offset:53256
v_mul_f32 v2, s62, v2
v_mfma_f32_16x16x32_bf16 v[48:51], v[216:219], a[84:87], v[48:51]
ds_read_b64_tr_b16 v[226:227], v241 offset:55304
v_xor_b32 v242, 64, v241
v_mfma_f32_16x16x32_bf16 v[52:55], v[204:207], a[52:55], v[52:55]
ds_read_b64_tr_b16 v[228:229], v241 offset:57352
v_mul_f32 v3, s62, v3
v_mfma_f32_16x16x32_bf16 v[52:55], v[208:211], a[64:67], v[52:55]
ds_read_b64_tr_b16 v[230:231], v241 offset:59400
v_cvt_pk_bf16_f32 v96, v0, v1
v_mfma_f32_16x16x32_bf16 v[52:55], v[212:215], a[76:79], v[52:55]
ds_read_b64_tr_b16 v[232:233], v241 offset:61448
v_cvt_pk_bf16_f32 v97, v2, v3
v_mfma_f32_16x16x32_bf16 v[52:55], v[216:219], a[88:91], v[52:55]
buffer_load_dwordx4 v245, s[12:15], s48 offen offset:0 nt lds
v_mfma_f32_16x16x32_bf16 v[56:59], v[204:207], a[56:59], v[56:59]
ds_read_b64_tr_b16 v[234:235], v241 offset:63496
v_mul_f32 v12, s62, v12
v_mfma_f32_16x16x32_bf16 v[56:59], v[208:211], a[68:71], v[56:59]
v_mul_f32 v13, s62, v13
v_mul_f32 v14, s62, v14
v_mfma_f32_16x16x32_bf16 v[56:59], v[212:215], a[80:83], v[56:59]
s_waitcnt lgkmcnt(4)
v_mul_f32 v15, s62, v15
v_cvt_pk_bf16_f32 v98, v12, v13
v_mfma_f32_16x16x32_bf16 v[56:59], v[216:219], a[92:95], v[56:59]
ds_read_b64_tr_b16 v[204:205], v242 offset:49152
v_cvt_pk_bf16_f32 v99, v14, v15
v_mfma_f32_16x16x32_bf16 v[60:63], v[220:223], a[48:51], v[60:63]
ds_read_b64_tr_b16 v[206:207], v242 offset:51200
v_mul_f32 v4, s62, v4
v_mfma_f32_16x16x32_bf16 v[60:63], v[224:227], a[60:63], v[60:63]
s_waitcnt lgkmcnt(2)
ds_read_b64_tr_b16 v[208:209], v242 offset:53248
v_mul_f32 v5, s62, v5
v_mfma_f32_16x16x32_bf16 v[60:63], v[228:231], a[72:75], v[60:63]
ds_read_b64_tr_b16 v[210:211], v242 offset:55296
v_mul_f32 v6, s62, v6
v_mfma_f32_16x16x32_bf16 v[60:63], v[232:235], a[84:87], v[60:63]
ds_read_b64_tr_b16 v[212:213], v242 offset:57344
v_mul_f32 v7, s62, v7
v_mfma_f32_16x16x32_bf16 v[64:67], v[220:223], a[52:55], v[64:67]
ds_read_b64_tr_b16 v[214:215], v242 offset:59392
v_cvt_pk_bf16_f32 v100, v4, v5
v_mfma_f32_16x16x32_bf16 v[64:67], v[224:227], a[64:67], v[64:67]
ds_read_b64_tr_b16 v[216:217], v242 offset:61440
v_cvt_pk_bf16_f32 v101, v6, v7
v_mfma_f32_16x16x32_bf16 v[64:67], v[228:231], a[76:79], v[64:67]
ds_read_b64_tr_b16 v[218:219], v242 offset:63488
v_mul_f32 v16, s62, v16
v_mfma_f32_16x16x32_bf16 v[64:67], v[232:235], a[88:91], v[64:67]
v_mul_f32 v17, s62, v17
v_mul_f32 v18, s62, v18
v_mfma_f32_16x16x32_bf16 v[68:71], v[220:223], a[56:59], v[68:71]
v_mul_f32 v19, s62, v19
v_cvt_pk_bf16_f32 v102, v16, v17
v_mfma_f32_16x16x32_bf16 v[68:71], v[224:227], a[68:71], v[68:71]
v_cvt_pk_bf16_f32 v103, v18, v19
v_add_u32 v241, 0xffff8000, v241
v_mfma_f32_16x16x32_bf16 v[68:71], v[228:231], a[80:83], v[68:71]
s_waitcnt lgkmcnt(4)
v_mul_f32 v8, s62, v8
v_mul_f32 v9, s62, v9
v_mfma_f32_16x16x32_bf16 v[68:71], v[232:235], a[92:95], v[68:71]
ds_read_b64_tr_b16 v[220:221], v242 offset:49160
v_mul_f32 v10, s62, v10
v_mfma_f32_16x16x32_bf16 v[72:75], v[204:207], a[48:51], v[72:75]
ds_read_b64_tr_b16 v[222:223], v242 offset:51208
v_mul_f32 v11, s62, v11
v_mfma_f32_16x16x32_bf16 v[72:75], v[208:211], a[60:63], v[72:75]
s_waitcnt lgkmcnt(2)
ds_read_b64_tr_b16 v[224:225], v242 offset:53256
v_cvt_pk_bf16_f32 v104, v8, v9
v_mfma_f32_16x16x32_bf16 v[72:75], v[212:215], a[72:75], v[72:75]
ds_read_b64_tr_b16 v[226:227], v242 offset:55304
v_cvt_pk_bf16_f32 v105, v10, v11
v_mfma_f32_16x16x32_bf16 v[72:75], v[216:219], a[84:87], v[72:75]
buffer_load_dwordx4 v245, s[12:15], s48 offen offset:1024 nt lds
v_mfma_f32_16x16x32_bf16 v[76:79], v[204:207], a[52:55], v[76:79]
ds_read_b64_tr_b16 v[228:229], v242 offset:57352
v_mul_f32 v20, s62, v20
v_mfma_f32_16x16x32_bf16 v[76:79], v[208:211], a[64:67], v[76:79]
ds_read_b64_tr_b16 v[230:231], v242 offset:59400
v_mul_f32 v21, s62, v21
v_mfma_f32_16x16x32_bf16 v[76:79], v[212:215], a[76:79], v[76:79]
ds_read_b64_tr_b16 v[232:233], v242 offset:61448
v_mul_f32 v22, s62, v22
v_mfma_f32_16x16x32_bf16 v[76:79], v[216:219], a[88:91], v[76:79]
ds_read_b64_tr_b16 v[234:235], v242 offset:63496
v_mul_f32 v23, s62, v23
v_mfma_f32_16x16x32_bf16 v[80:83], v[204:207], a[56:59], v[80:83]
v_cvt_pk_bf16_f32 v106, v20, v21
v_cvt_pk_bf16_f32 v107, v22, v23
v_mfma_f32_16x16x32_bf16 v[80:83], v[208:211], a[68:71], v[80:83]
v_mul_f32 v24, s62, v24
v_mul_f32 v25, s62, v25
v_mfma_f32_16x16x32_bf16 v[80:83], v[212:215], a[80:83], v[80:83]
s_waitcnt lgkmcnt(4)
v_mul_f32 v26, s62, v26
v_mul_f32 v27, s62, v27
v_mfma_f32_16x16x32_bf16 v[80:83], v[216:219], a[92:95], v[80:83]
v_cvt_pk_bf16_f32 v108, v24, v25
v_cvt_pk_bf16_f32 v109, v26, v27
v_mfma_f32_16x16x32_bf16 v[84:87], v[220:223], a[48:51], v[84:87]
s_waitcnt vmcnt(6) lgkmcnt(0)
v_mul_f32 v36, s62, v36
v_mul_f32 v37, s62, v37
v_mfma_f32_16x16x32_bf16 v[84:87], v[224:227], a[60:63], v[84:87]
s_barrier
ds_read_b64_tr_b16 v[204:205], v241 offset:32768
v_mul_f32 v38, s62, v38
v_mfma_f32_16x16x32_bf16 v[84:87], v[228:231], a[72:75], v[84:87]
ds_read_b64_tr_b16 v[206:207], v241 offset:34816
v_mul_f32 v39, s62, v39
v_mfma_f32_16x16x32_bf16 v[84:87], v[232:235], a[84:87], v[84:87]
ds_read_b64_tr_b16 v[208:209], v241 offset:36864
v_cvt_pk_bf16_f32 v110, v36, v37
v_mfma_f32_16x16x32_bf16 v[88:91], v[220:223], a[52:55], v[88:91]
ds_read_b64_tr_b16 v[210:211], v241 offset:38912
v_cvt_pk_bf16_f32 v111, v38, v39
v_mfma_f32_16x16x32_bf16 v[88:91], v[224:227], a[64:67], v[88:91]
ds_read_b64_tr_b16 v[212:213], v241 offset:40960
v_mul_f32 v28, s62, v28
v_mfma_f32_16x16x32_bf16 v[88:91], v[228:231], a[76:79], v[88:91]
ds_read_b64_tr_b16 v[214:215], v241 offset:43008
v_mul_f32 v29, s62, v29
v_mfma_f32_16x16x32_bf16 v[88:91], v[232:235], a[88:91], v[88:91]
ds_read_b64_tr_b16 v[216:217], v241 offset:45056
v_mul_f32 v30, s62, v30
v_mfma_f32_16x16x32_bf16 v[92:95], v[220:223], a[56:59], v[92:95]
ds_read_b64_tr_b16 v[218:219], v241 offset:47104
v_mul_f32 v31, s62, v31
v_mfma_f32_16x16x32_bf16 v[92:95], v[224:227], a[68:71], v[92:95]
buffer_load_dwordx4 v245, s[12:15], s48 offen offset:2048 nt lds
v_mfma_f32_16x16x32_bf16 v[92:95], v[228:231], a[80:83], v[92:95]
s_waitcnt lgkmcnt(4)
v_cvt_pk_bf16_f32 v112, v28, v29
v_cvt_pk_bf16_f32 v113, v30, v31
v_mfma_f32_16x16x32_bf16 v[92:95], v[232:235], a[92:95], v[92:95]
ds_read_b64_tr_b16 v[220:221], v241 offset:32776
v_mul_f32 v40, s62, v40
v_mfma_f32_16x16x32_bf16 v[48:51], v[204:207], a[96:99], v[48:51]
ds_read_b64_tr_b16 v[222:223], v241 offset:34824
v_mul_f32 v41, s62, v41
v_mfma_f32_16x16x32_bf16 v[48:51], v[208:211], a[108:111], v[48:51]
s_waitcnt lgkmcnt(2)
ds_read_b64_tr_b16 v[224:225], v241 offset:36872
v_mul_f32 v42, s62, v42
v_mfma_f32_16x16x32_bf16 v[48:51], v[212:215], a[120:123], v[48:51]
ds_read_b64_tr_b16 v[226:227], v241 offset:38920
v_mul_f32 v43, s62, v43
v_mfma_f32_16x16x32_bf16 v[48:51], v[216:219], a[132:135], v[48:51]
ds_read_b64_tr_b16 v[228:229], v241 offset:40968
v_cvt_pk_bf16_f32 v114, v40, v41
v_mfma_f32_16x16x32_bf16 v[52:55], v[204:207], a[100:103], v[52:55]
ds_read_b64_tr_b16 v[230:231], v241 offset:43016
v_cvt_pk_bf16_f32 v115, v42, v43
v_mfma_f32_16x16x32_bf16 v[52:55], v[208:211], a[112:115], v[52:55]
ds_read_b64_tr_b16 v[232:233], v241 offset:45064
v_xor_b32 v242, 64, v241
v_mfma_f32_16x16x32_bf16 v[52:55], v[212:215], a[124:127], v[52:55]
ds_read_b64_tr_b16 v[234:235], v241 offset:47112
v_mul_f32 v32, s62, v32
v_mfma_f32_16x16x32_bf16 v[52:55], v[216:219], a[136:139], v[52:55]
v_mul_f32 v33, s62, v33
v_mul_f32 v34, s62, v34
v_mfma_f32_16x16x32_bf16 v[56:59], v[204:207], a[104:107], v[56:59]
v_mul_f32 v35, s62, v35
v_cvt_pk_bf16_f32 v116, v32, v33
v_mfma_f32_16x16x32_bf16 v[56:59], v[208:211], a[116:119], v[56:59]
v_cvt_pk_bf16_f32 v117, v34, v35
v_mul_f32 v44, s62, v44
v_mfma_f32_16x16x32_bf16 v[56:59], v[212:215], a[128:131], v[56:59]
s_waitcnt lgkmcnt(4)
v_mul_f32 v45, s62, v45
v_mul_f32 v46, s62, v46
v_mfma_f32_16x16x32_bf16 v[56:59], v[216:219], a[140:143], v[56:59]
ds_read_b64_tr_b16 v[204:205], v242 offset:32768
v_mul_f32 v47, s62, v47
v_mfma_f32_16x16x32_bf16 v[60:63], v[220:223], a[96:99], v[60:63]
ds_read_b64_tr_b16 v[206:207], v242 offset:34816
v_cvt_pk_bf16_f32 v118, v44, v45
v_mfma_f32_16x16x32_bf16 v[60:63], v[224:227], a[108:111], v[60:63]
s_waitcnt lgkmcnt(2)
ds_read_b64_tr_b16 v[208:209], v242 offset:36864
v_cvt_pk_bf16_f32 v119, v46, v47
v_mfma_f32_16x16x32_bf16 v[60:63], v[228:231], a[120:123], v[60:63]
ds_read_b64_tr_b16 v[210:211], v242 offset:38912
v_mul_f32 v48, s62, v48
v_mfma_f32_16x16x32_bf16 v[60:63], v[232:235], a[132:135], v[60:63]
buffer_load_dwordx4 v245, s[12:15], s48 offen offset:3072 nt lds
v_mfma_f32_16x16x32_bf16 v[64:67], v[220:223], a[100:103], v[64:67]
s_add_u32 s48, s48, 0x4000
ds_read_b64_tr_b16 v[212:213], v242 offset:40960
v_mul_f32 v49, s62, v49
v_mfma_f32_16x16x32_bf16 v[64:67], v[224:227], a[112:115], v[64:67]
ds_read_b64_tr_b16 v[214:215], v242 offset:43008
v_mul_f32 v50, s62, v50
v_mfma_f32_16x16x32_bf16 v[64:67], v[228:231], a[124:127], v[64:67]
ds_read_b64_tr_b16 v[216:217], v242 offset:45056
v_mul_f32 v51, s62, v51
v_mfma_f32_16x16x32_bf16 v[64:67], v[232:235], a[136:139], v[64:67]
ds_read_b64_tr_b16 v[218:219], v242 offset:47104
v_cvt_pk_bf16_f32 v120, v48, v49
v_mfma_f32_16x16x32_bf16 v[68:71], v[220:223], a[104:107], v[68:71]
v_cvt_pk_bf16_f32 v121, v50, v51
v_mul_f32 v60, s62, v60
v_mfma_f32_16x16x32_bf16 v[68:71], v[224:227], a[116:119], v[68:71]
v_mul_f32 v61, s62, v61
v_mul_f32 v62, s62, v62
v_mfma_f32_16x16x32_bf16 v[68:71], v[228:231], a[128:131], v[68:71]
s_waitcnt lgkmcnt(4)
v_mul_f32 v63, s62, v63
v_cvt_pk_bf16_f32 v122, v60, v61
v_mfma_f32_16x16x32_bf16 v[68:71], v[232:235], a[140:143], v[68:71]
ds_read_b64_tr_b16 v[220:221], v242 offset:32776
v_cvt_pk_bf16_f32 v123, v62, v63
v_mfma_f32_16x16x32_bf16 v[72:75], v[204:207], a[96:99], v[72:75]
ds_read_b64_tr_b16 v[222:223], v242 offset:34824
v_mul_f32 v52, s62, v52
v_mfma_f32_16x16x32_bf16 v[72:75], v[208:211], a[108:111], v[72:75]
s_waitcnt lgkmcnt(2)
ds_read_b64_tr_b16 v[224:225], v242 offset:36872
v_mul_f32 v53, s62, v53
v_mfma_f32_16x16x32_bf16 v[72:75], v[212:215], a[120:123], v[72:75]
s_add_u32 m0, s60, 65536
ds_read_b64_tr_b16 v[226:227], v242 offset:38920
v_mul_f32 v54, s62, v54
v_mfma_f32_16x16x32_bf16 v[72:75], v[216:219], a[132:135], v[72:75]
ds_read_b64_tr_b16 v[228:229], v242 offset:40968
v_mul_f32 v55, s62, v55
v_mfma_f32_16x16x32_bf16 v[76:79], v[204:207], a[100:103], v[76:79]
ds_read_b64_tr_b16 v[230:231], v242 offset:43016
v_cvt_pk_bf16_f32 v124, v52, v53
v_mfma_f32_16x16x32_bf16 v[76:79], v[208:211], a[112:115], v[76:79]
ds_read_b64_tr_b16 v[232:233], v242 offset:45064
v_cvt_pk_bf16_f32 v125, v54, v55
v_mfma_f32_16x16x32_bf16 v[76:79], v[212:215], a[124:127], v[76:79]
ds_read_b64_tr_b16 v[234:235], v242 offset:47112
v_mul_f32 v72, s62, v72
v_mfma_f32_16x16x32_bf16 v[76:79], v[216:219], a[136:139], v[76:79]
buffer_load_dwordx4 v244, s[8:11], s47 offen offset:0 nt lds
v_mfma_f32_16x16x32_bf16 v[80:83], v[204:207], a[104:107], v[80:83]
v_mul_f32 v73, s62, v73
v_mul_f32 v74, s62, v74
v_mfma_f32_16x16x32_bf16 v[80:83], v[208:211], a[116:119], v[80:83]
v_mul_f32 v75, s62, v75
v_cvt_pk_bf16_f32 v132, v72, v73
v_mfma_f32_16x16x32_bf16 v[80:83], v[212:215], a[128:131], v[80:83]
s_waitcnt lgkmcnt(4)
v_cvt_pk_bf16_f32 v133, v74, v75
v_mul_f32 v64, s62, v64
v_mfma_f32_16x16x32_bf16 v[80:83], v[216:219], a[140:143], v[80:83]
v_mul_f32 v65, s62, v65
v_mul_f32 v66, s62, v66
v_mfma_f32_16x16x32_bf16 v[84:87], v[220:223], a[96:99], v[84:87]
s_waitcnt vmcnt(26) lgkmcnt(0)
v_mul_f32 v67, s62, v67
v_cvt_pk_bf16_f32 v126, v64, v65
v_mfma_f32_16x16x32_bf16 v[84:87], v[224:227], a[108:111], v[84:87]
s_barrier
ds_read_b128 v[204:207], v236 offset:49152
v_cvt_pk_bf16_f32 v127, v66, v67
v_mfma_f32_16x16x32_bf16 v[84:87], v[228:231], a[120:123], v[84:87]
ds_read_b128 v[208:211], v237 offset:49152
v_mul_f32 v76, s62, v76
v_mfma_f32_16x16x32_bf16 v[84:87], v[232:235], a[132:135], v[84:87]
ds_read_b128 v[212:215], v238 offset:49152
v_mul_f32 v77, s62, v77
v_mfma_f32_16x16x32_bf16 v[88:91], v[220:223], a[100:103], v[88:91]
ds_read_b128 v[216:219], v239 offset:49152
v_mul_f32 v78, s62, v78
v_mfma_f32_16x16x32_bf16 v[88:91], v[224:227], a[112:115], v[88:91]
v_mul_f32 v79, s62, v79
v_cvt_pk_bf16_f32 v136, v76, v77
v_mfma_f32_16x16x32_bf16 v[88:91], v[228:231], a[124:127], v[88:91]
v_mul_f32 v84, s62, v84
v_mul_f32 v85, s62, v85
v_mfma_f32_16x16x32_bf16 v[88:91], v[232:235], a[136:139], v[88:91]
v_mul_f32 v86, s62, v86
v_mul_f32 v87, s62, v87
v_mfma_f32_16x16x32_bf16 v[92:95], v[220:223], a[104:107], v[92:95]
v_cvt_pk_bf16_f32 v134, v84, v85
v_cvt_pk_bf16_f32 v135, v86, v87
v_mfma_f32_16x16x32_bf16 v[92:95], v[224:227], a[116:119], v[92:95]
v_cvt_pk_bf16_f32 v137, v78, v79
v_mul_f32 v56, s62, v56
v_mfma_f32_16x16x32_bf16 v[92:95], v[228:231], a[128:131], v[92:95]
s_waitcnt lgkmcnt(2)
v_mul_f32 v88, s62, v88
v_mul_f32 v89, s62, v89
v_mfma_f32_16x16x32_bf16 v[92:95], v[232:235], a[140:143], v[92:95]
ds_read_b128 v[220:223], v236 offset:50176
v_mul_f32 v90, s62, v90
v_mfma_f32_16x16x32_bf16 v[0:3], v[204:207], v[96:99], 0
v_mul_f32 v91, s62, v91
v_cvt_pk_bf16_f32 v138, v88, v89
v_mfma_f32_16x16x32_bf16 v[0:3], v[208:211], v[108:111], v[0:3]
s_waitcnt lgkmcnt(1)
ds_read_b128 v[224:227], v237 offset:50176
v_cvt_pk_bf16_f32 v139, v90, v91
v_mfma_f32_16x16x32_bf16 v[0:3], v[212:215], v[120:123], v[0:3]
buffer_load_dwordx4 v244, s[8:11], s47 offen offset:1024 nt lds
v_mfma_f32_16x16x32_bf16 v[0:3], v[216:219], v[132:135], v[0:3]
ds_read_b128 v[228:231], v238 offset:50176
v_mul_f32 v57, s62, v57
v_mfma_f32_16x16x32_bf16 v[4:7], v[204:207], v[100:103], 0
v_mul_f32 v58, s62, v58
v_mul_f32 v59, s62, v59
v_mfma_f32_16x16x32_bf16 v[4:7], v[208:211], v[112:115], v[4:7]
v_cvt_pk_bf16_f32 v128, v56, v57
v_cvt_pk_bf16_f32 v129, v58, v59
v_mfma_f32_16x16x32_bf16 v[4:7], v[212:215], v[124:127], v[4:7]
v_mul_f32 v68, s62, v68
v_mul_f32 v69, s62, v69
v_mfma_f32_16x16x32_bf16 v[4:7], v[216:219], v[136:139], v[4:7]
v_mul_f32 v70, s62, v70
v_mul_f32 v71, s62, v71
v_cvt_pk_bf16_f32 v130, v68, v69
v_cvt_pk_bf16_f32 v131, v70, v71
v_mfma_f32_16x16x32_bf16 v[8:11], v[204:207], v[104:107], 0
ds_read_b128 v[232:235], v239 offset:50176
v_mul_f32 v80, s62, v80
v_mul_f32 v81, s62, v81
v_mul_f32 v82, s62, v82
v_mul_f32 v83, s62, v83
v_cvt_pk_bf16_f32 v140, v80, v81
v_cvt_pk_bf16_f32 v141, v82, v83
v_mul_f32 v92, s62, v92
v_mul_f32 v93, s62, v93
v_mul_f32 v94, s62, v94
v_mul_f32 v95, s62, v95
v_cvt_pk_bf16_f32 v142, v92, v93
v_cvt_pk_bf16_f32 v143, v94, v95
v_mfma_f32_16x16x32_bf16 v[8:11], v[208:211], v[116:119], v[8:11]
v_exp_f32 v0, v0
v_mfma_f32_16x16x32_bf16 v[8:11], v[212:215], v[128:131], v[8:11]
s_waitcnt lgkmcnt(2)
v_exp_f32 v1, v1
v_mfma_f32_16x16x32_bf16 v[8:11], v[216:219], v[140:143], v[8:11]
ds_read_b128 v[204:207], v236 offset:51200
v_cvt_pk_bf16_f32 v144, v0, v1
v_mfma_f32_16x16x32_bf16 v[12:15], v[220:223], v[96:99], 0
v_exp_f32 v2, v2
v_mfma_f32_16x16x32_bf16 v[12:15], v[224:227], v[108:111], v[12:15]
s_waitcnt lgkmcnt(1)
ds_read_b128 v[208:211], v237 offset:51200
v_mad_i32_i24 v241, v248, s74, v241
v_mfma_f32_16x16x32_bf16 v[12:15], v[228:231], v[120:123], v[12:15]
v_exp_f32 v3, v3
v_mfma_f32_16x16x32_bf16 v[12:15], v[232:235], v[132:135], v[12:15]
ds_read_b128 v[212:215], v238 offset:51200
v_cvt_pk_bf16_f32 v145, v2, v3
v_mfma_f32_16x16x32_bf16 v[16:19], v[220:223], v[100:103], 0
v_exp_f32 v4, v4
v_mfma_f32_16x16x32_bf16 v[16:19], v[224:227], v[112:115], v[16:19]
v_exp_f32 v5, v5
v_mfma_f32_16x16x32_bf16 v[16:19], v[228:231], v[124:127], v[16:19]
ds_read_b128 v[216:219], v239 offset:51200
v_cvt_pk_bf16_f32 v148, v4, v5
v_mfma_f32_16x16x32_bf16 v[16:19], v[232:235], v[136:139], v[16:19]
v_exp_f32 v12, v12
v_mfma_f32_16x16x32_bf16 v[20:23], v[220:223], v[104:107], 0
v_exp_f32 v13, v13
v_mfma_f32_16x16x32_bf16 v[20:23], v[224:227], v[116:119], v[20:23]
buffer_load_dwordx4 v244, s[8:11], s47 offen offset:2048 nt lds
v_mfma_f32_16x16x32_bf16 v[20:23], v[228:231], v[128:131], v[20:23]
s_waitcnt lgkmcnt(2)
v_exp_f32 v14, v14
v_mfma_f32_16x16x32_bf16 v[20:23], v[232:235], v[140:143], v[20:23]
ds_read_b128 v[220:223], v236 offset:52224
v_cvt_pk_bf16_f32 v146, v12, v13
v_mfma_f32_16x16x32_bf16 v[24:27], v[204:207], v[96:99], 0
v_exp_f32 v15, v15
v_mfma_f32_16x16x32_bf16 v[24:27], v[208:211], v[108:111], v[24:27]
s_waitcnt lgkmcnt(1)
ds_read_b128 v[224:227], v237 offset:52224
v_cvt_pk_bf16_f32 v147, v14, v15
v_mfma_f32_16x16x32_bf16 v[24:27], v[212:215], v[120:123], v[24:27]
v_exp_f32 v6, v6
v_mfma_f32_16x16x32_bf16 v[24:27], v[216:219], v[132:135], v[24:27]
ds_read_b128 v[228:231], v238 offset:52224
v_mfma_f32_16x16x32_bf16 v[28:31], v[204:207], v[100:103], 0
v_exp_f32 v7, v7
v_mfma_f32_16x16x32_bf16 v[28:31], v[208:211], v[112:115], v[28:31]
ds_read_b128 v[232:235], v239 offset:52224
v_cvt_pk_bf16_f32 v149, v6, v7
v_mfma_f32_16x16x32_bf16 v[28:31], v[212:215], v[124:127], v[28:31]
v_exp_f32 v16, v16
v_mfma_f32_16x16x32_bf16 v[28:31], v[216:219], v[136:139], v[28:31]
v_exp_f32 v24, v24
v_mfma_f32_16x16x32_bf16 v[32:35], v[204:207], v[104:107], 0
v_exp_f32 v25, v25
v_mfma_f32_16x16x32_bf16 v[32:35], v[208:211], v[116:119], v[32:35]
v_exp_f32 v26, v26
v_mfma_f32_16x16x32_bf16 v[32:35], v[212:215], v[128:131], v[32:35]
s_waitcnt lgkmcnt(2)
v_exp_f32 v27, v27
v_mfma_f32_16x16x32_bf16 v[32:35], v[216:219], v[140:143], v[32:35]
v_exp_f32 v17, v17
v_mfma_f32_16x16x32_bf16 v[36:39], v[220:223], v[96:99], 0
s_waitcnt vmcnt(20) lgkmcnt(0)
v_exp_f32 v18, v18
v_mfma_f32_16x16x32_bf16 v[36:39], v[224:227], v[108:111], v[36:39]
s_barrier
ds_read_b128 v[204:207], v236 offset:32768
v_cvt_pk_bf16_f32 v156, v24, v25
v_mfma_f32_16x16x32_bf16 v[36:39], v[228:231], v[120:123], v[36:39]
v_exp_f32 v19, v19
v_mfma_f32_16x16x32_bf16 v[36:39], v[232:235], v[132:135], v[36:39]
ds_read_b128 v[208:211], v237 offset:32768
v_cvt_pk_bf16_f32 v157, v26, v27
v_mfma_f32_16x16x32_bf16 v[40:43], v[220:223], v[100:103], 0
buffer_load_dwordx4 v244, s[8:11], s47 offen offset:3072 nt lds
v_mfma_f32_16x16x32_bf16 v[40:43], v[224:227], v[112:115], v[40:43]
s_add_u32 s47, s47, 0x4000
ds_read_b128 v[212:215], v238 offset:32768
v_cvt_pk_bf16_f32 v150, v16, v17
v_mfma_f32_16x16x32_bf16 v[40:43], v[228:231], v[124:127], v[40:43]
v_exp_f32 v36, v36
v_mfma_f32_16x16x32_bf16 v[40:43], v[232:235], v[136:139], v[40:43]
ds_read_b128 v[216:219], v239 offset:32768
v_cvt_pk_bf16_f32 v151, v18, v19
v_mfma_f32_16x16x32_bf16 v[44:47], v[220:223], v[104:107], 0
v_exp_f32 v37, v37
v_mfma_f32_16x16x32_bf16 v[44:47], v[224:227], v[116:119], v[44:47]
v_exp_f32 v38, v38
v_mfma_f32_16x16x32_bf16 v[44:47], v[228:231], v[128:131], v[44:47]
s_waitcnt lgkmcnt(2)
v_exp_f32 v39, v39
v_mfma_f32_16x16x32_bf16 v[44:47], v[232:235], v[140:143], v[44:47]
ds_read_b128 v[220:223], v236 offset:33792
v_cvt_pk_bf16_f32 v158, v36, v37
v_mfma_f32_16x16x32_bf16 v[84:87], v[204:207], v[96:99], 0
v_exp_f32 v28, v28
v_mfma_f32_16x16x32_bf16 v[84:87], v[208:211], v[108:111], v[84:87]
s_waitcnt lgkmcnt(1)
ds_read_b128 v[224:227], v237 offset:33792
v_xor_b32 v243, 32, v240
v_mfma_f32_16x16x32_bf16 v[84:87], v[212:215], v[120:123], v[84:87]
v_exp_f32 v29, v29
v_mfma_f32_16x16x32_bf16 v[84:87], v[216:219], v[132:135], v[84:87]
ds_read_b128 v[228:231], v238 offset:33792
v_cvt_pk_bf16_f32 v159, v38, v39
v_mfma_f32_16x16x32_bf16 v[88:91], v[204:207], v[100:103], 0
s_add_u32 m0, s60, 32768
v_exp_f32 v30, v30
v_mfma_f32_16x16x32_bf16 v[88:91], v[208:211], v[112:115], v[88:91]
ds_read_b128 v[232:235], v239 offset:33792
v_cvt_pk_bf16_f32 v160, v28, v29
v_mfma_f32_16x16x32_bf16 v[88:91], v[212:215], v[124:127], v[88:91]
v_exp_f32 v31, v31
v_mfma_f32_16x16x32_bf16 v[88:91], v[216:219], v[136:139], v[88:91]
v_exp_f32 v40, v40
v_mfma_f32_16x16x32_bf16 v[92:95], v[204:207], v[104:107], 0
v_exp_f32 v41, v41
v_mfma_f32_16x16x32_bf16 v[92:95], v[208:211], v[116:119], v[92:95]
v_exp_f32 v42, v42
v_mfma_f32_16x16x32_bf16 v[92:95], v[212:215], v[128:131], v[92:95]
s_waitcnt lgkmcnt(2)
buffer_load_dwordx4 v245, s[12:15], s48 offen offset:0 nt lds
v_mfma_f32_16x16x32_bf16 v[92:95], v[216:219], v[140:143], v[92:95]
ds_read_b64_tr_b16 v[204:205], v240 offset:0
ds_read_b64_tr_b16 v[206:207], v240 offset:1024
v_mfma_f32_16x16x32_bf16 v[192:195], v[220:223], v[96:99], 0
ds_read_b64_tr_b16 v[208:209], v240 offset:2048
v_cvt_pk_bf16_f32 v161, v30, v31
v_mfma_f32_16x16x32_bf16 v[192:195], v[224:227], v[108:111], v[192:195]
s_waitcnt lgkmcnt(3)
ds_read_b64_tr_b16 v[210:211], v240 offset:3072
v_cvt_pk_bf16_f32 v162, v40, v41
v_mfma_f32_16x16x32_bf16 v[192:195], v[228:231], v[120:123], v[192:195]
ds_read_b64_tr_b16 v[212:213], v243 offset:0
v_mfma_f32_16x16x32_bf16 v[192:195], v[232:235], v[132:135], v[192:195]
ds_read_b64_tr_b16 v[214:215], v243 offset:1024
ds_read_b64_tr_b16 v[216:217], v243 offset:2048
v_mfma_f32_16x16x32_bf16 v[196:199], v[220:223], v[100:103], 0
ds_read_b64_tr_b16 v[218:219], v243 offset:3072
v_mfma_f32_16x16x32_bf16 v[196:199], v[224:227], v[112:115], v[196:199]
v_exp_f32 v43, v43
v_mfma_f32_16x16x32_bf16 v[196:199], v[228:231], v[124:127], v[196:199]
v_exp_f32 v8, v8
v_mfma_f32_16x16x32_bf16 v[196:199], v[232:235], v[136:139], v[196:199]
v_exp_f32 v9, v9
v_mfma_f32_16x16x32_bf16 v[200:203], v[220:223], v[104:107], 0
v_exp_f32 v10, v10
v_mfma_f32_16x16x32_bf16 v[200:203], v[224:227], v[116:119], v[200:203]
v_exp_f32 v11, v11
v_mfma_f32_16x16x32_bf16 v[200:203], v[228:231], v[128:131], v[200:203]
s_waitcnt lgkmcnt(4)
v_exp_f32 v20, v20
v_mfma_f32_16x16x32_bf16 v[200:203], v[232:235], v[140:143], v[200:203]
v_exp_f32 v21, v21
v_mfma_f32_16x16x32_bf16 v[0:3], v[204:207], v[144:147], 0
v_exp_f32 v22, v22
v_exp_f32 v23, v23
v_cvt_pk_bf16_f32 v163, v42, v43
v_mfma_f32_16x16x32_bf16 v[0:3], v[208:211], v[156:159], v[0:3]
v_cvt_pk_bf16_f32 v152, v8, v9
v_cvt_pk_bf16_f32 v153, v10, v11
v_cvt_pk_bf16_f32 v154, v20, v21
v_cvt_pk_bf16_f32 v155, v22, v23
v_exp_f32 v32, v32
v_exp_f32 v33, v33
v_exp_f32 v34, v34
v_exp_f32 v35, v35
v_exp_f32 v44, v44
v_exp_f32 v45, v45
v_exp_f32 v46, v46
v_exp_f32 v47, v47
v_mfma_f32_16x16x32_bf16 v[4:7], v[204:207], v[148:151], 0
ds_read_b128 v[220:223], v236 offset:34816
v_cvt_pk_bf16_f32 v164, v32, v33
v_cvt_pk_bf16_f32 v165, v34, v35
v_cvt_pk_bf16_f32 v166, v44, v45
v_cvt_pk_bf16_f32 v167, v46, v47
v_mfma_f32_16x16x32_bf16 v[4:7], v[208:211], v[160:163], v[4:7]
v_exp_f32 v192, v192
v_mfma_f32_16x16x32_bf16 v[8:11], v[204:207], v[152:155], 0
ds_read_b128 v[224:227], v237 offset:34816
v_xor_b32 v242, 64, v240
v_mfma_f32_16x16x32_bf16 v[8:11], v[208:211], v[164:167], v[8:11]
s_waitcnt lgkmcnt(2)
buffer_load_dwordx4 v245, s[12:15], s48 offen offset:1024 nt lds
v_mfma_f32_16x16x32_bf16 v[12:15], v[212:215], v[144:147], 0
ds_read_b128 v[228:231], v238 offset:34816
v_xor_b32 v243, 96, v240
v_mfma_f32_16x16x32_bf16 v[12:15], v[216:219], v[156:159], v[12:15]
v_exp_f32 v193, v193
v_mfma_f32_16x16x32_bf16 v[16:19], v[212:215], v[148:151], 0
ds_read_b128 v[232:235], v239 offset:34816
v_cvt_pk_bf16_f32 v170, v192, v193
v_mfma_f32_16x16x32_bf16 v[16:19], v[216:219], v[160:163], v[16:19]
v_exp_f32 v194, v194
v_mfma_f32_16x16x32_bf16 v[20:23], v[212:215], v[152:155], 0
v_exp_f32 v195, v195
v_mfma_f32_16x16x32_bf16 v[20:23], v[216:219], v[164:167], v[20:23]
v_exp_f32 v196, v196
v_mfma_f32_16x16x32_bf16 a[240:243], a[252:255], v[144:147], 0
s_waitcnt lgkmcnt(2)
v_cvt_pk_bf16_f32 v171, v194, v195
v_mfma_f32_16x16x32_bf16 a[240:243], a[252:255], v[156:159], a[240:243]
ds_read_b64_tr_b16 v[204:205], v242 offset:0
ds_read_b64_tr_b16 v[206:207], v242 offset:1024
v_mfma_f32_16x16x32_bf16 v[192:195], v[220:223], v[96:99], 0
v_exp_f32 v197, v197
v_mfma_f32_16x16x32_bf16 v[192:195], v[224:227], v[108:111], v[192:195]
s_waitcnt lgkmcnt(2)
v_exp_f32 v198, v198
v_mfma_f32_16x16x32_bf16 v[192:195], v[228:231], v[120:123], v[192:195]
v_exp_f32 v199, v199
v_mfma_f32_16x16x32_bf16 v[192:195], v[232:235], v[132:135], v[192:195]
ds_read_b64_tr_b16 v[208:209], v242 offset:2048
v_cvt_pk_bf16_f32 v174, v196, v197
v_cvt_pk_bf16_f32 v175, v198, v199
v_mfma_f32_16x16x32_bf16 v[196:199], v[220:223], v[100:103], 0
ds_read_b64_tr_b16 v[210:211], v242 offset:3072
ds_read_b64_tr_b16 v[212:213], v243 offset:0
v_mfma_f32_16x16x32_bf16 v[196:199], v[224:227], v[112:115], v[196:199]
v_exp_f32 v200, v200
v_mfma_f32_16x16x32_bf16 v[196:199], v[228:231], v[124:127], v[196:199]
ds_read_b64_tr_b16 v[214:215], v243 offset:1024
v_exp_f32 v201, v201
v_exp_f32 v202, v202
v_exp_f32 v203, v203
v_mfma_f32_16x16x32_bf16 v[196:199], v[232:235], v[136:139], v[196:199]
ds_read_b64_tr_b16 v[216:217], v243 offset:2048
v_cvt_pk_bf16_f32 v178, v200, v201
v_cvt_pk_bf16_f32 v179, v202, v203
v_mfma_f32_16x16x32_bf16 v[200:203], v[220:223], v[104:107], 0
ds_read_b64_tr_b16 v[218:219], v243 offset:3072
v_mfma_f32_16x16x32_bf16 v[200:203], v[224:227], v[116:119], v[200:203]
v_exp_f32 v192, v192
v_mfma_f32_16x16x32_bf16 v[200:203], v[228:231], v[128:131], v[200:203]
s_waitcnt lgkmcnt(4)
buffer_load_dwordx4 v245, s[12:15], s48 offen offset:2048 nt lds
v_mfma_f32_16x16x32_bf16 v[200:203], v[232:235], v[140:143], v[200:203]
ds_read_b128 v[220:223], v236 offset:35840
v_mfma_f32_16x16x32_bf16 v[24:27], v[204:207], v[144:147], 0
v_exp_f32 v193, v193
v_mfma_f32_16x16x32_bf16 v[24:27], v[208:211], v[156:159], v[24:27]
ds_read_b128 v[224:227], v237 offset:35840
v_cvt_pk_bf16_f32 v180, v192, v193
v_mfma_f32_16x16x32_bf16 v[28:31], v[204:207], v[148:151], 0
v_exp_f32 v194, v194
v_mfma_f32_16x16x32_bf16 v[28:31], v[208:211], v[160:163], v[28:31]
ds_read_b128 v[228:231], v238 offset:35840
v_xor_b32 v242, 128, v240
v_mfma_f32_16x16x32_bf16 v[32:35], v[204:207], v[152:155], 0
v_exp_f32 v195, v195
v_mfma_f32_16x16x32_bf16 v[32:35], v[208:211], v[164:167], v[32:35]
s_waitcnt lgkmcnt(3)
ds_read_b128 v[232:235], v239 offset:35840
v_cvt_pk_bf16_f32 v181, v194, v195
v_mfma_f32_16x16x32_bf16 v[36:39], v[212:215], v[144:147], 0
v_exp_f32 v196, v196
v_mfma_f32_16x16x32_bf16 v[36:39], v[216:219], v[156:159], v[36:39]
v_exp_f32 v197, v197
v_mfma_f32_16x16x32_bf16 v[40:43], v[212:215], v[148:151], 0
v_exp_f32 v198, v198
v_mfma_f32_16x16x32_bf16 v[40:43], v[216:219], v[160:163], v[40:43]
v_exp_f32 v199, v199
v_mfma_f32_16x16x32_bf16 v[44:47], v[212:215], v[152:155], 0
v_cvt_pk_bf16_f32 v184, v196, v197
v_cvt_pk_bf16_f32 v185, v198, v199
v_mfma_f32_16x16x32_bf16 v[44:47], v[216:219], v[164:167], v[44:47]
v_exp_f32 v200, v200
v_mfma_f32_16x16x32_bf16 a[244:247], a[252:255], v[148:151], 0
s_waitcnt lgkmcnt(2)
v_exp_f32 v201, v201
v_mfma_f32_16x16x32_bf16 a[244:247], a[252:255], v[160:163], a[244:247]
ds_read_b64_tr_b16 v[204:205], v242 offset:0
ds_read_b64_tr_b16 v[206:207], v242 offset:1024
v_mfma_f32_16x16x32_bf16 v[192:195], v[220:223], v[96:99], 0
ds_read_b64_tr_b16 v[208:209], v242 offset:2048
v_xor_b32 v243, 160, v240
v_mfma_f32_16x16x32_bf16 v[192:195], v[224:227], v[108:111], v[192:195]
s_waitcnt lgkmcnt(3)
ds_read_b64_tr_b16 v[210:211], v242 offset:3072
v_cvt_pk_bf16_f32 v188, v200, v201
v_mfma_f32_16x16x32_bf16 v[192:195], v[228:231], v[120:123], v[192:195]
ds_read_b64_tr_b16 v[212:213], v243 offset:0
v_xor_b32 v242, 192, v240
v_mfma_f32_16x16x32_bf16 v[192:195], v[232:235], v[132:135], v[192:195]
v_exp_f32 v202, v202
v_mfma_f32_16x16x32_bf16 v[196:199], v[220:223], v[100:103], 0
v_exp_f32 v203, v203
v_mfma_f32_16x16x32_bf16 v[196:199], v[224:227], v[112:115], v[196:199]
ds_read_b64_tr_b16 v[214:215], v243 offset:1024
v_cvt_pk_bf16_f32 v189, v202, v203
v_mfma_f32_16x16x32_bf16 v[196:199], v[228:231], v[124:127], v[196:199]
buffer_load_dwordx4 v245, s[12:15], s48 offen offset:3072 nt lds
v_mfma_f32_16x16x32_bf16 v[196:199], v[232:235], v[136:139], v[196:199]
s_add_u32 s48, s48, 0x4000
ds_read_b64_tr_b16 v[216:217], v243 offset:2048
ds_read_b64_tr_b16 v[218:219], v243 offset:3072
v_mfma_f32_16x16x32_bf16 v[200:203], v[220:223], v[104:107], 0
v_exp_f32 v84, v84
v_mfma_f32_16x16x32_bf16 v[200:203], v[224:227], v[116:119], v[200:203]
v_exp_f32 v85, v85
v_mfma_f32_16x16x32_bf16 v[200:203], v[228:231], v[128:131], v[200:203]
s_waitcnt lgkmcnt(4)
v_xor_b32 v243, 224, v240
v_cvt_pk_bf16_f32 v168, v84, v85
v_mfma_f32_16x16x32_bf16 v[200:203], v[232:235], v[140:143], v[200:203]
ds_read_b64_tr_b16 v[220:221], v242 offset:0
ds_read_b64_tr_b16 v[222:223], v242 offset:1024
v_mfma_f32_16x16x32_bf16 v[48:51], v[204:207], v[144:147], 0
ds_read_b64_tr_b16 v[224:225], v242 offset:2048
v_mfma_f32_16x16x32_bf16 v[48:51], v[208:211], v[156:159], v[48:51]
ds_read_b64_tr_b16 v[226:227], v242 offset:3072
v_mfma_f32_16x16x32_bf16 v[52:55], v[204:207], v[148:151], 0
ds_read_b64_tr_b16 v[228:229], v243 offset:0
v_mfma_f32_16x16x32_bf16 v[52:55], v[208:211], v[160:163], v[52:55]
s_add_u32 m0, s60, 147456
ds_read_b64_tr_b16 v[230:231], v243 offset:1024
ds_read_b64_tr_b16 v[232:233], v243 offset:2048
v_mfma_f32_16x16x32_bf16 v[56:59], v[204:207], v[152:155], 0
ds_read_b64_tr_b16 v[234:235], v243 offset:3072
v_mfma_f32_16x16x32_bf16 v[56:59], v[208:211], v[164:167], v[56:59]
s_waitcnt lgkmcnt(8)
v_exp_f32 v86, v86
v_mfma_f32_16x16x32_bf16 v[60:63], v[212:215], v[144:147], 0
v_exp_f32 v87, v87
v_mfma_f32_16x16x32_bf16 v[60:63], v[216:219], v[156:159], v[60:63]
v_exp_f32 v88, v88
v_mfma_f32_16x16x32_bf16 v[64:67], v[212:215], v[148:151], 0
v_exp_f32 v89, v89
v_mfma_f32_16x16x32_bf16 v[64:67], v[216:219], v[160:163], v[64:67]
buffer_load_dwordx4 v244, s[8:11], s47 offen offset:0 nt lds
v_mfma_f32_16x16x32_bf16 v[68:71], v[212:215], v[152:155], 0
v_cvt_pk_bf16_f32 v169, v86, v87
v_cvt_pk_bf16_f32 v172, v88, v89
v_mfma_f32_16x16x32_bf16 v[68:71], v[216:219], v[164:167], v[68:71]
v_exp_f32 v90, v90
v_mfma_f32_16x16x32_bf16 a[248:251], a[252:255], v[152:155], 0
s_waitcnt lgkmcnt(4)
v_exp_f32 v91, v91
v_mfma_f32_16x16x32_bf16 a[248:251], a[252:255], v[164:167], a[248:251]
s_waitcnt vmcnt(18) lgkmcnt(0)
v_exp_f32 v92, v92
v_mfma_f32_16x16x32_bf16 v[72:75], v[220:223], v[144:147], 0
s_barrier
ds_read_b128 v[204:207], v236 offset:16384
v_cvt_pk_bf16_f32 v173, v90, v91
v_mfma_f32_16x16x32_bf16 v[72:75], v[224:227], v[156:159], v[72:75]
v_exp_f32 v93, v93
v_mfma_f32_16x16x32_bf16 v[76:79], v[220:223], v[148:151], 0
ds_read_b128 v[208:211], v237 offset:16384
v_cvt_pk_bf16_f32 v176, v92, v93
v_mfma_f32_16x16x32_bf16 v[76:79], v[224:227], v[160:163], v[76:79]
v_exp_f32 v94, v94
v_mfma_f32_16x16x32_bf16 v[80:83], v[220:223], v[152:155], 0
ds_read_b128 v[212:215], v238 offset:16384
v_xor_b32 v243, 32, v240
v_mfma_f32_16x16x32_bf16 v[80:83], v[224:227], v[164:167], v[80:83]
v_exp_f32 v95, v95
v_mfma_f32_16x16x32_bf16 v[84:87], v[228:231], v[144:147], 0
ds_read_b128 v[216:219], v239 offset:16384
v_cvt_pk_bf16_f32 v177, v94, v95
v_mfma_f32_16x16x32_bf16 v[84:87], v[232:235], v[156:159], v[84:87]
v_exp_f32 v192, v192
v_mfma_f32_16x16x32_bf16 v[88:91], v[228:231], v[148:151], 0
v_exp_f32 v193, v193
v_mfma_f32_16x16x32_bf16 v[88:91], v[232:235], v[160:163], v[88:91]
v_exp_f32 v194, v194
v_mfma_f32_16x16x32_bf16 v[92:95], v[228:231], v[152:155], 0
s_waitcnt lgkmcnt(2)
v_exp_f32 v195, v195
v_mfma_f32_16x16x32_bf16 v[92:95], v[232:235], v[164:167], v[92:95]
v_cvt_pk_bf16_f32 v182, v192, v193
v_cvt_pk_bf16_f32 v183, v194, v195
v_mfma_f32_16x16x32_bf16 v[192:195], v[204:207], v[96:99], 0
ds_read_b64_tr_b16 v[220:221], v240 offset:16384
ds_read_b64_tr_b16 v[222:223], v240 offset:17408
v_mfma_f32_16x16x32_bf16 v[192:195], v[208:211], v[108:111], v[192:195]
s_waitcnt lgkmcnt(2)
v_exp_f32 v196, v196
v_mfma_f32_16x16x32_bf16 v[192:195], v[212:215], v[120:123], v[192:195]
v_exp_f32 v197, v197
v_exp_f32 v198, v198
v_exp_f32 v199, v199
v_mfma_f32_16x16x32_bf16 v[192:195], v[216:219], v[132:135], v[192:195]
ds_read_b64_tr_b16 v[224:225], v240 offset:18432
v_cvt_pk_bf16_f32 v186, v196, v197
v_cvt_pk_bf16_f32 v187, v198, v199
v_mfma_f32_16x16x32_bf16 v[196:199], v[204:207], v[100:103], 0
ds_read_b64_tr_b16 v[226:227], v240 offset:19456
ds_read_b64_tr_b16 v[228:229], v243 offset:16384
v_mfma_f32_16x16x32_bf16 v[196:199], v[208:211], v[112:115], v[196:199]
v_exp_f32 v200, v200
v_mfma_f32_16x16x32_bf16 v[196:199], v[212:215], v[124:127], v[196:199]
ds_read_b64_tr_b16 v[230:231], v243 offset:17408
buffer_load_dwordx4 v244, s[8:11], s47 offen offset:1024 nt lds
v_exp_f32 v201, v201
v_exp_f32 v202, v202
v_exp_f32 v203, v203
v_mfma_f32_16x16x32_bf16 v[196:199], v[216:219], v[136:139], v[196:199]
ds_read_b64_tr_b16 v[232:233], v243 offset:18432
v_cvt_pk_bf16_f32 v190, v200, v201
v_cvt_pk_bf16_f32 v191, v202, v203
v_mfma_f32_16x16x32_bf16 v[200:203], v[204:207], v[104:107], 0
ds_read_b64_tr_b16 v[234:235], v243 offset:19456
v_mfma_f32_16x16x32_bf16 v[200:203], v[208:211], v[116:119], v[200:203]
v_exp_f32 v192, v192
v_mfma_f32_16x16x32_bf16 v[200:203], v[212:215], v[128:131], v[200:203]
s_waitcnt lgkmcnt(4)
v_exp_f32 v193, v193
v_mfma_f32_16x16x32_bf16 v[200:203], v[216:219], v[140:143], v[200:203]
ds_read_b128 v[204:207], v236 offset:17408
v_cvt_pk_bf16_f32 v144, v192, v193
v_mfma_f32_16x16x32_bf16 v[0:3], v[220:223], v[168:171], v[0:3]
v_exp_f32 v194, v194
v_mfma_f32_16x16x32_bf16 v[0:3], v[224:227], v[180:183], v[0:3]
ds_read_b128 v[208:211], v237 offset:17408
v_mfma_f32_16x16x32_bf16 v[4:7], v[220:223], v[172:175], v[4:7]
v_exp_f32 v195, v195
v_mfma_f32_16x16x32_bf16 v[4:7], v[224:227], v[184:187], v[4:7]
ds_read_b128 v[212:215], v238 offset:17408
v_cvt_pk_bf16_f32 v145, v194, v195
v_mfma_f32_16x16x32_bf16 v[8:11], v[220:223], v[176:179], v[8:11]
v_xor_b32 v242, 64, v240
v_xor_b32 v243, 96, v240
v_mfma_f32_16x16x32_bf16 v[8:11], v[224:227], v[188:191], v[8:11]
s_waitcnt lgkmcnt(3)
v_exp_f32 v196, v196
v_mfma_f32_16x16x32_bf16 v[12:15], v[228:231], v[168:171], v[12:15]
v_exp_f32 v197, v197
v_mfma_f32_16x16x32_bf16 v[12:15], v[232:235], v[180:183], v[12:15]
ds_read_b128 v[216:219], v239 offset:17408
v_cvt_pk_bf16_f32 v148, v196, v197
v_mfma_f32_16x16x32_bf16 v[16:19], v[228:231], v[172:175], v[16:19]
v_exp_f32 v198, v198
v_mfma_f32_16x16x32_bf16 v[16:19], v[232:235], v[184:187], v[16:19]
buffer_load_dwordx4 v244, s[8:11], s47 offen offset:2048 nt lds
v_mfma_f32_16x16x32_bf16 v[20:23], v[228:231], v[176:179], v[20:23]
v_exp_f32 v199, v199
v_mfma_f32_16x16x32_bf16 v[20:23], v[232:235], v[188:191], v[20:23]
v_exp_f32 v200, v200
v_mfma_f32_16x16x32_bf16 a[240:243], a[252:255], v[168:171], a[240:243]
s_waitcnt lgkmcnt(2)
v_exp_f32 v201, v201
v_mfma_f32_16x16x32_bf16 a[240:243], a[252:255], v[180:183], a[240:243]
ds_read_b64_tr_b16 v[220:221], v242 offset:16384
ds_read_b64_tr_b16 v[222:223], v242 offset:17408
v_mfma_f32_16x16x32_bf16 v[192:195], v[204:207], v[96:99], 0
ds_read_b64_tr_b16 v[224:225], v242 offset:18432
v_cvt_pk_bf16_f32 v149, v198, v199
v_mfma_f32_16x16x32_bf16 v[192:195], v[208:211], v[108:111], v[192:195]
s_waitcnt lgkmcnt(3)
ds_read_b64_tr_b16 v[226:227], v242 offset:19456
v_cvt_pk_bf16_f32 v152, v200, v201
v_mfma_f32_16x16x32_bf16 v[192:195], v[212:215], v[120:123], v[192:195]
ds_read_b64_tr_b16 v[228:229], v243 offset:16384
v_mfma_f32_16x16x32_bf16 v[192:195], v[216:219], v[132:135], v[192:195]
v_exp_f32 v202, v202
v_mfma_f32_16x16x32_bf16 v[196:199], v[204:207], v[100:103], 0
v_exp_f32 v203, v203
v_mfma_f32_16x16x32_bf16 v[196:199], v[208:211], v[112:115], v[196:199]
ds_read_b64_tr_b16 v[230:231], v243 offset:17408
v_cvt_pk_bf16_f32 v153, v202, v203
v_mfma_f32_16x16x32_bf16 v[196:199], v[212:215], v[124:127], v[196:199]
ds_read_b64_tr_b16 v[232:233], v243 offset:18432
ds_read_b64_tr_b16 v[234:235], v243 offset:19456
v_mfma_f32_16x16x32_bf16 v[196:199], v[216:219], v[136:139], v[196:199]
v_exp_f32 v192, v192
v_mfma_f32_16x16x32_bf16 v[200:203], v[204:207], v[104:107], 0
v_exp_f32 v193, v193
v_mfma_f32_16x16x32_bf16 v[200:203], v[208:211], v[116:119], v[200:203]
v_exp_f32 v194, v194
v_mfma_f32_16x16x32_bf16 v[200:203], v[212:215], v[128:131], v[200:203]
s_waitcnt lgkmcnt(4)
v_exp_f32 v195, v195
v_mfma_f32_16x16x32_bf16 v[200:203], v[216:219], v[140:143], v[200:203]
ds_read_b128 v[204:207], v236 offset:18432
v_cvt_pk_bf16_f32 v146, v192, v193
v_mfma_f32_16x16x32_bf16 v[24:27], v[220:223], v[168:171], v[24:27]
v_exp_f32 v196, v196
v_mfma_f32_16x16x32_bf16 v[24:27], v[224:227], v[180:183], v[24:27]
ds_read_b128 v[208:211], v237 offset:18432
v_cvt_pk_bf16_f32 v147, v194, v195
v_mfma_f32_16x16x32_bf16 v[28:31], v[220:223], v[172:175], v[28:31]
buffer_load_dwordx4 v244, s[8:11], s47 offen offset:3072 nt lds
v_mfma_f32_16x16x32_bf16 v[28:31], v[224:227], v[184:187], v[28:31]
s_add_u32 s47, s47, 0x4000
ds_read_b128 v[212:215], v238 offset:18432
v_xor_b32 v242, 128, v240
v_mfma_f32_16x16x32_bf16 v[32:35], v[220:223], v[176:179], v[32:35]
v_exp_f32 v197, v197
v_mfma_f32_16x16x32_bf16 v[32:35], v[224:227], v[188:191], v[32:35]
s_waitcnt lgkmcnt(3)
ds_read_b128 v[216:219], v239 offset:18432
v_cvt_pk_bf16_f32 v150, v196, v197
v_mfma_f32_16x16x32_bf16 v[36:39], v[228:231], v[168:171], v[36:39]
v_exp_f32 v198, v198
v_mfma_f32_16x16x32_bf16 v[36:39], v[232:235], v[180:183], v[36:39]
v_exp_f32 v199, v199
v_mfma_f32_16x16x32_bf16 v[40:43], v[228:231], v[172:175], v[40:43]
v_cvt_pk_bf16_f32 v151, v198, v199
v_xor_b32 v243, 160, v240
v_mfma_f32_16x16x32_bf16 v[40:43], v[232:235], v[184:187], v[40:43]
v_exp_f32 v200, v200
v_mfma_f32_16x16x32_bf16 v[44:47], v[228:231], v[176:179], v[44:47]
v_exp_f32 v201, v201
v_mfma_f32_16x16x32_bf16 v[44:47], v[232:235], v[188:191], v[44:47]
v_exp_f32 v202, v202
v_mfma_f32_16x16x32_bf16 a[244:247], a[252:255], v[172:175], a[244:247]
s_waitcnt lgkmcnt(2)
v_exp_f32 v203, v203
v_mfma_f32_16x16x32_bf16 a[244:247], a[252:255], v[184:187], a[244:247]
ds_read_b64_tr_b16 v[220:221], v242 offset:16384
ds_read_b64_tr_b16 v[222:223], v242 offset:17408
v_mfma_f32_16x16x32_bf16 v[192:195], v[204:207], v[96:99], 0
s_add_u32 m0, s60, 0
ds_read_b64_tr_b16 v[224:225], v242 offset:18432
v_cvt_pk_bf16_f32 v154, v200, v201
v_mfma_f32_16x16x32_bf16 v[192:195], v[208:211], v[108:111], v[192:195]
s_waitcnt lgkmcnt(3)
ds_read_b64_tr_b16 v[226:227], v242 offset:19456
v_cvt_pk_bf16_f32 v155, v202, v203
v_mfma_f32_16x16x32_bf16 v[192:195], v[212:215], v[120:123], v[192:195]
ds_read_b64_tr_b16 v[228:229], v243 offset:16384
v_mfma_f32_16x16x32_bf16 v[192:195], v[216:219], v[132:135], v[192:195]
ds_read_b64_tr_b16 v[230:231], v243 offset:17408
ds_read_b64_tr_b16 v[232:233], v243 offset:18432
v_mfma_f32_16x16x32_bf16 v[196:199], v[204:207], v[100:103], 0
ds_read_b64_tr_b16 v[234:235], v243 offset:19456
v_mfma_f32_16x16x32_bf16 v[196:199], v[208:211], v[112:115], v[196:199]
v_mfma_f32_16x16x32_bf16 v[196:199], v[212:215], v[124:127], v[196:199]
buffer_load_dwordx4 v245, s[12:15], s48 offen offset:0 nt lds
v_mfma_f32_16x16x32_bf16 v[196:199], v[216:219], v[136:139], v[196:199]
v_exp_f32 v192, v192
v_mfma_f32_16x16x32_bf16 v[200:203], v[204:207], v[104:107], 0
v_exp_f32 v193, v193
v_mfma_f32_16x16x32_bf16 v[200:203], v[208:211], v[116:119], v[200:203]
v_exp_f32 v194, v194
v_mfma_f32_16x16x32_bf16 v[200:203], v[212:215], v[128:131], v[200:203]
s_waitcnt lgkmcnt(4)
v_exp_f32 v195, v195
v_mfma_f32_16x16x32_bf16 v[200:203], v[216:219], v[140:143], v[200:203]
ds_read_b128 v[204:207], v236 offset:19456
v_cvt_pk_bf16_f32 v156, v192, v193
v_mfma_f32_16x16x32_bf16 v[48:51], v[220:223], v[168:171], v[48:51]
v_exp_f32 v196, v196
v_mfma_f32_16x16x32_bf16 v[48:51], v[224:227], v[180:183], v[48:51]
ds_read_b128 v[208:211], v237 offset:19456
v_cvt_pk_bf16_f32 v157, v194, v195
v_mfma_f32_16x16x32_bf16 v[52:55], v[220:223], v[172:175], v[52:55]
v_exp_f32 v197, v197
v_mfma_f32_16x16x32_bf16 v[52:55], v[224:227], v[184:187], v[52:55]
ds_read_b128 v[212:215], v238 offset:19456
v_xor_b32 v242, 192, v240
v_mfma_f32_16x16x32_bf16 v[56:59], v[220:223], v[176:179], v[56:59]
v_exp_f32 v198, v198
v_mfma_f32_16x16x32_bf16 v[56:59], v[224:227], v[188:191], v[56:59]
s_waitcnt lgkmcnt(3)
ds_read_b128 v[216:219], v239 offset:19456
v_cvt_pk_bf16_f32 v160, v196, v197
v_mfma_f32_16x16x32_bf16 v[60:63], v[228:231], v[168:171], v[60:63]
v_exp_f32 v199, v199
v_mfma_f32_16x16x32_bf16 v[60:63], v[232:235], v[180:183], v[60:63]
v_cvt_pk_bf16_f32 v161, v198, v199
v_xor_b32 v243, 224, v240
v_mfma_f32_16x16x32_bf16 v[64:67], v[228:231], v[172:175], v[64:67]
v_exp_f32 v200, v200
v_mfma_f32_16x16x32_bf16 v[64:67], v[232:235], v[184:187], v[64:67]
v_exp_f32 v201, v201
v_mfma_f32_16x16x32_bf16 v[68:71], v[228:231], v[176:179], v[68:71]
v_exp_f32 v202, v202
v_mfma_f32_16x16x32_bf16 v[68:71], v[232:235], v[188:191], v[68:71]
v_exp_f32 v203, v203
v_mfma_f32_16x16x32_bf16 a[248:251], a[252:255], v[176:179], a[248:251]
s_waitcnt lgkmcnt(2)
v_cvt_pk_bf16_f32 v164, v200, v201
v_cvt_pk_bf16_f32 v165, v202, v203
v_mfma_f32_16x16x32_bf16 a[248:251], a[252:255], v[188:191], a[248:251]
ds_read_b64_tr_b16 v[220:221], v242 offset:16384
ds_read_b64_tr_b16 v[222:223], v242 offset:17408
v_mfma_f32_16x16x32_bf16 v[192:195], v[204:207], v[96:99], 0
ds_read_b64_tr_b16 v[224:225], v242 offset:18432
v_mfma_f32_16x16x32_bf16 v[192:195], v[208:211], v[108:111], v[192:195]
s_waitcnt lgkmcnt(3)
buffer_load_dwordx4 v245, s[12:15], s48 offen offset:1024 nt lds
v_mfma_f32_16x16x32_bf16 v[192:195], v[212:215], v[120:123], v[192:195]
ds_read_b64_tr_b16 v[226:227], v242 offset:19456
ds_read_b64_tr_b16 v[228:229], v243 offset:16384
v_mfma_f32_16x16x32_bf16 v[192:195], v[216:219], v[132:135], v[192:195]
ds_read_b64_tr_b16 v[230:231], v243 offset:17408
v_mfma_f32_16x16x32_bf16 v[196:199], v[204:207], v[100:103], 0
ds_read_b64_tr_b16 v[232:233], v243 offset:18432
v_mfma_f32_16x16x32_bf16 v[196:199], v[208:211], v[112:115], v[196:199]
ds_read_b64_tr_b16 v[234:235], v243 offset:19456
v_mfma_f32_16x16x32_bf16 v[196:199], v[212:215], v[124:127], v[196:199]
v_mfma_f32_16x16x32_bf16 v[196:199], v[216:219], v[136:139], v[196:199]
v_mfma_f32_16x16x32_bf16 v[200:203], v[204:207], v[104:107], 0
v_exp_f32 v192, v192
v_mfma_f32_16x16x32_bf16 v[200:203], v[208:211], v[116:119], v[200:203]
v_exp_f32 v193, v193
v_mfma_f32_16x16x32_bf16 v[200:203], v[212:215], v[128:131], v[200:203]
s_waitcnt lgkmcnt(4)
v_exp_f32 v194, v194
v_mfma_f32_16x16x32_bf16 v[200:203], v[216:219], v[140:143], v[200:203]
s_waitcnt vmcnt(14) lgkmcnt(0)
v_exp_f32 v195, v195
v_mfma_f32_16x16x32_bf16 v[72:75], v[220:223], v[168:171], v[72:75]
s_barrier
ds_read_b128 v[204:207], v236 offset:0
v_cvt_pk_bf16_f32 v158, v192, v193
v_mfma_f32_16x16x32_bf16 v[72:75], v[224:227], v[180:183], v[72:75]
v_cvt_pk_bf16_f32 v159, v194, v195
v_xor_b32 v243, 32, v240
v_mfma_f32_16x16x32_bf16 v[76:79], v[220:223], v[172:175], v[76:79]
ds_read_b128 v[208:211], v237 offset:0
v_mfma_f32_16x16x32_bf16 v[76:79], v[224:227], v[184:187], v[76:79]
v_exp_f32 v196, v196
v_mfma_f32_16x16x32_bf16 v[80:83], v[220:223], v[176:179], v[80:83]
ds_read_b128 v[212:215], v238 offset:0
v_mfma_f32_16x16x32_bf16 v[80:83], v[224:227], v[188:191], v[80:83]
v_exp_f32 v197, v197
v_mfma_f32_16x16x32_bf16 v[84:87], v[228:231], v[168:171], v[84:87]
ds_read_b128 v[216:219], v239 offset:0
v_cvt_pk_bf16_f32 v162, v196, v197
v_mfma_f32_16x16x32_bf16 v[84:87], v[232:235], v[180:183], v[84:87]
buffer_load_dwordx4 v245, s[12:15], s48 offen offset:2048 nt lds
v_mfma_f32_16x16x32_bf16 v[88:91], v[228:231], v[172:175], v[88:91]
v_exp_f32 v198, v198
v_mfma_f32_16x16x32_bf16 v[88:91], v[232:235], v[184:187], v[88:91]
v_exp_f32 v199, v199
v_mfma_f32_16x16x32_bf16 v[92:95], v[228:231], v[176:179], v[92:95]
s_waitcnt lgkmcnt(2)
v_exp_f32 v200, v200
v_mfma_f32_16x16x32_bf16 v[92:95], v[232:235], v[188:191], v[92:95]
ds_read_b64_tr_b16 v[220:221], v240 offset:49152
ds_read_b64_tr_b16 v[222:223], v240 offset:50176
v_mfma_f32_16x16x32_bf16 v[192:195], v[204:207], v[96:99], 0
ds_read_b64_tr_b16 v[224:225], v240 offset:51200
v_cvt_pk_bf16_f32 v163, v198, v199
v_mfma_f32_16x16x32_bf16 v[192:195], v[208:211], v[108:111], v[192:195]
s_waitcnt lgkmcnt(3)
ds_read_b64_tr_b16 v[226:227], v240 offset:52224
v_mfma_f32_16x16x32_bf16 v[192:195], v[212:215], v[120:123], v[192:195]
ds_read_b64_tr_b16 v[228:229], v243 offset:49152
v_mfma_f32_16x16x32_bf16 v[192:195], v[216:219], v[132:135], v[192:195]
v_exp_f32 v201, v201
v_mfma_f32_16x16x32_bf16 v[196:199], v[204:207], v[100:103], 0
v_exp_f32 v202, v202
v_mfma_f32_16x16x32_bf16 v[196:199], v[208:211], v[112:115], v[196:199]
v_exp_f32 v203, v203
v_mfma_f32_16x16x32_bf16 v[196:199], v[212:215], v[124:127], v[196:199]
ds_read_b64_tr_b16 v[230:231], v243 offset:50176
v_cvt_pk_bf16_f32 v166, v200, v201
v_mfma_f32_16x16x32_bf16 v[196:199], v[216:219], v[136:139], v[196:199]
ds_read_b64_tr_b16 v[232:233], v243 offset:51200
v_cvt_pk_bf16_f32 v167, v202, v203
v_mfma_f32_16x16x32_bf16 v[200:203], v[204:207], v[104:107], 0
ds_read_b64_tr_b16 v[234:235], v243 offset:52224
v_mfma_f32_16x16x32_bf16 v[200:203], v[208:211], v[116:119], v[200:203]
v_exp_f32 v192, v192
v_mfma_f32_16x16x32_bf16 v[200:203], v[212:215], v[128:131], v[200:203]
s_waitcnt lgkmcnt(4)
v_exp_f32 v193, v193
v_mfma_f32_16x16x32_bf16 v[200:203], v[216:219], v[140:143], v[200:203]
ds_read_b128 v[204:207], v236 offset:1024
v_cvt_pk_bf16_f32 v168, v192, v193
v_mfma_f32_16x16x32_bf16 v[0:3], v[220:223], v[144:147], v[0:3]
buffer_load_dwordx4 v245, s[12:15], s48 offen offset:3072 nt lds
v_mfma_f32_16x16x32_bf16 v[0:3], v[224:227], v[156:159], v[0:3]
s_add_u32 s48, s48, 0x4000
ds_read_b128 v[208:211], v237 offset:1024
v_mfma_f32_16x16x32_bf16 v[4:7], v[220:223], v[148:151], v[4:7]
v_exp_f32 v194, v194
v_mfma_f32_16x16x32_bf16 v[4:7], v[224:227], v[160:163], v[4:7]
ds_read_b128 v[212:215], v238 offset:1024
v_xor_b32 v242, 64, v240
v_mfma_f32_16x16x32_bf16 v[8:11], v[220:223], v[152:155], v[8:11]
v_exp_f32 v195, v195
v_mfma_f32_16x16x32_bf16 v[8:11], v[224:227], v[164:167], v[8:11]
s_waitcnt lgkmcnt(3)
ds_read_b128 v[216:219], v239 offset:1024
v_cvt_pk_bf16_f32 v169, v194, v195
v_mfma_f32_16x16x32_bf16 v[12:15], v[228:231], v[144:147], v[12:15]
v_exp_f32 v196, v196
v_mfma_f32_16x16x32_bf16 v[12:15], v[232:235], v[156:159], v[12:15]
v_exp_f32 v197, v197
v_mfma_f32_16x16x32_bf16 v[16:19], v[228:231], v[148:151], v[16:19]
v_exp_f32 v198, v198
v_mfma_f32_16x16x32_bf16 v[16:19], v[232:235], v[160:163], v[16:19]
v_exp_f32 v199, v199
v_mfma_f32_16x16x32_bf16 v[20:23], v[228:231], v[152:155], v[20:23]
v_cvt_pk_bf16_f32 v172, v196, v197
v_cvt_pk_bf16_f32 v173, v198, v199
v_mfma_f32_16x16x32_bf16 v[20:23], v[232:235], v[164:167], v[20:23]
v_exp_f32 v200, v200
v_mfma_f32_16x16x32_bf16 a[240:243], a[252:255], v[144:147], a[240:243]
s_waitcnt lgkmcnt(2)
v_exp_f32 v201, v201
v_mfma_f32_16x16x32_bf16 a[240:243], a[252:255], v[156:159], a[240:243]
s_add_u32 m0, s60, 131072
ds_read_b64_tr_b16 v[220:221], v242 offset:49152
ds_read_b64_tr_b16 v[222:223], v242 offset:50176
v_mfma_f32_16x16x32_bf16 v[192:195], v[204:207], v[96:99], 0
ds_read_b64_tr_b16 v[224:225], v242 offset:51200
v_xor_b32 v243, 96, v240
v_mfma_f32_16x16x32_bf16 v[192:195], v[208:211], v[108:111], v[192:195]
s_waitcnt lgkmcnt(3)
ds_read_b64_tr_b16 v[226:227], v242 offset:52224
v_cvt_pk_bf16_f32 v176, v200, v201
v_mfma_f32_16x16x32_bf16 v[192:195], v[212:215], v[120:123], v[192:195]
ds_read_b64_tr_b16 v[228:229], v243 offset:49152
v_mfma_f32_16x16x32_bf16 v[192:195], v[216:219], v[132:135], v[192:195]
v_exp_f32 v202, v202
v_mfma_f32_16x16x32_bf16 v[196:199], v[204:207], v[100:103], 0
v_exp_f32 v203, v203
v_mfma_f32_16x16x32_bf16 v[196:199], v[208:211], v[112:115], v[196:199]
ds_read_b64_tr_b16 v[230:231], v243 offset:50176
v_cvt_pk_bf16_f32 v177, v202, v203
v_mfma_f32_16x16x32_bf16 v[196:199], v[212:215], v[124:127], v[196:199]
ds_read_b64_tr_b16 v[232:233], v243 offset:51200
ds_read_b64_tr_b16 v[234:235], v243 offset:52224
v_mfma_f32_16x16x32_bf16 v[196:199], v[216:219], v[136:139], v[196:199]
buffer_load_dwordx4 v244, s[8:11], s47 offen offset:0 nt lds
v_mfma_f32_16x16x32_bf16 v[200:203], v[204:207], v[104:107], 0
v_exp_f32 v192, v192
v_mfma_f32_16x16x32_bf16 v[200:203], v[208:211], v[116:119], v[200:203]
v_exp_f32 v193, v193
v_mfma_f32_16x16x32_bf16 v[200:203], v[212:215], v[128:131], v[200:203]
s_waitcnt lgkmcnt(4)
v_exp_f32 v194, v194
v_mfma_f32_16x16x32_bf16 v[200:203], v[216:219], v[140:143], v[200:203]
ds_read_b128 v[204:207], v236 offset:2048
v_cvt_pk_bf16_f32 v170, v192, v193
v_mfma_f32_16x16x32_bf16 v[24:27], v[220:223], v[144:147], v[24:27]
v_exp_f32 v195, v195
v_mfma_f32_16x16x32_bf16 v[24:27], v[224:227], v[156:159], v[24:27]
ds_read_b128 v[208:211], v237 offset:2048
v_cvt_pk_bf16_f32 v171, v194, v195
v_mfma_f32_16x16x32_bf16 v[28:31], v[220:223], v[148:151], v[28:31]
v_exp_f32 v196, v196
v_mfma_f32_16x16x32_bf16 v[28:31], v[224:227], v[160:163], v[28:31]
ds_read_b128 v[212:215], v238 offset:2048
v_xor_b32 v242, 128, v240
v_mfma_f32_16x16x32_bf16 v[32:35], v[220:223], v[152:155], v[32:35]
v_exp_f32 v197, v197
v_mfma_f32_16x16x32_bf16 v[32:35], v[224:227], v[164:167], v[32:35]
s_waitcnt lgkmcnt(3)
ds_read_b128 v[216:219], v239 offset:2048
v_cvt_pk_bf16_f32 v174, v196, v197
v_mfma_f32_16x16x32_bf16 v[36:39], v[228:231], v[144:147], v[36:39]
v_exp_f32 v198, v198
v_mfma_f32_16x16x32_bf16 v[36:39], v[232:235], v[156:159], v[36:39]
v_exp_f32 v199, v199
v_mfma_f32_16x16x32_bf16 v[40:43], v[228:231], v[148:151], v[40:43]
v_cvt_pk_bf16_f32 v175, v198, v199
v_xor_b32 v243, 160, v240
v_mfma_f32_16x16x32_bf16 v[40:43], v[232:235], v[160:163], v[40:43]
v_exp_f32 v200, v200
v_mfma_f32_16x16x32_bf16 v[44:47], v[228:231], v[152:155], v[44:47]
v_exp_f32 v201, v201
v_mfma_f32_16x16x32_bf16 v[44:47], v[232:235], v[164:167], v[44:47]
v_exp_f32 v202, v202
v_mfma_f32_16x16x32_bf16 a[244:247], a[252:255], v[148:151], a[244:247]
s_waitcnt lgkmcnt(2)
buffer_load_dwordx4 v244, s[8:11], s47 offen offset:1024 nt lds
v_mfma_f32_16x16x32_bf16 a[244:247], a[252:255], v[160:163], a[244:247]
ds_read_b64_tr_b16 v[220:221], v242 offset:49152
ds_read_b64_tr_b16 v[222:223], v242 offset:50176
v_mfma_f32_16x16x32_bf16 v[192:195], v[204:207], v[96:99], 0
ds_read_b64_tr_b16 v[224:225], v242 offset:51200
v_cvt_pk_bf16_f32 v178, v200, v201
v_mfma_f32_16x16x32_bf16 v[192:195], v[208:211], v[108:111], v[192:195]
s_waitcnt lgkmcnt(3)
ds_read_b64_tr_b16 v[226:227], v242 offset:52224
v_mfma_f32_16x16x32_bf16 v[192:195], v[212:215], v[120:123], v[192:195]
ds_read_b64_tr_b16 v[228:229], v243 offset:49152
v_mfma_f32_16x16x32_bf16 v[192:195], v[216:219], v[132:135], v[192:195]
v_exp_f32 v203, v203
v_mfma_f32_16x16x32_bf16 v[196:199], v[204:207], v[100:103], 0
ds_read_b64_tr_b16 v[230:231], v243 offset:50176
v_cvt_pk_bf16_f32 v179, v202, v203
v_mfma_f32_16x16x32_bf16 v[196:199], v[208:211], v[112:115], v[196:199]
ds_read_b64_tr_b16 v[232:233], v243 offset:51200
ds_read_b64_tr_b16 v[234:235], v243 offset:52224
v_mfma_f32_16x16x32_bf16 v[196:199], v[212:215], v[124:127], v[196:199]
v_exp_f32 v192, v192
v_mfma_f32_16x16x32_bf16 v[196:199], v[216:219], v[136:139], v[196:199]
v_exp_f32 v193, v193
v_mfma_f32_16x16x32_bf16 v[200:203], v[204:207], v[104:107], 0
v_exp_f32 v194, v194
v_mfma_f32_16x16x32_bf16 v[200:203], v[208:211], v[116:119], v[200:203]
v_exp_f32 v195, v195
v_mfma_f32_16x16x32_bf16 v[200:203], v[212:215], v[128:131], v[200:203]
s_waitcnt lgkmcnt(4)
v_cvt_pk_bf16_f32 v180, v192, v193
v_cvt_pk_bf16_f32 v181, v194, v195
v_mfma_f32_16x16x32_bf16 v[200:203], v[216:219], v[140:143], v[200:203]
ds_read_b128 v[204:207], v236 offset:3072
v_mfma_f32_16x16x32_bf16 v[48:51], v[220:223], v[144:147], v[48:51]
v_exp_f32 v196, v196
v_mfma_f32_16x16x32_bf16 v[48:51], v[224:227], v[156:159], v[48:51]
ds_read_b128 v[208:211], v237 offset:3072
v_mfma_f32_16x16x32_bf16 v[52:55], v[220:223], v[148:151], v[52:55]
v_exp_f32 v197, v197
v_mfma_f32_16x16x32_bf16 v[52:55], v[224:227], v[160:163], v[52:55]
ds_read_b128 v[212:215], v238 offset:3072
v_xor_b32 v242, 192, v240
v_mfma_f32_16x16x32_bf16 v[56:59], v[220:223], v[152:155], v[56:59]
v_exp_f32 v198, v198
v_mfma_f32_16x16x32_bf16 v[56:59], v[224:227], v[164:167], v[56:59]
s_waitcnt lgkmcnt(3)
ds_read_b128 v[216:219], v239 offset:3072
v_cvt_pk_bf16_f32 v184, v196, v197
v_mfma_f32_16x16x32_bf16 v[60:63], v[228:231], v[144:147], v[60:63]
buffer_load_dwordx4 v244, s[8:11], s47 offen offset:2048 nt lds
v_mfma_f32_16x16x32_bf16 v[60:63], v[232:235], v[156:159], v[60:63]
v_exp_f32 v199, v199
v_mfma_f32_16x16x32_bf16 v[64:67], v[228:231], v[148:151], v[64:67]
v_cvt_pk_bf16_f32 v185, v198, v199
v_xor_b32 v243, 224, v240
v_mfma_f32_16x16x32_bf16 v[64:67], v[232:235], v[160:163], v[64:67]
v_exp_f32 v200, v200
v_mfma_f32_16x16x32_bf16 v[68:71], v[228:231], v[152:155], v[68:71]
v_exp_f32 v201, v201
v_mfma_f32_16x16x32_bf16 v[68:71], v[232:235], v[164:167], v[68:71]
v_exp_f32 v202, v202
v_mfma_f32_16x16x32_bf16 a[248:251], a[252:255], v[152:155], a[248:251]
s_waitcnt lgkmcnt(2)
v_exp_f32 v203, v203
v_mfma_f32_16x16x32_bf16 a[248:251], a[252:255], v[164:167], a[248:251]
ds_read_b64_tr_b16 v[220:221], v242 offset:49152
ds_read_b64_tr_b16 v[222:223], v242 offset:50176
v_mfma_f32_16x16x32_bf16 v[192:195], v[204:207], v[96:99], 0
ds_read_b64_tr_b16 v[224:225], v242 offset:51200
v_cvt_pk_bf16_f32 v188, v200, v201
v_mfma_f32_16x16x32_bf16 v[192:195], v[208:211], v[108:111], v[192:195]
s_waitcnt lgkmcnt(3)
ds_read_b64_tr_b16 v[226:227], v242 offset:52224
v_cvt_pk_bf16_f32 v189, v202, v203
v_mfma_f32_16x16x32_bf16 v[192:195], v[212:215], v[120:123], v[192:195]
ds_read_b64_tr_b16 v[228:229], v243 offset:49152
v_add_u32 v236, 0xfffec000, v236
v_mfma_f32_16x16x32_bf16 v[192:195], v[216:219], v[132:135], v[192:195]
ds_read_b64_tr_b16 v[230:231], v243 offset:50176
ds_read_b64_tr_b16 v[232:233], v243 offset:51200
v_mfma_f32_16x16x32_bf16 v[196:199], v[204:207], v[100:103], 0
ds_read_b64_tr_b16 v[234:235], v243 offset:52224
v_add_u32 v237, 0xfffec000, v237
v_mfma_f32_16x16x32_bf16 v[196:199], v[208:211], v[112:115], v[196:199]
v_add_u32 v238, 0xfffec000, v238
v_add_u32 v239, 0xfffec000, v239
v_mfma_f32_16x16x32_bf16 v[196:199], v[212:215], v[124:127], v[196:199]
v_exp_f32 v192, v192
v_mfma_f32_16x16x32_bf16 v[196:199], v[216:219], v[136:139], v[196:199]
v_exp_f32 v193, v193
v_mfma_f32_16x16x32_bf16 v[200:203], v[204:207], v[104:107], 0
v_exp_f32 v194, v194
v_mfma_f32_16x16x32_bf16 v[200:203], v[208:211], v[116:119], v[200:203]
buffer_load_dwordx4 v244, s[8:11], s47 offen offset:3072 nt lds
v_mfma_f32_16x16x32_bf16 v[200:203], v[212:215], v[128:131], v[200:203]
s_waitcnt lgkmcnt(4)
v_exp_f32 v195, v195
v_mfma_f32_16x16x32_bf16 v[200:203], v[216:219], v[140:143], v[200:203]
s_waitcnt vmcnt(12) lgkmcnt(0)
v_cvt_pk_bf16_f32 v182, v192, v193
v_cvt_pk_bf16_f32 v183, v194, v195
v_mfma_f32_16x16x32_bf16 v[72:75], v[220:223], v[144:147], v[72:75]
s_barrier
ds_read_b128 v[204:207], v236 offset:49152
v_mfma_f32_16x16x32_bf16 v[72:75], v[224:227], v[156:159], v[72:75]
s_add_u32 s47, s47, 0x4000
v_exp_f32 v196, v196
v_mfma_f32_16x16x32_bf16 v[76:79], v[220:223], v[148:151], v[76:79]
ds_read_b128 v[208:211], v237 offset:49152
v_xor_b32 v243, 32, v240
v_mfma_f32_16x16x32_bf16 v[76:79], v[224:227], v[160:163], v[76:79]
v_exp_f32 v197, v197
v_mfma_f32_16x16x32_bf16 v[80:83], v[220:223], v[152:155], v[80:83]
ds_read_b128 v[212:215], v238 offset:49152
v_cvt_pk_bf16_f32 v186, v196, v197
v_mfma_f32_16x16x32_bf16 v[80:83], v[224:227], v[164:167], v[80:83]
v_exp_f32 v198, v198
v_mfma_f32_16x16x32_bf16 v[84:87], v[228:231], v[144:147], v[84:87]
v_exp_f32 v199, v199
v_mfma_f32_16x16x32_bf16 v[84:87], v[232:235], v[156:159], v[84:87]
ds_read_b128 v[216:219], v239 offset:49152
v_cvt_pk_bf16_f32 v187, v198, v199
v_mfma_f32_16x16x32_bf16 v[88:91], v[228:231], v[148:151], v[88:91]
v_exp_f32 v200, v200
v_mfma_f32_16x16x32_bf16 v[88:91], v[232:235], v[160:163], v[88:91]
v_exp_f32 v201, v201
v_mfma_f32_16x16x32_bf16 v[92:95], v[228:231], v[152:155], v[92:95]
s_waitcnt lgkmcnt(2)
v_exp_f32 v202, v202
v_mfma_f32_16x16x32_bf16 v[92:95], v[232:235], v[164:167], v[92:95]
s_add_u32 m0, s60, 16384
ds_read_b64_tr_b16 v[220:221], v240 offset:32768
ds_read_b64_tr_b16 v[222:223], v240 offset:33792
v_mfma_f32_16x16x32_bf16 v[192:195], v[204:207], v[96:99], 0
ds_read_b64_tr_b16 v[224:225], v240 offset:34816
v_cvt_pk_bf16_f32 v190, v200, v201
v_mfma_f32_16x16x32_bf16 v[192:195], v[208:211], v[108:111], v[192:195]
s_waitcnt lgkmcnt(3)
ds_read_b64_tr_b16 v[226:227], v240 offset:35840
v_mfma_f32_16x16x32_bf16 v[192:195], v[212:215], v[120:123], v[192:195]
ds_read_b64_tr_b16 v[228:229], v243 offset:32768
v_mfma_f32_16x16x32_bf16 v[192:195], v[216:219], v[132:135], v[192:195]
v_exp_f32 v203, v203
v_mfma_f32_16x16x32_bf16 v[196:199], v[204:207], v[100:103], 0
ds_read_b64_tr_b16 v[230:231], v243 offset:33792
v_cvt_pk_bf16_f32 v191, v202, v203
v_mfma_f32_16x16x32_bf16 v[196:199], v[208:211], v[112:115], v[196:199]
ds_read_b64_tr_b16 v[232:233], v243 offset:34816
ds_read_b64_tr_b16 v[234:235], v243 offset:35840
v_mfma_f32_16x16x32_bf16 v[196:199], v[212:215], v[124:127], v[196:199]
buffer_load_dwordx4 v245, s[12:15], s48 offen offset:0 nt lds
v_mfma_f32_16x16x32_bf16 v[196:199], v[216:219], v[136:139], v[196:199]
v_exp_f32 v192, v192
v_mfma_f32_16x16x32_bf16 v[200:203], v[204:207], v[104:107], 0
v_exp_f32 v193, v193
v_mfma_f32_16x16x32_bf16 v[200:203], v[208:211], v[116:119], v[200:203]
v_exp_f32 v194, v194
v_mfma_f32_16x16x32_bf16 v[200:203], v[212:215], v[128:131], v[200:203]
s_waitcnt lgkmcnt(4)
v_exp_f32 v195, v195
v_mfma_f32_16x16x32_bf16 v[200:203], v[216:219], v[140:143], v[200:203]
ds_read_b128 v[204:207], v236 offset:50176
v_cvt_pk_bf16_f32 v144, v192, v193
v_mfma_f32_16x16x32_bf16 v[0:3], v[220:223], v[168:171], v[0:3]
v_exp_f32 v196, v196
v_mfma_f32_16x16x32_bf16 v[0:3], v[224:227], v[180:183], v[0:3]
ds_read_b128 v[208:211], v237 offset:50176
v_cvt_pk_bf16_f32 v145, v194, v195
v_mfma_f32_16x16x32_bf16 v[4:7], v[220:223], v[172:175], v[4:7]
v_exp_f32 v197, v197
v_mfma_f32_16x16x32_bf16 v[4:7], v[224:227], v[184:187], v[4:7]
ds_read_b128 v[212:215], v238 offset:50176
v_xor_b32 v242, 64, v240
v_mfma_f32_16x16x32_bf16 v[8:11], v[220:223], v[176:179], v[8:11]
v_exp_f32 v198, v198
v_mfma_f32_16x16x32_bf16 v[8:11], v[224:227], v[188:191], v[8:11]
s_waitcnt lgkmcnt(3)
ds_read_b128 v[216:219], v239 offset:50176
v_cvt_pk_bf16_f32 v148, v196, v197
v_mfma_f32_16x16x32_bf16 v[12:15], v[228:231], v[168:171], v[12:15]
v_exp_f32 v199, v199
v_mfma_f32_16x16x32_bf16 v[12:15], v[232:235], v[180:183], v[12:15]
v_cvt_pk_bf16_f32 v149, v198, v199
v_xor_b32 v243, 96, v240
v_mfma_f32_16x16x32_bf16 v[16:19], v[228:231], v[172:175], v[16:19]
s_mov_b32 s56, s87
v_exp_f32 v200, v200
v_mfma_f32_16x16x32_bf16 v[16:19], v[232:235], v[184:187], v[16:19]
s_add_u32 s57, s56, s53
v_exp_f32 v201, v201
v_mfma_f32_16x16x32_bf16 v[20:23], v[228:231], v[176:179], v[20:23]
s_add_u32 s58, s56, s54
v_exp_f32 v202, v202
v_mfma_f32_16x16x32_bf16 v[20:23], v[232:235], v[188:191], v[20:23]
s_add_u32 s59, s56, s55
buffer_load_dwordx4 v245, s[12:15], s48 offen offset:1024 nt lds
v_mfma_f32_16x16x32_bf16 a[240:243], a[252:255], v[168:171], a[240:243]
s_waitcnt lgkmcnt(2)
v_exp_f32 v203, v203
v_mfma_f32_16x16x32_bf16 a[240:243], a[252:255], v[180:183], a[240:243]
ds_read_b64_tr_b16 v[220:221], v242 offset:32768
ds_read_b64_tr_b16 v[222:223], v242 offset:33792
v_mfma_f32_16x16x32_bf16 v[192:195], v[204:207], v[96:99], 0
s_add_u32 m0, s60, 81920
ds_read_b64_tr_b16 v[224:225], v242 offset:34816
v_cvt_pk_bf16_f32 v152, v200, v201
v_mfma_f32_16x16x32_bf16 v[192:195], v[208:211], v[108:111], v[192:195]
s_waitcnt lgkmcnt(3)
ds_read_b64_tr_b16 v[226:227], v242 offset:35840
v_cvt_pk_bf16_f32 v153, v202, v203
v_mfma_f32_16x16x32_bf16 v[192:195], v[212:215], v[120:123], v[192:195]
ds_read_b64_tr_b16 v[228:229], v243 offset:32768
v_mfma_f32_16x16x32_bf16 v[192:195], v[216:219], v[132:135], v[192:195]
ds_read_b64_tr_b16 v[230:231], v243 offset:33792
ds_read_b64_tr_b16 v[232:233], v243 offset:34816
v_mfma_f32_16x16x32_bf16 v[196:199], v[204:207], v[100:103], 0
ds_read_b64_tr_b16 v[234:235], v243 offset:35840
v_mfma_f32_16x16x32_bf16 v[196:199], v[208:211], v[112:115], v[196:199]
v_mfma_f32_16x16x32_bf16 v[196:199], v[212:215], v[124:127], v[196:199]
buffer_load_dwordx4 v247, s[20:23], s56 offen offset:0 lds
v_mfma_f32_16x16x32_bf16 v[196:199], v[216:219], v[136:139], v[196:199]
v_exp_f32 v192, v192
v_mfma_f32_16x16x32_bf16 v[200:203], v[204:207], v[104:107], 0
v_exp_f32 v193, v193
v_mfma_f32_16x16x32_bf16 v[200:203], v[208:211], v[116:119], v[200:203]
v_exp_f32 v194, v194
v_mfma_f32_16x16x32_bf16 v[200:203], v[212:215], v[128:131], v[200:203]
s_waitcnt lgkmcnt(4)
v_exp_f32 v195, v195
v_mfma_f32_16x16x32_bf16 v[200:203], v[216:219], v[140:143], v[200:203]
ds_read_b128 v[204:207], v236 offset:51200
v_cvt_pk_bf16_f32 v146, v192, v193
v_mfma_f32_16x16x32_bf16 v[24:27], v[220:223], v[168:171], v[24:27]
v_exp_f32 v196, v196
v_mfma_f32_16x16x32_bf16 v[24:27], v[224:227], v[180:183], v[24:27]
ds_read_b128 v[208:211], v237 offset:51200
v_cvt_pk_bf16_f32 v147, v194, v195
v_mfma_f32_16x16x32_bf16 v[28:31], v[220:223], v[172:175], v[28:31]
buffer_load_dwordx4 v247, s[20:23], s57 offen offset:1024 lds
v_mfma_f32_16x16x32_bf16 v[28:31], v[224:227], v[184:187], v[28:31]
s_add_u32 m0, s60, 16384
ds_read_b128 v[212:215], v238 offset:51200
v_xor_b32 v242, 128, v240
v_mfma_f32_16x16x32_bf16 v[32:35], v[220:223], v[176:179], v[32:35]
v_exp_f32 v197, v197
v_mfma_f32_16x16x32_bf16 v[32:35], v[224:227], v[188:191], v[32:35]
s_waitcnt lgkmcnt(3)
ds_read_b128 v[216:219], v239 offset:51200
v_cvt_pk_bf16_f32 v150, v196, v197
v_mfma_f32_16x16x32_bf16 v[36:39], v[228:231], v[168:171], v[36:39]
buffer_load_dwordx4 v245, s[12:15], s48 offen offset:2048 nt lds
v_mfma_f32_16x16x32_bf16 v[36:39], v[232:235], v[180:183], v[36:39]
s_add_u32 m0, s60, 81920
v_exp_f32 v198, v198
v_mfma_f32_16x16x32_bf16 v[40:43], v[228:231], v[172:175], v[40:43]
v_exp_f32 v199, v199
v_mfma_f32_16x16x32_bf16 v[40:43], v[232:235], v[184:187], v[40:43]
v_cvt_pk_bf16_f32 v151, v198, v199
v_xor_b32 v243, 160, v240
v_mfma_f32_16x16x32_bf16 v[44:47], v[228:231], v[176:179], v[44:47]
buffer_load_dwordx4 v247, s[20:23], s58 offen offset:2048 lds
v_mfma_f32_16x16x32_bf16 v[44:47], v[232:235], v[188:191], v[44:47]
v_exp_f32 v200, v200
v_mfma_f32_16x16x32_bf16 a[244:247], a[252:255], v[172:175], a[244:247]
s_waitcnt lgkmcnt(2)
v_exp_f32 v201, v201
v_mfma_f32_16x16x32_bf16 a[244:247], a[252:255], v[184:187], a[244:247]
ds_read_b64_tr_b16 v[220:221], v242 offset:32768
ds_read_b64_tr_b16 v[222:223], v242 offset:33792
v_mfma_f32_16x16x32_bf16 v[192:195], v[204:207], v[96:99], 0
ds_read_b64_tr_b16 v[224:225], v242 offset:34816
v_cvt_pk_bf16_f32 v154, v200, v201
v_mfma_f32_16x16x32_bf16 v[192:195], v[208:211], v[108:111], v[192:195]
s_waitcnt lgkmcnt(3)
ds_read_b64_tr_b16 v[226:227], v242 offset:35840
v_mfma_f32_16x16x32_bf16 v[192:195], v[212:215], v[120:123], v[192:195]
ds_read_b64_tr_b16 v[228:229], v243 offset:32768
v_mfma_f32_16x16x32_bf16 v[192:195], v[216:219], v[132:135], v[192:195]
buffer_load_dwordx4 v247, s[20:23], s59 offen offset:3072 lds
v_mfma_f32_16x16x32_bf16 v[196:199], v[204:207], v[100:103], 0
s_add_u32 m0, s60, 16384
v_exp_f32 v202, v202
v_mfma_f32_16x16x32_bf16 v[196:199], v[208:211], v[112:115], v[196:199]
v_exp_f32 v203, v203
v_mfma_f32_16x16x32_bf16 v[196:199], v[212:215], v[124:127], v[196:199]
ds_read_b64_tr_b16 v[230:231], v243 offset:33792
v_cvt_pk_bf16_f32 v155, v202, v203
v_mfma_f32_16x16x32_bf16 v[196:199], v[216:219], v[136:139], v[196:199]
ds_read_b64_tr_b16 v[232:233], v243 offset:34816
ds_read_b64_tr_b16 v[234:235], v243 offset:35840
v_mfma_f32_16x16x32_bf16 v[200:203], v[204:207], v[104:107], 0
buffer_load_dwordx4 v245, s[12:15], s48 offen offset:3072 nt lds
v_mfma_f32_16x16x32_bf16 v[200:203], v[208:211], v[116:119], v[200:203]
s_add_u32 s48, s48, 0x4000
v_exp_f32 v192, v192
v_mfma_f32_16x16x32_bf16 v[200:203], v[212:215], v[128:131], v[200:203]
s_waitcnt lgkmcnt(4)
v_exp_f32 v193, v193
v_mfma_f32_16x16x32_bf16 v[200:203], v[216:219], v[140:143], v[200:203]
ds_read_b128 v[204:207], v236 offset:52224
v_cvt_pk_bf16_f32 v156, v192, v193
v_mfma_f32_16x16x32_bf16 v[48:51], v[220:223], v[168:171], v[48:51]
v_exp_f32 v194, v194
v_mfma_f32_16x16x32_bf16 v[48:51], v[224:227], v[180:183], v[48:51]
ds_read_b128 v[208:211], v237 offset:52224
v_mfma_f32_16x16x32_bf16 v[52:55], v[220:223], v[172:175], v[52:55]
v_exp_f32 v195, v195
v_mfma_f32_16x16x32_bf16 v[52:55], v[224:227], v[184:187], v[52:55]
ds_read_b128 v[212:215], v238 offset:52224
v_cvt_pk_bf16_f32 v157, v194, v195
v_mfma_f32_16x16x32_bf16 v[56:59], v[220:223], v[176:179], v[56:59]
v_xor_b32 v242, 192, v240
v_xor_b32 v243, 224, v240
v_mfma_f32_16x16x32_bf16 v[56:59], v[224:227], v[188:191], v[56:59]
s_waitcnt lgkmcnt(3)
ds_read_b128 v[216:219], v239 offset:52224
v_mfma_f32_16x16x32_bf16 v[60:63], v[228:231], v[168:171], v[60:63]
v_exp_f32 v196, v196
v_mfma_f32_16x16x32_bf16 v[60:63], v[232:235], v[180:183], v[60:63]
v_exp_f32 v197, v197
v_mfma_f32_16x16x32_bf16 v[64:67], v[228:231], v[172:175], v[64:67]
v_exp_f32 v198, v198
v_mfma_f32_16x16x32_bf16 v[64:67], v[232:235], v[184:187], v[64:67]
s_add_u32 m0, s60, 98304
v_exp_f32 v199, v199
v_mfma_f32_16x16x32_bf16 v[68:71], v[228:231], v[176:179], v[68:71]
v_cvt_pk_bf16_f32 v160, v196, v197
v_cvt_pk_bf16_f32 v161, v198, v199
v_mfma_f32_16x16x32_bf16 v[68:71], v[232:235], v[188:191], v[68:71]
v_exp_f32 v200, v200
v_mfma_f32_16x16x32_bf16 a[248:251], a[252:255], v[176:179], a[248:251]
s_waitcnt lgkmcnt(2)
v_exp_f32 v201, v201
v_mfma_f32_16x16x32_bf16 a[248:251], a[252:255], v[188:191], a[248:251]
ds_read_b64_tr_b16 v[220:221], v242 offset:32768
ds_read_b64_tr_b16 v[222:223], v242 offset:33792
v_mfma_f32_16x16x32_bf16 v[192:195], v[204:207], v[96:99], 0
ds_read_b64_tr_b16 v[224:225], v242 offset:34816
v_cvt_pk_bf16_f32 v164, v200, v201
v_mfma_f32_16x16x32_bf16 v[192:195], v[208:211], v[108:111], v[192:195]
s_waitcnt lgkmcnt(3)
ds_read_b64_tr_b16 v[226:227], v242 offset:35840
v_add_u32 v236, 0x14000, v236
v_mfma_f32_16x16x32_bf16 v[192:195], v[212:215], v[120:123], v[192:195]
ds_read_b64_tr_b16 v[228:229], v243 offset:32768
v_add_u32 v237, 0x14000, v237
v_mfma_f32_16x16x32_bf16 v[192:195], v[216:219], v[132:135], v[192:195]
buffer_load_dwordx4 v244, s[8:11], s47 offen offset:0 nt lds
v_mfma_f32_16x16x32_bf16 v[196:199], v[204:207], v[100:103], 0
v_exp_f32 v202, v202
v_mfma_f32_16x16x32_bf16 v[196:199], v[208:211], v[112:115], v[196:199]
v_exp_f32 v203, v203
v_mfma_f32_16x16x32_bf16 v[196:199], v[212:215], v[124:127], v[196:199]
ds_read_b64_tr_b16 v[230:231], v243 offset:33792
v_cvt_pk_bf16_f32 v165, v202, v203
v_mfma_f32_16x16x32_bf16 v[196:199], v[216:219], v[136:139], v[196:199]
ds_read_b64_tr_b16 v[232:233], v243 offset:34816
ds_read_b64_tr_b16 v[234:235], v243 offset:35840
v_mfma_f32_16x16x32_bf16 v[200:203], v[204:207], v[104:107], 0
v_add_u32 v238, 0x14000, v238
v_add_u32 v239, 0x14000, v239
v_mfma_f32_16x16x32_bf16 v[200:203], v[208:211], v[116:119], v[200:203]
v_exp_f32 v192, v192
v_mfma_f32_16x16x32_bf16 v[200:203], v[212:215], v[128:131], v[200:203]
s_waitcnt lgkmcnt(4)
v_exp_f32 v193, v193
v_mfma_f32_16x16x32_bf16 v[200:203], v[216:219], v[140:143], v[200:203]
s_waitcnt vmcnt(13) lgkmcnt(0)
v_exp_f32 v194, v194
v_mfma_f32_16x16x32_bf16 v[72:75], v[220:223], v[168:171], v[72:75]
s_barrier
ds_read_b128 v[204:207], v236 offset:49152
v_cvt_pk_bf16_f32 v158, v192, v193
v_mfma_f32_16x16x32_bf16 v[72:75], v[224:227], v[180:183], v[72:75]
v_exp_f32 v195, v195
v_mfma_f32_16x16x32_bf16 v[76:79], v[220:223], v[172:175], v[76:79]
ds_read_b128 v[208:211], v237 offset:49152
v_cvt_pk_bf16_f32 v159, v194, v195
v_mfma_f32_16x16x32_bf16 v[76:79], v[224:227], v[184:187], v[76:79]
v_exp_f32 v196, v196
v_mfma_f32_16x16x32_bf16 v[80:83], v[220:223], v[176:179], v[80:83]
ds_read_b128 v[212:215], v238 offset:49152
v_xor_b32 v243, 32, v240
v_mfma_f32_16x16x32_bf16 v[80:83], v[224:227], v[188:191], v[80:83]
v_exp_f32 v197, v197
v_mfma_f32_16x16x32_bf16 v[84:87], v[228:231], v[168:171], v[84:87]
ds_read_b128 v[216:219], v239 offset:49152
v_cvt_pk_bf16_f32 v162, v196, v197
v_mfma_f32_16x16x32_bf16 v[84:87], v[232:235], v[180:183], v[84:87]
v_exp_f32 v198, v198
v_mfma_f32_16x16x32_bf16 v[88:91], v[228:231], v[172:175], v[88:91]
buffer_load_dwordx4 v244, s[8:11], s47 offen offset:1024 nt lds
v_mfma_f32_16x16x32_bf16 v[88:91], v[232:235], v[184:187], v[88:91]
v_exp_f32 v199, v199
v_mfma_f32_16x16x32_bf16 v[92:95], v[228:231], v[176:179], v[92:95]
s_waitcnt lgkmcnt(2)
v_exp_f32 v200, v200
v_mfma_f32_16x16x32_bf16 v[92:95], v[232:235], v[188:191], v[92:95]
s_mov_b32 s56, s88
ds_read_b64_tr_b16 v[220:221], v240 offset:0
ds_read_b64_tr_b16 v[222:223], v240 offset:1024
v_mfma_f32_16x16x32_bf16 v[192:195], v[204:207], v[96:99], 0
s_add_u32 s57, s56, s53
ds_read_b64_tr_b16 v[224:225], v240 offset:2048
v_cvt_pk_bf16_f32 v163, v198, v199
v_mfma_f32_16x16x32_bf16 v[192:195], v[208:211], v[108:111], v[192:195]
s_waitcnt lgkmcnt(3)
ds_read_b64_tr_b16 v[226:227], v240 offset:3072
v_mfma_f32_16x16x32_bf16 v[192:195], v[212:215], v[120:123], v[192:195]
s_add_u32 s58, s56, s54
ds_read_b64_tr_b16 v[228:229], v243 offset:0
v_mfma_f32_16x16x32_bf16 v[192:195], v[216:219], v[132:135], v[192:195]
s_add_u32 s59, s56, s55
v_exp_f32 v201, v201
v_mfma_f32_16x16x32_bf16 v[196:199], v[204:207], v[100:103], 0
s_add_u32 m0, s60, 114688
v_exp_f32 v202, v202
v_mfma_f32_16x16x32_bf16 v[196:199], v[208:211], v[112:115], v[196:199]
v_exp_f32 v203, v203
v_mfma_f32_16x16x32_bf16 v[196:199], v[212:215], v[124:127], v[196:199]
ds_read_b64_tr_b16 v[230:231], v243 offset:1024
v_cvt_pk_bf16_f32 v166, v200, v201
v_mfma_f32_16x16x32_bf16 v[196:199], v[216:219], v[136:139], v[196:199]
ds_read_b64_tr_b16 v[232:233], v243 offset:2048
v_cvt_pk_bf16_f32 v167, v202, v203
v_mfma_f32_16x16x32_bf16 v[200:203], v[204:207], v[104:107], 0
ds_read_b64_tr_b16 v[234:235], v243 offset:3072
v_mfma_f32_16x16x32_bf16 v[200:203], v[208:211], v[116:119], v[200:203]
v_exp_f32 v192, v192
v_mfma_f32_16x16x32_bf16 v[200:203], v[212:215], v[128:131], v[200:203]
s_waitcnt lgkmcnt(4)
buffer_load_dwordx4 v247, s[20:23], s56 offen offset:0 lds
v_mfma_f32_16x16x32_bf16 v[200:203], v[216:219], v[140:143], v[200:203]
s_add_u32 m0, s60, 98304
ds_read_b128 v[204:207], v236 offset:50176
v_mfma_f32_16x16x32_bf16 v[0:3], v[220:223], v[144:147], v[0:3]
v_exp_f32 v193, v193
v_mfma_f32_16x16x32_bf16 v[0:3], v[224:227], v[156:159], v[0:3]
ds_read_b128 v[208:211], v237 offset:50176
v_cvt_pk_bf16_f32 v168, v192, v193
v_mfma_f32_16x16x32_bf16 v[4:7], v[220:223], v[148:151], v[4:7]
v_exp_f32 v194, v194
v_mfma_f32_16x16x32_bf16 v[4:7], v[224:227], v[160:163], v[4:7]
ds_read_b128 v[212:215], v238 offset:50176
v_xor_b32 v242, 64, v240
v_mfma_f32_16x16x32_bf16 v[8:11], v[220:223], v[152:155], v[8:11]
buffer_load_dwordx4 v244, s[8:11], s47 offen offset:2048 nt lds
v_mfma_f32_16x16x32_bf16 v[8:11], v[224:227], v[164:167], v[8:11]
s_waitcnt lgkmcnt(3)
ds_read_b128 v[216:219], v239 offset:50176
v_xor_b32 v243, 96, v240
v_mfma_f32_16x16x32_bf16 v[12:15], v[228:231], v[144:147], v[12:15]
s_add_u32 m0, s60, 114688
v_exp_f32 v195, v195
v_mfma_f32_16x16x32_bf16 v[12:15], v[232:235], v[156:159], v[12:15]
v_exp_f32 v196, v196
v_mfma_f32_16x16x32_bf16 v[16:19], v[228:231], v[148:151], v[16:19]
buffer_load_dwordx4 v247, s[20:23], s57 offen offset:1024 lds
v_mfma_f32_16x16x32_bf16 v[16:19], v[232:235], v[160:163], v[16:19]
v_exp_f32 v197, v197
v_mfma_f32_16x16x32_bf16 v[20:23], v[228:231], v[152:155], v[20:23]
v_cvt_pk_bf16_f32 v169, v194, v195
v_cvt_pk_bf16_f32 v172, v196, v197
v_mfma_f32_16x16x32_bf16 v[20:23], v[232:235], v[164:167], v[20:23]
v_exp_f32 v198, v198
v_mfma_f32_16x16x32_bf16 a[240:243], a[252:255], v[144:147], a[240:243]
s_waitcnt lgkmcnt(2)
v_exp_f32 v199, v199
v_mfma_f32_16x16x32_bf16 a[240:243], a[252:255], v[156:159], a[240:243]
ds_read_b64_tr_b16 v[220:221], v242 offset:0
ds_read_b64_tr_b16 v[222:223], v242 offset:1024
v_mfma_f32_16x16x32_bf16 v[192:195], v[204:207], v[96:99], 0
buffer_load_dwordx4 v247, s[20:23], s58 offen offset:2048 lds
v_mfma_f32_16x16x32_bf16 v[192:195], v[208:211], v[108:111], v[192:195]
s_waitcnt lgkmcnt(2)
ds_read_b64_tr_b16 v[224:225], v242 offset:2048
v_cvt_pk_bf16_f32 v173, v198, v199
v_mfma_f32_16x16x32_bf16 v[192:195], v[212:215], v[120:123], v[192:195]
ds_read_b64_tr_b16 v[226:227], v242 offset:3072
ds_read_b64_tr_b16 v[228:229], v243 offset:0
v_mfma_f32_16x16x32_bf16 v[192:195], v[216:219], v[132:135], v[192:195]
v_exp_f32 v200, v200
v_mfma_f32_16x16x32_bf16 v[196:199], v[204:207], v[100:103], 0
v_exp_f32 v201, v201
v_mfma_f32_16x16x32_bf16 v[196:199], v[208:211], v[112:115], v[196:199]
v_exp_f32 v202, v202
v_mfma_f32_16x16x32_bf16 v[196:199], v[212:215], v[124:127], v[196:199]
ds_read_b64_tr_b16 v[230:231], v243 offset:1024
v_exp_f32 v203, v203
v_mfma_f32_16x16x32_bf16 v[196:199], v[216:219], v[136:139], v[196:199]
ds_read_b64_tr_b16 v[232:233], v243 offset:2048
v_cvt_pk_bf16_f32 v176, v200, v201
v_cvt_pk_bf16_f32 v177, v202, v203
v_mfma_f32_16x16x32_bf16 v[200:203], v[204:207], v[104:107], 0
ds_read_b64_tr_b16 v[234:235], v243 offset:3072
v_mfma_f32_16x16x32_bf16 v[200:203], v[208:211], v[116:119], v[200:203]
buffer_load_dwordx4 v247, s[20:23], s59 offen offset:3072 lds
v_mfma_f32_16x16x32_bf16 v[200:203], v[212:215], v[128:131], v[200:203]
s_add_u32 m0, s60, 98304
v_exp_f32 v192, v192
v_mfma_f32_16x16x32_bf16 v[200:203], v[216:219], v[140:143], v[200:203]
s_waitcnt lgkmcnt(4)
buffer_load_dwordx4 v244, s[8:11], s47 offen offset:3072 nt lds
v_mfma_f32_16x16x32_bf16 v[24:27], v[220:223], v[144:147], v[24:27]
s_add_u32 s47, s47, 0x4000
ds_read_b128 v[204:207], v236 offset:51200
v_mfma_f32_16x16x32_bf16 v[24:27], v[224:227], v[156:159], v[24:27]
s_and_b32 s47, s47, 0x7ffff
v_exp_f32 v193, v193
v_mfma_f32_16x16x32_bf16 v[28:31], v[220:223], v[148:151], v[28:31]
s_cmp_eq_u32 s61, 3
ds_read_b128 v[208:211], v237 offset:51200
v_cvt_pk_bf16_f32 v170, v192, v193
v_mfma_f32_16x16x32_bf16 v[28:31], v[224:227], v[160:163], v[28:31]
s_cselect_b32 s10, 0, s10
v_exp_f32 v194, v194
v_mfma_f32_16x16x32_bf16 v[32:35], v[220:223], v[152:155], v[32:35]
ds_read_b128 v[212:215], v238 offset:51200
v_xor_b32 v242, 128, v240
v_mfma_f32_16x16x32_bf16 v[32:35], v[224:227], v[164:167], v[32:35]
s_waitcnt lgkmcnt(3)
v_exp_f32 v195, v195
v_mfma_f32_16x16x32_bf16 v[36:39], v[228:231], v[144:147], v[36:39]
ds_read_b128 v[216:219], v239 offset:51200
v_cvt_pk_bf16_f32 v171, v194, v195
v_mfma_f32_16x16x32_bf16 v[36:39], v[232:235], v[156:159], v[36:39]
v_exp_f32 v196, v196
v_mfma_f32_16x16x32_bf16 v[40:43], v[228:231], v[148:151], v[40:43]
s_add_u32 m0, s60, 32768
v_exp_f32 v197, v197
v_mfma_f32_16x16x32_bf16 v[40:43], v[232:235], v[160:163], v[40:43]
v_exp_f32 v198, v198
v_mfma_f32_16x16x32_bf16 v[44:47], v[228:231], v[152:155], v[44:47]
v_exp_f32 v199, v199
v_mfma_f32_16x16x32_bf16 v[44:47], v[232:235], v[164:167], v[44:47]
v_cvt_pk_bf16_f32 v174, v196, v197
v_cvt_pk_bf16_f32 v175, v198, v199
v_mfma_f32_16x16x32_bf16 a[244:247], a[252:255], v[148:151], a[244:247]
s_waitcnt lgkmcnt(2)
v_exp_f32 v200, v200
v_mfma_f32_16x16x32_bf16 a[244:247], a[252:255], v[160:163], a[244:247]
ds_read_b64_tr_b16 v[220:221], v242 offset:0
ds_read_b64_tr_b16 v[222:223], v242 offset:1024
v_mfma_f32_16x16x32_bf16 v[192:195], v[204:207], v[96:99], 0
ds_read_b64_tr_b16 v[224:225], v242 offset:2048
v_xor_b32 v243, 160, v240
v_mfma_f32_16x16x32_bf16 v[192:195], v[208:211], v[108:111], v[192:195]
s_waitcnt lgkmcnt(3)
ds_read_b64_tr_b16 v[226:227], v242 offset:3072
v_mfma_f32_16x16x32_bf16 v[192:195], v[212:215], v[120:123], v[192:195]
buffer_load_dwordx4 v245, s[12:15], s48 offen offset:0 nt lds
v_mfma_f32_16x16x32_bf16 v[192:195], v[216:219], v[132:135], v[192:195]
ds_read_b64_tr_b16 v[228:229], v243 offset:0
ds_read_b64_tr_b16 v[230:231], v243 offset:1024
v_mfma_f32_16x16x32_bf16 v[196:199], v[204:207], v[100:103], 0
v_exp_f32 v201, v201
v_mfma_f32_16x16x32_bf16 v[196:199], v[208:211], v[112:115], v[196:199]
v_exp_f32 v202, v202
v_mfma_f32_16x16x32_bf16 v[196:199], v[212:215], v[124:127], v[196:199]
v_exp_f32 v203, v203
v_mfma_f32_16x16x32_bf16 v[196:199], v[216:219], v[136:139], v[196:199]
ds_read_b64_tr_b16 v[232:233], v243 offset:2048
v_cvt_pk_bf16_f32 v178, v200, v201
v_cvt_pk_bf16_f32 v179, v202, v203
v_mfma_f32_16x16x32_bf16 v[200:203], v[204:207], v[104:107], 0
ds_read_b64_tr_b16 v[234:235], v243 offset:3072
v_mfma_f32_16x16x32_bf16 v[200:203], v[208:211], v[116:119], v[200:203]
v_exp_f32 v192, v192
v_mfma_f32_16x16x32_bf16 v[200:203], v[212:215], v[128:131], v[200:203]
s_waitcnt lgkmcnt(4)
v_exp_f32 v193, v193
v_mfma_f32_16x16x32_bf16 v[200:203], v[216:219], v[140:143], v[200:203]
ds_read_b128 v[204:207], v236 offset:52224
v_cvt_pk_bf16_f32 v180, v192, v193
v_mfma_f32_16x16x32_bf16 v[48:51], v[220:223], v[144:147], v[48:51]
v_exp_f32 v194, v194
v_mfma_f32_16x16x32_bf16 v[48:51], v[224:227], v[156:159], v[48:51]
ds_read_b128 v[208:211], v237 offset:52224
v_mfma_f32_16x16x32_bf16 v[52:55], v[220:223], v[148:151], v[52:55]
v_exp_f32 v195, v195
v_mfma_f32_16x16x32_bf16 v[52:55], v[224:227], v[160:163], v[52:55]
ds_read_b128 v[212:215], v238 offset:52224
v_cvt_pk_bf16_f32 v181, v194, v195
v_mfma_f32_16x16x32_bf16 v[56:59], v[220:223], v[152:155], v[56:59]
s_mov_b32 s56, s89
v_xor_b32 v242, 192, v240
v_xor_b32 v243, 224, v240
v_mfma_f32_16x16x32_bf16 v[56:59], v[224:227], v[164:167], v[56:59]
s_waitcnt lgkmcnt(3)
v_exp_f32 v196, v196
v_mfma_f32_16x16x32_bf16 v[60:63], v[228:231], v[144:147], v[60:63]
s_add_u32 s57, s56, s53
v_exp_f32 v197, v197
v_mfma_f32_16x16x32_bf16 v[60:63], v[232:235], v[156:159], v[60:63]
s_add_u32 s58, s56, s54
ds_read_b128 v[216:219], v239 offset:52224
v_cvt_pk_bf16_f32 v184, v196, v197
v_mfma_f32_16x16x32_bf16 v[64:67], v[228:231], v[148:151], v[64:67]
s_add_u32 s59, s56, s55
buffer_load_dwordx4 v245, s[12:15], s48 offen offset:1024 nt lds
v_mfma_f32_16x16x32_bf16 v[64:67], v[232:235], v[160:163], v[64:67]
v_exp_f32 v198, v198
v_mfma_f32_16x16x32_bf16 v[68:71], v[228:231], v[152:155], v[68:71]
s_add_u32 m0, s60, 65536
v_exp_f32 v199, v199
v_mfma_f32_16x16x32_bf16 v[68:71], v[232:235], v[164:167], v[68:71]
v_exp_f32 v200, v200
v_mfma_f32_16x16x32_bf16 a[248:251], a[252:255], v[152:155], a[248:251]
s_waitcnt lgkmcnt(2)
v_exp_f32 v201, v201
v_mfma_f32_16x16x32_bf16 a[248:251], a[252:255], v[164:167], a[248:251]
ds_read_b64_tr_b16 v[220:221], v242 offset:0
ds_read_b64_tr_b16 v[222:223], v242 offset:1024
v_mfma_f32_16x16x32_bf16 v[192:195], v[204:207], v[96:99], 0
ds_read_b64_tr_b16 v[224:225], v242 offset:2048
v_cvt_pk_bf16_f32 v185, v198, v199
v_mfma_f32_16x16x32_bf16 v[192:195], v[208:211], v[108:111], v[192:195]
s_waitcnt lgkmcnt(3)
ds_read_b64_tr_b16 v[226:227], v242 offset:3072
v_cvt_pk_bf16_f32 v188, v200, v201
v_mfma_f32_16x16x32_bf16 v[192:195], v[212:215], v[120:123], v[192:195]
ds_read_b64_tr_b16 v[228:229], v243 offset:0
v_mfma_f32_16x16x32_bf16 v[192:195], v[216:219], v[132:135], v[192:195]
v_exp_f32 v202, v202
v_mfma_f32_16x16x32_bf16 v[196:199], v[204:207], v[100:103], 0
v_exp_f32 v203, v203
v_mfma_f32_16x16x32_bf16 v[196:199], v[208:211], v[112:115], v[196:199]
ds_read_b64_tr_b16 v[230:231], v243 offset:1024
v_cvt_pk_bf16_f32 v189, v202, v203
v_mfma_f32_16x16x32_bf16 v[196:199], v[212:215], v[124:127], v[196:199]
buffer_load_dwordx4 v247, s[20:23], s56 offen offset:0 lds
v_mfma_f32_16x16x32_bf16 v[196:199], v[216:219], v[136:139], v[196:199]
ds_read_b64_tr_b16 v[232:233], v243 offset:2048
ds_read_b64_tr_b16 v[234:235], v243 offset:3072
v_mfma_f32_16x16x32_bf16 v[200:203], v[204:207], v[104:107], 0
v_exp_f32 v192, v192
v_mfma_f32_16x16x32_bf16 v[200:203], v[208:211], v[116:119], v[200:203]
v_exp_f32 v193, v193
v_mfma_f32_16x16x32_bf16 v[200:203], v[212:215], v[128:131], v[200:203]
s_waitcnt lgkmcnt(4)
buffer_load_dwordx4 v247, s[20:23], s57 offen offset:1024 lds
v_mfma_f32_16x16x32_bf16 v[200:203], v[216:219], v[140:143], v[200:203]
s_waitcnt vmcnt(12) lgkmcnt(0)
v_exp_f32 v194, v194
v_mfma_f32_16x16x32_bf16 v[72:75], v[220:223], v[144:147], v[72:75]
s_barrier
ds_read_b128 v[204:207], v236 offset:32768
v_cvt_pk_bf16_f32 v182, v192, v193
v_mfma_f32_16x16x32_bf16 v[72:75], v[224:227], v[156:159], v[72:75]
s_add_u32 m0, s60, 32768
v_exp_f32 v195, v195
v_mfma_f32_16x16x32_bf16 v[76:79], v[220:223], v[148:151], v[76:79]
buffer_load_dwordx4 v245, s[12:15], s48 offen offset:2048 nt lds
v_mfma_f32_16x16x32_bf16 v[76:79], v[224:227], v[160:163], v[76:79]
s_add_u32 m0, s60, 65536
ds_read_b128 v[208:211], v237 offset:32768
v_cvt_pk_bf16_f32 v183, v194, v195
v_mfma_f32_16x16x32_bf16 v[80:83], v[220:223], v[152:155], v[80:83]
v_exp_f32 v196, v196
v_mfma_f32_16x16x32_bf16 v[80:83], v[224:227], v[164:167], v[80:83]
ds_read_b128 v[212:215], v238 offset:32768
v_xor_b32 v243, 32, v240
v_mfma_f32_16x16x32_bf16 v[84:87], v[228:231], v[144:147], v[84:87]
buffer_load_dwordx4 v247, s[20:23], s58 offen offset:2048 lds
v_mfma_f32_16x16x32_bf16 v[84:87], v[232:235], v[156:159], v[84:87]
v_exp_f32 v197, v197
v_mfma_f32_16x16x32_bf16 v[88:91], v[228:231], v[148:151], v[88:91]
ds_read_b128 v[216:219], v239 offset:32768
v_cvt_pk_bf16_f32 v186, v196, v197
v_mfma_f32_16x16x32_bf16 v[88:91], v[232:235], v[160:163], v[88:91]
v_exp_f32 v198, v198
v_mfma_f32_16x16x32_bf16 v[92:95], v[228:231], v[152:155], v[92:95]
s_waitcnt lgkmcnt(2)
v_exp_f32 v199, v199
v_mfma_f32_16x16x32_bf16 v[92:95], v[232:235], v[164:167], v[92:95]
ds_read_b64_tr_b16 v[220:221], v240 offset:16384
ds_read_b64_tr_b16 v[222:223], v240 offset:17408
v_mfma_f32_16x16x32_bf16 v[192:195], v[204:207], v[96:99], 0
ds_read_b64_tr_b16 v[224:225], v240 offset:18432
v_cvt_pk_bf16_f32 v187, v198, v199
v_mfma_f32_16x16x32_bf16 v[192:195], v[208:211], v[108:111], v[192:195]
s_waitcnt lgkmcnt(3)
buffer_load_dwordx4 v247, s[20:23], s59 offen offset:3072 lds
v_mfma_f32_16x16x32_bf16 v[192:195], v[212:215], v[120:123], v[192:195]
s_add_u32 m0, s60, 32768
ds_read_b64_tr_b16 v[226:227], v240 offset:19456
ds_read_b64_tr_b16 v[228:229], v243 offset:16384
v_mfma_f32_16x16x32_bf16 v[192:195], v[216:219], v[132:135], v[192:195]
v_exp_f32 v200, v200
v_mfma_f32_16x16x32_bf16 v[196:199], v[204:207], v[100:103], 0
v_exp_f32 v201, v201
v_mfma_f32_16x16x32_bf16 v[196:199], v[208:211], v[112:115], v[196:199]
v_exp_f32 v202, v202
v_mfma_f32_16x16x32_bf16 v[196:199], v[212:215], v[124:127], v[196:199]
ds_read_b64_tr_b16 v[230:231], v243 offset:17408
v_exp_f32 v203, v203
v_mfma_f32_16x16x32_bf16 v[196:199], v[216:219], v[136:139], v[196:199]
ds_read_b64_tr_b16 v[232:233], v243 offset:18432
v_cvt_pk_bf16_f32 v190, v200, v201
v_cvt_pk_bf16_f32 v191, v202, v203
v_mfma_f32_16x16x32_bf16 v[200:203], v[204:207], v[104:107], 0
ds_read_b64_tr_b16 v[234:235], v243 offset:19456
v_mfma_f32_16x16x32_bf16 v[200:203], v[208:211], v[116:119], v[200:203]
buffer_load_dwordx4 v245, s[12:15], s48 offen offset:3072 nt lds
v_mfma_f32_16x16x32_bf16 v[200:203], v[212:215], v[128:131], v[200:203]
s_waitcnt lgkmcnt(4)
v_exp_f32 v192, v192
v_mfma_f32_16x16x32_bf16 v[200:203], v[216:219], v[140:143], v[200:203]
s_add_u32 s48, s48, 0x4000
ds_read_b128 v[204:207], v236 offset:33792
v_mfma_f32_16x16x32_bf16 v[0:3], v[220:223], v[168:171], v[0:3]
v_exp_f32 v193, v193
v_mfma_f32_16x16x32_bf16 v[0:3], v[224:227], v[180:183], v[0:3]
ds_read_b128 v[208:211], v237 offset:33792
v_cvt_pk_bf16_f32 v144, v192, v193
v_mfma_f32_16x16x32_bf16 v[4:7], v[220:223], v[172:175], v[4:7]
v_exp_f32 v194, v194
v_mfma_f32_16x16x32_bf16 v[4:7], v[224:227], v[184:187], v[4:7]
ds_read_b128 v[212:215], v238 offset:33792
v_xor_b32 v242, 64, v240
v_mfma_f32_16x16x32_bf16 v[8:11], v[220:223], v[176:179], v[8:11]
v_exp_f32 v195, v195
v_mfma_f32_16x16x32_bf16 v[8:11], v[224:227], v[188:191], v[8:11]
s_waitcnt lgkmcnt(3)
ds_read_b128 v[216:219], v239 offset:33792
v_cvt_pk_bf16_f32 v145, v194, v195
v_mfma_f32_16x16x32_bf16 v[12:15], v[228:231], v[168:171], v[12:15]
v_exp_f32 v196, v196
v_mfma_f32_16x16x32_bf16 v[12:15], v[232:235], v[180:183], v[12:15]
s_add_u32 m0, s60, 0
v_exp_f32 v197, v197
v_mfma_f32_16x16x32_bf16 v[16:19], v[228:231], v[172:175], v[16:19]
v_exp_f32 v198, v198
v_mfma_f32_16x16x32_bf16 v[16:19], v[232:235], v[184:187], v[16:19]
v_exp_f32 v199, v199
v_mfma_f32_16x16x32_bf16 v[20:23], v[228:231], v[176:179], v[20:23]
v_cvt_pk_bf16_f32 v148, v196, v197
v_cvt_pk_bf16_f32 v149, v198, v199
v_mfma_f32_16x16x32_bf16 v[20:23], v[232:235], v[188:191], v[20:23]
v_exp_f32 v200, v200
v_mfma_f32_16x16x32_bf16 a[240:243], a[252:255], v[168:171], a[240:243]
s_waitcnt lgkmcnt(2)
v_exp_f32 v201, v201
v_mfma_f32_16x16x32_bf16 a[240:243], a[252:255], v[180:183], a[240:243]
ds_read_b64_tr_b16 v[220:221], v242 offset:16384
ds_read_b64_tr_b16 v[222:223], v242 offset:17408
v_mfma_f32_16x16x32_bf16 v[192:195], v[204:207], v[96:99], 0
ds_read_b64_tr_b16 v[224:225], v242 offset:18432
v_xor_b32 v243, 96, v240
v_mfma_f32_16x16x32_bf16 v[192:195], v[208:211], v[108:111], v[192:195]
s_waitcnt lgkmcnt(3)
buffer_load_dwordx4 v245, s[12:15], s48 offen offset:0 nt lds
v_mfma_f32_16x16x32_bf16 v[192:195], v[212:215], v[120:123], v[192:195]
ds_read_b64_tr_b16 v[226:227], v242 offset:19456
ds_read_b64_tr_b16 v[228:229], v243 offset:16384
v_mfma_f32_16x16x32_bf16 v[192:195], v[216:219], v[132:135], v[192:195]
v_exp_f32 v202, v202
v_mfma_f32_16x16x32_bf16 v[196:199], v[204:207], v[100:103], 0
v_exp_f32 v203, v203
v_mfma_f32_16x16x32_bf16 v[196:199], v[208:211], v[112:115], v[196:199]
ds_read_b64_tr_b16 v[230:231], v243 offset:17408
v_cvt_pk_bf16_f32 v152, v200, v201
v_mfma_f32_16x16x32_bf16 v[196:199], v[212:215], v[124:127], v[196:199]
ds_read_b64_tr_b16 v[232:233], v243 offset:18432
v_cvt_pk_bf16_f32 v153, v202, v203
v_mfma_f32_16x16x32_bf16 v[196:199], v[216:219], v[136:139], v[196:199]
ds_read_b64_tr_b16 v[234:235], v243 offset:19456
v_mfma_f32_16x16x32_bf16 v[200:203], v[204:207], v[104:107], 0
v_exp_f32 v192, v192
v_mfma_f32_16x16x32_bf16 v[200:203], v[208:211], v[116:119], v[200:203]
v_exp_f32 v193, v193
v_mfma_f32_16x16x32_bf16 v[200:203], v[212:215], v[128:131], v[200:203]
s_waitcnt lgkmcnt(4)
v_exp_f32 v194, v194
v_mfma_f32_16x16x32_bf16 v[200:203], v[216:219], v[140:143], v[200:203]
s_mov_b32 s56, s86
ds_read_b128 v[204:207], v236 offset:34816
v_cvt_pk_bf16_f32 v146, v192, v193
v_mfma_f32_16x16x32_bf16 v[24:27], v[220:223], v[168:171], v[24:27]
s_add_u32 s57, s56, s50
v_exp_f32 v195, v195
v_mfma_f32_16x16x32_bf16 v[24:27], v[224:227], v[180:183], v[24:27]
s_add_u32 s58, s56, s51
ds_read_b128 v[208:211], v237 offset:34816
v_cvt_pk_bf16_f32 v147, v194, v195
v_mfma_f32_16x16x32_bf16 v[28:31], v[220:223], v[172:175], v[28:31]
s_add_u32 s59, s56, s52
v_exp_f32 v196, v196
v_mfma_f32_16x16x32_bf16 v[28:31], v[224:227], v[184:187], v[28:31]
ds_read_b128 v[212:215], v238 offset:34816
v_xor_b32 v242, 128, v240
v_mfma_f32_16x16x32_bf16 v[32:35], v[220:223], v[176:179], v[32:35]
v_exp_f32 v197, v197
v_mfma_f32_16x16x32_bf16 v[32:35], v[224:227], v[188:191], v[32:35]
s_waitcnt lgkmcnt(3)
ds_read_b128 v[216:219], v239 offset:34816
v_cvt_pk_bf16_f32 v150, v196, v197
v_mfma_f32_16x16x32_bf16 v[36:39], v[228:231], v[168:171], v[36:39]
buffer_load_dwordx4 v245, s[12:15], s48 offen offset:1024 nt lds
v_mfma_f32_16x16x32_bf16 v[36:39], v[232:235], v[180:183], v[36:39]
s_add_u32 m0, s60, 49152
v_exp_f32 v198, v198
v_mfma_f32_16x16x32_bf16 v[40:43], v[228:231], v[172:175], v[40:43]
v_exp_f32 v199, v199
v_mfma_f32_16x16x32_bf16 v[40:43], v[232:235], v[184:187], v[40:43]
v_cvt_pk_bf16_f32 v151, v198, v199
v_xor_b32 v243, 160, v240
v_mfma_f32_16x16x32_bf16 v[44:47], v[228:231], v[176:179], v[44:47]
buffer_load_dwordx4 v246, s[16:19], s56 offen offset:0 lds
v_mfma_f32_16x16x32_bf16 v[44:47], v[232:235], v[188:191], v[44:47]
v_exp_f32 v200, v200
v_mfma_f32_16x16x32_bf16 a[244:247], a[252:255], v[172:175], a[244:247]
s_waitcnt lgkmcnt(2)
v_exp_f32 v201, v201
v_mfma_f32_16x16x32_bf16 a[244:247], a[252:255], v[184:187], a[244:247]
ds_read_b64_tr_b16 v[220:221], v242 offset:16384
ds_read_b64_tr_b16 v[222:223], v242 offset:17408
v_mfma_f32_16x16x32_bf16 v[192:195], v[204:207], v[96:99], 0
ds_read_b64_tr_b16 v[224:225], v242 offset:18432
v_cvt_pk_bf16_f32 v154, v200, v201
v_mfma_f32_16x16x32_bf16 v[192:195], v[208:211], v[108:111], v[192:195]
s_waitcnt lgkmcnt(3)
ds_read_b64_tr_b16 v[226:227], v242 offset:19456
v_mfma_f32_16x16x32_bf16 v[192:195], v[212:215], v[120:123], v[192:195]
ds_read_b64_tr_b16 v[228:229], v243 offset:16384
v_mfma_f32_16x16x32_bf16 v[192:195], v[216:219], v[132:135], v[192:195]
v_exp_f32 v202, v202
v_mfma_f32_16x16x32_bf16 v[196:199], v[204:207], v[100:103], 0
v_exp_f32 v203, v203
v_mfma_f32_16x16x32_bf16 v[196:199], v[208:211], v[112:115], v[196:199]
ds_read_b64_tr_b16 v[230:231], v243 offset:17408
v_cvt_pk_bf16_f32 v155, v202, v203
v_mfma_f32_16x16x32_bf16 v[196:199], v[212:215], v[124:127], v[196:199]
ds_read_b64_tr_b16 v[232:233], v243 offset:18432
ds_read_b64_tr_b16 v[234:235], v243 offset:19456
v_mfma_f32_16x16x32_bf16 v[196:199], v[216:219], v[136:139], v[196:199]
buffer_load_dwordx4 v246, s[16:19], s57 offen offset:1024 lds
v_mfma_f32_16x16x32_bf16 v[200:203], v[204:207], v[104:107], 0
v_exp_f32 v192, v192
v_mfma_f32_16x16x32_bf16 v[200:203], v[208:211], v[116:119], v[200:203]
v_exp_f32 v193, v193
v_mfma_f32_16x16x32_bf16 v[200:203], v[212:215], v[128:131], v[200:203]
s_waitcnt lgkmcnt(4)
v_exp_f32 v194, v194
v_mfma_f32_16x16x32_bf16 v[200:203], v[216:219], v[140:143], v[200:203]
buffer_load_dwordx4 v246, s[16:19], s58 offen offset:2048 lds
v_mfma_f32_16x16x32_bf16 v[48:51], v[220:223], v[168:171], v[48:51]
s_add_u32 m0, s60, 0
ds_read_b128 v[204:207], v236 offset:35840
v_cvt_pk_bf16_f32 v156, v192, v193
v_mfma_f32_16x16x32_bf16 v[48:51], v[224:227], v[180:183], v[48:51]
v_exp_f32 v195, v195
v_mfma_f32_16x16x32_bf16 v[52:55], v[220:223], v[172:175], v[52:55]
ds_read_b128 v[208:211], v237 offset:35840
v_cvt_pk_bf16_f32 v157, v194, v195
v_mfma_f32_16x16x32_bf16 v[52:55], v[224:227], v[184:187], v[52:55]
buffer_load_dwordx4 v245, s[12:15], s48 offen offset:2048 nt lds
v_mfma_f32_16x16x32_bf16 v[56:59], v[220:223], v[176:179], v[56:59]
s_add_u32 m0, s60, 49152
ds_read_b128 v[212:215], v238 offset:35840
v_xor_b32 v242, 192, v240
v_mfma_f32_16x16x32_bf16 v[56:59], v[224:227], v[188:191], v[56:59]
s_waitcnt lgkmcnt(3)
v_exp_f32 v196, v196
v_mfma_f32_16x16x32_bf16 v[60:63], v[228:231], v[168:171], v[60:63]
ds_read_b128 v[216:219], v239 offset:35840
v_xor_b32 v243, 224, v240
v_mfma_f32_16x16x32_bf16 v[60:63], v[232:235], v[180:183], v[60:63]
buffer_load_dwordx4 v246, s[16:19], s59 offen offset:3072 lds
v_mfma_f32_16x16x32_bf16 v[64:67], v[228:231], v[172:175], v[64:67]
v_exp_f32 v197, v197
v_mfma_f32_16x16x32_bf16 v[64:67], v[232:235], v[184:187], v[64:67]
v_exp_f32 v198, v198
v_mfma_f32_16x16x32_bf16 v[68:71], v[228:231], v[176:179], v[68:71]
v_exp_f32 v199, v199
v_mfma_f32_16x16x32_bf16 v[68:71], v[232:235], v[188:191], v[68:71]
s_add_u32 m0, s60, 0
v_cvt_pk_bf16_f32 v160, v196, v197
v_cvt_pk_bf16_f32 v161, v198, v199
v_mfma_f32_16x16x32_bf16 a[248:251], a[252:255], v[176:179], a[248:251]
s_waitcnt lgkmcnt(2)
v_exp_f32 v200, v200
v_mfma_f32_16x16x32_bf16 a[248:251], a[252:255], v[188:191], a[248:251]
ds_read_b64_tr_b16 v[220:221], v242 offset:16384
ds_read_b64_tr_b16 v[222:223], v242 offset:17408
v_mfma_f32_16x16x32_bf16 v[192:195], v[204:207], v[96:99], 0
ds_read_b64_tr_b16 v[224:225], v242 offset:18432
v_mfma_f32_16x16x32_bf16 v[192:195], v[208:211], v[108:111], v[192:195]
s_waitcnt lgkmcnt(3)
ds_read_b64_tr_b16 v[226:227], v242 offset:19456
v_mfma_f32_16x16x32_bf16 v[192:195], v[212:215], v[120:123], v[192:195]
ds_read_b64_tr_b16 v[228:229], v243 offset:16384
v_mfma_f32_16x16x32_bf16 v[192:195], v[216:219], v[132:135], v[192:195]
v_exp_f32 v201, v201
v_mfma_f32_16x16x32_bf16 v[196:199], v[204:207], v[100:103], 0
v_exp_f32 v202, v202
v_mfma_f32_16x16x32_bf16 v[196:199], v[208:211], v[112:115], v[196:199]
v_exp_f32 v203, v203
v_mfma_f32_16x16x32_bf16 v[196:199], v[212:215], v[124:127], v[196:199]
ds_read_b64_tr_b16 v[230:231], v243 offset:17408
v_cvt_pk_bf16_f32 v164, v200, v201
v_mfma_f32_16x16x32_bf16 v[196:199], v[216:219], v[136:139], v[196:199]
ds_read_b64_tr_b16 v[232:233], v243 offset:18432
buffer_load_dwordx4 v245, s[12:15], s48 offen offset:3072 nt lds
v_cvt_pk_bf16_f32 v165, v202, v203
v_mfma_f32_16x16x32_bf16 v[200:203], v[204:207], v[104:107], 0
s_add_u32 s48, s48, 0x4000
ds_read_b64_tr_b16 v[234:235], v243 offset:19456
v_mfma_f32_16x16x32_bf16 v[200:203], v[208:211], v[116:119], v[200:203]
s_and_b32 s48, s48, 0x7ffff
v_exp_f32 v192, v192
v_mfma_f32_16x16x32_bf16 v[200:203], v[212:215], v[128:131], v[200:203]
s_waitcnt lgkmcnt(4)
v_exp_f32 v193, v193
v_mfma_f32_16x16x32_bf16 v[200:203], v[216:219], v[140:143], v[200:203]
s_waitcnt vmcnt(8) lgkmcnt(0)
v_exp_f32 v194, v194
v_mfma_f32_16x16x32_bf16 v[72:75], v[220:223], v[168:171], v[72:75]
s_barrier
ds_read_b128 v[204:207], v236 offset:0
v_cvt_pk_bf16_f32 v158, v192, v193
v_mfma_f32_16x16x32_bf16 v[72:75], v[224:227], v[180:183], v[72:75]
s_cmp_eq_u32 s61, 3
v_exp_f32 v195, v195
v_mfma_f32_16x16x32_bf16 v[76:79], v[220:223], v[172:175], v[76:79]
s_cselect_b32 s14, 0, s14
ds_read_b128 v[208:211], v237 offset:0
v_cvt_pk_bf16_f32 v159, v194, v195
v_mfma_f32_16x16x32_bf16 v[76:79], v[224:227], v[184:187], v[76:79]
v_exp_f32 v196, v196
v_mfma_f32_16x16x32_bf16 v[80:83], v[220:223], v[176:179], v[80:83]
s_add_u32 m0, s60, 147456
ds_read_b128 v[212:215], v238 offset:0
v_xor_b32 v243, 32, v240
v_mfma_f32_16x16x32_bf16 v[80:83], v[224:227], v[188:191], v[80:83]
v_exp_f32 v197, v197
v_mfma_f32_16x16x32_bf16 v[84:87], v[228:231], v[168:171], v[84:87]
ds_read_b128 v[216:219], v239 offset:0
v_cvt_pk_bf16_f32 v162, v196, v197
v_mfma_f32_16x16x32_bf16 v[84:87], v[232:235], v[180:183], v[84:87]
v_exp_f32 v198, v198
v_mfma_f32_16x16x32_bf16 v[88:91], v[228:231], v[172:175], v[88:91]
v_exp_f32 v199, v199
v_mfma_f32_16x16x32_bf16 v[88:91], v[232:235], v[184:187], v[88:91]
v_exp_f32 v200, v200
v_mfma_f32_16x16x32_bf16 v[92:95], v[228:231], v[176:179], v[92:95]
s_waitcnt lgkmcnt(2)
buffer_load_dwordx4 v244, s[8:11], s47 offen offset:0 nt lds
v_mfma_f32_16x16x32_bf16 v[92:95], v[232:235], v[188:191], v[92:95]
ds_read_b64_tr_b16 v[220:221], v240 offset:32768
ds_read_b64_tr_b16 v[222:223], v240 offset:33792
v_mfma_f32_16x16x32_bf16 v[192:195], v[204:207], v[96:99], 0
ds_read_b64_tr_b16 v[224:225], v240 offset:34816
v_cvt_pk_bf16_f32 v163, v198, v199
v_mfma_f32_16x16x32_bf16 v[192:195], v[208:211], v[108:111], v[192:195]
s_waitcnt lgkmcnt(3)
ds_read_b64_tr_b16 v[226:227], v240 offset:35840
v_mfma_f32_16x16x32_bf16 v[192:195], v[212:215], v[120:123], v[192:195]
ds_read_b64_tr_b16 v[228:229], v243 offset:32768
v_mfma_f32_16x16x32_bf16 v[192:195], v[216:219], v[132:135], v[192:195]
v_exp_f32 v201, v201
v_mfma_f32_16x16x32_bf16 v[196:199], v[204:207], v[100:103], 0
v_exp_f32 v202, v202
v_mfma_f32_16x16x32_bf16 v[196:199], v[208:211], v[112:115], v[196:199]
v_exp_f32 v203, v203
v_mfma_f32_16x16x32_bf16 v[196:199], v[212:215], v[124:127], v[196:199]
ds_read_b64_tr_b16 v[230:231], v243 offset:33792
v_cvt_pk_bf16_f32 v166, v200, v201
v_mfma_f32_16x16x32_bf16 v[196:199], v[216:219], v[136:139], v[196:199]
ds_read_b64_tr_b16 v[232:233], v243 offset:34816
v_cvt_pk_bf16_f32 v167, v202, v203
v_mfma_f32_16x16x32_bf16 v[200:203], v[204:207], v[104:107], 0
ds_read_b64_tr_b16 v[234:235], v243 offset:35840
v_mfma_f32_16x16x32_bf16 v[200:203], v[208:211], v[116:119], v[200:203]
s_mov_b32 s56, s90
v_exp_f32 v192, v192
v_mfma_f32_16x16x32_bf16 v[200:203], v[212:215], v[128:131], v[200:203]
s_waitcnt lgkmcnt(4)
v_exp_f32 v193, v193
v_mfma_f32_16x16x32_bf16 v[200:203], v[216:219], v[140:143], v[200:203]
s_add_u32 s57, s56, s50
ds_read_b128 v[204:207], v236 offset:1024
v_cvt_pk_bf16_f32 v168, v192, v193
v_mfma_f32_16x16x32_bf16 v[0:3], v[220:223], v[144:147], v[0:3]
s_add_u32 s58, s56, s51
v_exp_f32 v194, v194
v_mfma_f32_16x16x32_bf16 v[0:3], v[224:227], v[156:159], v[0:3]
s_add_u32 s59, s56, s52
ds_read_b128 v[208:211], v237 offset:1024
v_mfma_f32_16x16x32_bf16 v[4:7], v[220:223], v[148:151], v[4:7]
v_exp_f32 v195, v195
v_mfma_f32_16x16x32_bf16 v[4:7], v[224:227], v[160:163], v[4:7]
ds_read_b128 v[212:215], v238 offset:1024
v_cvt_pk_bf16_f32 v169, v194, v195
v_mfma_f32_16x16x32_bf16 v[8:11], v[220:223], v[152:155], v[8:11]
v_xor_b32 v242, 64, v240
v_xor_b32 v243, 96, v240
v_mfma_f32_16x16x32_bf16 v[8:11], v[224:227], v[164:167], v[8:11]
s_waitcnt lgkmcnt(3)
buffer_load_dwordx4 v244, s[8:11], s47 offen offset:1024 nt lds
v_mfma_f32_16x16x32_bf16 v[12:15], v[228:231], v[144:147], v[12:15]
s_add_u32 m0, s60, 16384
v_exp_f32 v196, v196
v_mfma_f32_16x16x32_bf16 v[12:15], v[232:235], v[156:159], v[12:15]
ds_read_b128 v[216:219], v239 offset:1024
v_mfma_f32_16x16x32_bf16 v[16:19], v[228:231], v[148:151], v[16:19]
v_exp_f32 v197, v197
v_mfma_f32_16x16x32_bf16 v[16:19], v[232:235], v[160:163], v[16:19]
buffer_load_dwordx4 v246, s[16:19], s56 offen offset:0 lds
v_mfma_f32_16x16x32_bf16 v[20:23], v[228:231], v[152:155], v[20:23]
v_exp_f32 v198, v198
v_mfma_f32_16x16x32_bf16 v[20:23], v[232:235], v[164:167], v[20:23]
v_exp_f32 v199, v199
v_mfma_f32_16x16x32_bf16 a[240:243], a[252:255], v[144:147], a[240:243]
s_waitcnt lgkmcnt(2)
v_cvt_pk_bf16_f32 v172, v196, v197
v_cvt_pk_bf16_f32 v173, v198, v199
v_mfma_f32_16x16x32_bf16 a[240:243], a[252:255], v[156:159], a[240:243]
ds_read_b64_tr_b16 v[220:221], v242 offset:32768
ds_read_b64_tr_b16 v[222:223], v242 offset:33792
v_mfma_f32_16x16x32_bf16 v[192:195], v[204:207], v[96:99], 0
ds_read_b64_tr_b16 v[224:225], v242 offset:34816
v_mfma_f32_16x16x32_bf16 v[192:195], v[208:211], v[108:111], v[192:195]
s_waitcnt lgkmcnt(3)
ds_read_b64_tr_b16 v[226:227], v242 offset:35840
v_mfma_f32_16x16x32_bf16 v[192:195], v[212:215], v[120:123], v[192:195]
ds_read_b64_tr_b16 v[228:229], v243 offset:32768
v_mfma_f32_16x16x32_bf16 v[192:195], v[216:219], v[132:135], v[192:195]
v_exp_f32 v200, v200
v_mfma_f32_16x16x32_bf16 v[196:199], v[204:207], v[100:103], 0
v_exp_f32 v201, v201
v_mfma_f32_16x16x32_bf16 v[196:199], v[208:211], v[112:115], v[196:199]
v_exp_f32 v202, v202
v_mfma_f32_16x16x32_bf16 v[196:199], v[212:215], v[124:127], v[196:199]
ds_read_b64_tr_b16 v[230:231], v243 offset:33792
buffer_load_dwordx4 v246, s[16:19], s57 offen offset:1024 lds
v_exp_f32 v203, v203
v_mfma_f32_16x16x32_bf16 v[196:199], v[216:219], v[136:139], v[196:199]
ds_read_b64_tr_b16 v[232:233], v243 offset:34816
v_cvt_pk_bf16_f32 v176, v200, v201
v_cvt_pk_bf16_f32 v177, v202, v203
v_mfma_f32_16x16x32_bf16 v[200:203], v[204:207], v[104:107], 0
ds_read_b64_tr_b16 v[234:235], v243 offset:35840
v_mfma_f32_16x16x32_bf16 v[200:203], v[208:211], v[116:119], v[200:203]
v_exp_f32 v192, v192
v_mfma_f32_16x16x32_bf16 v[200:203], v[212:215], v[128:131], v[200:203]
s_waitcnt lgkmcnt(4)
buffer_load_dwordx4 v246, s[16:19], s58 offen offset:2048 lds
v_mfma_f32_16x16x32_bf16 v[200:203], v[216:219], v[140:143], v[200:203]
s_add_u32 m0, s60, 147456
ds_read_b128 v[204:207], v236 offset:2048
v_mfma_f32_16x16x32_bf16 v[24:27], v[220:223], v[144:147], v[24:27]
v_exp_f32 v193, v193
v_mfma_f32_16x16x32_bf16 v[24:27], v[224:227], v[156:159], v[24:27]
ds_read_b128 v[208:211], v237 offset:2048
v_cvt_pk_bf16_f32 v170, v192, v193
v_mfma_f32_16x16x32_bf16 v[28:31], v[220:223], v[148:151], v[28:31]
buffer_load_dwordx4 v244, s[8:11], s47 offen offset:2048 nt lds
v_mfma_f32_16x16x32_bf16 v[28:31], v[224:227], v[160:163], v[28:31]
s_add_u32 m0, s60, 16384
ds_read_b128 v[212:215], v238 offset:2048
v_xor_b32 v242, 128, v240
v_mfma_f32_16x16x32_bf16 v[32:35], v[220:223], v[152:155], v[32:35]
v_exp_f32 v194, v194
v_mfma_f32_16x16x32_bf16 v[32:35], v[224:227], v[164:167], v[32:35]
s_waitcnt lgkmcnt(3)
ds_read_b128 v[216:219], v239 offset:2048
v_xor_b32 v243, 160, v240
v_mfma_f32_16x16x32_bf16 v[36:39], v[228:231], v[144:147], v[36:39]
buffer_load_dwordx4 v246, s[16:19], s59 offen offset:3072 lds
v_mfma_f32_16x16x32_bf16 v[36:39], v[232:235], v[156:159], v[36:39]
v_exp_f32 v195, v195
v_mfma_f32_16x16x32_bf16 v[40:43], v[228:231], v[148:151], v[40:43]
v_exp_f32 v196, v196
v_mfma_f32_16x16x32_bf16 v[40:43], v[232:235], v[160:163], v[40:43]
v_exp_f32 v197, v197
v_mfma_f32_16x16x32_bf16 v[44:47], v[228:231], v[152:155], v[44:47]
s_add_u32 m0, s60, 147456
v_cvt_pk_bf16_f32 v171, v194, v195
v_cvt_pk_bf16_f32 v174, v196, v197
v_mfma_f32_16x16x32_bf16 v[44:47], v[232:235], v[164:167], v[44:47]
v_exp_f32 v198, v198
v_mfma_f32_16x16x32_bf16 a[244:247], a[252:255], v[148:151], a[244:247]
s_waitcnt lgkmcnt(2)
v_exp_f32 v199, v199
v_mfma_f32_16x16x32_bf16 a[244:247], a[252:255], v[160:163], a[244:247]
ds_read_b64_tr_b16 v[220:221], v242 offset:32768
ds_read_b64_tr_b16 v[222:223], v242 offset:33792
v_mfma_f32_16x16x32_bf16 v[192:195], v[204:207], v[96:99], 0
ds_read_b64_tr_b16 v[224:225], v242 offset:34816
v_cvt_pk_bf16_f32 v175, v198, v199
v_mfma_f32_16x16x32_bf16 v[192:195], v[208:211], v[108:111], v[192:195]
s_waitcnt lgkmcnt(3)
ds_read_b64_tr_b16 v[226:227], v242 offset:35840
v_mfma_f32_16x16x32_bf16 v[192:195], v[212:215], v[120:123], v[192:195]
ds_read_b64_tr_b16 v[228:229], v243 offset:32768
v_mfma_f32_16x16x32_bf16 v[192:195], v[216:219], v[132:135], v[192:195]
v_exp_f32 v200, v200
v_mfma_f32_16x16x32_bf16 v[196:199], v[204:207], v[100:103], 0
v_exp_f32 v201, v201
v_mfma_f32_16x16x32_bf16 v[196:199], v[208:211], v[112:115], v[196:199]
v_exp_f32 v202, v202
v_mfma_f32_16x16x32_bf16 v[196:199], v[212:215], v[124:127], v[196:199]
ds_read_b64_tr_b16 v[230:231], v243 offset:33792
buffer_load_dwordx4 v244, s[8:11], s47 offen offset:3072 nt lds
v_exp_f32 v203, v203
v_mfma_f32_16x16x32_bf16 v[196:199], v[216:219], v[136:139], v[196:199]
s_add_u32 s47, s47, 0x4000
ds_read_b64_tr_b16 v[232:233], v243 offset:34816
v_cvt_pk_bf16_f32 v178, v200, v201
v_cvt_pk_bf16_f32 v179, v202, v203
v_mfma_f32_16x16x32_bf16 v[200:203], v[204:207], v[104:107], 0
ds_read_b64_tr_b16 v[234:235], v243 offset:35840
v_mfma_f32_16x16x32_bf16 v[200:203], v[208:211], v[116:119], v[200:203]
v_exp_f32 v192, v192
v_mfma_f32_16x16x32_bf16 v[200:203], v[212:215], v[128:131], v[200:203]
s_waitcnt lgkmcnt(4)
v_exp_f32 v193, v193
v_mfma_f32_16x16x32_bf16 v[200:203], v[216:219], v[140:143], v[200:203]
ds_read_b128 v[204:207], v236 offset:3072
v_cvt_pk_bf16_f32 v180, v192, v193
v_mfma_f32_16x16x32_bf16 v[48:51], v[220:223], v[144:147], v[48:51]
v_exp_f32 v194, v194
v_mfma_f32_16x16x32_bf16 v[48:51], v[224:227], v[156:159], v[48:51]
ds_read_b128 v[208:211], v237 offset:3072
v_mfma_f32_16x16x32_bf16 v[52:55], v[220:223], v[148:151], v[52:55]
v_exp_f32 v195, v195
v_mfma_f32_16x16x32_bf16 v[52:55], v[224:227], v[160:163], v[52:55]
s_add_u32 m0, s60, 131072
ds_read_b128 v[212:215], v238 offset:3072
v_cvt_pk_bf16_f32 v181, v194, v195
v_mfma_f32_16x16x32_bf16 v[56:59], v[220:223], v[152:155], v[56:59]
v_xor_b32 v242, 192, v240
v_xor_b32 v243, 224, v240
v_mfma_f32_16x16x32_bf16 v[56:59], v[224:227], v[164:167], v[56:59]
s_waitcnt lgkmcnt(3)
v_exp_f32 v196, v196
v_mfma_f32_16x16x32_bf16 v[60:63], v[228:231], v[144:147], v[60:63]
v_exp_f32 v197, v197
v_mfma_f32_16x16x32_bf16 v[60:63], v[232:235], v[156:159], v[60:63]
ds_read_b128 v[216:219], v239 offset:3072
v_cvt_pk_bf16_f32 v184, v196, v197
v_mfma_f32_16x16x32_bf16 v[64:67], v[228:231], v[148:151], v[64:67]
v_exp_f32 v198, v198
v_mfma_f32_16x16x32_bf16 v[64:67], v[232:235], v[160:163], v[64:67]
buffer_load_dwordx4 v244, s[8:11], s47 offen offset:0 nt lds
v_mfma_f32_16x16x32_bf16 v[68:71], v[228:231], v[152:155], v[68:71]
v_exp_f32 v199, v199
v_mfma_f32_16x16x32_bf16 v[68:71], v[232:235], v[164:167], v[68:71]
v_exp_f32 v200, v200
v_mfma_f32_16x16x32_bf16 a[248:251], a[252:255], v[152:155], a[248:251]
s_waitcnt lgkmcnt(2)
v_exp_f32 v201, v201
v_mfma_f32_16x16x32_bf16 a[248:251], a[252:255], v[164:167], a[248:251]
ds_read_b64_tr_b16 v[220:221], v242 offset:32768
ds_read_b64_tr_b16 v[222:223], v242 offset:33792
v_mfma_f32_16x16x32_bf16 v[192:195], v[204:207], v[96:99], 0
ds_read_b64_tr_b16 v[224:225], v242 offset:34816
v_cvt_pk_bf16_f32 v185, v198, v199
v_mfma_f32_16x16x32_bf16 v[192:195], v[208:211], v[108:111], v[192:195]
s_waitcnt lgkmcnt(3)
ds_read_b64_tr_b16 v[226:227], v242 offset:35840
v_cvt_pk_bf16_f32 v188, v200, v201
v_mfma_f32_16x16x32_bf16 v[192:195], v[212:215], v[120:123], v[192:195]
ds_read_b64_tr_b16 v[228:229], v243 offset:32768
v_mfma_f32_16x16x32_bf16 v[192:195], v[216:219], v[132:135], v[192:195]
v_exp_f32 v202, v202
v_mfma_f32_16x16x32_bf16 v[196:199], v[204:207], v[100:103], 0
v_exp_f32 v203, v203
v_mfma_f32_16x16x32_bf16 v[196:199], v[208:211], v[112:115], v[196:199]
ds_read_b64_tr_b16 v[230:231], v243 offset:33792
v_cvt_pk_bf16_f32 v189, v202, v203
v_mfma_f32_16x16x32_bf16 v[196:199], v[212:215], v[124:127], v[196:199]
ds_read_b64_tr_b16 v[232:233], v243 offset:34816
ds_read_b64_tr_b16 v[234:235], v243 offset:35840
v_mfma_f32_16x16x32_bf16 v[196:199], v[216:219], v[136:139], v[196:199]
v_exp_f32 v192, v192
v_mfma_f32_16x16x32_bf16 v[200:203], v[204:207], v[104:107], 0
v_exp_f32 v193, v193
v_mfma_f32_16x16x32_bf16 v[200:203], v[208:211], v[116:119], v[200:203]
v_xor_b32 v243, 32, v240
v_cvt_pk_bf16_f32 v182, v192, v193
v_mfma_f32_16x16x32_bf16 v[200:203], v[212:215], v[128:131], v[200:203]
s_waitcnt lgkmcnt(4)
v_exp_f32 v194, v194
v_mfma_f32_16x16x32_bf16 v[200:203], v[216:219], v[140:143], v[200:203]
s_waitcnt vmcnt(9) lgkmcnt(0)
v_exp_f32 v195, v195
v_mfma_f32_16x16x32_bf16 v[72:75], v[220:223], v[144:147], v[72:75]
s_barrier
ds_read_b64_tr_b16 v[204:205], v240 offset:0
ds_read_b64_tr_b16 v[206:207], v240 offset:1024
v_mfma_f32_16x16x32_bf16 v[72:75], v[224:227], v[156:159], v[72:75]
s_mov_b32 s56, s91
ds_read_b64_tr_b16 v[208:209], v240 offset:2048
v_cvt_pk_bf16_f32 v183, v194, v195
v_mfma_f32_16x16x32_bf16 v[76:79], v[220:223], v[148:151], v[76:79]
s_add_u32 s57, s56, s50
ds_read_b64_tr_b16 v[210:211], v240 offset:3072
v_mfma_f32_16x16x32_bf16 v[76:79], v[224:227], v[160:163], v[76:79]
s_add_u32 s58, s56, s51
ds_read_b64_tr_b16 v[212:213], v243 offset:0
v_mfma_f32_16x16x32_bf16 v[80:83], v[220:223], v[152:155], v[80:83]
s_add_u32 s59, s56, s52
buffer_load_dwordx4 v244, s[8:11], s47 offen offset:1024 nt lds
v_mfma_f32_16x16x32_bf16 v[80:83], v[224:227], v[164:167], v[80:83]
s_add_u32 m0, s60, 98304
ds_read_b64_tr_b16 v[214:215], v243 offset:1024
ds_read_b64_tr_b16 v[216:217], v243 offset:2048
v_mfma_f32_16x16x32_bf16 v[84:87], v[228:231], v[144:147], v[84:87]
ds_read_b64_tr_b16 v[218:219], v243 offset:3072
v_xor_b32 v242, 64, v240
v_mfma_f32_16x16x32_bf16 v[84:87], v[232:235], v[156:159], v[84:87]
v_exp_f32 v196, v196
v_mfma_f32_16x16x32_bf16 v[88:91], v[228:231], v[148:151], v[88:91]
v_exp_f32 v197, v197
v_mfma_f32_16x16x32_bf16 v[88:91], v[232:235], v[160:163], v[88:91]
v_exp_f32 v198, v198
v_mfma_f32_16x16x32_bf16 v[92:95], v[228:231], v[152:155], v[92:95]
s_waitcnt lgkmcnt(4)
v_exp_f32 v199, v199
v_mfma_f32_16x16x32_bf16 v[92:95], v[232:235], v[164:167], v[92:95]
v_cvt_pk_bf16_f32 v186, v196, v197
v_cvt_pk_bf16_f32 v187, v198, v199
v_mfma_f32_16x16x32_bf16 v[0:3], v[204:207], v[168:171], v[0:3]
buffer_load_dwordx4 v246, s[16:19], s56 offen offset:0 lds
v_mfma_f32_16x16x32_bf16 v[0:3], v[208:211], v[180:183], v[0:3]
s_waitcnt lgkmcnt(0)
v_exp_f32 v200, v200
v_mfma_f32_16x16x32_bf16 v[12:15], v[212:215], v[168:171], v[12:15]
v_exp_f32 v201, v201
v_mfma_f32_16x16x32_bf16 v[12:15], v[216:219], v[180:183], v[12:15]
v_exp_f32 v202, v202
v_mfma_f32_16x16x32_bf16 v[4:7], v[204:207], v[172:175], v[4:7]
v_exp_f32 v203, v203
v_mfma_f32_16x16x32_bf16 v[4:7], v[208:211], v[184:187], v[4:7]
ds_read_b64_tr_b16 v[220:221], v242 offset:0
v_cvt_pk_bf16_f32 v190, v200, v201
v_mfma_f32_16x16x32_bf16 v[16:19], v[212:215], v[172:175], v[16:19]
ds_read_b64_tr_b16 v[222:223], v242 offset:1024
v_cvt_pk_bf16_f32 v191, v202, v203
v_mfma_f32_16x16x32_bf16 v[16:19], v[216:219], v[184:187], v[16:19]
ds_read_b64_tr_b16 v[224:225], v242 offset:2048
v_xor_b32 v243, 96, v240
v_mfma_f32_16x16x32_bf16 v[8:11], v[204:207], v[176:179], v[8:11]
ds_read_b64_tr_b16 v[226:227], v242 offset:3072
ds_read_b64_tr_b16 v[228:229], v243 offset:0
v_mfma_f32_16x16x32_bf16 v[8:11], v[208:211], v[188:191], v[8:11]
ds_read_b64_tr_b16 v[230:231], v243 offset:1024
v_xor_b32 v242, 128, v240
v_mfma_f32_16x16x32_bf16 v[20:23], v[212:215], v[176:179], v[20:23]
buffer_load_dwordx4 v246, s[16:19], s57 offen offset:1024 lds
v_mfma_f32_16x16x32_bf16 v[20:23], v[216:219], v[188:191], v[20:23]
s_add_u32 m0, s60, 131072
ds_read_b64_tr_b16 v[232:233], v243 offset:2048
ds_read_b64_tr_b16 v[234:235], v243 offset:3072
v_mfma_f32_16x16x32_bf16 a[240:243], a[252:255], v[168:171], a[240:243]
v_xor_b32 v243, 160, v240
v_mfma_f32_16x16x32_bf16 a[240:243], a[252:255], v[180:183], a[240:243]
buffer_load_dwordx4 v244, s[8:11], s47 offen offset:2048 nt lds
v_mfma_f32_16x16x32_bf16 a[244:247], a[252:255], v[172:175], a[244:247]
s_add_u32 m0, s60, 98304
v_mfma_f32_16x16x32_bf16 a[244:247], a[252:255], v[184:187], a[244:247]
v_mfma_f32_16x16x32_bf16 a[248:251], a[252:255], v[176:179], a[248:251]
s_waitcnt lgkmcnt(4)
v_mfma_f32_16x16x32_bf16 a[248:251], a[252:255], v[188:191], a[248:251]
buffer_load_dwordx4 v246, s[16:19], s58 offen offset:2048 lds
v_mfma_f32_16x16x32_bf16 v[24:27], v[220:223], v[168:171], v[24:27]
ds_read_b64_tr_b16 v[204:205], v242 offset:0
ds_read_b64_tr_b16 v[206:207], v242 offset:1024
v_mfma_f32_16x16x32_bf16 v[24:27], v[224:227], v[180:183], v[24:27]
ds_read_b64_tr_b16 v[208:209], v242 offset:2048
v_accvgpr_read_b32 v249, a240
v_mfma_f32_16x16x32_bf16 v[28:31], v[220:223], v[172:175], v[28:31]
ds_read_b64_tr_b16 v[210:211], v242 offset:3072
v_accvgpr_read_b32 v250, a244
v_mfma_f32_16x16x32_bf16 v[28:31], v[224:227], v[184:187], v[28:31]
ds_read_b64_tr_b16 v[212:213], v243 offset:0
v_accvgpr_read_b32 v251, a248
v_mfma_f32_16x16x32_bf16 v[32:35], v[220:223], v[176:179], v[32:35]
ds_read_b64_tr_b16 v[214:215], v243 offset:1024
ds_read_b64_tr_b16 v[216:217], v243 offset:2048
v_mfma_f32_16x16x32_bf16 v[32:35], v[224:227], v[188:191], v[32:35]
s_waitcnt lgkmcnt(7)
buffer_load_dwordx4 v246, s[16:19], s59 offen offset:3072 lds
v_mfma_f32_16x16x32_bf16 v[36:39], v[228:231], v[168:171], v[36:39]
s_add_u32 m0, s60, 131072
ds_read_b64_tr_b16 v[218:219], v243 offset:3072
v_xor_b32 v242, 192, v240
v_mfma_f32_16x16x32_bf16 v[36:39], v[232:235], v[180:183], v[36:39]
v_min3_f32 v254, v249, v250, v251
v_max3_f32 v255, v249, v250, v251
v_mfma_f32_16x16x32_bf16 v[40:43], v[228:231], v[172:175], v[40:43]
v_xor_b32 v243, 224, v240
v_cmp_gt_f32 s[84:85], s66, v254
v_mfma_f32_16x16x32_bf16 v[40:43], v[232:235], v[184:187], v[40:43]
buffer_load_dwordx4 v244, s[8:11], s47 offen offset:3072 nt lds
v_mfma_f32_16x16x32_bf16 v[44:47], v[228:231], v[176:179], v[44:47]
s_waitcnt lgkmcnt(4)
v_rcp_f32 v249, v249
v_mfma_f32_16x16x32_bf16 v[44:47], v[232:235], v[188:191], v[44:47]
s_add_u32 s47, s47, 0x4000
ds_read_b64_tr_b16 v[220:221], v242 offset:0
ds_read_b64_tr_b16 v[222:223], v242 offset:1024
v_mfma_f32_16x16x32_bf16 v[48:51], v[204:207], v[168:171], v[48:51]
ds_read_b64_tr_b16 v[224:225], v242 offset:2048
v_cmp_lt_f32 vcc, s67, v255
v_mfma_f32_16x16x32_bf16 v[48:51], v[208:211], v[180:183], v[48:51]
v_rcp_f32 v250, v250
v_mfma_f32_16x16x32_bf16 v[52:55], v[204:207], v[172:175], v[52:55]
v_rcp_f32 v251, v251
v_mfma_f32_16x16x32_bf16 v[52:55], v[208:211], v[184:187], v[52:55]
ds_read_b64_tr_b16 v[226:227], v242 offset:3072
ds_read_b64_tr_b16 v[228:229], v243 offset:0
v_mfma_f32_16x16x32_bf16 v[56:59], v[204:207], v[176:179], v[56:59]
ds_read_b64_tr_b16 v[230:231], v243 offset:1024
v_mul_f32 v0, v249, v0
v_mfma_f32_16x16x32_bf16 v[56:59], v[208:211], v[188:191], v[56:59]
s_waitcnt lgkmcnt(6)
ds_read_b64_tr_b16 v[232:233], v243 offset:2048
v_mul_f32 v1, v249, v1
v_mfma_f32_16x16x32_bf16 v[60:63], v[212:215], v[168:171], v[60:63]
ds_read_b64_tr_b16 v[234:235], v243 offset:3072
v_mul_f32 v2, v249, v2
v_mfma_f32_16x16x32_bf16 v[60:63], v[216:219], v[180:183], v[60:63]
v_mul_f32 v3, v249, v3
v_cvt_pk_bf16_f32 v144, v0, v1
v_mfma_f32_16x16x32_bf16 v[64:67], v[212:215], v[172:175], v[64:67]
v_cvt_pk_bf16_f32 v145, v2, v3
v_mul_f32 v12, v249, v12
v_mfma_f32_16x16x32_bf16 v[64:67], v[216:219], v[184:187], v[64:67]
v_mul_f32 v13, v249, v13
v_mul_f32 v14, v249, v14
v_mfma_f32_16x16x32_bf16 v[68:71], v[212:215], v[176:179], v[68:71]
s_waitcnt lgkmcnt(4)
v_mul_f32 v15, v249, v15
v_cvt_pk_bf16_f32 v146, v12, v13
v_mfma_f32_16x16x32_bf16 v[68:71], v[216:219], v[188:191], v[68:71]
s_add_u32 m0, s60, 0
v_cvt_pk_bf16_f32 v147, v14, v15
v_mul_f32 v4, v250, v4
v_mfma_f32_16x16x32_bf16 v[72:75], v[220:223], v[168:171], v[72:75]
s_waitcnt vmcnt(17) lgkmcnt(0)
v_mul_f32 v5, v250, v5
v_mul_f32 v6, v250, v6
v_mfma_f32_16x16x32_bf16 v[72:75], v[224:227], v[180:183], v[72:75]
s_barrier
ds_read_b64_tr_b16 v[204:205], v241 offset:49152
ds_read_b64_tr_b16 v[206:207], v241 offset:51200
v_mfma_f32_16x16x32_bf16 v[76:79], v[220:223], v[172:175], v[76:79]
ds_read_b64_tr_b16 v[208:209], v241 offset:53248
v_mul_f32 v7, v250, v7
v_mfma_f32_16x16x32_bf16 v[76:79], v[224:227], v[184:187], v[76:79]
ds_read_b64_tr_b16 v[210:211], v241 offset:55296
v_cvt_pk_bf16_f32 v148, v4, v5
v_mfma_f32_16x16x32_bf16 v[80:83], v[220:223], v[176:179], v[80:83]
ds_read_b64_tr_b16 v[212:213], v241 offset:57344
v_cvt_pk_bf16_f32 v149, v6, v7
v_mfma_f32_16x16x32_bf16 v[80:83], v[224:227], v[188:191], v[80:83]
ds_read_b64_tr_b16 v[214:215], v241 offset:59392
ds_read_b64_tr_b16 v[216:217], v241 offset:61440
v_mfma_f32_16x16x32_bf16 v[84:87], v[228:231], v[168:171], v[84:87]
buffer_load_dwordx4 v245, s[12:15], s48 offen offset:0 nt lds
v_mfma_f32_16x16x32_bf16 v[84:87], v[232:235], v[180:183], v[84:87]
ds_read_b64_tr_b16 v[218:219], v241 offset:63488
v_mul_f32 v16, v250, v16
v_mfma_f32_16x16x32_bf16 v[88:91], v[228:231], v[172:175], v[88:91]
v_mul_f32 v17, v250, v17
v_mul_f32 v18, v250, v18
v_mfma_f32_16x16x32_bf16 v[88:91], v[232:235], v[184:187], v[88:91]
v_mul_f32 v19, v250, v19
v_cvt_pk_bf16_f32 v150, v16, v17
v_mfma_f32_16x16x32_bf16 v[92:95], v[228:231], v[176:179], v[92:95]
v_cvt_pk_bf16_f32 v151, v18, v19
v_mul_f32 v8, v251, v8
v_mfma_f32_16x16x32_bf16 v[92:95], v[232:235], v[188:191], v[92:95]
v_mul_f32 v9, v251, v9
v_mul_f32 v10, v251, v10
s_or_b64 s[84:85], s[84:85], vcc
s_cbranch_scc1 L_slow
L_join:
s_add_u32 s61, s61, 1
s_cmp_lt_u32 s61, 4
s_cbranch_scc1 L_loop
L_g3:
s_cmp_eq_u32 s72, 7
s_cbranch_scc1 L_G0S
L_G0:
s_waitcnt lgkmcnt(4)
v_mfma_f32_16x16x32_bf16 v[0:3], v[204:207], a[144:147], 0
s_lshl_b32 s5, s65, 2
v_xor_b32 v243, 32, v241
v_mul_f32 v11, v251, v11
v_mfma_f32_16x16x32_bf16 v[0:3], v[208:211], a[156:159], v[0:3]
s_waitcnt lgkmcnt(0)
ds_read_b64_tr_b16 v[220:221], v243 offset:49152
v_cvt_pk_bf16_f32 v152, v8, v9
v_mfma_f32_16x16x32_bf16 v[0:3], v[212:215], a[168:171], v[0:3]
s_cmp_eq_u32 s63, 0
ds_read_b64_tr_b16 v[222:223], v243 offset:51200
v_cvt_pk_bf16_f32 v153, v10, v11
v_mfma_f32_16x16x32_bf16 v[0:3], v[216:219], a[180:183], v[0:3]
s_cselect_b32 s5, s5, 0x40000000
ds_read_b64_tr_b16 v[224:225], v243 offset:53248
v_mbcnt_lo_u32_b32 v254, -1, 0
v_mfma_f32_16x16x32_bf16 v[4:7], v[204:207], a[148:151], 0
s_mov_b32 s6, 0xffff0000
ds_read_b64_tr_b16 v[226:227], v243 offset:55296
v_mbcnt_hi_u32_b32 v254, -1, v254
v_mfma_f32_16x16x32_bf16 v[4:7], v[208:211], a[160:163], v[4:7]
s_mov_b32 s90, s69
ds_read_b64_tr_b16 v[228:229], v243 offset:57344
v_lshlrev_b32 v244, 4, v254
v_mfma_f32_16x16x32_bf16 v[4:7], v[212:215], a[172:175], v[4:7]
s_add_u32 s91, s90, 0x1000
ds_read_b64_tr_b16 v[230:231], v243 offset:59392
v_xor_b32 v242, 64, v241
v_mfma_f32_16x16x32_bf16 v[4:7], v[216:219], a[184:187], v[4:7]
s_mov_b32 s88, s70
ds_read_b64_tr_b16 v[232:233], v243 offset:61440
v_mul_f32 v20, v251, v20
v_mfma_f32_16x16x32_bf16 v[8:11], v[204:207], a[152:155], 0
s_mov_b32 s89, 16
ds_read_b64_tr_b16 v[234:235], v243 offset:63488
v_mul_f32 v21, v251, v21
v_mfma_f32_16x16x32_bf16 v[8:11], v[208:211], a[164:167], v[8:11]
buffer_load_dwordx4 v[96:99], v244, s[24:27], s90 offen offset:0
v_mfma_f32_16x16x32_bf16 v[8:11], v[212:215], a[176:179], v[8:11]
s_waitcnt lgkmcnt(4)
v_mul_f32 v22, v251, v22
v_mul_f32 v23, v251, v23
v_mfma_f32_16x16x32_bf16 v[8:11], v[216:219], a[188:191], v[8:11]
ds_read_b64_tr_b16 v[204:205], v242 offset:49152
v_cvt_pk_bf16_f32 v154, v20, v21
v_mfma_f32_16x16x32_bf16 v[12:15], v[220:223], a[144:147], 0
ds_read_b64_tr_b16 v[206:207], v242 offset:51200
v_cvt_pk_bf16_f32 v155, v22, v23
v_mfma_f32_16x16x32_bf16 v[12:15], v[224:227], a[156:159], v[12:15]
s_waitcnt lgkmcnt(2)
ds_read_b64_tr_b16 v[208:209], v242 offset:53248
v_mul_f32 v24, v249, v24
v_mfma_f32_16x16x32_bf16 v[12:15], v[228:231], a[168:171], v[12:15]
buffer_load_dwordx4 v[100:103], v244, s[24:27], s90 offen offset:1024
v_mfma_f32_16x16x32_bf16 v[12:15], v[232:235], a[180:183], v[12:15]
ds_read_b64_tr_b16 v[210:211], v242 offset:55296
v_mul_f32 v25, v249, v25
v_mfma_f32_16x16x32_bf16 v[16:19], v[220:223], a[148:151], 0
ds_read_b64_tr_b16 v[212:213], v242 offset:57344
v_mul_f32 v26, v249, v26
v_mfma_f32_16x16x32_bf16 v[16:19], v[224:227], a[160:163], v[16:19]
ds_read_b64_tr_b16 v[214:215], v242 offset:59392
v_mul_f32 v27, v249, v27
v_mfma_f32_16x16x32_bf16 v[16:19], v[228:231], a[172:175], v[16:19]
buffer_load_dwordx4 v[104:107], v244, s[24:27], s90 offen offset:2048
v_mfma_f32_16x16x32_bf16 v[16:19], v[232:235], a[184:187], v[16:19]
ds_read_b64_tr_b16 v[216:217], v242 offset:61440
v_cvt_pk_bf16_f32 v156, v24, v25
v_mfma_f32_16x16x32_bf16 v[20:23], v[220:223], a[152:155], 0
ds_read_b64_tr_b16 v[218:219], v242 offset:63488
v_cvt_pk_bf16_f32 v157, v26, v27
v_mfma_f32_16x16x32_bf16 v[20:23], v[224:227], a[164:167], v[20:23]
v_xor_b32 v243, 96, v241
v_mul_f32 v28, v250, v28
v_mfma_f32_16x16x32_bf16 v[20:23], v[228:231], a[176:179], v[20:23]
s_waitcnt lgkmcnt(4)
buffer_load_dwordx4 v[108:111], v244, s[24:27], s90 offen offset:3072
v_mfma_f32_16x16x32_bf16 v[20:23], v[232:235], a[188:191], v[20:23]
ds_read_b64_tr_b16 v[220:221], v243 offset:49152
v_mul_f32 v29, v250, v29
v_mfma_f32_16x16x32_bf16 v[24:27], v[204:207], a[144:147], 0
ds_read_b64_tr_b16 v[222:223], v243 offset:51200
v_mul_f32 v30, v250, v30
v_mfma_f32_16x16x32_bf16 v[24:27], v[208:211], a[156:159], v[24:27]
s_waitcnt lgkmcnt(2)
ds_read_b64_tr_b16 v[224:225], v243 offset:53248
v_mul_f32 v31, v250, v31
v_mfma_f32_16x16x32_bf16 v[24:27], v[212:215], a[168:171], v[24:27]
v_cvt_pk_bf16_f32 v160, v28, v29
v_cvt_pk_bf16_f32 v161, v30, v31
v_mfma_f32_16x16x32_bf16 v[24:27], v[216:219], a[180:183], v[24:27]
buffer_load_dwordx4 v[112:115], v244, s[24:27], s91 offen offset:0
ds_read_b64_tr_b16 v[226:227], v243 offset:55296
v_mfma_f32_16x16x32_bf16 v[28:31], v[204:207], a[148:151], 0
s_add_u32 s56, s40, s96
ds_read_b64_tr_b16 v[228:229], v243 offset:57344
v_mul_f32 v32, v251, v32
v_mfma_f32_16x16x32_bf16 v[28:31], v[208:211], a[160:163], v[28:31]
s_add_u32 s57, s56, s50
ds_read_b64_tr_b16 v[230:231], v243 offset:59392
v_mul_f32 v33, v251, v33
v_mfma_f32_16x16x32_bf16 v[28:31], v[212:215], a[172:175], v[28:31]
s_add_u32 s58, s56, s51
v_mul_f32 v34, v251, v34
v_mul_f32 v35, v251, v35
v_mfma_f32_16x16x32_bf16 v[28:31], v[216:219], a[184:187], v[28:31]
s_add_u32 s59, s56, s52
buffer_load_dwordx4 v[116:119], v244, s[24:27], s91 offen offset:1024
ds_read_b64_tr_b16 v[232:233], v243 offset:61440
v_cvt_pk_bf16_f32 v164, v32, v33
v_cvt_pk_bf16_f32 v165, v34, v35
v_mfma_f32_16x16x32_bf16 v[32:35], v[204:207], a[152:155], 0
ds_read_b64_tr_b16 v[234:235], v243 offset:63488
v_add_u32 v241, 0x10000, v241
v_mfma_f32_16x16x32_bf16 v[32:35], v[208:211], a[164:167], v[32:35]
v_mul_f32 v36, v249, v36
v_mul_f32 v37, v249, v37
v_mfma_f32_16x16x32_bf16 v[32:35], v[212:215], a[176:179], v[32:35]
s_waitcnt lgkmcnt(4)
v_mul_f32 v38, v249, v38
v_mul_f32 v39, v249, v39
v_mfma_f32_16x16x32_bf16 v[32:35], v[216:219], a[188:191], v[32:35]
s_add_u32 m0, s60, 147456
buffer_load_dwordx4 v[120:123], v244, s[24:27], s91 offen offset:2048
v_cvt_pk_bf16_f32 v158, v36, v37
v_cvt_pk_bf16_f32 v159, v38, v39
v_mfma_f32_16x16x32_bf16 v[36:39], v[220:223], a[144:147], 0
ds_read_b64_tr_b16 v[204:205], v241 offset:16384
v_mul_f32 v40, v250, v40
v_mfma_f32_16x16x32_bf16 v[36:39], v[224:227], a[156:159], v[36:39]
s_waitcnt lgkmcnt(1)
ds_read_b64_tr_b16 v[206:207], v241 offset:18432
v_mul_f32 v41, v250, v41
v_mfma_f32_16x16x32_bf16 v[36:39], v[228:231], a[168:171], v[36:39]
ds_read_b64_tr_b16 v[208:209], v241 offset:20480
v_mul_f32 v42, v250, v42
v_mfma_f32_16x16x32_bf16 v[36:39], v[232:235], a[180:183], v[36:39]
buffer_load_dwordx4 v[124:127], v244, s[24:27], s91 offen offset:3072
ds_read_b64_tr_b16 v[210:211], v241 offset:22528
v_mul_f32 v43, v250, v43
v_cvt_pk_bf16_f32 v162, v40, v41
v_cvt_pk_bf16_f32 v163, v42, v43
v_mfma_f32_16x16x32_bf16 v[40:43], v[220:223], a[148:151], 0
s_add_u32 s90, s90, 196608
ds_read_b64_tr_b16 v[212:213], v241 offset:24576
v_mul_f32 v44, v251, v44
v_mfma_f32_16x16x32_bf16 v[40:43], v[224:227], a[160:163], v[40:43]
s_add_u32 s91, s90, 0x1000
ds_read_b64_tr_b16 v[214:215], v241 offset:26624
v_mul_f32 v45, v251, v45
v_mfma_f32_16x16x32_bf16 v[40:43], v[228:231], a[172:175], v[40:43]
v_mul_f32 v46, v251, v46
v_mul_f32 v47, v251, v47
v_mfma_f32_16x16x32_bf16 v[40:43], v[232:235], a[184:187], v[40:43]
ds_read_b64_tr_b16 v[216:217], v241 offset:28672
v_cvt_pk_bf16_f32 v166, v44, v45
v_cvt_pk_bf16_f32 v167, v46, v47
v_mfma_f32_16x16x32_bf16 v[44:47], v[220:223], a[152:155], 0
ds_read_b64_tr_b16 v[218:219], v241 offset:30720
buffer_load_dwordx4 v246, s[16:19], s56 offen offset:0 lds
v_mfma_f32_16x16x32_bf16 v[44:47], v[224:227], a[164:167], v[44:47]
v_xor_b32 v243, 32, v241
v_and_b32 v240, 7, v254
v_mfma_f32_16x16x32_bf16 v[44:47], v[228:231], a[176:179], v[44:47]
s_waitcnt lgkmcnt(4)
v_lshlrev_b32 v240, 2, v240
v_lshrrev_b32 v255, 4, v254
v_mfma_f32_16x16x32_bf16 v[44:47], v[232:235], a[188:191], v[44:47]
ds_read_b64_tr_b16 v[220:221], v243 offset:16384
v_bfe_u32 v248, v254, 2, 2
v_mfma_f32_16x16x32_bf16 v[0:3], v[204:207], a[192:195], v[0:3]
ds_read_b64_tr_b16 v[222:223], v243 offset:18432
v_and_b32 v254, 3, v254
v_mfma_f32_16x16x32_bf16 v[0:3], v[208:211], a[204:207], v[0:3]
s_waitcnt lgkmcnt(2)
buffer_load_dwordx4 v246, s[16:19], s57 offen offset:1024 lds
v_mfma_f32_16x16x32_bf16 v[0:3], v[212:215], a[216:219], v[0:3]
ds_read_b64_tr_b16 v[224:225], v243 offset:20480
v_lshl_add_u32 v254, v248, 4, v254
v_mfma_f32_16x16x32_bf16 v[0:3], v[216:219], a[228:231], v[0:3]
ds_read_b64_tr_b16 v[226:227], v243 offset:22528
v_xor_b32 v242, 64, v241
v_mfma_f32_16x16x32_bf16 v[4:7], v[204:207], a[196:199], v[4:7]
ds_read_b64_tr_b16 v[228:229], v243 offset:24576
v_lshlrev_b32 v254, 10, v254
v_mfma_f32_16x16x32_bf16 v[4:7], v[208:211], a[208:211], v[4:7]
ds_read_b64_tr_b16 v[230:231], v243 offset:26624
v_lshl_add_u32 v248, v255, 4, v254
v_mfma_f32_16x16x32_bf16 v[4:7], v[212:215], a[220:223], v[4:7]
buffer_load_dwordx4 v246, s[16:19], s58 offen offset:2048 lds
v_mfma_f32_16x16x32_bf16 v[4:7], v[216:219], a[232:235], v[4:7]
ds_read_b64_tr_b16 v[232:233], v243 offset:28672
v_mov_b32 v245, 0x40000000
v_mfma_f32_16x16x32_bf16 v[8:11], v[204:207], a[200:203], v[8:11]
ds_read_b64_tr_b16 v[234:235], v243 offset:30720
v_writelane_b32 v245, s5, 1
v_mfma_f32_16x16x32_bf16 v[8:11], v[208:211], a[212:215], v[8:11]
v_mul_f32 v48, v249, v48
v_mul_f32 v49, v249, v49
v_mfma_f32_16x16x32_bf16 v[8:11], v[212:215], a[224:227], v[8:11]
s_waitcnt lgkmcnt(4)
buffer_load_dwordx4 v246, s[16:19], s59 offen offset:3072 lds
v_mfma_f32_16x16x32_bf16 v[8:11], v[216:219], a[236:239], v[8:11]
s_add_u32 m0, s60, 32768
ds_read_b64_tr_b16 v[204:205], v242 offset:16384
v_mul_f32 v50, v249, v50
v_mfma_f32_16x16x32_bf16 v[12:15], v[220:223], a[192:195], v[12:15]
s_add_u32 s56, s40, s97
ds_read_b64_tr_b16 v[206:207], v242 offset:18432
v_mul_f32 v51, v249, v51
v_mfma_f32_16x16x32_bf16 v[12:15], v[224:227], a[204:207], v[12:15]
s_waitcnt lgkmcnt(2)
ds_read_b64_tr_b16 v[208:209], v242 offset:20480
v_cvt_pk_bf16_f32 v168, v48, v49
v_mfma_f32_16x16x32_bf16 v[12:15], v[228:231], a[216:219], v[12:15]
s_add_u32 s57, s56, s50
ds_read_b64_tr_b16 v[210:211], v242 offset:22528
v_cvt_pk_bf16_f32 v169, v50, v51
v_mfma_f32_16x16x32_bf16 v[12:15], v[232:235], a[228:231], v[12:15]
s_add_u32 s58, s56, s51
ds_read_b64_tr_b16 v[212:213], v242 offset:24576
v_xor_b32 v243, 96, v241
v_mfma_f32_16x16x32_bf16 v[16:19], v[220:223], a[196:199], v[16:19]
s_add_u32 s59, s56, s52
buffer_load_dwordx4 v246, s[16:19], s56 offen offset:0 lds
v_mfma_f32_16x16x32_bf16 v[16:19], v[224:227], a[208:211], v[16:19]
ds_read_b64_tr_b16 v[214:215], v242 offset:26624
v_mul_f32 v60, v249, v60
v_mfma_f32_16x16x32_bf16 v[16:19], v[228:231], a[220:223], v[16:19]
ds_read_b64_tr_b16 v[216:217], v242 offset:28672
v_mul_f32 v61, v249, v61
v_mfma_f32_16x16x32_bf16 v[16:19], v[232:235], a[232:235], v[16:19]
ds_read_b64_tr_b16 v[218:219], v242 offset:30720
v_mul_f32 v62, v249, v62
v_mfma_f32_16x16x32_bf16 v[20:23], v[220:223], a[200:203], v[20:23]
buffer_load_dwordx4 v246, s[16:19], s57 offen offset:1024 lds
v_mfma_f32_16x16x32_bf16 v[20:23], v[224:227], a[212:215], v[20:23]
v_mul_f32 v63, v249, v63
v_cvt_pk_bf16_f32 v170, v60, v61
v_mfma_f32_16x16x32_bf16 v[20:23], v[228:231], a[224:227], v[20:23]
s_waitcnt lgkmcnt(4)
v_cvt_pk_bf16_f32 v171, v62, v63
v_mul_f32 v72, v249, v72
v_mfma_f32_16x16x32_bf16 v[20:23], v[232:235], a[236:239], v[20:23]
ds_read_b64_tr_b16 v[220:221], v243 offset:16384
v_mul_f32 v73, v249, v73
v_mfma_f32_16x16x32_bf16 v[24:27], v[204:207], a[192:195], v[24:27]
ds_read_b64_tr_b16 v[222:223], v243 offset:18432
v_mul_f32 v74, v249, v74
v_mfma_f32_16x16x32_bf16 v[24:27], v[208:211], a[204:207], v[24:27]
s_waitcnt lgkmcnt(2)
ds_read_b64_tr_b16 v[224:225], v243 offset:20480
v_mul_f32 v75, v249, v75
v_mfma_f32_16x16x32_bf16 v[24:27], v[212:215], a[216:219], v[24:27]
ds_read_b64_tr_b16 v[226:227], v243 offset:22528
v_cvt_pk_bf16_f32 v180, v72, v73
v_mfma_f32_16x16x32_bf16 v[24:27], v[216:219], a[228:231], v[24:27]
buffer_load_dwordx4 v246, s[16:19], s58 offen offset:2048 lds
v_mfma_f32_16x16x32_bf16 v[28:31], v[204:207], a[196:199], v[28:31]
ds_read_b64_tr_b16 v[228:229], v243 offset:24576
v_cvt_pk_bf16_f32 v181, v74, v75
v_mfma_f32_16x16x32_bf16 v[28:31], v[208:211], a[208:211], v[28:31]
ds_read_b64_tr_b16 v[230:231], v243 offset:26624
v_mul_f32 v84, v249, v84
v_mfma_f32_16x16x32_bf16 v[28:31], v[212:215], a[220:223], v[28:31]
ds_read_b64_tr_b16 v[232:233], v243 offset:28672
v_mul_f32 v85, v249, v85
v_mfma_f32_16x16x32_bf16 v[28:31], v[216:219], a[232:235], v[28:31]
ds_read_b64_tr_b16 v[234:235], v243 offset:30720
v_mul_f32 v86, v249, v86
v_mfma_f32_16x16x32_bf16 v[32:35], v[204:207], a[200:203], v[32:35]
buffer_load_dwordx4 v246, s[16:19], s59 offen offset:3072 lds
v_mfma_f32_16x16x32_bf16 v[32:35], v[208:211], a[212:215], v[32:35]
s_add_u32 m0, s60, 49152
v_mul_f32 v87, v249, v87
v_cvt_pk_bf16_f32 v182, v84, v85
v_mfma_f32_16x16x32_bf16 v[32:35], v[212:215], a[224:227], v[32:35]
s_waitcnt lgkmcnt(4)
v_cvt_pk_bf16_f32 v183, v86, v87
v_mul_f32 v52, v250, v52
v_mfma_f32_16x16x32_bf16 v[32:35], v[216:219], a[236:239], v[32:35]
s_add_u32 s56, s41, s93
v_mul_f32 v53, v250, v53
v_mul_f32 v54, v250, v54
v_mfma_f32_16x16x32_bf16 v[36:39], v[220:223], a[192:195], v[36:39]
s_waitcnt vmcnt(34) lgkmcnt(0)
v_mul_f32 v55, v250, v55
v_cvt_pk_bf16_f32 v172, v52, v53
v_mfma_f32_16x16x32_bf16 v[36:39], v[224:227], a[204:207], v[36:39]
s_barrier
ds_read_b64_tr_b16 v[204:205], v241 offset:49152
v_cvt_pk_bf16_f32 v173, v54, v55
v_mfma_f32_16x16x32_bf16 v[36:39], v[228:231], a[216:219], v[36:39]
s_add_u32 s57, s56, s50
ds_read_b64_tr_b16 v[206:207], v241 offset:51200
v_mul_f32 v64, v250, v64
v_mfma_f32_16x16x32_bf16 v[36:39], v[232:235], a[228:231], v[36:39]
s_add_u32 s58, s56, s51
ds_read_b64_tr_b16 v[208:209], v241 offset:53248
v_xor_b32 v243, 32, v241
v_mfma_f32_16x16x32_bf16 v[40:43], v[220:223], a[196:199], v[40:43]
s_add_u32 s59, s56, s52
ds_read_b64_tr_b16 v[210:211], v241 offset:55296
v_mul_f32 v65, v250, v65
v_mfma_f32_16x16x32_bf16 v[40:43], v[224:227], a[208:211], v[40:43]
buffer_load_dwordx4 v246, s[16:19], s56 offen offset:0 lds
v_mfma_f32_16x16x32_bf16 v[40:43], v[228:231], a[220:223], v[40:43]
ds_read_b64_tr_b16 v[212:213], v241 offset:57344
v_mul_f32 v66, v250, v66
v_mfma_f32_16x16x32_bf16 v[40:43], v[232:235], a[232:235], v[40:43]
ds_read_b64_tr_b16 v[214:215], v241 offset:59392
v_mul_f32 v67, v250, v67
v_mfma_f32_16x16x32_bf16 v[44:47], v[220:223], a[200:203], v[44:47]
ds_read_b64_tr_b16 v[216:217], v241 offset:61440
v_cvt_pk_bf16_f32 v174, v64, v65
v_mfma_f32_16x16x32_bf16 v[44:47], v[224:227], a[212:215], v[44:47]
ds_read_b64_tr_b16 v[218:219], v241 offset:63488
v_cvt_pk_bf16_f32 v175, v66, v67
v_mfma_f32_16x16x32_bf16 v[44:47], v[228:231], a[224:227], v[44:47]
s_waitcnt lgkmcnt(4)
buffer_load_dwordx4 v246, s[16:19], s57 offen offset:1024 lds
v_mfma_f32_16x16x32_bf16 v[44:47], v[232:235], a[236:239], v[44:47]
ds_read_b64_tr_b16 v[220:221], v243 offset:49152
v_mul_f32 v76, v250, v76
v_mfma_f32_16x16x32_bf16 v[0:3], v[204:207], a[0:3], v[0:3]
ds_read_b64_tr_b16 v[222:223], v243 offset:51200
v_mul_f32 v77, v250, v77
v_mfma_f32_16x16x32_bf16 v[0:3], v[208:211], a[12:15], v[0:3]
s_waitcnt lgkmcnt(2)
ds_read_b64_tr_b16 v[224:225], v243 offset:53248
v_mul_f32 v78, v250, v78
v_mfma_f32_16x16x32_bf16 v[0:3], v[212:215], a[24:27], v[0:3]
ds_read_b64_tr_b16 v[226:227], v243 offset:55296
v_mul_f32 v79, v250, v79
v_mfma_f32_16x16x32_bf16 v[0:3], v[216:219], a[36:39], v[0:3]
buffer_load_dwordx4 v246, s[16:19], s58 offen offset:2048 lds
v_mfma_f32_16x16x32_bf16 v[4:7], v[204:207], a[4:7], v[4:7]
ds_read_b64_tr_b16 v[228:229], v243 offset:57344
v_xor_b32 v242, 64, v241
v_mfma_f32_16x16x32_bf16 v[4:7], v[208:211], a[16:19], v[4:7]
ds_read_b64_tr_b16 v[230:231], v243 offset:59392
v_cvt_pk_bf16_f32 v184, v76, v77
v_mfma_f32_16x16x32_bf16 v[4:7], v[212:215], a[28:31], v[4:7]
ds_read_b64_tr_b16 v[232:233], v243 offset:61440
v_cvt_pk_bf16_f32 v185, v78, v79
v_mfma_f32_16x16x32_bf16 v[4:7], v[216:219], a[40:43], v[4:7]
ds_read_b64_tr_b16 v[234:235], v243 offset:63488
v_mul_f32 v88, v250, v88
v_mfma_f32_16x16x32_bf16 v[8:11], v[204:207], a[8:11], v[8:11]
buffer_load_dwordx4 v246, s[16:19], s59 offen offset:3072 lds
v_mfma_f32_16x16x32_bf16 v[8:11], v[208:211], a[20:23], v[8:11]
s_add_u32 m0, s60, 81920
v_mul_f32 v89, v250, v89
v_mul_f32 v90, v250, v90
v_mfma_f32_16x16x32_bf16 v[8:11], v[212:215], a[32:35], v[8:11]
s_waitcnt lgkmcnt(4)
v_mul_f32 v91, v250, v91
v_cvt_pk_bf16_f32 v186, v88, v89
v_mfma_f32_16x16x32_bf16 v[8:11], v[216:219], a[44:47], v[8:11]
s_add_u32 s56, s41, s95
ds_read_b64_tr_b16 v[204:205], v242 offset:49152
v_cvt_pk_bf16_f32 v187, v90, v91
v_mfma_f32_16x16x32_bf16 v[12:15], v[220:223], a[0:3], v[12:15]
s_add_u32 s57, s56, s50
ds_read_b64_tr_b16 v[206:207], v242 offset:51200
v_mul_f32 v56, v251, v56
v_mfma_f32_16x16x32_bf16 v[12:15], v[224:227], a[12:15], v[12:15]
s_waitcnt lgkmcnt(2)
ds_read_b64_tr_b16 v[208:209], v242 offset:53248
v_mul_f32 v57, v251, v57
v_mfma_f32_16x16x32_bf16 v[12:15], v[228:231], a[24:27], v[12:15]
s_add_u32 s58, s56, s51
ds_read_b64_tr_b16 v[210:211], v242 offset:55296
v_mul_f32 v58, v251, v58
v_mfma_f32_16x16x32_bf16 v[12:15], v[232:235], a[36:39], v[12:15]
s_add_u32 s59, s56, s52
buffer_load_dwordx4 v246, s[16:19], s56 offen offset:0 lds
v_mfma_f32_16x16x32_bf16 v[16:19], v[220:223], a[4:7], v[16:19]
ds_read_b64_tr_b16 v[212:213], v242 offset:57344
v_xor_b32 v243, 96, v241
v_mfma_f32_16x16x32_bf16 v[16:19], v[224:227], a[16:19], v[16:19]
ds_read_b64_tr_b16 v[214:215], v242 offset:59392
v_mul_f32 v59, v251, v59
v_mfma_f32_16x16x32_bf16 v[16:19], v[228:231], a[28:31], v[16:19]
ds_read_b64_tr_b16 v[216:217], v242 offset:61440
v_cvt_pk_bf16_f32 v176, v56, v57
v_mfma_f32_16x16x32_bf16 v[16:19], v[232:235], a[40:43], v[16:19]
ds_read_b64_tr_b16 v[218:219], v242 offset:63488
v_cvt_pk_bf16_f32 v177, v58, v59
v_mfma_f32_16x16x32_bf16 v[20:23], v[220:223], a[8:11], v[20:23]
buffer_load_dwordx4 v246, s[16:19], s57 offen offset:1024 lds
v_mfma_f32_16x16x32_bf16 v[20:23], v[224:227], a[20:23], v[20:23]
v_mul_f32 v68, v251, v68
v_mul_f32 v69, v251, v69
v_mfma_f32_16x16x32_bf16 v[20:23], v[228:231], a[32:35], v[20:23]
s_waitcnt lgkmcnt(4)
v_mul_f32 v70, v251, v70
v_mul_f32 v71, v251, v71
v_mfma_f32_16x16x32_bf16 v[20:23], v[232:235], a[44:47], v[20:23]
ds_read_b64_tr_b16 v[220:221], v243 offset:49152
v_cvt_pk_bf16_f32 v178, v68, v69
v_mfma_f32_16x16x32_bf16 v[24:27], v[204:207], a[0:3], v[24:27]
ds_read_b64_tr_b16 v[222:223], v243 offset:51200
v_cvt_pk_bf16_f32 v179, v70, v71
v_mfma_f32_16x16x32_bf16 v[24:27], v[208:211], a[12:15], v[24:27]
s_waitcnt lgkmcnt(2)
buffer_load_dwordx4 v246, s[16:19], s58 offen offset:2048 lds
v_mfma_f32_16x16x32_bf16 v[24:27], v[212:215], a[24:27], v[24:27]
ds_read_b64_tr_b16 v[224:225], v243 offset:53248
v_mul_f32 v80, v251, v80
v_mfma_f32_16x16x32_bf16 v[24:27], v[216:219], a[36:39], v[24:27]
ds_read_b64_tr_b16 v[226:227], v243 offset:55296
v_mul_f32 v81, v251, v81
v_mfma_f32_16x16x32_bf16 v[28:31], v[204:207], a[4:7], v[28:31]
ds_read_b64_tr_b16 v[228:229], v243 offset:57344
v_mul_f32 v82, v251, v82
v_mfma_f32_16x16x32_bf16 v[28:31], v[208:211], a[16:19], v[28:31]
ds_read_b64_tr_b16 v[230:231], v243 offset:59392
v_mul_f32 v83, v251, v83
v_mfma_f32_16x16x32_bf16 v[28:31], v[212:215], a[28:31], v[28:31]
buffer_load_dwordx4 v246, s[16:19], s59 offen offset:3072 lds
v_mfma_f32_16x16x32_bf16 v[28:31], v[216:219], a[40:43], v[28:31]
buffer_load_dwordx4 v[128:131], v244, s[24:27], s90 offen offset:0
ds_read_b64_tr_b16 v[232:233], v243 offset:61440
v_mfma_f32_16x16x32_bf16 v[32:35], v[204:207], a[8:11], v[32:35]
ds_read_b64_tr_b16 v[234:235], v243 offset:63488
v_cvt_pk_bf16_f32 v188, v80, v81
v_mfma_f32_16x16x32_bf16 v[32:35], v[208:211], a[20:23], v[32:35]
v_cvt_pk_bf16_f32 v189, v82, v83
v_mul_f32 v92, v251, v92
v_mfma_f32_16x16x32_bf16 v[32:35], v[212:215], a[32:35], v[32:35]
s_waitcnt lgkmcnt(4)
v_mul_f32 v93, v251, v93
v_mul_f32 v94, v251, v94
v_mfma_f32_16x16x32_bf16 v[32:35], v[216:219], a[44:47], v[32:35]
buffer_load_dwordx4 v[132:135], v244, s[24:27], s90 offen offset:1024
v_mfma_f32_16x16x32_bf16 v[36:39], v[220:223], a[0:3], v[36:39]
ds_read_b64_tr_b16 v[204:205], v241 offset:0
v_mul_f32 v95, v251, v95
v_mfma_f32_16x16x32_bf16 v[36:39], v[224:227], a[12:15], v[36:39]
s_waitcnt lgkmcnt(1)
ds_read_b64_tr_b16 v[206:207], v241 offset:2048
v_cvt_pk_bf16_f32 v190, v92, v93
v_mfma_f32_16x16x32_bf16 v[36:39], v[228:231], a[24:27], v[36:39]
ds_read_b64_tr_b16 v[208:209], v241 offset:4096
v_cvt_pk_bf16_f32 v191, v94, v95
v_mfma_f32_16x16x32_bf16 v[36:39], v[232:235], a[36:39], v[36:39]
buffer_load_dwordx4 v[136:139], v244, s[24:27], s90 offen offset:2048
ds_read_b64_tr_b16 v[210:211], v241 offset:6144
v_mfma_f32_16x16x32_bf16 v[40:43], v[220:223], a[4:7], v[40:43]
ds_read_b64_tr_b16 v[212:213], v241 offset:8192
v_xor_b32 v243, 32, v241
v_mfma_f32_16x16x32_bf16 v[40:43], v[224:227], a[16:19], v[40:43]
ds_read_b64_tr_b16 v[214:215], v241 offset:10240
v_mfma_f32_16x16x32_bf16 v[40:43], v[228:231], a[28:31], v[40:43]
ds_read_b64_tr_b16 v[216:217], v241 offset:12288
v_mfma_f32_16x16x32_bf16 v[40:43], v[232:235], a[40:43], v[40:43]
buffer_load_dwordx4 v[140:143], v244, s[24:27], s90 offen offset:3072
v_mfma_f32_16x16x32_bf16 v[44:47], v[220:223], a[8:11], v[44:47]
ds_read_b64_tr_b16 v[218:219], v241 offset:14336
v_mfma_f32_16x16x32_bf16 v[44:47], v[224:227], a[20:23], v[44:47]
v_mfma_f32_16x16x32_bf16 v[44:47], v[228:231], a[32:35], v[44:47]
s_waitcnt lgkmcnt(4)
v_mfma_f32_16x16x32_bf16 v[44:47], v[232:235], a[44:47], v[44:47]
buffer_load_dwordx4 v[192:195], v244, s[24:27], s91 offen offset:0
v_mfma_f32_16x16x32_bf16 v[0:3], v[204:207], v[144:147], v[0:3]
ds_read_b64_tr_b16 v[220:221], v243 offset:0
v_mfma_f32_16x16x32_bf16 v[0:3], v[208:211], v[156:159], v[0:3]
s_waitcnt lgkmcnt(1)
ds_read_b64_tr_b16 v[222:223], v243 offset:2048
v_mfma_f32_16x16x32_bf16 v[0:3], v[212:215], v[168:171], v[0:3]
ds_read_b64_tr_b16 v[224:225], v243 offset:4096
v_mfma_f32_16x16x32_bf16 v[0:3], v[216:219], v[180:183], v[0:3]
buffer_load_dwordx4 v[196:199], v244, s[24:27], s91 offen offset:1024
ds_read_b64_tr_b16 v[226:227], v243 offset:6144
v_mfma_f32_16x16x32_bf16 v[4:7], v[204:207], v[148:151], v[4:7]
ds_read_b64_tr_b16 v[228:229], v243 offset:8192
v_xor_b32 v242, 64, v241
v_mfma_f32_16x16x32_bf16 v[4:7], v[208:211], v[160:163], v[4:7]
ds_read_b64_tr_b16 v[230:231], v243 offset:10240
v_mfma_f32_16x16x32_bf16 v[4:7], v[212:215], v[172:175], v[4:7]
ds_read_b64_tr_b16 v[232:233], v243 offset:12288
v_mfma_f32_16x16x32_bf16 v[4:7], v[216:219], v[184:187], v[4:7]
buffer_load_dwordx4 v[200:203], v244, s[24:27], s91 offen offset:2048
v_mfma_f32_16x16x32_bf16 v[8:11], v[204:207], v[152:155], v[8:11]
ds_read_b64_tr_b16 v[234:235], v243 offset:14336
v_lshrrev_b32 v48, 4, v244
v_mfma_f32_16x16x32_bf16 v[8:11], v[208:211], v[164:167], v[8:11]
v_lshrrev_b32 v49, 4, v48
v_and_b32 v50, 1, v48
v_mfma_f32_16x16x32_bf16 v[8:11], v[212:215], v[176:179], v[8:11]
s_waitcnt lgkmcnt(4)
v_lshlrev_b32 v50, 4, v50
v_mov_b32 v51, 0x3f80
v_mfma_f32_16x16x32_bf16 v[8:11], v[216:219], v[188:191], v[8:11]
buffer_load_dwordx4 v[236:239], v244, s[24:27], s91 offen offset:3072
v_mfma_f32_16x16x32_bf16 v[12:15], v[220:223], v[144:147], v[12:15]
s_mov_b32 s86, 1
ds_read_b64_tr_b16 v[204:205], v242 offset:0
v_lshlrev_b32 v50, v50, v51
v_mfma_f32_16x16x32_bf16 v[12:15], v[224:227], v[156:159], v[12:15]
s_waitcnt lgkmcnt(1)
ds_read_b64_tr_b16 v[206:207], v242 offset:2048
v_bfe_u32 v51, v48, 1, 1
v_mfma_f32_16x16x32_bf16 v[12:15], v[228:231], v[168:171], v[12:15]
s_sub_u32 s100, s86, 1
ds_read_b64_tr_b16 v[208:209], v242 offset:4096
v_bfe_u32 v52, v48, 3, 1
v_mfma_f32_16x16x32_bf16 v[12:15], v[232:235], v[180:183], v[12:15]
s_and_b32 s100, s100, s72
ds_read_b64_tr_b16 v[210:211], v242 offset:6144
v_xor_b32 v243, 96, v241
v_mfma_f32_16x16x32_bf16 v[16:19], v[220:223], v[148:151], v[16:19]
s_mul_i32 s100, s100, 196608
ds_read_b64_tr_b16 v[212:213], v242 offset:8192
v_lshl_add_u32 v51, v52, 1, v51
v_mfma_f32_16x16x32_bf16 v[16:19], v[224:227], v[160:163], v[16:19]
s_add_u32 s87, s68, s100
ds_read_b64_tr_b16 v[214:215], v242 offset:10240
v_bfe_u32 v52, v48, 2, 1
v_mfma_f32_16x16x32_bf16 v[16:19], v[228:231], v[172:175], v[16:19]
s_add_u32 s90, s69, s100
ds_read_b64_tr_b16 v[216:217], v242 offset:12288
v_lshlrev_b32 v52, 1, v52
v_mfma_f32_16x16x32_bf16 v[16:19], v[232:235], v[184:187], v[16:19]
s_add_u32 s91, s90, 0x1000
ds_read_b64_tr_b16 v[218:219], v242 offset:14336
v_add_u32 v53, 1, v52
v_mfma_f32_16x16x32_bf16 v[20:23], v[220:223], v[152:155], v[20:23]
s_add_u32 s88, s88, 256
v_cmp_eq_u32 vcc, v49, v52
v_cmp_eq_u32 s[84:85], v49, v53
v_mfma_f32_16x16x32_bf16 v[20:23], v[224:227], v[164:167], v[20:23]
s_add_u32 s4, s87, 0
v_add_u32 v241, 0xffff0000, v241
v_cndmask_b32 v54, 0, v50, vcc
v_mfma_f32_16x16x32_bf16 v[20:23], v[228:231], v[176:179], v[20:23]
s_waitcnt lgkmcnt(4)
v_cndmask_b32 v55, 0, v50, s[84:85]
v_cmp_eq_u32 vcc, 0, v51
v_mfma_f32_16x16x32_bf16 v[20:23], v[232:235], v[188:191], v[20:23]
s_add_u32 s5, s87, 8192
ds_read_b64_tr_b16 v[220:221], v243 offset:0
v_cndmask_b32 v48, 0, v54, vcc
v_mfma_f32_16x16x32_bf16 v[24:27], v[204:207], v[144:147], v[24:27]
ds_read_b64_tr_b16 v[222:223], v243 offset:2048
v_cndmask_b32 v49, 0, v55, vcc
v_mfma_f32_16x16x32_bf16 v[24:27], v[208:211], v[156:159], v[24:27]
s_waitcnt lgkmcnt(2)
ds_read_b64_tr_b16 v[224:225], v243 offset:4096
v_accvgpr_write_b32 a48, v48
v_mfma_f32_16x16x32_bf16 v[24:27], v[212:215], v[168:171], v[24:27]
ds_read_b64_tr_b16 v[226:227], v243 offset:6144
v_accvgpr_write_b32 a52, v49
v_mfma_f32_16x16x32_bf16 v[24:27], v[216:219], v[180:183], v[24:27]
ds_read_b64_tr_b16 v[228:229], v243 offset:8192
v_cmp_eq_u32 vcc, 1, v51
v_mfma_f32_16x16x32_bf16 v[28:31], v[204:207], v[148:151], v[28:31]
ds_read_b64_tr_b16 v[230:231], v243 offset:10240
v_cndmask_b32 v48, 0, v54, vcc
v_mfma_f32_16x16x32_bf16 v[28:31], v[208:211], v[160:163], v[28:31]
ds_read_b64_tr_b16 v[232:233], v243 offset:12288
v_cndmask_b32 v49, 0, v55, vcc
v_mfma_f32_16x16x32_bf16 v[28:31], v[212:215], v[172:175], v[28:31]
ds_read_b64_tr_b16 v[234:235], v243 offset:14336
v_accvgpr_write_b32 a49, v48
v_mfma_f32_16x16x32_bf16 v[28:31], v[216:219], v[184:187], v[28:31]
v_accvgpr_write_b32 a53, v49
v_cmp_eq_u32 vcc, 2, v51
v_mfma_f32_16x16x32_bf16 v[32:35], v[204:207], v[152:155], v[32:35]
v_mfma_f32_16x16x32_bf16 v[32:35], v[208:211], v[164:167], v[32:35]
v_cndmask_b32 v48, 0, v54, vcc
v_cndmask_b32 v49, 0, v55, vcc
v_mfma_f32_16x16x32_bf16 v[32:35], v[212:215], v[176:179], v[32:35]
s_waitcnt lgkmcnt(4)
v_accvgpr_write_b32 a50, v48
v_accvgpr_write_b32 a54, v49
v_mfma_f32_16x16x32_bf16 v[32:35], v[216:219], v[188:191], v[32:35]
v_cmp_eq_u32 vcc, 3, v51
v_mfma_f32_16x16x32_bf16 v[36:39], v[220:223], v[144:147], v[36:39]
s_waitcnt vmcnt(18) lgkmcnt(0)
v_cndmask_b32 v48, 0, v54, vcc
v_cndmask_b32 v49, 0, v55, vcc
v_mfma_f32_16x16x32_bf16 v[36:39], v[224:227], v[156:159], v[36:39]
s_barrier
ds_read_b64_tr_b16 v[204:205], v241 offset:16384
v_accvgpr_write_b32 a51, v48
v_mfma_f32_16x16x32_bf16 v[36:39], v[228:231], v[168:171], v[36:39]
ds_read_b64_tr_b16 v[206:207], v241 offset:18432
v_accvgpr_write_b32 a55, v49
v_mfma_f32_16x16x32_bf16 v[36:39], v[232:235], v[180:183], v[36:39]
ds_read_b64_tr_b16 v[208:209], v241 offset:20480
v_xor_b32 v243, 32, v241
v_mfma_f32_16x16x32_bf16 v[40:43], v[220:223], v[148:151], v[40:43]
ds_read_b64_tr_b16 v[210:211], v241 offset:22528
v_mfma_f32_16x16x32_bf16 v[40:43], v[224:227], v[160:163], v[40:43]
ds_read_b64_tr_b16 v[212:213], v241 offset:24576
v_mfma_f32_16x16x32_bf16 v[40:43], v[228:231], v[172:175], v[40:43]
ds_read_b64_tr_b16 v[214:215], v241 offset:26624
v_mfma_f32_16x16x32_bf16 v[40:43], v[232:235], v[184:187], v[40:43]
ds_read_b64_tr_b16 v[216:217], v241 offset:28672
v_mfma_f32_16x16x32_bf16 v[44:47], v[220:223], v[152:155], v[44:47]
ds_read_b64_tr_b16 v[218:219], v241 offset:30720
v_mfma_f32_16x16x32_bf16 v[44:47], v[224:227], v[164:167], v[44:47]
v_mfma_f32_16x16x32_bf16 v[44:47], v[228:231], v[176:179], v[44:47]
s_waitcnt lgkmcnt(4)
v_mfma_f32_16x16x32_bf16 v[44:47], v[232:235], v[188:191], v[44:47]
ds_read_b64_tr_b16 v[220:221], v243 offset:16384
v_mfma_f32_16x16x32_bf16 v[48:51], v[204:207], a[144:147], 0
ds_read_b64_tr_b16 v[222:223], v243 offset:18432
v_mfma_f32_16x16x32_bf16 v[48:51], v[208:211], a[156:159], v[48:51]
s_waitcnt lgkmcnt(2)
ds_read_b64_tr_b16 v[224:225], v243 offset:20480
v_mfma_f32_16x16x32_bf16 v[48:51], v[212:215], a[168:171], v[48:51]
ds_read_b64_tr_b16 v[226:227], v243 offset:22528
v_mfma_f32_16x16x32_bf16 v[48:51], v[216:219], a[180:183], v[48:51]
ds_read_b64_tr_b16 v[228:229], v243 offset:24576
v_xor_b32 v242, 64, v241
v_mfma_f32_16x16x32_bf16 v[52:55], v[204:207], a[148:151], 0
ds_read_b64_tr_b16 v[230:231], v243 offset:26624
v_mfma_f32_16x16x32_bf16 v[52:55], v[208:211], a[160:163], v[52:55]
ds_read_b64_tr_b16 v[232:233], v243 offset:28672
v_mfma_f32_16x16x32_bf16 v[52:55], v[212:215], a[172:175], v[52:55]
ds_read_b64_tr_b16 v[234:235], v243 offset:30720
v_mfma_f32_16x16x32_bf16 v[52:55], v[216:219], a[184:187], v[52:55]
v_mfma_f32_16x16x32_bf16 v[56:59], v[204:207], a[152:155], 0
v_cvt_pk_bf16_f32 v0, v0, v1
v_cvt_pk_bf16_f32 v1, v2, v3
v_mfma_f32_16x16x32_bf16 v[56:59], v[208:211], a[164:167], v[56:59]
v_cvt_pk_bf16_f32 v2, v12, v13
v_cvt_pk_bf16_f32 v3, v14, v15
v_mfma_f32_16x16x32_bf16 v[56:59], v[212:215], a[176:179], v[56:59]
s_waitcnt lgkmcnt(4)
buffer_store_dwordx4 v[0:3], v244, s[24:27], s4 offen
v_mfma_f32_16x16x32_bf16 v[56:59], v[216:219], a[188:191], v[56:59]
s_add_u32 s4, s87, 16384
ds_read_b64_tr_b16 v[204:205], v242 offset:16384
v_cvt_pk_bf16_f32 v24, v24, v25
v_mfma_f32_16x16x32_bf16 v[60:63], v[220:223], a[144:147], 0
ds_read_b64_tr_b16 v[206:207], v242 offset:18432
v_cvt_pk_bf16_f32 v25, v26, v27
v_mfma_f32_16x16x32_bf16 v[60:63], v[224:227], a[156:159], v[60:63]
s_waitcnt lgkmcnt(2)
ds_read_b64_tr_b16 v[208:209], v242 offset:20480
v_cvt_pk_bf16_f32 v26, v36, v37
v_mfma_f32_16x16x32_bf16 v[60:63], v[228:231], a[168:171], v[60:63]
ds_read_b64_tr_b16 v[210:211], v242 offset:22528
v_cvt_pk_bf16_f32 v27, v38, v39
v_mfma_f32_16x16x32_bf16 v[60:63], v[232:235], a[180:183], v[60:63]
buffer_store_dwordx4 v[24:27], v244, s[24:27], s5 offen
v_mfma_f32_16x16x32_bf16 v[64:67], v[220:223], a[148:151], 0
s_add_u32 s5, s87, 24576
ds_read_b64_tr_b16 v[212:213], v242 offset:24576
v_cvt_pk_bf16_f32 v4, v4, v5
v_mfma_f32_16x16x32_bf16 v[64:67], v[224:227], a[160:163], v[64:67]
ds_read_b64_tr_b16 v[214:215], v242 offset:26624
v_cvt_pk_bf16_f32 v5, v6, v7
v_mfma_f32_16x16x32_bf16 v[64:67], v[228:231], a[172:175], v[64:67]
ds_read_b64_tr_b16 v[216:217], v242 offset:28672
v_cvt_pk_bf16_f32 v6, v16, v17
v_mfma_f32_16x16x32_bf16 v[64:67], v[232:235], a[184:187], v[64:67]
ds_read_b64_tr_b16 v[218:219], v242 offset:30720
v_cvt_pk_bf16_f32 v7, v18, v19
v_mfma_f32_16x16x32_bf16 v[68:71], v[220:223], a[152:155], 0
buffer_store_dwordx4 v[4:7], v244, s[24:27], s4 offen
v_mfma_f32_16x16x32_bf16 v[68:71], v[224:227], a[164:167], v[68:71]
s_add_u32 s4, s87, 32768
v_xor_b32 v243, 96, v241
v_cvt_pk_bf16_f32 v28, v28, v29
v_mfma_f32_16x16x32_bf16 v[68:71], v[228:231], a[176:179], v[68:71]
s_waitcnt lgkmcnt(4)
v_cvt_pk_bf16_f32 v29, v30, v31
v_cvt_pk_bf16_f32 v30, v40, v41
v_mfma_f32_16x16x32_bf16 v[68:71], v[232:235], a[188:191], v[68:71]
ds_read_b64_tr_b16 v[220:221], v243 offset:16384
v_cvt_pk_bf16_f32 v31, v42, v43
v_mfma_f32_16x16x32_bf16 v[72:75], v[204:207], a[144:147], 0
buffer_store_dwordx4 v[28:31], v244, s[24:27], s5 offen
v_mfma_f32_16x16x32_bf16 v[72:75], v[208:211], a[156:159], v[72:75]
s_waitcnt lgkmcnt(1)
ds_read_b64_tr_b16 v[222:223], v243 offset:18432
v_cvt_pk_bf16_f32 v8, v8, v9
v_mfma_f32_16x16x32_bf16 v[72:75], v[212:215], a[168:171], v[72:75]
s_add_u32 s5, s87, 40960
ds_read_b64_tr_b16 v[224:225], v243 offset:20480
v_cvt_pk_bf16_f32 v9, v10, v11
v_mfma_f32_16x16x32_bf16 v[72:75], v[216:219], a[180:183], v[72:75]
ds_read_b64_tr_b16 v[226:227], v243 offset:22528
v_cvt_pk_bf16_f32 v10, v20, v21
v_mfma_f32_16x16x32_bf16 v[76:79], v[204:207], a[148:151], 0
s_add_u32 s56, s41, s96
ds_read_b64_tr_b16 v[228:229], v243 offset:24576
v_cvt_pk_bf16_f32 v11, v22, v23
v_mfma_f32_16x16x32_bf16 v[76:79], v[208:211], a[160:163], v[76:79]
s_add_u32 s57, s56, s50
buffer_store_dwordx4 v[8:11], v244, s[24:27], s4 offen
v_mfma_f32_16x16x32_bf16 v[76:79], v[212:215], a[172:175], v[76:79]
s_add_u32 s58, s56, s51
ds_read_b64_tr_b16 v[230:231], v243 offset:26624
v_cvt_pk_bf16_f32 v32, v32, v33
v_mfma_f32_16x16x32_bf16 v[76:79], v[216:219], a[184:187], v[76:79]
s_add_u32 s59, s56, s52
ds_read_b64_tr_b16 v[232:233], v243 offset:28672
v_cvt_pk_bf16_f32 v33, v34, v35
v_mfma_f32_16x16x32_bf16 v[80:83], v[204:207], a[152:155], 0
ds_read_b64_tr_b16 v[234:235], v243 offset:30720
v_cvt_pk_bf16_f32 v34, v44, v45
v_cvt_pk_bf16_f32 v35, v46, v47
v_mfma_f32_16x16x32_bf16 v[80:83], v[208:211], a[164:167], v[80:83]
buffer_store_dwordx4 v[32:35], v244, s[24:27], s5 offen
v_mfma_f32_16x16x32_bf16 v[80:83], v[212:215], a[176:179], v[80:83]
s_waitcnt lgkmcnt(4)
v_add_u32 v241, 0x18000, v241
v_mfma_f32_16x16x32_bf16 v[80:83], v[216:219], a[188:191], v[80:83]
s_add_u32 m0, s60, 114688
ds_read_b64_tr_b16 v[204:205], v241 offset:0
v_mfma_f32_16x16x32_bf16 v[84:87], v[220:223], a[144:147], 0
ds_read_b64_tr_b16 v[206:207], v241 offset:2048
v_mfma_f32_16x16x32_bf16 v[84:87], v[224:227], a[156:159], v[84:87]
s_waitcnt lgkmcnt(2)
ds_read_b64_tr_b16 v[208:209], v241 offset:4096
v_mfma_f32_16x16x32_bf16 v[84:87], v[228:231], a[168:171], v[84:87]
ds_read_b64_tr_b16 v[210:211], v241 offset:6144
v_mfma_f32_16x16x32_bf16 v[84:87], v[232:235], a[180:183], v[84:87]
ds_read_b64_tr_b16 v[212:213], v241 offset:8192
v_xor_b32 v243, 32, v241
v_mfma_f32_16x16x32_bf16 v[88:91], v[220:223], a[148:151], 0
ds_read_b64_tr_b16 v[214:215], v241 offset:10240
v_mfma_f32_16x16x32_bf16 v[88:91], v[224:227], a[160:163], v[88:91]
ds_read_b64_tr_b16 v[216:217], v241 offset:12288
v_mfma_f32_16x16x32_bf16 v[88:91], v[228:231], a[172:175], v[88:91]
buffer_load_dwordx4 v246, s[16:19], s56 offen offset:0 lds
v_mfma_f32_16x16x32_bf16 v[88:91], v[232:235], a[184:187], v[88:91]
ds_read_b64_tr_b16 v[218:219], v241 offset:14336
v_mfma_f32_16x16x32_bf16 v[92:95], v[220:223], a[152:155], 0
v_mfma_f32_16x16x32_bf16 v[92:95], v[224:227], a[164:167], v[92:95]
v_mfma_f32_16x16x32_bf16 v[92:95], v[228:231], a[176:179], v[92:95]
s_waitcnt lgkmcnt(4)
buffer_load_dwordx4 v246, s[16:19], s57 offen offset:1024 lds
v_mfma_f32_16x16x32_bf16 v[92:95], v[232:235], a[188:191], v[92:95]
ds_read_b64_tr_b16 v[220:221], v243 offset:0
v_mfma_f32_16x16x32_bf16 v[48:51], v[204:207], a[192:195], v[48:51]
ds_read_b64_tr_b16 v[222:223], v243 offset:2048
v_mfma_f32_16x16x32_bf16 v[48:51], v[208:211], a[204:207], v[48:51]
s_waitcnt lgkmcnt(2)
ds_read_b64_tr_b16 v[224:225], v243 offset:4096
v_mfma_f32_16x16x32_bf16 v[48:51], v[212:215], a[216:219], v[48:51]
ds_read_b64_tr_b16 v[226:227], v243 offset:6144
v_mfma_f32_16x16x32_bf16 v[48:51], v[216:219], a[228:231], v[48:51]
ds_read_b64_tr_b16 v[228:229], v243 offset:8192
v_xor_b32 v242, 64, v241
v_mfma_f32_16x16x32_bf16 v[52:55], v[204:207], a[196:199], v[52:55]
ds_read_b64_tr_b16 v[230:231], v243 offset:10240
v_mfma_f32_16x16x32_bf16 v[52:55], v[208:211], a[208:211], v[52:55]
buffer_load_dwordx4 v246, s[16:19], s58 offen offset:2048 lds
v_mfma_f32_16x16x32_bf16 v[52:55], v[212:215], a[220:223], v[52:55]
ds_read_b64_tr_b16 v[232:233], v243 offset:12288
v_mfma_f32_16x16x32_bf16 v[52:55], v[216:219], a[232:235], v[52:55]
ds_read_b64_tr_b16 v[234:235], v243 offset:14336
v_mfma_f32_16x16x32_bf16 v[56:59], v[204:207], a[200:203], v[56:59]
v_mfma_f32_16x16x32_bf16 v[56:59], v[208:211], a[212:215], v[56:59]
buffer_load_dwordx4 v246, s[16:19], s59 offen offset:3072 lds
v_mfma_f32_16x16x32_bf16 v[56:59], v[212:215], a[224:227], v[56:59]
s_waitcnt lgkmcnt(4)
v_mfma_f32_16x16x32_bf16 v[56:59], v[216:219], a[236:239], v[56:59]
s_add_u32 m0, s60, 65536
ds_read_b64_tr_b16 v[204:205], v242 offset:0
v_mfma_f32_16x16x32_bf16 v[60:63], v[220:223], a[192:195], v[60:63]
s_add_u32 s56, s41, s97
ds_read_b64_tr_b16 v[206:207], v242 offset:2048
v_mfma_f32_16x16x32_bf16 v[60:63], v[224:227], a[204:207], v[60:63]
s_waitcnt lgkmcnt(2)
ds_read_b64_tr_b16 v[208:209], v242 offset:4096
v_mfma_f32_16x16x32_bf16 v[60:63], v[228:231], a[216:219], v[60:63]
s_add_u32 s57, s56, s50
ds_read_b64_tr_b16 v[210:211], v242 offset:6144
v_mfma_f32_16x16x32_bf16 v[60:63], v[232:235], a[228:231], v[60:63]
s_add_u32 s58, s56, s51
ds_read_b64_tr_b16 v[212:213], v242 offset:8192
v_xor_b32 v243, 96, v241
v_mfma_f32_16x16x32_bf16 v[64:67], v[220:223], a[196:199], v[64:67]
s_add_u32 s59, s56, s52
buffer_load_dwordx4 v246, s[16:19], s56 offen offset:0 lds
v_mfma_f32_16x16x32_bf16 v[64:67], v[224:227], a[208:211], v[64:67]
ds_read_b64_tr_b16 v[214:215], v242 offset:10240
v_mfma_f32_16x16x32_bf16 v[64:67], v[228:231], a[220:223], v[64:67]
ds_read_b64_tr_b16 v[216:217], v242 offset:12288
v_mfma_f32_16x16x32_bf16 v[64:67], v[232:235], a[232:235], v[64:67]
ds_read_b64_tr_b16 v[218:219], v242 offset:14336
v_mfma_f32_16x16x32_bf16 v[68:71], v[220:223], a[200:203], v[68:71]
buffer_load_dwordx4 v246, s[16:19], s57 offen offset:1024 lds
v_mfma_f32_16x16x32_bf16 v[68:71], v[224:227], a[212:215], v[68:71]
v_mfma_f32_16x16x32_bf16 v[68:71], v[228:231], a[224:227], v[68:71]
s_waitcnt lgkmcnt(4)
v_mfma_f32_16x16x32_bf16 v[68:71], v[232:235], a[236:239], v[68:71]
ds_read_b64_tr_b16 v[220:221], v243 offset:0
v_mfma_f32_16x16x32_bf16 v[72:75], v[204:207], a[192:195], v[72:75]
ds_read_b64_tr_b16 v[222:223], v243 offset:2048
v_mfma_f32_16x16x32_bf16 v[72:75], v[208:211], a[204:207], v[72:75]
s_waitcnt lgkmcnt(2)
ds_read_b64_tr_b16 v[224:225], v243 offset:4096
v_mfma_f32_16x16x32_bf16 v[72:75], v[212:215], a[216:219], v[72:75]
ds_read_b64_tr_b16 v[226:227], v243 offset:6144
v_mfma_f32_16x16x32_bf16 v[72:75], v[216:219], a[228:231], v[72:75]
buffer_load_dwordx4 v246, s[16:19], s58 offen offset:2048 lds
v_mfma_f32_16x16x32_bf16 v[76:79], v[204:207], a[196:199], v[76:79]
ds_read_b64_tr_b16 v[228:229], v243 offset:8192
v_mfma_f32_16x16x32_bf16 v[76:79], v[208:211], a[208:211], v[76:79]
ds_read_b64_tr_b16 v[230:231], v243 offset:10240
v_mfma_f32_16x16x32_bf16 v[76:79], v[212:215], a[220:223], v[76:79]
ds_read_b64_tr_b16 v[232:233], v243 offset:12288
v_mfma_f32_16x16x32_bf16 v[76:79], v[216:219], a[232:235], v[76:79]
ds_read_b64_tr_b16 v[234:235], v243 offset:14336
v_mfma_f32_16x16x32_bf16 v[80:83], v[204:207], a[200:203], v[80:83]
buffer_load_dwordx4 v246, s[16:19], s59 offen offset:3072 lds
v_mfma_f32_16x16x32_bf16 v[80:83], v[208:211], a[212:215], v[80:83]
s_add_u32 m0, s60, 16384
v_mfma_f32_16x16x32_bf16 v[80:83], v[212:215], a[224:227], v[80:83]
s_waitcnt lgkmcnt(4)
v_mfma_f32_16x16x32_bf16 v[80:83], v[216:219], a[236:239], v[80:83]
s_add_u32 s56, s42, s93
v_mfma_f32_16x16x32_bf16 v[84:87], v[220:223], a[192:195], v[84:87]
s_waitcnt vmcnt(8) lgkmcnt(0)
v_mfma_f32_16x16x32_bf16 v[84:87], v[224:227], a[204:207], v[84:87]
s_barrier
ds_read_b64_tr_b16 v[204:205], v241 offset:49152
v_mfma_f32_16x16x32_bf16 v[84:87], v[228:231], a[216:219], v[84:87]
s_add_u32 s57, s56, s50
buffer_store_dword v244, v245, s[24:27], s88 offen
v_mfma_f32_16x16x32_bf16 v[84:87], v[232:235], a[228:231], v[84:87]
s_add_u32 s58, s56, s51
ds_read_b64_tr_b16 v[206:207], v241 offset:51200
v_xor_b32 v243, 32, v241
v_mfma_f32_16x16x32_bf16 v[88:91], v[220:223], a[196:199], v[88:91]
s_add_u32 s59, s56, s52
ds_read_b64_tr_b16 v[208:209], v241 offset:53248
v_mfma_f32_16x16x32_bf16 v[88:91], v[224:227], a[208:211], v[88:91]
ds_read_b64_tr_b16 v[210:211], v241 offset:55296
v_mfma_f32_16x16x32_bf16 v[88:91], v[228:231], a[220:223], v[88:91]
buffer_load_dwordx4 v246, s[16:19], s56 offen offset:0 lds
v_mfma_f32_16x16x32_bf16 v[88:91], v[232:235], a[232:235], v[88:91]
ds_read_b64_tr_b16 v[212:213], v241 offset:57344
v_mfma_f32_16x16x32_bf16 v[92:95], v[220:223], a[200:203], v[92:95]
ds_read_b64_tr_b16 v[214:215], v241 offset:59392
v_mfma_f32_16x16x32_bf16 v[92:95], v[224:227], a[212:215], v[92:95]
ds_read_b64_tr_b16 v[216:217], v241 offset:61440
v_mfma_f32_16x16x32_bf16 v[92:95], v[228:231], a[224:227], v[92:95]
s_waitcnt lgkmcnt(3)
ds_read_b64_tr_b16 v[218:219], v241 offset:63488
v_mfma_f32_16x16x32_bf16 v[92:95], v[232:235], a[236:239], v[92:95]
buffer_load_dwordx4 v246, s[16:19], s57 offen offset:1024 lds
v_mfma_f32_16x16x32_bf16 v[48:51], v[204:207], a[0:3], v[48:51]
ds_read_b64_tr_b16 v[220:221], v243 offset:49152
v_mfma_f32_16x16x32_bf16 v[48:51], v[208:211], a[12:15], v[48:51]
s_waitcnt lgkmcnt(1)
ds_read_b64_tr_b16 v[222:223], v243 offset:51200
v_mfma_f32_16x16x32_bf16 v[48:51], v[212:215], a[24:27], v[48:51]
ds_read_b64_tr_b16 v[224:225], v243 offset:53248
v_mfma_f32_16x16x32_bf16 v[48:51], v[216:219], a[36:39], v[48:51]
ds_read_b64_tr_b16 v[226:227], v243 offset:55296
v_xor_b32 v242, 64, v241
v_mfma_f32_16x16x32_bf16 v[52:55], v[204:207], a[4:7], v[52:55]
buffer_load_dwordx4 v246, s[16:19], s58 offen offset:2048 lds
v_mfma_f32_16x16x32_bf16 v[52:55], v[208:211], a[16:19], v[52:55]
ds_read_b64_tr_b16 v[228:229], v243 offset:57344
v_mfma_f32_16x16x32_bf16 v[52:55], v[212:215], a[28:31], v[52:55]
ds_read_b64_tr_b16 v[230:231], v243 offset:59392
v_mfma_f32_16x16x32_bf16 v[52:55], v[216:219], a[40:43], v[52:55]
ds_read_b64_tr_b16 v[232:233], v243 offset:61440
v_mfma_f32_16x16x32_bf16 v[56:59], v[204:207], a[8:11], v[56:59]
ds_read_b64_tr_b16 v[234:235], v243 offset:63488
v_mfma_f32_16x16x32_bf16 v[56:59], v[208:211], a[20:23], v[56:59]
buffer_load_dwordx4 v246, s[16:19], s59 offen offset:3072 lds
v_mfma_f32_16x16x32_bf16 v[56:59], v[212:215], a[32:35], v[56:59]
s_waitcnt lgkmcnt(4)
v_mfma_f32_16x16x32_bf16 v[56:59], v[216:219], a[44:47], v[56:59]
s_add_u32 m0, s60, 98304
ds_read_b64_tr_b16 v[204:205], v242 offset:49152
v_mfma_f32_16x16x32_bf16 v[60:63], v[220:223], a[0:3], v[60:63]
s_add_u32 s56, s42, s95
ds_read_b64_tr_b16 v[206:207], v242 offset:51200
v_mfma_f32_16x16x32_bf16 v[60:63], v[224:227], a[12:15], v[60:63]
s_waitcnt lgkmcnt(2)
ds_read_b64_tr_b16 v[208:209], v242 offset:53248
v_mfma_f32_16x16x32_bf16 v[60:63], v[228:231], a[24:27], v[60:63]
s_load_dwordx8 s[8:15], s[82:83], s88
ds_read_b64_tr_b16 v[210:211], v242 offset:55296
v_mfma_f32_16x16x32_bf16 v[60:63], v[232:235], a[36:39], v[60:63]
s_add_u32 s57, s56, s50
buffer_load_dwordx4 v246, s[16:19], s56 offen offset:0 lds
v_mfma_f32_16x16x32_bf16 v[64:67], v[220:223], a[4:7], v[64:67]
s_add_u32 s58, s56, s51
ds_read_b64_tr_b16 v[212:213], v242 offset:57344
v_xor_b32 v243, 96, v241
v_mfma_f32_16x16x32_bf16 v[64:67], v[224:227], a[16:19], v[64:67]
s_add_u32 s59, s56, s52
ds_read_b64_tr_b16 v[214:215], v242 offset:59392
v_mfma_f32_16x16x32_bf16 v[64:67], v[228:231], a[28:31], v[64:67]
ds_read_b64_tr_b16 v[216:217], v242 offset:61440
v_mfma_f32_16x16x32_bf16 v[64:67], v[232:235], a[40:43], v[64:67]
ds_read_b64_tr_b16 v[218:219], v242 offset:63488
v_mfma_f32_16x16x32_bf16 v[68:71], v[220:223], a[8:11], v[68:71]
buffer_load_dwordx4 v246, s[16:19], s57 offen offset:1024 lds
v_mfma_f32_16x16x32_bf16 v[68:71], v[224:227], a[20:23], v[68:71]
v_add_u32 v241, 0xfffe8000, v241
v_mfma_f32_16x16x32_bf16 v[68:71], v[228:231], a[32:35], v[68:71]
s_waitcnt lgkmcnt(4)
v_mfma_f32_16x16x32_bf16 v[68:71], v[232:235], a[44:47], v[68:71]
ds_read_b64_tr_b16 v[220:221], v243 offset:49152
v_mfma_f32_16x16x32_bf16 v[72:75], v[204:207], a[0:3], v[72:75]
ds_read_b64_tr_b16 v[222:223], v243 offset:51200
v_mfma_f32_16x16x32_bf16 v[72:75], v[208:211], a[12:15], v[72:75]
s_waitcnt lgkmcnt(2)
buffer_load_dwordx4 v246, s[16:19], s58 offen offset:2048 lds
v_mfma_f32_16x16x32_bf16 v[72:75], v[212:215], a[24:27], v[72:75]
ds_read_b64_tr_b16 v[224:225], v243 offset:53248
v_mfma_f32_16x16x32_bf16 v[72:75], v[216:219], a[36:39], v[72:75]
ds_read_b64_tr_b16 v[226:227], v243 offset:55296
v_mfma_f32_16x16x32_bf16 v[76:79], v[204:207], a[4:7], v[76:79]
ds_read_b64_tr_b16 v[228:229], v243 offset:57344
v_mfma_f32_16x16x32_bf16 v[76:79], v[208:211], a[16:19], v[76:79]
ds_read_b64_tr_b16 v[230:231], v243 offset:59392
v_mfma_f32_16x16x32_bf16 v[76:79], v[212:215], a[28:31], v[76:79]
buffer_load_dwordx4 v246, s[16:19], s59 offen offset:3072 lds
v_mfma_f32_16x16x32_bf16 v[76:79], v[216:219], a[40:43], v[76:79]
ds_read_b64_tr_b16 v[232:233], v243 offset:61440
v_mfma_f32_16x16x32_bf16 v[80:83], v[204:207], a[8:11], v[80:83]
ds_read_b64_tr_b16 v[234:235], v243 offset:63488
v_mfma_f32_16x16x32_bf16 v[80:83], v[208:211], a[20:23], v[80:83]
v_mfma_f32_16x16x32_bf16 v[80:83], v[212:215], a[32:35], v[80:83]
s_waitcnt lgkmcnt(4)
v_mfma_f32_16x16x32_bf16 v[80:83], v[216:219], a[44:47], v[80:83]
ds_read_b64_tr_b16 v[204:205], v241 offset:32768
v_mfma_f32_16x16x32_bf16 v[84:87], v[220:223], a[0:3], v[84:87]
s_waitcnt lgkmcnt(0)
ds_read_b64_tr_b16 v[206:207], v241 offset:34816
v_mfma_f32_16x16x32_bf16 v[84:87], v[224:227], a[12:15], v[84:87]
s_waitcnt lgkmcnt(2)
ds_read_b64_tr_b16 v[208:209], v241 offset:36864
v_mfma_f32_16x16x32_bf16 v[84:87], v[228:231], a[24:27], v[84:87]
s_and_b32 s8, s8, s9
ds_read_b64_tr_b16 v[210:211], v241 offset:38912
v_mfma_f32_16x16x32_bf16 v[84:87], v[232:235], a[36:39], v[84:87]
s_and_b32 s10, s10, s11
ds_read_b64_tr_b16 v[212:213], v241 offset:40960
v_xor_b32 v243, 32, v241
v_mfma_f32_16x16x32_bf16 v[88:91], v[220:223], a[4:7], v[88:91]
s_and_b32 s12, s12, s13
ds_read_b64_tr_b16 v[214:215], v241 offset:43008
v_mfma_f32_16x16x32_bf16 v[88:91], v[224:227], a[16:19], v[88:91]
s_and_b32 s14, s14, s15
ds_read_b64_tr_b16 v[216:217], v241 offset:45056
v_mfma_f32_16x16x32_bf16 v[88:91], v[228:231], a[28:31], v[88:91]
s_and_b32 s8, s8, s10
ds_read_b64_tr_b16 v[218:219], v241 offset:47104
v_mfma_f32_16x16x32_bf16 v[88:91], v[232:235], a[40:43], v[88:91]
s_and_b32 s12, s12, s14
v_mfma_f32_16x16x32_bf16 v[92:95], v[220:223], a[8:11], v[92:95]
s_and_b32 s8, s8, s12
v_mfma_f32_16x16x32_bf16 v[92:95], v[224:227], a[20:23], v[92:95]
s_bitcmp0_b32 s8, 4
v_mfma_f32_16x16x32_bf16 v[92:95], v[228:231], a[32:35], v[92:95]
s_waitcnt lgkmcnt(4)
v_mfma_f32_16x16x32_bf16 v[92:95], v[232:235], a[44:47], v[92:95]
s_cbranch_scc1 L_spinG1F
L_backG1F:
ds_read_b64_tr_b16 v[220:221], v243 offset:32768
v_mfma_f32_16x16x32_bf16 v[48:51], v[204:207], v[144:147], v[48:51]
ds_read_b64_tr_b16 v[222:223], v243 offset:34816
v_mfma_f32_16x16x32_bf16 v[48:51], v[208:211], v[156:159], v[48:51]
s_waitcnt lgkmcnt(2)
buffer_load_dwordx4 v[128:131], v244, s[24:27], s90 offen offset:0 sc1
v_mfma_f32_16x16x32_bf16 v[48:51], v[212:215], v[168:171], v[48:51]
ds_read_b64_tr_b16 v[224:225], v243 offset:36864
v_mfma_f32_16x16x32_bf16 v[48:51], v[216:219], v[180:183], v[48:51]
ds_read_b64_tr_b16 v[226:227], v243 offset:38912
v_xor_b32 v242, 64, v241
v_mfma_f32_16x16x32_bf16 v[52:55], v[204:207], v[148:151], v[52:55]
ds_read_b64_tr_b16 v[228:229], v243 offset:40960
v_mfma_f32_16x16x32_bf16 v[52:55], v[208:211], v[160:163], v[52:55]
buffer_load_dwordx4 v[132:135], v244, s[24:27], s90 offen offset:1024 sc1
v_mfma_f32_16x16x32_bf16 v[52:55], v[212:215], v[172:175], v[52:55]
ds_read_b64_tr_b16 v[230:231], v243 offset:43008
v_mfma_f32_16x16x32_bf16 v[52:55], v[216:219], v[184:187], v[52:55]
ds_read_b64_tr_b16 v[232:233], v243 offset:45056
v_mfma_f32_16x16x32_bf16 v[56:59], v[204:207], v[152:155], v[56:59]
ds_read_b64_tr_b16 v[234:235], v243 offset:47104
v_mfma_f32_16x16x32_bf16 v[56:59], v[208:211], v[164:167], v[56:59]
buffer_load_dwordx4 v[136:139], v244, s[24:27], s90 offen offset:2048 sc1
v_mfma_f32_16x16x32_bf16 v[56:59], v[212:215], v[176:179], v[56:59]
s_waitcnt lgkmcnt(4)
v_mfma_f32_16x16x32_bf16 v[56:59], v[216:219], v[188:191], v[56:59]
ds_read_b64_tr_b16 v[204:205], v242 offset:32768
v_mfma_f32_16x16x32_bf16 v[60:63], v[220:223], v[144:147], v[60:63]
ds_read_b64_tr_b16 v[206:207], v242 offset:34816
v_mfma_f32_16x16x32_bf16 v[60:63], v[224:227], v[156:159], v[60:63]
s_waitcnt lgkmcnt(2)
buffer_load_dwordx4 v[140:143], v244, s[24:27], s90 offen offset:3072 sc1
v_mfma_f32_16x16x32_bf16 v[60:63], v[228:231], v[168:171], v[60:63]
ds_read_b64_tr_b16 v[208:209], v242 offset:36864
v_mfma_f32_16x16x32_bf16 v[60:63], v[232:235], v[180:183], v[60:63]
ds_read_b64_tr_b16 v[210:211], v242 offset:38912
v_xor_b32 v243, 96, v241
v_mfma_f32_16x16x32_bf16 v[64:67], v[220:223], v[148:151], v[64:67]
ds_read_b64_tr_b16 v[212:213], v242 offset:40960
v_mfma_f32_16x16x32_bf16 v[64:67], v[224:227], v[160:163], v[64:67]
buffer_load_dwordx4 v[192:195], v244, s[24:27], s91 offen offset:0 sc1
v_mfma_f32_16x16x32_bf16 v[64:67], v[228:231], v[172:175], v[64:67]
ds_read_b64_tr_b16 v[214:215], v242 offset:43008
v_mfma_f32_16x16x32_bf16 v[64:67], v[232:235], v[184:187], v[64:67]
ds_read_b64_tr_b16 v[216:217], v242 offset:45056
v_mfma_f32_16x16x32_bf16 v[68:71], v[220:223], v[152:155], v[68:71]
ds_read_b64_tr_b16 v[218:219], v242 offset:47104
v_mfma_f32_16x16x32_bf16 v[68:71], v[224:227], v[164:167], v[68:71]
buffer_load_dwordx4 v[196:199], v244, s[24:27], s91 offen offset:1024 sc1
v_mfma_f32_16x16x32_bf16 v[68:71], v[228:231], v[176:179], v[68:71]
s_waitcnt lgkmcnt(4)
v_mfma_f32_16x16x32_bf16 v[68:71], v[232:235], v[188:191], v[68:71]
ds_read_b64_tr_b16 v[220:221], v243 offset:32768
v_mfma_f32_16x16x32_bf16 v[72:75], v[204:207], v[144:147], v[72:75]
ds_read_b64_tr_b16 v[222:223], v243 offset:34816
v_mfma_f32_16x16x32_bf16 v[72:75], v[208:211], v[156:159], v[72:75]
s_waitcnt lgkmcnt(2)
buffer_load_dwordx4 v[200:203], v244, s[24:27], s91 offen offset:2048 sc1
v_mfma_f32_16x16x32_bf16 v[72:75], v[212:215], v[168:171], v[72:75]
ds_read_b64_tr_b16 v[224:225], v243 offset:36864
v_mfma_f32_16x16x32_bf16 v[72:75], v[216:219], v[180:183], v[72:75]
ds_read_b64_tr_b16 v[226:227], v243 offset:38912
v_mfma_f32_16x16x32_bf16 v[76:79], v[204:207], v[148:151], v[76:79]
ds_read_b64_tr_b16 v[228:229], v243 offset:40960
v_mfma_f32_16x16x32_bf16 v[76:79], v[208:211], v[160:163], v[76:79]
buffer_load_dwordx4 v[236:239], v244, s[24:27], s91 offen offset:3072 sc1
v_mfma_f32_16x16x32_bf16 v[76:79], v[212:215], v[172:175], v[76:79]
s_mov_b32 s86, 2
ds_read_b64_tr_b16 v[230:231], v243 offset:43008
v_mfma_f32_16x16x32_bf16 v[76:79], v[216:219], v[184:187], v[76:79]
s_sub_u32 s100, s86, 1
ds_read_b64_tr_b16 v[232:233], v243 offset:45056
v_mfma_f32_16x16x32_bf16 v[80:83], v[204:207], v[152:155], v[80:83]
s_and_b32 s100, s100, s72
ds_read_b64_tr_b16 v[234:235], v243 offset:47104
v_mfma_f32_16x16x32_bf16 v[80:83], v[208:211], v[164:167], v[80:83]
s_mul_i32 s100, s100, 196608
v_mfma_f32_16x16x32_bf16 v[80:83], v[212:215], v[176:179], v[80:83]
s_waitcnt lgkmcnt(4)
v_mfma_f32_16x16x32_bf16 v[80:83], v[216:219], v[188:191], v[80:83]
s_add_u32 s87, s68, s100
v_mfma_f32_16x16x32_bf16 v[84:87], v[220:223], v[144:147], v[84:87]
s_waitcnt vmcnt(31) lgkmcnt(0)
v_mfma_f32_16x16x32_bf16 v[84:87], v[224:227], v[156:159], v[84:87]
s_barrier
ds_read_b64_tr_b16 v[204:205], v241 offset:49152
v_mfma_f32_16x16x32_bf16 v[84:87], v[228:231], v[168:171], v[84:87]
s_add_u32 s90, s69, s100
ds_read_b64_tr_b16 v[206:207], v241 offset:51200
v_mfma_f32_16x16x32_bf16 v[84:87], v[232:235], v[180:183], v[84:87]
s_add_u32 s91, s90, 0x1000
ds_read_b64_tr_b16 v[208:209], v241 offset:53248
v_mfma_f32_16x16x32_bf16 v[88:91], v[220:223], v[148:151], v[88:91]
s_add_u32 s88, s88, 256
ds_read_b64_tr_b16 v[210:211], v241 offset:55296
v_mfma_f32_16x16x32_bf16 v[88:91], v[224:227], v[160:163], v[88:91]
ds_read_b64_tr_b16 v[212:213], v241 offset:57344
v_mfma_f32_16x16x32_bf16 v[88:91], v[228:231], v[172:175], v[88:91]
ds_read_b64_tr_b16 v[214:215], v241 offset:59392
v_mfma_f32_16x16x32_bf16 v[88:91], v[232:235], v[184:187], v[88:91]
ds_read_b64_tr_b16 v[216:217], v241 offset:61440
v_mfma_f32_16x16x32_bf16 v[92:95], v[220:223], v[152:155], v[92:95]
ds_read_b64_tr_b16 v[218:219], v241 offset:63488
v_mfma_f32_16x16x32_bf16 v[92:95], v[224:227], v[164:167], v[92:95]
v_mfma_f32_16x16x32_bf16 v[92:95], v[228:231], v[176:179], v[92:95]
v_mfma_f32_16x16x32_bf16 v[92:95], v[232:235], v[188:191], v[92:95]
s_mov_b32 s40, s42
s_add_u32 s41, s40, 128
s_and_b32 s41, s41, 0x3ff
s_add_u32 s42, s41, 128
s_and_b32 s42, s42, 0x3ff
s_cmp_lt_u32 s86, 8
L_G:
s_waitcnt lgkmcnt(4)
v_mfma_f32_16x16x32_bf16 v[0:3], v[204:207], a[144:147], 0
s_add_u32 s4, s87, 0
v_xor_b32 v243, 32, v241
v_mfma_f32_16x16x32_bf16 v[0:3], v[208:211], a[156:159], v[0:3]
s_waitcnt lgkmcnt(0)
ds_read_b64_tr_b16 v[220:221], v243 offset:49152
v_mfma_f32_16x16x32_bf16 v[0:3], v[212:215], a[168:171], v[0:3]
s_add_u32 s5, s87, 8192
ds_read_b64_tr_b16 v[222:223], v243 offset:51200
v_mfma_f32_16x16x32_bf16 v[0:3], v[216:219], a[180:183], v[0:3]
ds_read_b64_tr_b16 v[224:225], v243 offset:53248
v_xor_b32 v242, 64, v241
v_mfma_f32_16x16x32_bf16 v[4:7], v[204:207], a[148:151], 0
ds_read_b64_tr_b16 v[226:227], v243 offset:55296
v_mfma_f32_16x16x32_bf16 v[4:7], v[208:211], a[160:163], v[4:7]
ds_read_b64_tr_b16 v[228:229], v243 offset:57344
v_mfma_f32_16x16x32_bf16 v[4:7], v[212:215], a[172:175], v[4:7]
ds_read_b64_tr_b16 v[230:231], v243 offset:59392
v_mfma_f32_16x16x32_bf16 v[4:7], v[216:219], a[184:187], v[4:7]
ds_read_b64_tr_b16 v[232:233], v243 offset:61440
v_mfma_f32_16x16x32_bf16 v[8:11], v[204:207], a[152:155], 0
s_waitcnt vmcnt(0)
ds_read_b64_tr_b16 v[234:235], v243 offset:63488
v_cvt_pk_bf16_f32 v48, v48, v49
v_mfma_f32_16x16x32_bf16 v[8:11], v[208:211], a[164:167], v[8:11]
v_cvt_pk_bf16_f32 v49, v50, v51
v_cvt_pk_bf16_f32 v50, v60, v61
v_mfma_f32_16x16x32_bf16 v[8:11], v[212:215], a[176:179], v[8:11]
s_waitcnt lgkmcnt(4)
v_cvt_pk_bf16_f32 v51, v62, v63
v_cvt_pk_bf16_f32 v72, v72, v73
v_mfma_f32_16x16x32_bf16 v[8:11], v[216:219], a[188:191], v[8:11]
ds_read_b64_tr_b16 v[204:205], v242 offset:49152
v_cvt_pk_bf16_f32 v73, v74, v75
v_mfma_f32_16x16x32_bf16 v[12:15], v[220:223], a[144:147], 0
buffer_store_dwordx4 v[48:51], v244, s[24:27], s4 offen
v_mfma_f32_16x16x32_bf16 v[12:15], v[224:227], a[156:159], v[12:15]
s_waitcnt lgkmcnt(1)
ds_read_b64_tr_b16 v[206:207], v242 offset:51200
v_cvt_pk_bf16_f32 v74, v84, v85
v_mfma_f32_16x16x32_bf16 v[12:15], v[228:231], a[168:171], v[12:15]
s_add_u32 s4, s87, 16384
ds_read_b64_tr_b16 v[208:209], v242 offset:53248
v_cvt_pk_bf16_f32 v75, v86, v87
v_mfma_f32_16x16x32_bf16 v[12:15], v[232:235], a[180:183], v[12:15]
ds_read_b64_tr_b16 v[210:211], v242 offset:55296
v_cvt_pk_bf16_f32 v52, v52, v53
v_mfma_f32_16x16x32_bf16 v[16:19], v[220:223], a[148:151], 0
buffer_store_dwordx4 v[72:75], v244, s[24:27], s5 offen
v_mfma_f32_16x16x32_bf16 v[16:19], v[224:227], a[160:163], v[16:19]
s_add_u32 s5, s87, 24576
ds_read_b64_tr_b16 v[212:213], v242 offset:57344
v_cvt_pk_bf16_f32 v53, v54, v55
v_mfma_f32_16x16x32_bf16 v[16:19], v[228:231], a[172:175], v[16:19]
ds_read_b64_tr_b16 v[214:215], v242 offset:59392
v_cvt_pk_bf16_f32 v54, v64, v65
v_mfma_f32_16x16x32_bf16 v[16:19], v[232:235], a[184:187], v[16:19]
ds_read_b64_tr_b16 v[216:217], v242 offset:61440
v_cvt_pk_bf16_f32 v55, v66, v67
v_mfma_f32_16x16x32_bf16 v[20:23], v[220:223], a[152:155], 0
ds_read_b64_tr_b16 v[218:219], v242 offset:63488
v_xor_b32 v243, 96, v241
v_mfma_f32_16x16x32_bf16 v[20:23], v[224:227], a[164:167], v[20:23]
buffer_store_dwordx4 v[52:55], v244, s[24:27], s4 offen
v_mfma_f32_16x16x32_bf16 v[20:23], v[228:231], a[176:179], v[20:23]
s_waitcnt lgkmcnt(4)
v_cvt_pk_bf16_f32 v76, v76, v77
v_cvt_pk_bf16_f32 v77, v78, v79
v_mfma_f32_16x16x32_bf16 v[20:23], v[232:235], a[188:191], v[20:23]
s_add_u32 s4, s87, 32768
v_cvt_pk_bf16_f32 v78, v88, v89
v_cvt_pk_bf16_f32 v79, v90, v91
v_mfma_f32_16x16x32_bf16 v[24:27], v[204:207], a[144:147], 0
ds_read_b64_tr_b16 v[220:221], v243 offset:49152
v_cvt_pk_bf16_f32 v56, v56, v57
v_mfma_f32_16x16x32_bf16 v[24:27], v[208:211], a[156:159], v[24:27]
s_waitcnt lgkmcnt(1)
buffer_store_dwordx4 v[76:79], v244, s[24:27], s5 offen
ds_read_b64_tr_b16 v[222:223], v243 offset:51200
v_mfma_f32_16x16x32_bf16 v[24:27], v[212:215], a[168:171], v[24:27]
s_add_u32 s5, s87, 40960
ds_read_b64_tr_b16 v[224:225], v243 offset:53248
v_cvt_pk_bf16_f32 v57, v58, v59
v_mfma_f32_16x16x32_bf16 v[24:27], v[216:219], a[180:183], v[24:27]
s_add_u32 s92, s71, s39
ds_read_b64_tr_b16 v[226:227], v243 offset:55296
v_cvt_pk_bf16_f32 v58, v68, v69
v_mfma_f32_16x16x32_bf16 v[28:31], v[204:207], a[148:151], 0
s_add_u32 s56, s40, s96
ds_read_b64_tr_b16 v[228:229], v243 offset:57344
v_cvt_pk_bf16_f32 v59, v70, v71
v_mfma_f32_16x16x32_bf16 v[28:31], v[208:211], a[160:163], v[28:31]
s_add_u32 s57, s56, s50
buffer_store_dwordx4 v[56:59], v244, s[24:27], s4 offen
v_mfma_f32_16x16x32_bf16 v[28:31], v[212:215], a[172:175], v[28:31]
s_add_u32 s58, s56, s51
ds_read_b64_tr_b16 v[230:231], v243 offset:59392
v_cvt_pk_bf16_f32 v80, v80, v81
v_mfma_f32_16x16x32_bf16 v[28:31], v[216:219], a[184:187], v[28:31]
s_add_u32 s59, s56, s52
ds_read_b64_tr_b16 v[232:233], v243 offset:61440
v_cvt_pk_bf16_f32 v81, v82, v83
v_mfma_f32_16x16x32_bf16 v[32:35], v[204:207], a[152:155], 0
s_add_u32 s39, s39, 128
ds_read_b64_tr_b16 v[234:235], v243 offset:63488
v_cvt_pk_bf16_f32 v82, v92, v93
v_cvt_pk_bf16_f32 v83, v94, v95
v_mfma_f32_16x16x32_bf16 v[32:35], v[208:211], a[164:167], v[32:35]
s_and_b32 s39, s39, 0x3ff
buffer_store_dwordx4 v[80:83], v244, s[24:27], s5 offen
v_mfma_f32_16x16x32_bf16 v[32:35], v[212:215], a[176:179], v[32:35]
s_waitcnt lgkmcnt(4)
v_add_u32 v241, 0x10000, v241
v_lshlrev_b32 v249, 16, v128
v_mfma_f32_16x16x32_bf16 v[32:35], v[216:219], a[188:191], v[32:35]
s_add_u32 m0, s60, 147456
ds_read_b64_tr_b16 v[204:205], v241 offset:16384
v_and_b32 v128, s6, v128
v_mfma_f32_16x16x32_bf16 v[36:39], v[220:223], a[144:147], 0
s_add_u32 s86, s86, 1
ds_read_b64_tr_b16 v[206:207], v241 offset:18432
v_lshlrev_b32 v254, 16, v132
v_mfma_f32_16x16x32_bf16 v[36:39], v[224:227], a[156:159], v[36:39]
s_waitcnt lgkmcnt(2)
ds_read_b64_tr_b16 v[208:209], v241 offset:20480
v_and_b32 v132, s6, v132
v_mfma_f32_16x16x32_bf16 v[36:39], v[228:231], a[168:171], v[36:39]
ds_read_b64_tr_b16 v[210:211], v241 offset:22528
v_add_f32 v249, v249, v254
v_mfma_f32_16x16x32_bf16 v[36:39], v[232:235], a[180:183], v[36:39]
ds_read_b64_tr_b16 v[212:213], v241 offset:24576
v_xor_b32 v243, 32, v241
v_mfma_f32_16x16x32_bf16 v[40:43], v[220:223], a[148:151], 0
ds_read_b64_tr_b16 v[214:215], v241 offset:26624
v_add_f32 v128, v128, v132
v_mfma_f32_16x16x32_bf16 v[40:43], v[224:227], a[160:163], v[40:43]
ds_read_b64_tr_b16 v[216:217], v241 offset:28672
v_lshlrev_b32 v255, 16, v136
v_mfma_f32_16x16x32_bf16 v[40:43], v[228:231], a[172:175], v[40:43]
ds_read_b64_tr_b16 v[218:219], v241 offset:30720
v_and_b32 v136, s6, v136
v_mfma_f32_16x16x32_bf16 v[40:43], v[232:235], a[184:187], v[40:43]
buffer_load_dwordx4 v246, s[16:19], s56 offen offset:0 lds
v_mfma_f32_16x16x32_bf16 v[44:47], v[220:223], a[152:155], 0
v_add_f32 v249, v249, v255
v_add_f32 v128, v128, v136
v_mfma_f32_16x16x32_bf16 v[44:47], v[224:227], a[164:167], v[44:47]
v_lshlrev_b32 v254, 16, v140
v_and_b32 v140, s6, v140
v_mfma_f32_16x16x32_bf16 v[44:47], v[228:231], a[176:179], v[44:47]
s_waitcnt lgkmcnt(4)
v_add_f32 v249, v249, v254
v_add_f32 v128, v128, v140
v_mfma_f32_16x16x32_bf16 v[44:47], v[232:235], a[188:191], v[44:47]
ds_read_b64_tr_b16 v[220:221], v243 offset:16384
v_lshlrev_b32 v255, 16, v192
v_mfma_f32_16x16x32_bf16 v[0:3], v[204:207], a[192:195], v[0:3]
ds_read_b64_tr_b16 v[222:223], v243 offset:18432
v_and_b32 v192, s6, v192
v_mfma_f32_16x16x32_bf16 v[0:3], v[208:211], a[204:207], v[0:3]
s_waitcnt lgkmcnt(2)
buffer_load_dwordx4 v246, s[16:19], s57 offen offset:1024 lds
v_mfma_f32_16x16x32_bf16 v[0:3], v[212:215], a[216:219], v[0:3]
ds_read_b64_tr_b16 v[224:225], v243 offset:20480
v_add_f32 v249, v249, v255
v_mfma_f32_16x16x32_bf16 v[0:3], v[216:219], a[228:231], v[0:3]
ds_read_b64_tr_b16 v[226:227], v243 offset:22528
v_xor_b32 v242, 64, v241
v_mfma_f32_16x16x32_bf16 v[4:7], v[204:207], a[196:199], v[4:7]
ds_read_b64_tr_b16 v[228:229], v243 offset:24576
v_add_f32 v128, v128, v192
v_mfma_f32_16x16x32_bf16 v[4:7], v[208:211], a[208:211], v[4:7]
ds_read_b64_tr_b16 v[230:231], v243 offset:26624
v_lshlrev_b32 v254, 16, v196
v_mfma_f32_16x16x32_bf16 v[4:7], v[212:215], a[220:223], v[4:7]
buffer_load_dwordx4 v246, s[16:19], s58 offen offset:2048 lds
v_mfma_f32_16x16x32_bf16 v[4:7], v[216:219], a[232:235], v[4:7]
ds_read_b64_tr_b16 v[232:233], v243 offset:28672
v_and_b32 v196, s6, v196
v_mfma_f32_16x16x32_bf16 v[8:11], v[204:207], a[200:203], v[8:11]
ds_read_b64_tr_b16 v[234:235], v243 offset:30720
v_add_f32 v249, v249, v254
v_mfma_f32_16x16x32_bf16 v[8:11], v[208:211], a[212:215], v[8:11]
v_add_f32 v128, v128, v196
v_lshlrev_b32 v255, 16, v200
v_mfma_f32_16x16x32_bf16 v[8:11], v[212:215], a[224:227], v[8:11]
s_waitcnt lgkmcnt(4)
buffer_load_dwordx4 v246, s[16:19], s59 offen offset:3072 lds
v_mfma_f32_16x16x32_bf16 v[8:11], v[216:219], a[236:239], v[8:11]
s_add_u32 m0, s60, 32768
ds_read_b64_tr_b16 v[204:205], v242 offset:16384
v_and_b32 v200, s6, v200
v_mfma_f32_16x16x32_bf16 v[12:15], v[220:223], a[192:195], v[12:15]
s_add_u32 s56, s40, s97
ds_read_b64_tr_b16 v[206:207], v242 offset:18432
v_add_f32 v249, v249, v255
v_mfma_f32_16x16x32_bf16 v[12:15], v[224:227], a[204:207], v[12:15]
s_waitcnt lgkmcnt(2)
ds_read_b64_tr_b16 v[208:209], v242 offset:20480
v_add_f32 v128, v128, v200
v_mfma_f32_16x16x32_bf16 v[12:15], v[228:231], a[216:219], v[12:15]
s_add_u32 s57, s56, s50
ds_read_b64_tr_b16 v[210:211], v242 offset:22528
v_lshlrev_b32 v254, 16, v236
v_mfma_f32_16x16x32_bf16 v[12:15], v[232:235], a[228:231], v[12:15]
s_add_u32 s58, s56, s51
ds_read_b64_tr_b16 v[212:213], v242 offset:24576
v_xor_b32 v243, 96, v241
v_mfma_f32_16x16x32_bf16 v[16:19], v[220:223], a[196:199], v[16:19]
s_add_u32 s59, s56, s52
buffer_load_dwordx4 v246, s[16:19], s56 offen offset:0 lds
v_mfma_f32_16x16x32_bf16 v[16:19], v[224:227], a[208:211], v[16:19]
ds_read_b64_tr_b16 v[214:215], v242 offset:26624
v_and_b32 v236, s6, v236
v_mfma_f32_16x16x32_bf16 v[16:19], v[228:231], a[220:223], v[16:19]
ds_read_b64_tr_b16 v[216:217], v242 offset:28672
v_add_f32 v249, v249, v254
v_mfma_f32_16x16x32_bf16 v[16:19], v[232:235], a[232:235], v[16:19]
ds_read_b64_tr_b16 v[218:219], v242 offset:30720
v_add_f32 v128, v128, v236
v_mfma_f32_16x16x32_bf16 v[20:23], v[220:223], a[200:203], v[20:23]
buffer_load_dwordx4 v246, s[16:19], s57 offen offset:1024 lds
v_mfma_f32_16x16x32_bf16 v[20:23], v[224:227], a[212:215], v[20:23]
v_cvt_pk_bf16_f32 v128, v249, v128
v_lshlrev_b32 v250, 16, v129
v_mfma_f32_16x16x32_bf16 v[20:23], v[228:231], a[224:227], v[20:23]
s_waitcnt lgkmcnt(4)
v_and_b32 v129, s6, v129
v_lshlrev_b32 v255, 16, v133
v_mfma_f32_16x16x32_bf16 v[20:23], v[232:235], a[236:239], v[20:23]
ds_read_b64_tr_b16 v[220:221], v243 offset:16384
v_and_b32 v133, s6, v133
v_mfma_f32_16x16x32_bf16 v[24:27], v[204:207], a[192:195], v[24:27]
ds_read_b64_tr_b16 v[222:223], v243 offset:18432
v_add_f32 v250, v250, v255
v_mfma_f32_16x16x32_bf16 v[24:27], v[208:211], a[204:207], v[24:27]
s_waitcnt lgkmcnt(2)
ds_read_b64_tr_b16 v[224:225], v243 offset:20480
v_add_f32 v129, v129, v133
v_mfma_f32_16x16x32_bf16 v[24:27], v[212:215], a[216:219], v[24:27]
ds_read_b64_tr_b16 v[226:227], v243 offset:22528
v_lshlrev_b32 v254, 16, v137
v_mfma_f32_16x16x32_bf16 v[24:27], v[216:219], a[228:231], v[24:27]
buffer_load_dwordx4 v246, s[16:19], s58 offen offset:2048 lds
v_mfma_f32_16x16x32_bf16 v[28:31], v[204:207], a[196:199], v[28:31]
ds_read_b64_tr_b16 v[228:229], v243 offset:24576
v_and_b32 v137, s6, v137
v_mfma_f32_16x16x32_bf16 v[28:31], v[208:211], a[208:211], v[28:31]
ds_read_b64_tr_b16 v[230:231], v243 offset:26624
v_add_f32 v250, v250, v254
v_mfma_f32_16x16x32_bf16 v[28:31], v[212:215], a[220:223], v[28:31]
ds_read_b64_tr_b16 v[232:233], v243 offset:28672
v_add_f32 v129, v129, v137
v_mfma_f32_16x16x32_bf16 v[28:31], v[216:219], a[232:235], v[28:31]
ds_read_b64_tr_b16 v[234:235], v243 offset:30720
v_lshlrev_b32 v255, 16, v141
v_mfma_f32_16x16x32_bf16 v[32:35], v[204:207], a[200:203], v[32:35]
buffer_load_dwordx4 v246, s[16:19], s59 offen offset:3072 lds
v_mfma_f32_16x16x32_bf16 v[32:35], v[208:211], a[212:215], v[32:35]
s_add_u32 m0, s60, 49152
v_and_b32 v141, s6, v141
v_add_f32 v250, v250, v255
v_mfma_f32_16x16x32_bf16 v[32:35], v[212:215], a[224:227], v[32:35]
s_waitcnt lgkmcnt(4)
v_add_f32 v129, v129, v141
v_lshlrev_b32 v254, 16, v193
v_mfma_f32_16x16x32_bf16 v[32:35], v[216:219], a[236:239], v[32:35]
s_cmp_ge_u32 s86, 7
v_and_b32 v193, s6, v193
v_add_f32 v250, v250, v254
v_mfma_f32_16x16x32_bf16 v[36:39], v[220:223], a[192:195], v[36:39]
s_waitcnt vmcnt(8) lgkmcnt(0)
v_add_f32 v129, v129, v193
v_lshlrev_b32 v255, 16, v197
v_mfma_f32_16x16x32_bf16 v[36:39], v[224:227], a[204:207], v[36:39]
s_barrier
ds_read_b64_tr_b16 v[204:205], v241 offset:49152
v_and_b32 v197, s6, v197
v_mfma_f32_16x16x32_bf16 v[36:39], v[228:231], a[216:219], v[36:39]
s_cselect_b32 s18, 0, s18
buffer_store_dword v244, v245, s[24:27], s88 offen
v_mfma_f32_16x16x32_bf16 v[36:39], v[232:235], a[228:231], v[36:39]
s_add_u32 s56, s41, s93
ds_read_b64_tr_b16 v[206:207], v241 offset:51200
v_xor_b32 v243, 32, v241
v_mfma_f32_16x16x32_bf16 v[40:43], v[220:223], a[196:199], v[40:43]
s_add_u32 s57, s56, s50
ds_read_b64_tr_b16 v[208:209], v241 offset:53248
v_add_f32 v250, v250, v255
v_mfma_f32_16x16x32_bf16 v[40:43], v[224:227], a[208:211], v[40:43]
s_add_u32 s58, s56, s51
ds_read_b64_tr_b16 v[210:211], v241 offset:55296
v_add_f32 v129, v129, v197
v_mfma_f32_16x16x32_bf16 v[40:43], v[228:231], a[220:223], v[40:43]
s_add_u32 s59, s56, s52
buffer_load_dwordx4 v246, s[16:19], s56 offen offset:0 lds
v_mfma_f32_16x16x32_bf16 v[40:43], v[232:235], a[232:235], v[40:43]
ds_read_b64_tr_b16 v[212:213], v241 offset:57344
v_lshlrev_b32 v254, 16, v201
v_mfma_f32_16x16x32_bf16 v[44:47], v[220:223], a[200:203], v[44:47]
ds_read_b64_tr_b16 v[214:215], v241 offset:59392
v_and_b32 v201, s6, v201
v_mfma_f32_16x16x32_bf16 v[44:47], v[224:227], a[212:215], v[44:47]
ds_read_b64_tr_b16 v[216:217], v241 offset:61440
v_add_f32 v250, v250, v254
v_mfma_f32_16x16x32_bf16 v[44:47], v[228:231], a[224:227], v[44:47]
s_waitcnt lgkmcnt(3)
ds_read_b64_tr_b16 v[218:219], v241 offset:63488
v_add_f32 v129, v129, v201
v_mfma_f32_16x16x32_bf16 v[44:47], v[232:235], a[236:239], v[44:47]
buffer_load_dwordx4 v246, s[16:19], s57 offen offset:1024 lds
v_mfma_f32_16x16x32_bf16 v[0:3], v[204:207], a[0:3], v[0:3]
ds_read_b64_tr_b16 v[220:221], v243 offset:49152
v_lshlrev_b32 v255, 16, v237
v_mfma_f32_16x16x32_bf16 v[0:3], v[208:211], a[12:15], v[0:3]
s_waitcnt lgkmcnt(1)
ds_read_b64_tr_b16 v[222:223], v243 offset:51200
v_and_b32 v237, s6, v237
v_mfma_f32_16x16x32_bf16 v[0:3], v[212:215], a[24:27], v[0:3]
ds_read_b64_tr_b16 v[224:225], v243 offset:53248
v_add_f32 v250, v250, v255
v_mfma_f32_16x16x32_bf16 v[0:3], v[216:219], a[36:39], v[0:3]
ds_read_b64_tr_b16 v[226:227], v243 offset:55296
v_xor_b32 v242, 64, v241
v_mfma_f32_16x16x32_bf16 v[4:7], v[204:207], a[4:7], v[4:7]
buffer_load_dwordx4 v246, s[16:19], s58 offen offset:2048 lds
v_mfma_f32_16x16x32_bf16 v[4:7], v[208:211], a[16:19], v[4:7]
ds_read_b64_tr_b16 v[228:229], v243 offset:57344
v_add_f32 v129, v129, v237
v_mfma_f32_16x16x32_bf16 v[4:7], v[212:215], a[28:31], v[4:7]
ds_read_b64_tr_b16 v[230:231], v243 offset:59392
v_cvt_pk_bf16_f32 v129, v250, v129
v_mfma_f32_16x16x32_bf16 v[4:7], v[216:219], a[40:43], v[4:7]
ds_read_b64_tr_b16 v[232:233], v243 offset:61440
v_lshlrev_b32 v251, 16, v130
v_mfma_f32_16x16x32_bf16 v[8:11], v[204:207], a[8:11], v[8:11]
ds_read_b64_tr_b16 v[234:235], v243 offset:63488
v_and_b32 v130, s6, v130
v_mfma_f32_16x16x32_bf16 v[8:11], v[208:211], a[20:23], v[8:11]
buffer_load_dwordx4 v246, s[16:19], s59 offen offset:3072 lds
v_mfma_f32_16x16x32_bf16 v[8:11], v[212:215], a[32:35], v[8:11]
s_waitcnt lgkmcnt(4)
v_lshlrev_b32 v254, 16, v134
v_and_b32 v134, s6, v134
v_mfma_f32_16x16x32_bf16 v[8:11], v[216:219], a[44:47], v[8:11]
s_add_u32 m0, s60, 81920
ds_read_b64_tr_b16 v[204:205], v242 offset:49152
v_add_f32 v251, v251, v254
v_mfma_f32_16x16x32_bf16 v[12:15], v[220:223], a[0:3], v[12:15]
s_add_u32 s56, s41, s95
ds_read_b64_tr_b16 v[206:207], v242 offset:51200
v_add_f32 v130, v130, v134
v_mfma_f32_16x16x32_bf16 v[12:15], v[224:227], a[12:15], v[12:15]
s_waitcnt lgkmcnt(2)
ds_read_b64_tr_b16 v[208:209], v242 offset:53248
v_lshlrev_b32 v255, 16, v138
v_mfma_f32_16x16x32_bf16 v[12:15], v[228:231], a[24:27], v[12:15]
s_load_dwordx8 s[8:15], s[82:83], s88
ds_read_b64_tr_b16 v[210:211], v242 offset:55296
v_and_b32 v138, s6, v138
v_mfma_f32_16x16x32_bf16 v[12:15], v[232:235], a[36:39], v[12:15]
s_add_u32 s57, s56, s50
buffer_load_dwordx4 v246, s[16:19], s56 offen offset:0 lds
v_mfma_f32_16x16x32_bf16 v[16:19], v[220:223], a[4:7], v[16:19]
s_add_u32 s58, s56, s51
ds_read_b64_tr_b16 v[212:213], v242 offset:57344
v_xor_b32 v243, 96, v241
v_mfma_f32_16x16x32_bf16 v[16:19], v[224:227], a[16:19], v[16:19]
s_add_u32 s59, s56, s52
ds_read_b64_tr_b16 v[214:215], v242 offset:59392
v_add_f32 v251, v251, v255
v_mfma_f32_16x16x32_bf16 v[16:19], v[228:231], a[28:31], v[16:19]
ds_read_b64_tr_b16 v[216:217], v242 offset:61440
v_add_f32 v130, v130, v138
v_mfma_f32_16x16x32_bf16 v[16:19], v[232:235], a[40:43], v[16:19]
ds_read_b64_tr_b16 v[218:219], v242 offset:63488
v_lshlrev_b32 v254, 16, v142
v_mfma_f32_16x16x32_bf16 v[20:23], v[220:223], a[8:11], v[20:23]
buffer_load_dwordx4 v246, s[16:19], s57 offen offset:1024 lds
v_mfma_f32_16x16x32_bf16 v[20:23], v[224:227], a[20:23], v[20:23]
v_and_b32 v142, s6, v142
v_add_f32 v251, v251, v254
v_mfma_f32_16x16x32_bf16 v[20:23], v[228:231], a[32:35], v[20:23]
s_waitcnt lgkmcnt(4)
v_add_f32 v130, v130, v142
v_lshlrev_b32 v255, 16, v194
v_mfma_f32_16x16x32_bf16 v[20:23], v[232:235], a[44:47], v[20:23]
ds_read_b64_tr_b16 v[220:221], v243 offset:49152
v_and_b32 v194, s6, v194
v_mfma_f32_16x16x32_bf16 v[24:27], v[204:207], a[0:3], v[24:27]
ds_read_b64_tr_b16 v[222:223], v243 offset:51200
v_add_f32 v251, v251, v255
v_mfma_f32_16x16x32_bf16 v[24:27], v[208:211], a[12:15], v[24:27]
s_waitcnt lgkmcnt(2)
buffer_load_dwordx4 v246, s[16:19], s58 offen offset:2048 lds
v_mfma_f32_16x16x32_bf16 v[24:27], v[212:215], a[24:27], v[24:27]
ds_read_b64_tr_b16 v[224:225], v243 offset:53248
v_add_f32 v130, v130, v194
v_mfma_f32_16x16x32_bf16 v[24:27], v[216:219], a[36:39], v[24:27]
ds_read_b64_tr_b16 v[226:227], v243 offset:55296
v_lshlrev_b32 v254, 16, v198
v_mfma_f32_16x16x32_bf16 v[28:31], v[204:207], a[4:7], v[28:31]
ds_read_b64_tr_b16 v[228:229], v243 offset:57344
v_and_b32 v198, s6, v198
v_mfma_f32_16x16x32_bf16 v[28:31], v[208:211], a[16:19], v[28:31]
ds_read_b64_tr_b16 v[230:231], v243 offset:59392
v_add_f32 v251, v251, v254
v_mfma_f32_16x16x32_bf16 v[28:31], v[212:215], a[28:31], v[28:31]
buffer_load_dwordx4 v246, s[16:19], s59 offen offset:3072 lds
v_mfma_f32_16x16x32_bf16 v[28:31], v[216:219], a[40:43], v[28:31]
ds_read_b64_tr_b16 v[232:233], v243 offset:61440
v_add_f32 v130, v130, v198
v_mfma_f32_16x16x32_bf16 v[32:35], v[204:207], a[8:11], v[32:35]
ds_read_b64_tr_b16 v[234:235], v243 offset:63488
v_lshlrev_b32 v255, 16, v202
v_mfma_f32_16x16x32_bf16 v[32:35], v[208:211], a[20:23], v[32:35]
v_and_b32 v202, s6, v202
v_add_f32 v251, v251, v255
v_mfma_f32_16x16x32_bf16 v[32:35], v[212:215], a[32:35], v[32:35]
s_waitcnt lgkmcnt(4)
v_add_f32 v130, v130, v202
v_lshlrev_b32 v254, 16, v238
v_mfma_f32_16x16x32_bf16 v[32:35], v[216:219], a[44:47], v[32:35]
ds_read_b64_tr_b16 v[204:205], v241 offset:0
v_and_b32 v238, s6, v238
v_mfma_f32_16x16x32_bf16 v[36:39], v[220:223], a[0:3], v[36:39]
s_waitcnt lgkmcnt(0)
ds_read_b64_tr_b16 v[206:207], v241 offset:2048
v_add_f32 v251, v251, v254
v_mfma_f32_16x16x32_bf16 v[36:39], v[224:227], a[12:15], v[36:39]
s_waitcnt lgkmcnt(2)
ds_read_b64_tr_b16 v[208:209], v241 offset:4096
v_add_f32 v130, v130, v238
v_mfma_f32_16x16x32_bf16 v[36:39], v[228:231], a[24:27], v[36:39]
s_and_b32 s8, s8, s9
ds_read_b64_tr_b16 v[210:211], v241 offset:6144
v_cvt_pk_bf16_f32 v130, v251, v130
v_mfma_f32_16x16x32_bf16 v[36:39], v[232:235], a[36:39], v[36:39]
s_and_b32 s10, s10, s11
ds_read_b64_tr_b16 v[212:213], v241 offset:8192
v_xor_b32 v243, 32, v241
v_mfma_f32_16x16x32_bf16 v[40:43], v[220:223], a[4:7], v[40:43]
s_and_b32 s12, s12, s13
ds_read_b64_tr_b16 v[214:215], v241 offset:10240
v_lshlrev_b32 v253, 16, v131
v_mfma_f32_16x16x32_bf16 v[40:43], v[224:227], a[16:19], v[40:43]
s_and_b32 s14, s14, s15
ds_read_b64_tr_b16 v[216:217], v241 offset:12288
v_and_b32 v131, s6, v131
v_mfma_f32_16x16x32_bf16 v[40:43], v[228:231], a[28:31], v[40:43]
s_and_b32 s8, s8, s10
ds_read_b64_tr_b16 v[218:219], v241 offset:14336
v_lshlrev_b32 v255, 16, v135
v_mfma_f32_16x16x32_bf16 v[40:43], v[232:235], a[40:43], v[40:43]
s_and_b32 s12, s12, s14
v_and_b32 v135, s6, v135
v_add_f32 v253, v253, v255
v_mfma_f32_16x16x32_bf16 v[44:47], v[220:223], a[8:11], v[44:47]
s_and_b32 s8, s8, s12
v_add_f32 v131, v131, v135
v_lshlrev_b32 v254, 16, v139
v_mfma_f32_16x16x32_bf16 v[44:47], v[224:227], a[20:23], v[44:47]
s_bitcmp0_b32 s8, 4
v_and_b32 v139, s6, v139
v_add_f32 v253, v253, v254
v_mfma_f32_16x16x32_bf16 v[44:47], v[228:231], a[32:35], v[44:47]
s_waitcnt lgkmcnt(4)
v_add_f32 v131, v131, v139
v_lshlrev_b32 v255, 16, v143
v_mfma_f32_16x16x32_bf16 v[44:47], v[232:235], a[44:47], v[44:47]
s_cbranch_scc1 L_spinG0
L_backG0:
ds_read_b64_tr_b16 v[220:221], v243 offset:0
v_and_b32 v143, s6, v143
v_mfma_f32_16x16x32_bf16 v[0:3], v[204:207], v[144:147], v[0:3]
ds_read_b64_tr_b16 v[222:223], v243 offset:2048
v_add_f32 v253, v253, v255
v_mfma_f32_16x16x32_bf16 v[0:3], v[208:211], v[156:159], v[0:3]
s_waitcnt lgkmcnt(2)
buffer_load_dwordx4 v[96:99], v244, s[24:27], s90 offen offset:0 sc1
v_mfma_f32_16x16x32_bf16 v[0:3], v[212:215], v[168:171], v[0:3]
ds_read_b64_tr_b16 v[224:225], v243 offset:4096
v_add_f32 v131, v131, v143
v_mfma_f32_16x16x32_bf16 v[0:3], v[216:219], v[180:183], v[0:3]
ds_read_b64_tr_b16 v[226:227], v243 offset:6144
v_xor_b32 v242, 64, v241
v_mfma_f32_16x16x32_bf16 v[4:7], v[204:207], v[148:151], v[4:7]
ds_read_b64_tr_b16 v[228:229], v243 offset:8192
v_lshlrev_b32 v254, 16, v195
v_mfma_f32_16x16x32_bf16 v[4:7], v[208:211], v[160:163], v[4:7]
buffer_load_dwordx4 v[100:103], v244, s[24:27], s90 offen offset:1024 sc1
v_mfma_f32_16x16x32_bf16 v[4:7], v[212:215], v[172:175], v[4:7]
ds_read_b64_tr_b16 v[230:231], v243 offset:10240
v_and_b32 v195, s6, v195
v_mfma_f32_16x16x32_bf16 v[4:7], v[216:219], v[184:187], v[4:7]
ds_read_b64_tr_b16 v[232:233], v243 offset:12288
v_add_f32 v253, v253, v254
v_mfma_f32_16x16x32_bf16 v[8:11], v[204:207], v[152:155], v[8:11]
ds_read_b64_tr_b16 v[234:235], v243 offset:14336
v_add_f32 v131, v131, v195
v_mfma_f32_16x16x32_bf16 v[8:11], v[208:211], v[164:167], v[8:11]
buffer_load_dwordx4 v[104:107], v244, s[24:27], s90 offen offset:2048 sc1
v_mfma_f32_16x16x32_bf16 v[8:11], v[212:215], v[176:179], v[8:11]
s_waitcnt lgkmcnt(4)
v_lshlrev_b32 v255, 16, v199
v_and_b32 v199, s6, v199
v_mfma_f32_16x16x32_bf16 v[8:11], v[216:219], v[188:191], v[8:11]
ds_read_b64_tr_b16 v[204:205], v242 offset:0
v_add_f32 v253, v253, v255
v_mfma_f32_16x16x32_bf16 v[12:15], v[220:223], v[144:147], v[12:15]
ds_read_b64_tr_b16 v[206:207], v242 offset:2048
v_add_f32 v131, v131, v199
v_mfma_f32_16x16x32_bf16 v[12:15], v[224:227], v[156:159], v[12:15]
s_waitcnt lgkmcnt(2)
buffer_load_dwordx4 v[108:111], v244, s[24:27], s90 offen offset:3072 sc1
v_mfma_f32_16x16x32_bf16 v[12:15], v[228:231], v[168:171], v[12:15]
ds_read_b64_tr_b16 v[208:209], v242 offset:4096
v_lshlrev_b32 v254, 16, v203
v_mfma_f32_16x16x32_bf16 v[12:15], v[232:235], v[180:183], v[12:15]
ds_read_b64_tr_b16 v[210:211], v242 offset:6144
v_xor_b32 v243, 96, v241
v_mfma_f32_16x16x32_bf16 v[16:19], v[220:223], v[148:151], v[16:19]
ds_read_b64_tr_b16 v[212:213], v242 offset:8192
v_and_b32 v203, s6, v203
v_mfma_f32_16x16x32_bf16 v[16:19], v[224:227], v[160:163], v[16:19]
buffer_load_dwordx4 v[112:115], v244, s[24:27], s91 offen offset:0 sc1
v_mfma_f32_16x16x32_bf16 v[16:19], v[228:231], v[172:175], v[16:19]
ds_read_b64_tr_b16 v[214:215], v242 offset:10240
v_add_f32 v253, v253, v254
v_mfma_f32_16x16x32_bf16 v[16:19], v[232:235], v[184:187], v[16:19]
ds_read_b64_tr_b16 v[216:217], v242 offset:12288
v_add_f32 v131, v131, v203
v_mfma_f32_16x16x32_bf16 v[20:23], v[220:223], v[152:155], v[20:23]
ds_read_b64_tr_b16 v[218:219], v242 offset:14336
v_add_u32 v241, 0xffff0000, v241
v_mfma_f32_16x16x32_bf16 v[20:23], v[224:227], v[164:167], v[20:23]
buffer_load_dwordx4 v[116:119], v244, s[24:27], s91 offen offset:1024 sc1
v_mfma_f32_16x16x32_bf16 v[20:23], v[228:231], v[176:179], v[20:23]
s_waitcnt lgkmcnt(4)
v_lshlrev_b32 v255, 16, v239
v_and_b32 v239, s6, v239
v_mfma_f32_16x16x32_bf16 v[20:23], v[232:235], v[188:191], v[20:23]
ds_read_b64_tr_b16 v[220:221], v243 offset:0
v_add_f32 v253, v253, v255
v_mfma_f32_16x16x32_bf16 v[24:27], v[204:207], v[144:147], v[24:27]
ds_read_b64_tr_b16 v[222:223], v243 offset:2048
v_add_f32 v131, v131, v239
v_mfma_f32_16x16x32_bf16 v[24:27], v[208:211], v[156:159], v[24:27]
s_waitcnt lgkmcnt(2)
buffer_load_dwordx4 v[120:123], v244, s[24:27], s91 offen offset:2048 sc1
v_mfma_f32_16x16x32_bf16 v[24:27], v[212:215], v[168:171], v[24:27]
ds_read_b64_tr_b16 v[224:225], v243 offset:4096
v_cvt_pk_bf16_f32 v131, v253, v131
v_mfma_f32_16x16x32_bf16 v[24:27], v[216:219], v[180:183], v[24:27]
ds_read_b64_tr_b16 v[226:227], v243 offset:6144
v_mfma_f32_16x16x32_bf16 v[28:31], v[204:207], v[148:151], v[28:31]
ds_read_b64_tr_b16 v[228:229], v243 offset:8192
v_mfma_f32_16x16x32_bf16 v[28:31], v[208:211], v[160:163], v[28:31]
buffer_load_dwordx4 v[124:127], v244, s[24:27], s91 offen offset:3072 sc1
v_mfma_f32_16x16x32_bf16 v[28:31], v[212:215], v[172:175], v[28:31]
s_sub_u32 s100, s86, 1
ds_read_b64_tr_b16 v[230:231], v243 offset:10240
v_mfma_f32_16x16x32_bf16 v[28:31], v[216:219], v[184:187], v[28:31]
s_and_b32 s100, s100, s72
ds_read_b64_tr_b16 v[232:233], v243 offset:12288
v_mfma_f32_16x16x32_bf16 v[32:35], v[204:207], v[152:155], v[32:35]
s_mul_i32 s100, s100, 196608
ds_read_b64_tr_b16 v[234:235], v243 offset:14336
v_mfma_f32_16x16x32_bf16 v[32:35], v[208:211], v[164:167], v[32:35]
s_add_u32 s87, s68, s100
v_permlane32_swap_b32 v128, v130
v_mfma_f32_16x16x32_bf16 v[32:35], v[212:215], v[176:179], v[32:35]
s_waitcnt lgkmcnt(4)
v_permlane32_swap_b32 v129, v131
v_mfma_f32_16x16x32_bf16 v[32:35], v[216:219], v[188:191], v[32:35]
s_add_u32 s90, s69, s100
v_permlane16_swap_b32 v128, v130
v_mfma_f32_16x16x32_bf16 v[36:39], v[220:223], v[144:147], v[36:39]
s_waitcnt vmcnt(39) lgkmcnt(0)
v_permlane16_swap_b32 v129, v131
v_mfma_f32_16x16x32_bf16 v[36:39], v[224:227], v[156:159], v[36:39]
s_barrier
ds_read_b64_tr_b16 v[204:205], v241 offset:16384
v_mfma_f32_16x16x32_bf16 v[36:39], v[228:231], v[168:171], v[36:39]
s_add_u32 s91, s90, 0x1000
ds_read_b64_tr_b16 v[206:207], v241 offset:18432
v_mfma_f32_16x16x32_bf16 v[36:39], v[232:235], v[180:183], v[36:39]
s_add_u32 s88, s88, 256
ds_read_b64_tr_b16 v[208:209], v241 offset:20480
v_xor_b32 v243, 32, v241
v_mfma_f32_16x16x32_bf16 v[40:43], v[220:223], v[148:151], v[40:43]
s_add_u32 s4, s87, 0
ds_read_b64_tr_b16 v[210:211], v241 offset:22528
v_mfma_f32_16x16x32_bf16 v[40:43], v[224:227], v[160:163], v[40:43]
s_add_u32 s5, s87, 8192
ds_read_b64_tr_b16 v[212:213], v241 offset:24576
v_mfma_f32_16x16x32_bf16 v[40:43], v[228:231], v[172:175], v[40:43]
ds_read_b64_tr_b16 v[214:215], v241 offset:26624
v_mfma_f32_16x16x32_bf16 v[40:43], v[232:235], v[184:187], v[40:43]
buffer_store_dwordx4 v[128:131], v248, s[28:31], s92 offen
v_mfma_f32_16x16x32_bf16 v[44:47], v[220:223], v[152:155], v[44:47]
ds_read_b64_tr_b16 v[216:217], v241 offset:28672
v_mfma_f32_16x16x32_bf16 v[44:47], v[224:227], v[164:167], v[44:47]
ds_read_b64_tr_b16 v[218:219], v241 offset:30720
v_mfma_f32_16x16x32_bf16 v[44:47], v[228:231], v[176:179], v[44:47]
s_waitcnt lgkmcnt(4)
v_mfma_f32_16x16x32_bf16 v[44:47], v[232:235], v[188:191], v[44:47]
ds_read_b64_tr_b16 v[220:221], v243 offset:16384
v_mfma_f32_16x16x32_bf16 v[48:51], v[204:207], a[144:147], 0
ds_read_b64_tr_b16 v[222:223], v243 offset:18432
v_mfma_f32_16x16x32_bf16 v[48:51], v[208:211], a[156:159], v[48:51]
s_waitcnt lgkmcnt(2)
ds_read_b64_tr_b16 v[224:225], v243 offset:20480
v_mfma_f32_16x16x32_bf16 v[48:51], v[212:215], a[168:171], v[48:51]
ds_read_b64_tr_b16 v[226:227], v243 offset:22528
v_mfma_f32_16x16x32_bf16 v[48:51], v[216:219], a[180:183], v[48:51]
ds_read_b64_tr_b16 v[228:229], v243 offset:24576
v_xor_b32 v242, 64, v241
v_mfma_f32_16x16x32_bf16 v[52:55], v[204:207], a[148:151], 0
ds_read_b64_tr_b16 v[230:231], v243 offset:26624
v_mfma_f32_16x16x32_bf16 v[52:55], v[208:211], a[160:163], v[52:55]
ds_read_b64_tr_b16 v[232:233], v243 offset:28672
v_mfma_f32_16x16x32_bf16 v[52:55], v[212:215], a[172:175], v[52:55]
ds_read_b64_tr_b16 v[234:235], v243 offset:30720
v_mfma_f32_16x16x32_bf16 v[52:55], v[216:219], a[184:187], v[52:55]
v_mfma_f32_16x16x32_bf16 v[56:59], v[204:207], a[152:155], 0
s_waitcnt vmcnt(1)
v_cvt_pk_bf16_f32 v0, v0, v1
v_cvt_pk_bf16_f32 v1, v2, v3
v_mfma_f32_16x16x32_bf16 v[56:59], v[208:211], a[164:167], v[56:59]
v_cvt_pk_bf16_f32 v2, v12, v13
v_cvt_pk_bf16_f32 v3, v14, v15
v_mfma_f32_16x16x32_bf16 v[56:59], v[212:215], a[176:179], v[56:59]
s_waitcnt lgkmcnt(4)
buffer_store_dwordx4 v[0:3], v244, s[24:27], s4 offen
v_mfma_f32_16x16x32_bf16 v[56:59], v[216:219], a[188:191], v[56:59]
s_add_u32 s4, s87, 16384
ds_read_b64_tr_b16 v[204:205], v242 offset:16384
v_cvt_pk_bf16_f32 v24, v24, v25
v_mfma_f32_16x16x32_bf16 v[60:63], v[220:223], a[144:147], 0
ds_read_b64_tr_b16 v[206:207], v242 offset:18432
v_cvt_pk_bf16_f32 v25, v26, v27
v_mfma_f32_16x16x32_bf16 v[60:63], v[224:227], a[156:159], v[60:63]
s_waitcnt lgkmcnt(2)
ds_read_b64_tr_b16 v[208:209], v242 offset:20480
v_cvt_pk_bf16_f32 v26, v36, v37
v_mfma_f32_16x16x32_bf16 v[60:63], v[228:231], a[168:171], v[60:63]
ds_read_b64_tr_b16 v[210:211], v242 offset:22528
v_cvt_pk_bf16_f32 v27, v38, v39
v_mfma_f32_16x16x32_bf16 v[60:63], v[232:235], a[180:183], v[60:63]
buffer_store_dwordx4 v[24:27], v244, s[24:27], s5 offen
v_mfma_f32_16x16x32_bf16 v[64:67], v[220:223], a[148:151], 0
s_add_u32 s5, s87, 24576
ds_read_b64_tr_b16 v[212:213], v242 offset:24576
v_cvt_pk_bf16_f32 v4, v4, v5
v_mfma_f32_16x16x32_bf16 v[64:67], v[224:227], a[160:163], v[64:67]
ds_read_b64_tr_b16 v[214:215], v242 offset:26624
v_cvt_pk_bf16_f32 v5, v6, v7
v_mfma_f32_16x16x32_bf16 v[64:67], v[228:231], a[172:175], v[64:67]
ds_read_b64_tr_b16 v[216:217], v242 offset:28672
v_cvt_pk_bf16_f32 v6, v16, v17
v_mfma_f32_16x16x32_bf16 v[64:67], v[232:235], a[184:187], v[64:67]
ds_read_b64_tr_b16 v[218:219], v242 offset:30720
v_cvt_pk_bf16_f32 v7, v18, v19
v_mfma_f32_16x16x32_bf16 v[68:71], v[220:223], a[152:155], 0
buffer_store_dwordx4 v[4:7], v244, s[24:27], s4 offen
v_mfma_f32_16x16x32_bf16 v[68:71], v[224:227], a[164:167], v[68:71]
s_add_u32 s4, s87, 32768
v_xor_b32 v243, 96, v241
v_cvt_pk_bf16_f32 v28, v28, v29
v_mfma_f32_16x16x32_bf16 v[68:71], v[228:231], a[176:179], v[68:71]
s_waitcnt lgkmcnt(4)
v_cvt_pk_bf16_f32 v29, v30, v31
v_cvt_pk_bf16_f32 v30, v40, v41
v_mfma_f32_16x16x32_bf16 v[68:71], v[232:235], a[188:191], v[68:71]
ds_read_b64_tr_b16 v[220:221], v243 offset:16384
v_cvt_pk_bf16_f32 v31, v42, v43
v_mfma_f32_16x16x32_bf16 v[72:75], v[204:207], a[144:147], 0
buffer_store_dwordx4 v[28:31], v244, s[24:27], s5 offen
v_mfma_f32_16x16x32_bf16 v[72:75], v[208:211], a[156:159], v[72:75]
s_waitcnt lgkmcnt(1)
ds_read_b64_tr_b16 v[222:223], v243 offset:18432
v_cvt_pk_bf16_f32 v8, v8, v9
v_mfma_f32_16x16x32_bf16 v[72:75], v[212:215], a[168:171], v[72:75]
s_add_u32 s5, s87, 40960
ds_read_b64_tr_b16 v[224:225], v243 offset:20480
v_cvt_pk_bf16_f32 v9, v10, v11
v_mfma_f32_16x16x32_bf16 v[72:75], v[216:219], a[180:183], v[72:75]
s_add_u32 s92, s71, s39
ds_read_b64_tr_b16 v[226:227], v243 offset:22528
v_cvt_pk_bf16_f32 v10, v20, v21
v_mfma_f32_16x16x32_bf16 v[76:79], v[204:207], a[148:151], 0
s_add_u32 s56, s41, s96
ds_read_b64_tr_b16 v[228:229], v243 offset:24576
v_cvt_pk_bf16_f32 v11, v22, v23
v_mfma_f32_16x16x32_bf16 v[76:79], v[208:211], a[160:163], v[76:79]
s_add_u32 s57, s56, s50
buffer_store_dwordx4 v[8:11], v244, s[24:27], s4 offen
v_mfma_f32_16x16x32_bf16 v[76:79], v[212:215], a[172:175], v[76:79]
s_add_u32 s58, s56, s51
ds_read_b64_tr_b16 v[230:231], v243 offset:26624
v_cvt_pk_bf16_f32 v32, v32, v33
v_mfma_f32_16x16x32_bf16 v[76:79], v[216:219], a[184:187], v[76:79]
s_add_u32 s59, s56, s52
ds_read_b64_tr_b16 v[232:233], v243 offset:28672
v_cvt_pk_bf16_f32 v33, v34, v35
v_mfma_f32_16x16x32_bf16 v[80:83], v[204:207], a[152:155], 0
s_add_u32 s39, s39, 128
ds_read_b64_tr_b16 v[234:235], v243 offset:30720
v_cvt_pk_bf16_f32 v34, v44, v45
v_cvt_pk_bf16_f32 v35, v46, v47
v_mfma_f32_16x16x32_bf16 v[80:83], v[208:211], a[164:167], v[80:83]
s_and_b32 s39, s39, 0x3ff
buffer_store_dwordx4 v[32:35], v244, s[24:27], s5 offen
v_mfma_f32_16x16x32_bf16 v[80:83], v[212:215], a[176:179], v[80:83]
s_waitcnt lgkmcnt(4)
v_add_u32 v241, 0x18000, v241
v_lshlrev_b32 v249, 16, v96
v_mfma_f32_16x16x32_bf16 v[80:83], v[216:219], a[188:191], v[80:83]
s_add_u32 m0, s60, 114688
ds_read_b64_tr_b16 v[204:205], v241 offset:0
v_and_b32 v96, s6, v96
v_mfma_f32_16x16x32_bf16 v[84:87], v[220:223], a[144:147], 0
s_add_u32 s86, s86, 1
ds_read_b64_tr_b16 v[206:207], v241 offset:2048
v_lshlrev_b32 v254, 16, v100
v_mfma_f32_16x16x32_bf16 v[84:87], v[224:227], a[156:159], v[84:87]
s_waitcnt lgkmcnt(2)
ds_read_b64_tr_b16 v[208:209], v241 offset:4096
v_and_b32 v100, s6, v100
v_mfma_f32_16x16x32_bf16 v[84:87], v[228:231], a[168:171], v[84:87]
ds_read_b64_tr_b16 v[210:211], v241 offset:6144
v_add_f32 v249, v249, v254
v_mfma_f32_16x16x32_bf16 v[84:87], v[232:235], a[180:183], v[84:87]
ds_read_b64_tr_b16 v[212:213], v241 offset:8192
v_xor_b32 v243, 32, v241
v_mfma_f32_16x16x32_bf16 v[88:91], v[220:223], a[148:151], 0
ds_read_b64_tr_b16 v[214:215], v241 offset:10240
v_add_f32 v96, v96, v100
v_mfma_f32_16x16x32_bf16 v[88:91], v[224:227], a[160:163], v[88:91]
ds_read_b64_tr_b16 v[216:217], v241 offset:12288
v_lshlrev_b32 v255, 16, v104
v_mfma_f32_16x16x32_bf16 v[88:91], v[228:231], a[172:175], v[88:91]
ds_read_b64_tr_b16 v[218:219], v241 offset:14336
v_and_b32 v104, s6, v104
v_mfma_f32_16x16x32_bf16 v[88:91], v[232:235], a[184:187], v[88:91]
buffer_load_dwordx4 v246, s[16:19], s56 offen offset:0 lds
v_mfma_f32_16x16x32_bf16 v[92:95], v[220:223], a[152:155], 0
v_add_f32 v249, v249, v255
v_add_f32 v96, v96, v104
v_mfma_f32_16x16x32_bf16 v[92:95], v[224:227], a[164:167], v[92:95]
v_lshlrev_b32 v254, 16, v108
v_and_b32 v108, s6, v108
v_mfma_f32_16x16x32_bf16 v[92:95], v[228:231], a[176:179], v[92:95]
s_waitcnt lgkmcnt(4)
v_add_f32 v249, v249, v254
v_add_f32 v96, v96, v108
v_mfma_f32_16x16x32_bf16 v[92:95], v[232:235], a[188:191], v[92:95]
ds_read_b64_tr_b16 v[220:221], v243 offset:0
v_lshlrev_b32 v255, 16, v112
v_mfma_f32_16x16x32_bf16 v[48:51], v[204:207], a[192:195], v[48:51]
ds_read_b64_tr_b16 v[222:223], v243 offset:2048
v_and_b32 v112, s6, v112
v_mfma_f32_16x16x32_bf16 v[48:51], v[208:211], a[204:207], v[48:51]
s_waitcnt lgkmcnt(2)
buffer_load_dwordx4 v246, s[16:19], s57 offen offset:1024 lds
v_mfma_f32_16x16x32_bf16 v[48:51], v[212:215], a[216:219], v[48:51]
ds_read_b64_tr_b16 v[224:225], v243 offset:4096
v_add_f32 v249, v249, v255
v_mfma_f32_16x16x32_bf16 v[48:51], v[216:219], a[228:231], v[48:51]
ds_read_b64_tr_b16 v[226:227], v243 offset:6144
v_xor_b32 v242, 64, v241
v_mfma_f32_16x16x32_bf16 v[52:55], v[204:207], a[196:199], v[52:55]
ds_read_b64_tr_b16 v[228:229], v243 offset:8192
v_add_f32 v96, v96, v112
v_mfma_f32_16x16x32_bf16 v[52:55], v[208:211], a[208:211], v[52:55]
ds_read_b64_tr_b16 v[230:231], v243 offset:10240
v_lshlrev_b32 v254, 16, v116
v_mfma_f32_16x16x32_bf16 v[52:55], v[212:215], a[220:223], v[52:55]
buffer_load_dwordx4 v246, s[16:19], s58 offen offset:2048 lds
v_mfma_f32_16x16x32_bf16 v[52:55], v[216:219], a[232:235], v[52:55]
ds_read_b64_tr_b16 v[232:233], v243 offset:12288
v_and_b32 v116, s6, v116
v_mfma_f32_16x16x32_bf16 v[56:59], v[204:207], a[200:203], v[56:59]
ds_read_b64_tr_b16 v[234:235], v243 offset:14336
v_add_f32 v249, v249, v254
v_mfma_f32_16x16x32_bf16 v[56:59], v[208:211], a[212:215], v[56:59]
v_add_f32 v96, v96, v116
v_lshlrev_b32 v255, 16, v120
v_mfma_f32_16x16x32_bf16 v[56:59], v[212:215], a[224:227], v[56:59]
s_waitcnt lgkmcnt(4)
buffer_load_dwordx4 v246, s[16:19], s59 offen offset:3072 lds
v_mfma_f32_16x16x32_bf16 v[56:59], v[216:219], a[236:239], v[56:59]
s_add_u32 m0, s60, 65536
ds_read_b64_tr_b16 v[204:205], v242 offset:0
v_and_b32 v120, s6, v120
v_mfma_f32_16x16x32_bf16 v[60:63], v[220:223], a[192:195], v[60:63]
s_add_u32 s56, s41, s97
ds_read_b64_tr_b16 v[206:207], v242 offset:2048
v_add_f32 v249, v249, v255
v_mfma_f32_16x16x32_bf16 v[60:63], v[224:227], a[204:207], v[60:63]
s_waitcnt lgkmcnt(2)
ds_read_b64_tr_b16 v[208:209], v242 offset:4096
v_add_f32 v96, v96, v120
v_mfma_f32_16x16x32_bf16 v[60:63], v[228:231], a[216:219], v[60:63]
s_add_u32 s57, s56, s50
ds_read_b64_tr_b16 v[210:211], v242 offset:6144
v_lshlrev_b32 v254, 16, v124
v_mfma_f32_16x16x32_bf16 v[60:63], v[232:235], a[228:231], v[60:63]
s_add_u32 s58, s56, s51
ds_read_b64_tr_b16 v[212:213], v242 offset:8192
v_xor_b32 v243, 96, v241
v_mfma_f32_16x16x32_bf16 v[64:67], v[220:223], a[196:199], v[64:67]
s_add_u32 s59, s56, s52
buffer_load_dwordx4 v246, s[16:19], s56 offen offset:0 lds
v_mfma_f32_16x16x32_bf16 v[64:67], v[224:227], a[208:211], v[64:67]
ds_read_b64_tr_b16 v[214:215], v242 offset:10240
v_and_b32 v124, s6, v124
v_mfma_f32_16x16x32_bf16 v[64:67], v[228:231], a[220:223], v[64:67]
ds_read_b64_tr_b16 v[216:217], v242 offset:12288
v_add_f32 v249, v249, v254
v_mfma_f32_16x16x32_bf16 v[64:67], v[232:235], a[232:235], v[64:67]
ds_read_b64_tr_b16 v[218:219], v242 offset:14336
v_add_f32 v96, v96, v124
v_mfma_f32_16x16x32_bf16 v[68:71], v[220:223], a[200:203], v[68:71]
buffer_load_dwordx4 v246, s[16:19], s57 offen offset:1024 lds
v_mfma_f32_16x16x32_bf16 v[68:71], v[224:227], a[212:215], v[68:71]
v_cvt_pk_bf16_f32 v96, v249, v96
v_lshlrev_b32 v250, 16, v97
v_mfma_f32_16x16x32_bf16 v[68:71], v[228:231], a[224:227], v[68:71]
s_waitcnt lgkmcnt(4)
v_and_b32 v97, s6, v97
v_lshlrev_b32 v255, 16, v101
v_mfma_f32_16x16x32_bf16 v[68:71], v[232:235], a[236:239], v[68:71]
ds_read_b64_tr_b16 v[220:221], v243 offset:0
v_and_b32 v101, s6, v101
v_mfma_f32_16x16x32_bf16 v[72:75], v[204:207], a[192:195], v[72:75]
ds_read_b64_tr_b16 v[222:223], v243 offset:2048
v_add_f32 v250, v250, v255
v_mfma_f32_16x16x32_bf16 v[72:75], v[208:211], a[204:207], v[72:75]
s_waitcnt lgkmcnt(2)
ds_read_b64_tr_b16 v[224:225], v243 offset:4096
v_add_f32 v97, v97, v101
v_mfma_f32_16x16x32_bf16 v[72:75], v[212:215], a[216:219], v[72:75]
ds_read_b64_tr_b16 v[226:227], v243 offset:6144
v_lshlrev_b32 v254, 16, v105
v_mfma_f32_16x16x32_bf16 v[72:75], v[216:219], a[228:231], v[72:75]
buffer_load_dwordx4 v246, s[16:19], s58 offen offset:2048 lds
v_mfma_f32_16x16x32_bf16 v[76:79], v[204:207], a[196:199], v[76:79]
ds_read_b64_tr_b16 v[228:229], v243 offset:8192
v_and_b32 v105, s6, v105
v_mfma_f32_16x16x32_bf16 v[76:79], v[208:211], a[208:211], v[76:79]
ds_read_b64_tr_b16 v[230:231], v243 offset:10240
v_add_f32 v250, v250, v254
v_mfma_f32_16x16x32_bf16 v[76:79], v[212:215], a[220:223], v[76:79]
ds_read_b64_tr_b16 v[232:233], v243 offset:12288
v_add_f32 v97, v97, v105
v_mfma_f32_16x16x32_bf16 v[76:79], v[216:219], a[232:235], v[76:79]
ds_read_b64_tr_b16 v[234:235], v243 offset:14336
v_lshlrev_b32 v255, 16, v109
v_mfma_f32_16x16x32_bf16 v[80:83], v[204:207], a[200:203], v[80:83]
buffer_load_dwordx4 v246, s[16:19], s59 offen offset:3072 lds
v_mfma_f32_16x16x32_bf16 v[80:83], v[208:211], a[212:215], v[80:83]
s_add_u32 m0, s60, 16384
v_and_b32 v109, s6, v109
v_add_f32 v250, v250, v255
v_mfma_f32_16x16x32_bf16 v[80:83], v[212:215], a[224:227], v[80:83]
s_waitcnt lgkmcnt(4)
v_add_f32 v97, v97, v109
v_lshlrev_b32 v254, 16, v113
v_mfma_f32_16x16x32_bf16 v[80:83], v[216:219], a[236:239], v[80:83]
s_add_u32 s56, s42, s93
v_and_b32 v113, s6, v113
v_add_f32 v250, v250, v254
v_mfma_f32_16x16x32_bf16 v[84:87], v[220:223], a[192:195], v[84:87]
s_waitcnt vmcnt(8) lgkmcnt(0)
v_add_f32 v97, v97, v113
v_lshlrev_b32 v255, 16, v117
v_mfma_f32_16x16x32_bf16 v[84:87], v[224:227], a[204:207], v[84:87]
s_barrier
ds_read_b64_tr_b16 v[204:205], v241 offset:49152
v_and_b32 v117, s6, v117
v_mfma_f32_16x16x32_bf16 v[84:87], v[228:231], a[216:219], v[84:87]
s_add_u32 s57, s56, s50
buffer_store_dword v244, v245, s[24:27], s88 offen
v_mfma_f32_16x16x32_bf16 v[84:87], v[232:235], a[228:231], v[84:87]
s_add_u32 s58, s56, s51
ds_read_b64_tr_b16 v[206:207], v241 offset:51200
v_xor_b32 v243, 32, v241
v_mfma_f32_16x16x32_bf16 v[88:91], v[220:223], a[196:199], v[88:91]
s_add_u32 s59, s56, s52
ds_read_b64_tr_b16 v[208:209], v241 offset:53248
v_add_f32 v250, v250, v255
v_mfma_f32_16x16x32_bf16 v[88:91], v[224:227], a[208:211], v[88:91]
ds_read_b64_tr_b16 v[210:211], v241 offset:55296
v_add_f32 v97, v97, v117
v_mfma_f32_16x16x32_bf16 v[88:91], v[228:231], a[220:223], v[88:91]
buffer_load_dwordx4 v246, s[16:19], s56 offen offset:0 lds
v_mfma_f32_16x16x32_bf16 v[88:91], v[232:235], a[232:235], v[88:91]
ds_read_b64_tr_b16 v[212:213], v241 offset:57344
v_lshlrev_b32 v254, 16, v121
v_mfma_f32_16x16x32_bf16 v[92:95], v[220:223], a[200:203], v[92:95]
ds_read_b64_tr_b16 v[214:215], v241 offset:59392
v_and_b32 v121, s6, v121
v_mfma_f32_16x16x32_bf16 v[92:95], v[224:227], a[212:215], v[92:95]
ds_read_b64_tr_b16 v[216:217], v241 offset:61440
v_add_f32 v250, v250, v254
v_mfma_f32_16x16x32_bf16 v[92:95], v[228:231], a[224:227], v[92:95]
s_waitcnt lgkmcnt(3)
ds_read_b64_tr_b16 v[218:219], v241 offset:63488
v_add_f32 v97, v97, v121
v_mfma_f32_16x16x32_bf16 v[92:95], v[232:235], a[236:239], v[92:95]
buffer_load_dwordx4 v246, s[16:19], s57 offen offset:1024 lds
v_mfma_f32_16x16x32_bf16 v[48:51], v[204:207], a[0:3], v[48:51]
ds_read_b64_tr_b16 v[220:221], v243 offset:49152
v_lshlrev_b32 v255, 16, v125
v_mfma_f32_16x16x32_bf16 v[48:51], v[208:211], a[12:15], v[48:51]
s_waitcnt lgkmcnt(1)
ds_read_b64_tr_b16 v[222:223], v243 offset:51200
v_and_b32 v125, s6, v125
v_mfma_f32_16x16x32_bf16 v[48:51], v[212:215], a[24:27], v[48:51]
ds_read_b64_tr_b16 v[224:225], v243 offset:53248
v_add_f32 v250, v250, v255
v_mfma_f32_16x16x32_bf16 v[48:51], v[216:219], a[36:39], v[48:51]
ds_read_b64_tr_b16 v[226:227], v243 offset:55296
v_xor_b32 v242, 64, v241
v_mfma_f32_16x16x32_bf16 v[52:55], v[204:207], a[4:7], v[52:55]
buffer_load_dwordx4 v246, s[16:19], s58 offen offset:2048 lds
v_mfma_f32_16x16x32_bf16 v[52:55], v[208:211], a[16:19], v[52:55]
ds_read_b64_tr_b16 v[228:229], v243 offset:57344
v_add_f32 v97, v97, v125
v_mfma_f32_16x16x32_bf16 v[52:55], v[212:215], a[28:31], v[52:55]
ds_read_b64_tr_b16 v[230:231], v243 offset:59392
v_cvt_pk_bf16_f32 v97, v250, v97
v_mfma_f32_16x16x32_bf16 v[52:55], v[216:219], a[40:43], v[52:55]
ds_read_b64_tr_b16 v[232:233], v243 offset:61440
v_lshlrev_b32 v251, 16, v98
v_mfma_f32_16x16x32_bf16 v[56:59], v[204:207], a[8:11], v[56:59]
ds_read_b64_tr_b16 v[234:235], v243 offset:63488
v_and_b32 v98, s6, v98
v_mfma_f32_16x16x32_bf16 v[56:59], v[208:211], a[20:23], v[56:59]
buffer_load_dwordx4 v246, s[16:19], s59 offen offset:3072 lds
v_mfma_f32_16x16x32_bf16 v[56:59], v[212:215], a[32:35], v[56:59]
s_waitcnt lgkmcnt(4)
v_lshlrev_b32 v254, 16, v102
v_and_b32 v102, s6, v102
v_mfma_f32_16x16x32_bf16 v[56:59], v[216:219], a[44:47], v[56:59]
s_add_u32 m0, s60, 98304
ds_read_b64_tr_b16 v[204:205], v242 offset:49152
v_add_f32 v251, v251, v254
v_mfma_f32_16x16x32_bf16 v[60:63], v[220:223], a[0:3], v[60:63]
s_add_u32 s56, s42, s95
ds_read_b64_tr_b16 v[206:207], v242 offset:51200
v_add_f32 v98, v98, v102
v_mfma_f32_16x16x32_bf16 v[60:63], v[224:227], a[12:15], v[60:63]
s_waitcnt lgkmcnt(2)
ds_read_b64_tr_b16 v[208:209], v242 offset:53248
v_lshlrev_b32 v255, 16, v106
v_mfma_f32_16x16x32_bf16 v[60:63], v[228:231], a[24:27], v[60:63]
s_load_dwordx8 s[8:15], s[82:83], s88
ds_read_b64_tr_b16 v[210:211], v242 offset:55296
v_and_b32 v106, s6, v106
v_mfma_f32_16x16x32_bf16 v[60:63], v[232:235], a[36:39], v[60:63]
s_add_u32 s57, s56, s50
buffer_load_dwordx4 v246, s[16:19], s56 offen offset:0 lds
v_mfma_f32_16x16x32_bf16 v[64:67], v[220:223], a[4:7], v[64:67]
s_add_u32 s58, s56, s51
ds_read_b64_tr_b16 v[212:213], v242 offset:57344
v_xor_b32 v243, 96, v241
v_mfma_f32_16x16x32_bf16 v[64:67], v[224:227], a[16:19], v[64:67]
s_add_u32 s59, s56, s52
ds_read_b64_tr_b16 v[214:215], v242 offset:59392
v_add_f32 v251, v251, v255
v_mfma_f32_16x16x32_bf16 v[64:67], v[228:231], a[28:31], v[64:67]
ds_read_b64_tr_b16 v[216:217], v242 offset:61440
v_add_f32 v98, v98, v106
v_mfma_f32_16x16x32_bf16 v[64:67], v[232:235], a[40:43], v[64:67]
ds_read_b64_tr_b16 v[218:219], v242 offset:63488
v_lshlrev_b32 v254, 16, v110
v_mfma_f32_16x16x32_bf16 v[68:71], v[220:223], a[8:11], v[68:71]
buffer_load_dwordx4 v246, s[16:19], s57 offen offset:1024 lds
v_mfma_f32_16x16x32_bf16 v[68:71], v[224:227], a[20:23], v[68:71]
v_add_u32 v241, 0xfffe8000, v241
v_and_b32 v110, s6, v110
v_mfma_f32_16x16x32_bf16 v[68:71], v[228:231], a[32:35], v[68:71]
s_waitcnt lgkmcnt(4)
v_add_f32 v251, v251, v254
v_add_f32 v98, v98, v110
v_mfma_f32_16x16x32_bf16 v[68:71], v[232:235], a[44:47], v[68:71]
ds_read_b64_tr_b16 v[220:221], v243 offset:49152
v_lshlrev_b32 v255, 16, v114
v_mfma_f32_16x16x32_bf16 v[72:75], v[204:207], a[0:3], v[72:75]
ds_read_b64_tr_b16 v[222:223], v243 offset:51200
v_and_b32 v114, s6, v114
v_mfma_f32_16x16x32_bf16 v[72:75], v[208:211], a[12:15], v[72:75]
s_waitcnt lgkmcnt(2)
buffer_load_dwordx4 v246, s[16:19], s58 offen offset:2048 lds
v_mfma_f32_16x16x32_bf16 v[72:75], v[212:215], a[24:27], v[72:75]
ds_read_b64_tr_b16 v[224:225], v243 offset:53248
v_add_f32 v251, v251, v255
v_mfma_f32_16x16x32_bf16 v[72:75], v[216:219], a[36:39], v[72:75]
ds_read_b64_tr_b16 v[226:227], v243 offset:55296
v_add_f32 v98, v98, v114
v_mfma_f32_16x16x32_bf16 v[76:79], v[204:207], a[4:7], v[76:79]
ds_read_b64_tr_b16 v[228:229], v243 offset:57344
v_lshlrev_b32 v254, 16, v118
v_mfma_f32_16x16x32_bf16 v[76:79], v[208:211], a[16:19], v[76:79]
ds_read_b64_tr_b16 v[230:231], v243 offset:59392
v_and_b32 v118, s6, v118
v_mfma_f32_16x16x32_bf16 v[76:79], v[212:215], a[28:31], v[76:79]
buffer_load_dwordx4 v246, s[16:19], s59 offen offset:3072 lds
v_mfma_f32_16x16x32_bf16 v[76:79], v[216:219], a[40:43], v[76:79]
ds_read_b64_tr_b16 v[232:233], v243 offset:61440
v_add_f32 v251, v251, v254
v_mfma_f32_16x16x32_bf16 v[80:83], v[204:207], a[8:11], v[80:83]
ds_read_b64_tr_b16 v[234:235], v243 offset:63488
v_add_f32 v98, v98, v118
v_mfma_f32_16x16x32_bf16 v[80:83], v[208:211], a[20:23], v[80:83]
v_lshlrev_b32 v255, 16, v122
v_and_b32 v122, s6, v122
v_mfma_f32_16x16x32_bf16 v[80:83], v[212:215], a[32:35], v[80:83]
s_waitcnt lgkmcnt(4)
v_add_f32 v251, v251, v255
v_add_f32 v98, v98, v122
v_mfma_f32_16x16x32_bf16 v[80:83], v[216:219], a[44:47], v[80:83]
ds_read_b64_tr_b16 v[204:205], v241 offset:32768
v_lshlrev_b32 v254, 16, v126
v_mfma_f32_16x16x32_bf16 v[84:87], v[220:223], a[0:3], v[84:87]
s_waitcnt lgkmcnt(0)
ds_read_b64_tr_b16 v[206:207], v241 offset:34816
v_and_b32 v126, s6, v126
v_mfma_f32_16x16x32_bf16 v[84:87], v[224:227], a[12:15], v[84:87]
s_waitcnt lgkmcnt(2)
ds_read_b64_tr_b16 v[208:209], v241 offset:36864
v_add_f32 v251, v251, v254
v_mfma_f32_16x16x32_bf16 v[84:87], v[228:231], a[24:27], v[84:87]
s_and_b32 s8, s8, s9
ds_read_b64_tr_b16 v[210:211], v241 offset:38912
v_add_f32 v98, v98, v126
v_mfma_f32_16x16x32_bf16 v[84:87], v[232:235], a[36:39], v[84:87]
s_and_b32 s10, s10, s11
ds_read_b64_tr_b16 v[212:213], v241 offset:40960
v_xor_b32 v243, 32, v241
v_mfma_f32_16x16x32_bf16 v[88:91], v[220:223], a[4:7], v[88:91]
s_and_b32 s12, s12, s13
ds_read_b64_tr_b16 v[214:215], v241 offset:43008
v_cvt_pk_bf16_f32 v98, v251, v98
v_mfma_f32_16x16x32_bf16 v[88:91], v[224:227], a[16:19], v[88:91]
s_and_b32 s14, s14, s15
ds_read_b64_tr_b16 v[216:217], v241 offset:45056
v_lshlrev_b32 v253, 16, v99
v_mfma_f32_16x16x32_bf16 v[88:91], v[228:231], a[28:31], v[88:91]
s_and_b32 s8, s8, s10
ds_read_b64_tr_b16 v[218:219], v241 offset:47104
v_and_b32 v99, s6, v99
v_mfma_f32_16x16x32_bf16 v[88:91], v[232:235], a[40:43], v[88:91]
s_and_b32 s12, s12, s14
v_lshlrev_b32 v255, 16, v103
v_and_b32 v103, s6, v103
v_mfma_f32_16x16x32_bf16 v[92:95], v[220:223], a[8:11], v[92:95]
s_and_b32 s8, s8, s12
v_add_f32 v253, v253, v255
v_add_f32 v99, v99, v103
v_mfma_f32_16x16x32_bf16 v[92:95], v[224:227], a[20:23], v[92:95]
s_bitcmp0_b32 s8, 4
v_lshlrev_b32 v254, 16, v107
v_and_b32 v107, s6, v107
v_mfma_f32_16x16x32_bf16 v[92:95], v[228:231], a[32:35], v[92:95]
s_waitcnt lgkmcnt(4)
v_add_f32 v253, v253, v254
v_add_f32 v99, v99, v107
v_mfma_f32_16x16x32_bf16 v[92:95], v[232:235], a[44:47], v[92:95]
s_cbranch_scc1 L_spinG1
L_backG1:
ds_read_b64_tr_b16 v[220:221], v243 offset:32768
v_lshlrev_b32 v255, 16, v111
v_mfma_f32_16x16x32_bf16 v[48:51], v[204:207], v[144:147], v[48:51]
ds_read_b64_tr_b16 v[222:223], v243 offset:34816
v_and_b32 v111, s6, v111
v_mfma_f32_16x16x32_bf16 v[48:51], v[208:211], v[156:159], v[48:51]
s_waitcnt lgkmcnt(2)
buffer_load_dwordx4 v[128:131], v244, s[24:27], s90 offen offset:0 sc1
v_mfma_f32_16x16x32_bf16 v[48:51], v[212:215], v[168:171], v[48:51]
ds_read_b64_tr_b16 v[224:225], v243 offset:36864
v_add_f32 v253, v253, v255
v_mfma_f32_16x16x32_bf16 v[48:51], v[216:219], v[180:183], v[48:51]
ds_read_b64_tr_b16 v[226:227], v243 offset:38912
v_xor_b32 v242, 64, v241
v_mfma_f32_16x16x32_bf16 v[52:55], v[204:207], v[148:151], v[52:55]
ds_read_b64_tr_b16 v[228:229], v243 offset:40960
v_add_f32 v99, v99, v111
v_mfma_f32_16x16x32_bf16 v[52:55], v[208:211], v[160:163], v[52:55]
buffer_load_dwordx4 v[132:135], v244, s[24:27], s90 offen offset:1024 sc1
v_mfma_f32_16x16x32_bf16 v[52:55], v[212:215], v[172:175], v[52:55]
ds_read_b64_tr_b16 v[230:231], v243 offset:43008
v_lshlrev_b32 v254, 16, v115
v_mfma_f32_16x16x32_bf16 v[52:55], v[216:219], v[184:187], v[52:55]
ds_read_b64_tr_b16 v[232:233], v243 offset:45056
v_and_b32 v115, s6, v115
v_mfma_f32_16x16x32_bf16 v[56:59], v[204:207], v[152:155], v[56:59]
ds_read_b64_tr_b16 v[234:235], v243 offset:47104
v_add_f32 v253, v253, v254
v_mfma_f32_16x16x32_bf16 v[56:59], v[208:211], v[164:167], v[56:59]
buffer_load_dwordx4 v[136:139], v244, s[24:27], s90 offen offset:2048 sc1
v_mfma_f32_16x16x32_bf16 v[56:59], v[212:215], v[176:179], v[56:59]
s_waitcnt lgkmcnt(4)
v_add_f32 v99, v99, v115
v_lshlrev_b32 v255, 16, v119
v_mfma_f32_16x16x32_bf16 v[56:59], v[216:219], v[188:191], v[56:59]
ds_read_b64_tr_b16 v[204:205], v242 offset:32768
v_and_b32 v119, s6, v119
v_mfma_f32_16x16x32_bf16 v[60:63], v[220:223], v[144:147], v[60:63]
ds_read_b64_tr_b16 v[206:207], v242 offset:34816
v_add_f32 v253, v253, v255
v_mfma_f32_16x16x32_bf16 v[60:63], v[224:227], v[156:159], v[60:63]
s_waitcnt lgkmcnt(2)
buffer_load_dwordx4 v[140:143], v244, s[24:27], s90 offen offset:3072 sc1
v_mfma_f32_16x16x32_bf16 v[60:63], v[228:231], v[168:171], v[60:63]
ds_read_b64_tr_b16 v[208:209], v242 offset:36864
v_add_f32 v99, v99, v119
v_mfma_f32_16x16x32_bf16 v[60:63], v[232:235], v[180:183], v[60:63]
ds_read_b64_tr_b16 v[210:211], v242 offset:38912
v_xor_b32 v243, 96, v241
v_mfma_f32_16x16x32_bf16 v[64:67], v[220:223], v[148:151], v[64:67]
ds_read_b64_tr_b16 v[212:213], v242 offset:40960
v_lshlrev_b32 v254, 16, v123
v_mfma_f32_16x16x32_bf16 v[64:67], v[224:227], v[160:163], v[64:67]
buffer_load_dwordx4 v[192:195], v244, s[24:27], s91 offen offset:0 sc1
v_mfma_f32_16x16x32_bf16 v[64:67], v[228:231], v[172:175], v[64:67]
ds_read_b64_tr_b16 v[214:215], v242 offset:43008
v_and_b32 v123, s6, v123
v_mfma_f32_16x16x32_bf16 v[64:67], v[232:235], v[184:187], v[64:67]
ds_read_b64_tr_b16 v[216:217], v242 offset:45056
v_add_f32 v253, v253, v254
v_mfma_f32_16x16x32_bf16 v[68:71], v[220:223], v[152:155], v[68:71]
ds_read_b64_tr_b16 v[218:219], v242 offset:47104
v_add_f32 v99, v99, v123
v_mfma_f32_16x16x32_bf16 v[68:71], v[224:227], v[164:167], v[68:71]
buffer_load_dwordx4 v[196:199], v244, s[24:27], s91 offen offset:1024 sc1
v_mfma_f32_16x16x32_bf16 v[68:71], v[228:231], v[176:179], v[68:71]
s_waitcnt lgkmcnt(4)
v_lshlrev_b32 v255, 16, v127
v_and_b32 v127, s6, v127
v_mfma_f32_16x16x32_bf16 v[68:71], v[232:235], v[188:191], v[68:71]
ds_read_b64_tr_b16 v[220:221], v243 offset:32768
v_add_f32 v253, v253, v255
v_mfma_f32_16x16x32_bf16 v[72:75], v[204:207], v[144:147], v[72:75]
ds_read_b64_tr_b16 v[222:223], v243 offset:34816
v_add_f32 v99, v99, v127
v_mfma_f32_16x16x32_bf16 v[72:75], v[208:211], v[156:159], v[72:75]
s_waitcnt lgkmcnt(2)
buffer_load_dwordx4 v[200:203], v244, s[24:27], s91 offen offset:2048 sc1
v_mfma_f32_16x16x32_bf16 v[72:75], v[212:215], v[168:171], v[72:75]
ds_read_b64_tr_b16 v[224:225], v243 offset:36864
v_cvt_pk_bf16_f32 v99, v253, v99
v_mfma_f32_16x16x32_bf16 v[72:75], v[216:219], v[180:183], v[72:75]
ds_read_b64_tr_b16 v[226:227], v243 offset:38912
v_mfma_f32_16x16x32_bf16 v[76:79], v[204:207], v[148:151], v[76:79]
ds_read_b64_tr_b16 v[228:229], v243 offset:40960
v_mfma_f32_16x16x32_bf16 v[76:79], v[208:211], v[160:163], v[76:79]
buffer_load_dwordx4 v[236:239], v244, s[24:27], s91 offen offset:3072 sc1
v_mfma_f32_16x16x32_bf16 v[76:79], v[212:215], v[172:175], v[76:79]
s_sub_u32 s100, s86, 1
ds_read_b64_tr_b16 v[230:231], v243 offset:43008
v_mfma_f32_16x16x32_bf16 v[76:79], v[216:219], v[184:187], v[76:79]
s_and_b32 s100, s100, s72
ds_read_b64_tr_b16 v[232:233], v243 offset:45056
v_mfma_f32_16x16x32_bf16 v[80:83], v[204:207], v[152:155], v[80:83]
s_mul_i32 s100, s100, 196608
ds_read_b64_tr_b16 v[234:235], v243 offset:47104
v_mfma_f32_16x16x32_bf16 v[80:83], v[208:211], v[164:167], v[80:83]
s_add_u32 s87, s68, s100
v_permlane32_swap_b32 v96, v98
v_mfma_f32_16x16x32_bf16 v[80:83], v[212:215], v[176:179], v[80:83]
s_waitcnt lgkmcnt(4)
v_permlane32_swap_b32 v97, v99
v_mfma_f32_16x16x32_bf16 v[80:83], v[216:219], v[188:191], v[80:83]
s_add_u32 s90, s69, s100
v_permlane16_swap_b32 v96, v98
v_mfma_f32_16x16x32_bf16 v[84:87], v[220:223], v[144:147], v[84:87]
s_waitcnt vmcnt(40) lgkmcnt(0)
v_permlane16_swap_b32 v97, v99
v_mfma_f32_16x16x32_bf16 v[84:87], v[224:227], v[156:159], v[84:87]
s_barrier
ds_read_b64_tr_b16 v[204:205], v241 offset:49152
v_mfma_f32_16x16x32_bf16 v[84:87], v[228:231], v[168:171], v[84:87]
s_add_u32 s91, s90, 0x1000
ds_read_b64_tr_b16 v[206:207], v241 offset:51200
v_mfma_f32_16x16x32_bf16 v[84:87], v[232:235], v[180:183], v[84:87]
s_add_u32 s88, s88, 256
ds_read_b64_tr_b16 v[208:209], v241 offset:53248
v_mfma_f32_16x16x32_bf16 v[88:91], v[220:223], v[148:151], v[88:91]
ds_read_b64_tr_b16 v[210:211], v241 offset:55296
v_mfma_f32_16x16x32_bf16 v[88:91], v[224:227], v[160:163], v[88:91]
ds_read_b64_tr_b16 v[212:213], v241 offset:57344
v_mfma_f32_16x16x32_bf16 v[88:91], v[228:231], v[172:175], v[88:91]
ds_read_b64_tr_b16 v[214:215], v241 offset:59392
v_mfma_f32_16x16x32_bf16 v[88:91], v[232:235], v[184:187], v[88:91]
buffer_store_dwordx4 v[96:99], v248, s[28:31], s92 offen
v_mfma_f32_16x16x32_bf16 v[92:95], v[220:223], v[152:155], v[92:95]
ds_read_b64_tr_b16 v[216:217], v241 offset:61440
v_mfma_f32_16x16x32_bf16 v[92:95], v[224:227], v[164:167], v[92:95]
ds_read_b64_tr_b16 v[218:219], v241 offset:63488
v_mfma_f32_16x16x32_bf16 v[92:95], v[228:231], v[176:179], v[92:95]
v_mfma_f32_16x16x32_bf16 v[92:95], v[232:235], v[188:191], v[92:95]
s_mov_b32 s40, s42
s_add_u32 s41, s40, 128
s_and_b32 s41, s41, 0x3ff
s_add_u32 s42, s41, 128
s_and_b32 s42, s42, 0x3ff
s_cmp_lt_u32 s86, 8
s_cbranch_scc1 L_G
s_add_u32 s92, s71, s39
s_add_u32 s39, s39, 128
s_and_b32 s39, s39, 0x3ff
s_add_u32 s86, s86, 1
s_nop 1
v_cvt_pk_bf16_f32 v48, v48, v49
v_cvt_pk_bf16_f32 v49, v50, v51
v_cvt_pk_bf16_f32 v50, v60, v61
v_cvt_pk_bf16_f32 v51, v62, v63
s_add_u32 s4, s87, 0
buffer_store_dwordx4 v[48:51], v244, s[24:27], s4 offen
v_cvt_pk_bf16_f32 v72, v72, v73
v_cvt_pk_bf16_f32 v73, v74, v75
v_cvt_pk_bf16_f32 v74, v84, v85
v_cvt_pk_bf16_f32 v75, v86, v87
s_add_u32 s5, s87, 8192
buffer_store_dwordx4 v[72:75], v244, s[24:27], s5 offen
v_cvt_pk_bf16_f32 v52, v52, v53
v_cvt_pk_bf16_f32 v53, v54, v55
v_cvt_pk_bf16_f32 v54, v64, v65
v_cvt_pk_bf16_f32 v55, v66, v67
s_add_u32 s4, s87, 16384
buffer_store_dwordx4 v[52:55], v244, s[24:27], s4 offen
v_cvt_pk_bf16_f32 v76, v76, v77
v_cvt_pk_bf16_f32 v77, v78, v79
v_cvt_pk_bf16_f32 v78, v88, v89
v_cvt_pk_bf16_f32 v79, v90, v91
s_add_u32 s5, s87, 24576
buffer_store_dwordx4 v[76:79], v244, s[24:27], s5 offen
v_cvt_pk_bf16_f32 v56, v56, v57
v_cvt_pk_bf16_f32 v57, v58, v59
v_cvt_pk_bf16_f32 v58, v68, v69
v_cvt_pk_bf16_f32 v59, v70, v71
s_add_u32 s4, s87, 32768
buffer_store_dwordx4 v[56:59], v244, s[24:27], s4 offen
v_cvt_pk_bf16_f32 v80, v80, v81
v_cvt_pk_bf16_f32 v81, v82, v83
v_cvt_pk_bf16_f32 v82, v92, v93
v_cvt_pk_bf16_f32 v83, v94, v95
s_add_u32 s5, s87, 40960
buffer_store_dwordx4 v[80:83], v244, s[24:27], s5 offen
s_waitcnt vmcnt(14)
v_mfma_f32_16x16x32_bf16 v[220:223], a[48:51], v[128:131], 0
v_mfma_f32_16x16x32_bf16 v[224:227], a[52:55], v[128:131], 0
s_waitcnt vmcnt(13)
v_mfma_f32_16x16x32_bf16 v[220:223], a[48:51], v[132:135], v[220:223]
v_mfma_f32_16x16x32_bf16 v[224:227], a[52:55], v[132:135], v[224:227]
s_waitcnt vmcnt(12)
v_mfma_f32_16x16x32_bf16 v[220:223], a[48:51], v[136:139], v[220:223]
v_mfma_f32_16x16x32_bf16 v[224:227], a[52:55], v[136:139], v[224:227]
s_waitcnt vmcnt(11)
v_mfma_f32_16x16x32_bf16 v[220:223], a[48:51], v[140:143], v[220:223]
v_mfma_f32_16x16x32_bf16 v[224:227], a[52:55], v[140:143], v[224:227]
s_waitcnt vmcnt(10)
v_mfma_f32_16x16x32_bf16 v[220:223], a[48:51], v[192:195], v[220:223]
v_mfma_f32_16x16x32_bf16 v[224:227], a[52:55], v[192:195], v[224:227]
s_waitcnt vmcnt(9)
v_mfma_f32_16x16x32_bf16 v[220:223], a[48:51], v[196:199], v[220:223]
v_mfma_f32_16x16x32_bf16 v[224:227], a[52:55], v[196:199], v[224:227]
s_waitcnt vmcnt(8)
v_mfma_f32_16x16x32_bf16 v[220:223], a[48:51], v[200:203], v[220:223]
v_mfma_f32_16x16x32_bf16 v[224:227], a[52:55], v[200:203], v[224:227]
s_waitcnt vmcnt(7)
v_mfma_f32_16x16x32_bf16 v[220:223], a[48:51], v[236:239], v[220:223]
v_mfma_f32_16x16x32_bf16 v[224:227], a[52:55], v[236:239], v[224:227]
s_nop 7
v_cvt_pk_bf16_f32 v232, v220, v221
v_cvt_pk_bf16_f32 v233, v222, v223
v_cvt_pk_bf16_f32 v234, v224, v225
v_cvt_pk_bf16_f32 v235, v226, v227
buffer_store_dwordx4 v[232:235], v248, s[28:31], s92 offen
s_waitcnt vmcnt(1)
s_barrier
buffer_store_dword v244, v245, s[24:27], s88 offen
s_branch L_spinU
L_backU:
buffer_load_dwordx4 v[96:99], v244, s[24:27], s90 offen offset:0 sc1
buffer_load_dwordx4 v[100:103], v244, s[24:27], s90 offen offset:1024 sc1
buffer_load_dwordx4 v[104:107], v244, s[24:27], s90 offen offset:2048 sc1
buffer_load_dwordx4 v[108:111], v244, s[24:27], s90 offen offset:3072 sc1
buffer_load_dwordx4 v[112:115], v244, s[24:27], s91 offen offset:0 sc1
buffer_load_dwordx4 v[116:119], v244, s[24:27], s91 offen offset:1024 sc1
buffer_load_dwordx4 v[120:123], v244, s[24:27], s91 offen offset:2048 sc1
buffer_load_dwordx4 v[124:127], v244, s[24:27], s91 offen offset:3072 sc1
s_add_u32 s92, s71, s39
s_waitcnt vmcnt(7)
v_mfma_f32_16x16x32_bf16 v[220:223], a[48:51], v[96:99], 0
v_mfma_f32_16x16x32_bf16 v[224:227], a[52:55], v[96:99], 0
s_waitcnt vmcnt(6)
v_mfma_f32_16x16x32_bf16 v[220:223], a[48:51], v[100:103], v[220:223]
v_mfma_f32_16x16x32_bf16 v[224:227], a[52:55], v[100:103], v[224:227]
s_waitcnt vmcnt(5)
v_mfma_f32_16x16x32_bf16 v[220:223], a[48:51], v[104:107], v[220:223]
v_mfma_f32_16x16x32_bf16 v[224:227], a[52:55], v[104:107], v[224:227]
s_waitcnt vmcnt(4)
v_mfma_f32_16x16x32_bf16 v[220:223], a[48:51], v[108:111], v[220:223]
v_mfma_f32_16x16x32_bf16 v[224:227], a[52:55], v[108:111], v[224:227]
s_waitcnt vmcnt(3)
v_mfma_f32_16x16x32_bf16 v[220:223], a[48:51], v[112:115], v[220:223]
v_mfma_f32_16x16x32_bf16 v[224:227], a[52:55], v[112:115], v[224:227]
s_waitcnt vmcnt(2)
v_mfma_f32_16x16x32_bf16 v[220:223], a[48:51], v[116:119], v[220:223]
v_mfma_f32_16x16x32_bf16 v[224:227], a[52:55], v[116:119], v[224:227]
s_waitcnt vmcnt(1)
v_mfma_f32_16x16x32_bf16 v[220:223], a[48:51], v[120:123], v[220:223]
v_mfma_f32_16x16x32_bf16 v[224:227], a[52:55], v[120:123], v[224:227]
s_waitcnt vmcnt(0)
v_mfma_f32_16x16x32_bf16 v[220:223], a[48:51], v[124:127], v[220:223]
v_mfma_f32_16x16x32_bf16 v[224:227], a[52:55], v[124:127], v[224:227]
s_nop 7
v_cvt_pk_bf16_f32 v228, v220, v221
v_cvt_pk_bf16_f32 v229, v222, v223
v_cvt_pk_bf16_f32 v230, v224, v225
v_cvt_pk_bf16_f32 v231, v226, v227
buffer_store_dwordx4 v[228:231], v248, s[28:31], s92 offen
s_endpgm
L_codeend:
L_spinG0:
s_mov_b32 s3, 0
L_spinG0_l:
buffer_load_dword v247, v240, s[24:27], s88 offen sc1
s_add_u32 s3, s3, 1
s_waitcnt vmcnt(0)
v_cmp_ne_u32 vcc, s89, v247
s_cmp_gt_u32 s3, 0x10000
s_cbranch_scc1 L_backG0
s_nop 2
s_cbranch_vccnz L_spinG0_l
s_branch L_backG0
L_spinG1:
s_mov_b32 s3, 0
L_spinG1_l:
buffer_load_dword v247, v240, s[24:27], s88 offen sc1
s_add_u32 s3, s3, 1
s_waitcnt vmcnt(0)
v_cmp_ne_u32 vcc, s89, v247
s_cmp_gt_u32 s3, 0x10000
s_cbranch_scc1 L_backG1
s_nop 2
s_cbranch_vccnz L_spinG1_l
s_branch L_backG1
L_spinG1F:
s_mov_b32 s3, 0
L_spinG1F_l:
buffer_load_dword v247, v240, s[24:27], s88 offen sc1
s_add_u32 s3, s3, 1
s_waitcnt vmcnt(0)
v_cmp_ne_u32 vcc, s89, v247
s_cmp_gt_u32 s3, 0x10000
s_cbranch_scc1 L_backG1F
s_nop 2
s_cbranch_vccnz L_spinG1F_l
s_branch L_backG1F
L_spinU:
s_mov_b32 s3, 0
L_spinU_l:
buffer_load_dword v247, v240, s[24:27], s88 offen sc1
s_add_u32 s3, s3, 1
s_waitcnt vmcnt(0)
v_cmp_ne_u32 vcc, s89, v247
s_cmp_gt_u32 s3, 0x10000
s_cbranch_scc1 L_backU
s_nop 2
s_cbranch_vccnz L_spinU_l
s_branch L_backU
L_G0S:
s_waitcnt lgkmcnt(4)
v_mfma_f32_16x16x32_bf16 v[0:3], v[204:207], a[144:147], 0
s_lshl_b32 s5, s65, 2
v_xor_b32 v243, 32, v241
v_mul_f32 v11, v251, v11
v_mfma_f32_16x16x32_bf16 v[0:3], v[208:211], a[156:159], v[0:3]
s_waitcnt lgkmcnt(0)
ds_read_b64_tr_b16 v[220:221], v243 offset:49152
v_cvt_pk_bf16_f32 v152, v8, v9
v_mfma_f32_16x16x32_bf16 v[0:3], v[212:215], a[168:171], v[0:3]
s_cmp_eq_u32 s63, 0
ds_read_b64_tr_b16 v[222:223], v243 offset:51200
v_cvt_pk_bf16_f32 v153, v10, v11
v_mfma_f32_16x16x32_bf16 v[0:3], v[216:219], a[180:183], v[0:3]
s_cselect_b32 s5, s5, 0x40000000
ds_read_b64_tr_b16 v[224:225], v243 offset:53248
v_mbcnt_lo_u32_b32 v254, -1, 0
v_mfma_f32_16x16x32_bf16 v[4:7], v[204:207], a[148:151], 0
s_mov_b32 s6, 0xffff0000
ds_read_b64_tr_b16 v[226:227], v243 offset:55296
v_mbcnt_hi_u32_b32 v254, -1, v254
v_mfma_f32_16x16x32_bf16 v[4:7], v[208:211], a[160:163], v[4:7]
s_mov_b32 s90, s69
ds_read_b64_tr_b16 v[228:229], v243 offset:57344
v_lshlrev_b32 v244, 4, v254
v_mfma_f32_16x16x32_bf16 v[4:7], v[212:215], a[172:175], v[4:7]
s_add_u32 s91, s90, 0x1000
ds_read_b64_tr_b16 v[230:231], v243 offset:59392
v_xor_b32 v242, 64, v241
v_mfma_f32_16x16x32_bf16 v[4:7], v[216:219], a[184:187], v[4:7]
s_mov_b32 s88, s70
ds_read_b64_tr_b16 v[232:233], v243 offset:61440
v_mul_f32 v20, v251, v20
v_mfma_f32_16x16x32_bf16 v[8:11], v[204:207], a[152:155], 0
s_mov_b32 s89, 16
ds_read_b64_tr_b16 v[234:235], v243 offset:63488
v_mul_f32 v21, v251, v21
v_mfma_f32_16x16x32_bf16 v[8:11], v[208:211], a[164:167], v[8:11]
s_nop 0
v_mfma_f32_16x16x32_bf16 v[8:11], v[212:215], a[176:179], v[8:11]
s_waitcnt lgkmcnt(4)
v_mul_f32 v22, v251, v22
v_mul_f32 v23, v251, v23
v_mfma_f32_16x16x32_bf16 v[8:11], v[216:219], a[188:191], v[8:11]
ds_read_b64_tr_b16 v[204:205], v242 offset:49152
v_cvt_pk_bf16_f32 v154, v20, v21
v_mfma_f32_16x16x32_bf16 v[12:15], v[220:223], a[144:147], 0
ds_read_b64_tr_b16 v[206:207], v242 offset:51200
v_cvt_pk_bf16_f32 v155, v22, v23
v_mfma_f32_16x16x32_bf16 v[12:15], v[224:227], a[156:159], v[12:15]
s_waitcnt lgkmcnt(2)
ds_read_b64_tr_b16 v[208:209], v242 offset:53248
v_mul_f32 v24, v249, v24
v_mfma_f32_16x16x32_bf16 v[12:15], v[228:231], a[168:171], v[12:15]
s_nop 0
v_mfma_f32_16x16x32_bf16 v[12:15], v[232:235], a[180:183], v[12:15]
ds_read_b64_tr_b16 v[210:211], v242 offset:55296
v_mul_f32 v25, v249, v25
v_mfma_f32_16x16x32_bf16 v[16:19], v[220:223], a[148:151], 0
ds_read_b64_tr_b16 v[212:213], v242 offset:57344
v_mul_f32 v26, v249, v26
v_mfma_f32_16x16x32_bf16 v[16:19], v[224:227], a[160:163], v[16:19]
ds_read_b64_tr_b16 v[214:215], v242 offset:59392
v_mul_f32 v27, v249, v27
v_mfma_f32_16x16x32_bf16 v[16:19], v[228:231], a[172:175], v[16:19]
s_nop 0
v_mfma_f32_16x16x32_bf16 v[16:19], v[232:235], a[184:187], v[16:19]
ds_read_b64_tr_b16 v[216:217], v242 offset:61440
v_cvt_pk_bf16_f32 v156, v24, v25
v_mfma_f32_16x16x32_bf16 v[20:23], v[220:223], a[152:155], 0
ds_read_b64_tr_b16 v[218:219], v242 offset:63488
v_cvt_pk_bf16_f32 v157, v26, v27
v_mfma_f32_16x16x32_bf16 v[20:23], v[224:227], a[164:167], v[20:23]
v_xor_b32 v243, 96, v241
v_mul_f32 v28, v250, v28
v_mfma_f32_16x16x32_bf16 v[20:23], v[228:231], a[176:179], v[20:23]
s_waitcnt lgkmcnt(4)
s_nop 0
v_mfma_f32_16x16x32_bf16 v[20:23], v[232:235], a[188:191], v[20:23]
ds_read_b64_tr_b16 v[220:221], v243 offset:49152
v_mul_f32 v29, v250, v29
v_mfma_f32_16x16x32_bf16 v[24:27], v[204:207], a[144:147], 0
ds_read_b64_tr_b16 v[222:223], v243 offset:51200
v_mul_f32 v30, v250, v30
v_mfma_f32_16x16x32_bf16 v[24:27], v[208:211], a[156:159], v[24:27]
s_waitcnt lgkmcnt(2)
ds_read_b64_tr_b16 v[224:225], v243 offset:53248
v_mul_f32 v31, v250, v31
v_mfma_f32_16x16x32_bf16 v[24:27], v[212:215], a[168:171], v[24:27]
v_cvt_pk_bf16_f32 v160, v28, v29
v_cvt_pk_bf16_f32 v161, v30, v31
v_mfma_f32_16x16x32_bf16 v[24:27], v[216:219], a[180:183], v[24:27]
s_nop 0
ds_read_b64_tr_b16 v[226:227], v243 offset:55296
v_mfma_f32_16x16x32_bf16 v[28:31], v[204:207], a[148:151], 0
s_add_u32 s56, s40, s96
ds_read_b64_tr_b16 v[228:229], v243 offset:57344
v_mul_f32 v32, v251, v32
v_mfma_f32_16x16x32_bf16 v[28:31], v[208:211], a[160:163], v[28:31]
s_add_u32 s57, s56, s50
ds_read_b64_tr_b16 v[230:231], v243 offset:59392
v_mul_f32 v33, v251, v33
v_mfma_f32_16x16x32_bf16 v[28:31], v[212:215], a[172:175], v[28:31]
s_add_u32 s58, s56, s51
v_mul_f32 v34, v251, v34
v_mul_f32 v35, v251, v35
v_mfma_f32_16x16x32_bf16 v[28:31], v[216:219], a[184:187], v[28:31]
s_add_u32 s59, s56, s52
s_nop 0
ds_read_b64_tr_b16 v[232:233], v243 offset:61440
v_cvt_pk_bf16_f32 v164, v32, v33
v_cvt_pk_bf16_f32 v165, v34, v35
v_mfma_f32_16x16x32_bf16 v[32:35], v[204:207], a[152:155], 0
ds_read_b64_tr_b16 v[234:235], v243 offset:63488
v_add_u32 v241, 0x10000, v241
v_mfma_f32_16x16x32_bf16 v[32:35], v[208:211], a[164:167], v[32:35]
v_mul_f32 v36, v249, v36
v_mul_f32 v37, v249, v37
v_mfma_f32_16x16x32_bf16 v[32:35], v[212:215], a[176:179], v[32:35]
s_waitcnt lgkmcnt(4)
v_mul_f32 v38, v249, v38
v_mul_f32 v39, v249, v39
v_mfma_f32_16x16x32_bf16 v[32:35], v[216:219], a[188:191], v[32:35]
s_add_u32 m0, s60, 147456
s_nop 0
v_cvt_pk_bf16_f32 v158, v36, v37
v_cvt_pk_bf16_f32 v159, v38, v39
v_mfma_f32_16x16x32_bf16 v[36:39], v[220:223], a[144:147], 0
ds_read_b64_tr_b16 v[204:205], v241 offset:16384
v_mul_f32 v40, v250, v40
v_mfma_f32_16x16x32_bf16 v[36:39], v[224:227], a[156:159], v[36:39]
s_waitcnt lgkmcnt(1)
ds_read_b64_tr_b16 v[206:207], v241 offset:18432
v_mul_f32 v41, v250, v41
v_mfma_f32_16x16x32_bf16 v[36:39], v[228:231], a[168:171], v[36:39]
ds_read_b64_tr_b16 v[208:209], v241 offset:20480
v_mul_f32 v42, v250, v42
v_mfma_f32_16x16x32_bf16 v[36:39], v[232:235], a[180:183], v[36:39]
s_nop 0
ds_read_b64_tr_b16 v[210:211], v241 offset:22528
v_mul_f32 v43, v250, v43
v_cvt_pk_bf16_f32 v162, v40, v41
v_cvt_pk_bf16_f32 v163, v42, v43
v_mfma_f32_16x16x32_bf16 v[40:43], v[220:223], a[148:151], 0
s_add_u32 s90, s90, 196608
ds_read_b64_tr_b16 v[212:213], v241 offset:24576
v_mul_f32 v44, v251, v44
v_mfma_f32_16x16x32_bf16 v[40:43], v[224:227], a[160:163], v[40:43]
s_add_u32 s91, s90, 0x1000
ds_read_b64_tr_b16 v[214:215], v241 offset:26624
v_mul_f32 v45, v251, v45
v_mfma_f32_16x16x32_bf16 v[40:43], v[228:231], a[172:175], v[40:43]
v_mul_f32 v46, v251, v46
v_mul_f32 v47, v251, v47
v_mfma_f32_16x16x32_bf16 v[40:43], v[232:235], a[184:187], v[40:43]
ds_read_b64_tr_b16 v[216:217], v241 offset:28672
v_cvt_pk_bf16_f32 v166, v44, v45
v_cvt_pk_bf16_f32 v167, v46, v47
v_mfma_f32_16x16x32_bf16 v[44:47], v[220:223], a[152:155], 0
ds_read_b64_tr_b16 v[218:219], v241 offset:30720
buffer_load_dwordx4 v246, s[16:19], s56 offen offset:0 lds
v_mfma_f32_16x16x32_bf16 v[44:47], v[224:227], a[164:167], v[44:47]
v_xor_b32 v243, 32, v241
v_and_b32 v240, 7, v254
v_mfma_f32_16x16x32_bf16 v[44:47], v[228:231], a[176:179], v[44:47]
s_waitcnt lgkmcnt(4)
v_lshlrev_b32 v240, 2, v240
v_lshrrev_b32 v255, 4, v254
v_mfma_f32_16x16x32_bf16 v[44:47], v[232:235], a[188:191], v[44:47]
ds_read_b64_tr_b16 v[220:221], v243 offset:16384
v_bfe_u32 v248, v254, 2, 2
v_mfma_f32_16x16x32_bf16 v[0:3], v[204:207], a[192:195], v[0:3]
ds_read_b64_tr_b16 v[222:223], v243 offset:18432
v_and_b32 v254, 3, v254
v_mfma_f32_16x16x32_bf16 v[0:3], v[208:211], a[204:207], v[0:3]
s_waitcnt lgkmcnt(2)
buffer_load_dwordx4 v246, s[16:19], s57 offen offset:1024 lds
v_mfma_f32_16x16x32_bf16 v[0:3], v[212:215], a[216:219], v[0:3]
ds_read_b64_tr_b16 v[224:225], v243 offset:20480
v_lshl_add_u32 v254, v248, 4, v254
v_mfma_f32_16x16x32_bf16 v[0:3], v[216:219], a[228:231], v[0:3]
ds_read_b64_tr_b16 v[226:227], v243 offset:22528
v_xor_b32 v242, 64, v241
v_mfma_f32_16x16x32_bf16 v[4:7], v[204:207], a[196:199], v[4:7]
ds_read_b64_tr_b16 v[228:229], v243 offset:24576
v_lshlrev_b32 v254, 10, v254
v_mfma_f32_16x16x32_bf16 v[4:7], v[208:211], a[208:211], v[4:7]
ds_read_b64_tr_b16 v[230:231], v243 offset:26624
v_lshl_add_u32 v248, v255, 4, v254
v_mfma_f32_16x16x32_bf16 v[4:7], v[212:215], a[220:223], v[4:7]
buffer_load_dwordx4 v246, s[16:19], s58 offen offset:2048 lds
v_mfma_f32_16x16x32_bf16 v[4:7], v[216:219], a[232:235], v[4:7]
ds_read_b64_tr_b16 v[232:233], v243 offset:28672
v_mov_b32 v245, 0x40000000
v_mfma_f32_16x16x32_bf16 v[8:11], v[204:207], a[200:203], v[8:11]
ds_read_b64_tr_b16 v[234:235], v243 offset:30720
v_writelane_b32 v245, s5, 1
v_mfma_f32_16x16x32_bf16 v[8:11], v[208:211], a[212:215], v[8:11]
v_mul_f32 v48, v249, v48
v_mul_f32 v49, v249, v49
v_mfma_f32_16x16x32_bf16 v[8:11], v[212:215], a[224:227], v[8:11]
s_waitcnt lgkmcnt(4)
buffer_load_dwordx4 v246, s[16:19], s59 offen offset:3072 lds
v_mfma_f32_16x16x32_bf16 v[8:11], v[216:219], a[236:239], v[8:11]
s_add_u32 m0, s60, 32768
ds_read_b64_tr_b16 v[204:205], v242 offset:16384
v_mul_f32 v50, v249, v50
v_mfma_f32_16x16x32_bf16 v[12:15], v[220:223], a[192:195], v[12:15]
s_add_u32 s56, s40, s97
ds_read_b64_tr_b16 v[206:207], v242 offset:18432
v_mul_f32 v51, v249, v51
v_mfma_f32_16x16x32_bf16 v[12:15], v[224:227], a[204:207], v[12:15]
s_waitcnt lgkmcnt(2)
ds_read_b64_tr_b16 v[208:209], v242 offset:20480
v_cvt_pk_bf16_f32 v168, v48, v49
v_mfma_f32_16x16x32_bf16 v[12:15], v[228:231], a[216:219], v[12:15]
s_add_u32 s57, s56, s50
ds_read_b64_tr_b16 v[210:211], v242 offset:22528
v_cvt_pk_bf16_f32 v169, v50, v51
v_mfma_f32_16x16x32_bf16 v[12:15], v[232:235], a[228:231], v[12:15]
s_add_u32 s58, s56, s51
ds_read_b64_tr_b16 v[212:213], v242 offset:24576
v_xor_b32 v243, 96, v241
v_mfma_f32_16x16x32_bf16 v[16:19], v[220:223], a[196:199], v[16:19]
s_add_u32 s59, s56, s52
buffer_load_dwordx4 v246, s[16:19], s56 offen offset:0 lds
v_mfma_f32_16x16x32_bf16 v[16:19], v[224:227], a[208:211], v[16:19]
ds_read_b64_tr_b16 v[214:215], v242 offset:26624
v_mul_f32 v60, v249, v60
v_mfma_f32_16x16x32_bf16 v[16:19], v[228:231], a[220:223], v[16:19]
ds_read_b64_tr_b16 v[216:217], v242 offset:28672
v_mul_f32 v61, v249, v61
v_mfma_f32_16x16x32_bf16 v[16:19], v[232:235], a[232:235], v[16:19]
ds_read_b64_tr_b16 v[218:219], v242 offset:30720
v_mul_f32 v62, v249, v62
v_mfma_f32_16x16x32_bf16 v[20:23], v[220:223], a[200:203], v[20:23]
buffer_load_dwordx4 v246, s[16:19], s57 offen offset:1024 lds
v_mfma_f32_16x16x32_bf16 v[20:23], v[224:227], a[212:215], v[20:23]
v_mul_f32 v63, v249, v63
v_cvt_pk_bf16_f32 v170, v60, v61
v_mfma_f32_16x16x32_bf16 v[20:23], v[228:231], a[224:227], v[20:23]
s_waitcnt lgkmcnt(4)
v_cvt_pk_bf16_f32 v171, v62, v63
v_mul_f32 v72, v249, v72
v_mfma_f32_16x16x32_bf16 v[20:23], v[232:235], a[236:239], v[20:23]
ds_read_b64_tr_b16 v[220:221], v243 offset:16384
v_mul_f32 v73, v249, v73
v_mfma_f32_16x16x32_bf16 v[24:27], v[204:207], a[192:195], v[24:27]
ds_read_b64_tr_b16 v[222:223], v243 offset:18432
v_mul_f32 v74, v249, v74
v_mfma_f32_16x16x32_bf16 v[24:27], v[208:211], a[204:207], v[24:27]
s_waitcnt lgkmcnt(2)
ds_read_b64_tr_b16 v[224:225], v243 offset:20480
v_mul_f32 v75, v249, v75
v_mfma_f32_16x16x32_bf16 v[24:27], v[212:215], a[216:219], v[24:27]
ds_read_b64_tr_b16 v[226:227], v243 offset:22528
v_cvt_pk_bf16_f32 v180, v72, v73
v_mfma_f32_16x16x32_bf16 v[24:27], v[216:219], a[228:231], v[24:27]
buffer_load_dwordx4 v246, s[16:19], s58 offen offset:2048 lds
v_mfma_f32_16x16x32_bf16 v[28:31], v[204:207], a[196:199], v[28:31]
ds_read_b64_tr_b16 v[228:229], v243 offset:24576
v_cvt_pk_bf16_f32 v181, v74, v75
v_mfma_f32_16x16x32_bf16 v[28:31], v[208:211], a[208:211], v[28:31]
ds_read_b64_tr_b16 v[230:231], v243 offset:26624
v_mul_f32 v84, v249, v84
v_mfma_f32_16x16x32_bf16 v[28:31], v[212:215], a[220:223], v[28:31]
ds_read_b64_tr_b16 v[232:233], v243 offset:28672
v_mul_f32 v85, v249, v85
v_mfma_f32_16x16x32_bf16 v[28:31], v[216:219], a[232:235], v[28:31]
ds_read_b64_tr_b16 v[234:235], v243 offset:30720
v_mul_f32 v86, v249, v86
v_mfma_f32_16x16x32_bf16 v[32:35], v[204:207], a[200:203], v[32:35]
buffer_load_dwordx4 v246, s[16:19], s59 offen offset:3072 lds
v_mfma_f32_16x16x32_bf16 v[32:35], v[208:211], a[212:215], v[32:35]
s_add_u32 m0, s60, 49152
v_mul_f32 v87, v249, v87
v_cvt_pk_bf16_f32 v182, v84, v85
v_mfma_f32_16x16x32_bf16 v[32:35], v[212:215], a[224:227], v[32:35]
s_waitcnt lgkmcnt(4)
v_cvt_pk_bf16_f32 v183, v86, v87
v_mul_f32 v52, v250, v52
v_mfma_f32_16x16x32_bf16 v[32:35], v[216:219], a[236:239], v[32:35]
s_add_u32 s56, s41, s93
v_mul_f32 v53, v250, v53
v_mul_f32 v54, v250, v54
v_mfma_f32_16x16x32_bf16 v[36:39], v[220:223], a[192:195], v[36:39]
s_waitcnt vmcnt(34) lgkmcnt(0)
v_mul_f32 v55, v250, v55
v_cvt_pk_bf16_f32 v172, v52, v53
v_mfma_f32_16x16x32_bf16 v[36:39], v[224:227], a[204:207], v[36:39]
s_barrier
ds_read_b64_tr_b16 v[204:205], v241 offset:49152
v_cvt_pk_bf16_f32 v173, v54, v55
v_mfma_f32_16x16x32_bf16 v[36:39], v[228:231], a[216:219], v[36:39]
s_add_u32 s57, s56, s50
ds_read_b64_tr_b16 v[206:207], v241 offset:51200
v_mul_f32 v64, v250, v64
v_mfma_f32_16x16x32_bf16 v[36:39], v[232:235], a[228:231], v[36:39]
s_add_u32 s58, s56, s51
ds_read_b64_tr_b16 v[208:209], v241 offset:53248
v_xor_b32 v243, 32, v241
v_mfma_f32_16x16x32_bf16 v[40:43], v[220:223], a[196:199], v[40:43]
s_add_u32 s59, s56, s52
ds_read_b64_tr_b16 v[210:211], v241 offset:55296
v_mul_f32 v65, v250, v65
v_mfma_f32_16x16x32_bf16 v[40:43], v[224:227], a[208:211], v[40:43]
buffer_load_dwordx4 v246, s[16:19], s56 offen offset:0 lds
v_mfma_f32_16x16x32_bf16 v[40:43], v[228:231], a[220:223], v[40:43]
ds_read_b64_tr_b16 v[212:213], v241 offset:57344
v_mul_f32 v66, v250, v66
v_mfma_f32_16x16x32_bf16 v[40:43], v[232:235], a[232:235], v[40:43]
ds_read_b64_tr_b16 v[214:215], v241 offset:59392
v_mul_f32 v67, v250, v67
v_mfma_f32_16x16x32_bf16 v[44:47], v[220:223], a[200:203], v[44:47]
ds_read_b64_tr_b16 v[216:217], v241 offset:61440
v_cvt_pk_bf16_f32 v174, v64, v65
v_mfma_f32_16x16x32_bf16 v[44:47], v[224:227], a[212:215], v[44:47]
ds_read_b64_tr_b16 v[218:219], v241 offset:63488
v_cvt_pk_bf16_f32 v175, v66, v67
v_mfma_f32_16x16x32_bf16 v[44:47], v[228:231], a[224:227], v[44:47]
s_waitcnt lgkmcnt(4)
buffer_load_dwordx4 v246, s[16:19], s57 offen offset:1024 lds
v_mfma_f32_16x16x32_bf16 v[44:47], v[232:235], a[236:239], v[44:47]
ds_read_b64_tr_b16 v[220:221], v243 offset:49152
v_mul_f32 v76, v250, v76
v_mfma_f32_16x16x32_bf16 v[0:3], v[204:207], a[0:3], v[0:3]
ds_read_b64_tr_b16 v[222:223], v243 offset:51200
v_mul_f32 v77, v250, v77
v_mfma_f32_16x16x32_bf16 v[0:3], v[208:211], a[12:15], v[0:3]
s_waitcnt lgkmcnt(2)
ds_read_b64_tr_b16 v[224:225], v243 offset:53248
v_mul_f32 v78, v250, v78
v_mfma_f32_16x16x32_bf16 v[0:3], v[212:215], a[24:27], v[0:3]
ds_read_b64_tr_b16 v[226:227], v243 offset:55296
v_mul_f32 v79, v250, v79
v_mfma_f32_16x16x32_bf16 v[0:3], v[216:219], a[36:39], v[0:3]
buffer_load_dwordx4 v246, s[16:19], s58 offen offset:2048 lds
v_mfma_f32_16x16x32_bf16 v[4:7], v[204:207], a[4:7], v[4:7]
ds_read_b64_tr_b16 v[228:229], v243 offset:57344
v_xor_b32 v242, 64, v241
v_mfma_f32_16x16x32_bf16 v[4:7], v[208:211], a[16:19], v[4:7]
ds_read_b64_tr_b16 v[230:231], v243 offset:59392
v_cvt_pk_bf16_f32 v184, v76, v77
v_mfma_f32_16x16x32_bf16 v[4:7], v[212:215], a[28:31], v[4:7]
ds_read_b64_tr_b16 v[232:233], v243 offset:61440
v_cvt_pk_bf16_f32 v185, v78, v79
v_mfma_f32_16x16x32_bf16 v[4:7], v[216:219], a[40:43], v[4:7]
ds_read_b64_tr_b16 v[234:235], v243 offset:63488
v_mul_f32 v88, v250, v88
v_mfma_f32_16x16x32_bf16 v[8:11], v[204:207], a[8:11], v[8:11]
buffer_load_dwordx4 v246, s[16:19], s59 offen offset:3072 lds
v_mfma_f32_16x16x32_bf16 v[8:11], v[208:211], a[20:23], v[8:11]
s_add_u32 m0, s60, 81920
v_mul_f32 v89, v250, v89
v_mul_f32 v90, v250, v90
v_mfma_f32_16x16x32_bf16 v[8:11], v[212:215], a[32:35], v[8:11]
s_waitcnt lgkmcnt(4)
v_mul_f32 v91, v250, v91
v_cvt_pk_bf16_f32 v186, v88, v89
v_mfma_f32_16x16x32_bf16 v[8:11], v[216:219], a[44:47], v[8:11]
s_add_u32 s56, s41, s95
ds_read_b64_tr_b16 v[204:205], v242 offset:49152
v_cvt_pk_bf16_f32 v187, v90, v91
v_mfma_f32_16x16x32_bf16 v[12:15], v[220:223], a[0:3], v[12:15]
s_add_u32 s57, s56, s50
ds_read_b64_tr_b16 v[206:207], v242 offset:51200
v_mul_f32 v56, v251, v56
v_mfma_f32_16x16x32_bf16 v[12:15], v[224:227], a[12:15], v[12:15]
s_waitcnt lgkmcnt(2)
ds_read_b64_tr_b16 v[208:209], v242 offset:53248
v_mul_f32 v57, v251, v57
v_mfma_f32_16x16x32_bf16 v[12:15], v[228:231], a[24:27], v[12:15]
s_add_u32 s58, s56, s51
ds_read_b64_tr_b16 v[210:211], v242 offset:55296
v_mul_f32 v58, v251, v58
v_mfma_f32_16x16x32_bf16 v[12:15], v[232:235], a[36:39], v[12:15]
s_add_u32 s59, s56, s52
buffer_load_dwordx4 v246, s[16:19], s56 offen offset:0 lds
v_mfma_f32_16x16x32_bf16 v[16:19], v[220:223], a[4:7], v[16:19]
ds_read_b64_tr_b16 v[212:213], v242 offset:57344
v_xor_b32 v243, 96, v241
v_mfma_f32_16x16x32_bf16 v[16:19], v[224:227], a[16:19], v[16:19]
ds_read_b64_tr_b16 v[214:215], v242 offset:59392
v_mul_f32 v59, v251, v59
v_mfma_f32_16x16x32_bf16 v[16:19], v[228:231], a[28:31], v[16:19]
ds_read_b64_tr_b16 v[216:217], v242 offset:61440
v_cvt_pk_bf16_f32 v176, v56, v57
v_mfma_f32_16x16x32_bf16 v[16:19], v[232:235], a[40:43], v[16:19]
ds_read_b64_tr_b16 v[218:219], v242 offset:63488
v_cvt_pk_bf16_f32 v177, v58, v59
v_mfma_f32_16x16x32_bf16 v[20:23], v[220:223], a[8:11], v[20:23]
buffer_load_dwordx4 v246, s[16:19], s57 offen offset:1024 lds
v_mfma_f32_16x16x32_bf16 v[20:23], v[224:227], a[20:23], v[20:23]
v_mul_f32 v68, v251, v68
v_mul_f32 v69, v251, v69
v_mfma_f32_16x16x32_bf16 v[20:23], v[228:231], a[32:35], v[20:23]
s_waitcnt lgkmcnt(4)
v_mul_f32 v70, v251, v70
v_mul_f32 v71, v251, v71
v_mfma_f32_16x16x32_bf16 v[20:23], v[232:235], a[44:47], v[20:23]
ds_read_b64_tr_b16 v[220:221], v243 offset:49152
v_cvt_pk_bf16_f32 v178, v68, v69
v_mfma_f32_16x16x32_bf16 v[24:27], v[204:207], a[0:3], v[24:27]
ds_read_b64_tr_b16 v[222:223], v243 offset:51200
v_cvt_pk_bf16_f32 v179, v70, v71
v_mfma_f32_16x16x32_bf16 v[24:27], v[208:211], a[12:15], v[24:27]
s_waitcnt lgkmcnt(2)
buffer_load_dwordx4 v246, s[16:19], s58 offen offset:2048 lds
v_mfma_f32_16x16x32_bf16 v[24:27], v[212:215], a[24:27], v[24:27]
ds_read_b64_tr_b16 v[224:225], v243 offset:53248
v_mul_f32 v80, v251, v80
v_mfma_f32_16x16x32_bf16 v[24:27], v[216:219], a[36:39], v[24:27]
ds_read_b64_tr_b16 v[226:227], v243 offset:55296
v_mul_f32 v81, v251, v81
v_mfma_f32_16x16x32_bf16 v[28:31], v[204:207], a[4:7], v[28:31]
ds_read_b64_tr_b16 v[228:229], v243 offset:57344
v_mul_f32 v82, v251, v82
v_mfma_f32_16x16x32_bf16 v[28:31], v[208:211], a[16:19], v[28:31]
ds_read_b64_tr_b16 v[230:231], v243 offset:59392
v_mul_f32 v83, v251, v83
v_mfma_f32_16x16x32_bf16 v[28:31], v[212:215], a[28:31], v[28:31]
buffer_load_dwordx4 v246, s[16:19], s59 offen offset:3072 lds
v_mfma_f32_16x16x32_bf16 v[28:31], v[216:219], a[40:43], v[28:31]
s_nop 0
ds_read_b64_tr_b16 v[232:233], v243 offset:61440
v_mfma_f32_16x16x32_bf16 v[32:35], v[204:207], a[8:11], v[32:35]
ds_read_b64_tr_b16 v[234:235], v243 offset:63488
v_cvt_pk_bf16_f32 v188, v80, v81
v_mfma_f32_16x16x32_bf16 v[32:35], v[208:211], a[20:23], v[32:35]
v_cvt_pk_bf16_f32 v189, v82, v83
v_mul_f32 v92, v251, v92
v_mfma_f32_16x16x32_bf16 v[32:35], v[212:215], a[32:35], v[32:35]
s_waitcnt lgkmcnt(4)
v_mul_f32 v93, v251, v93
v_mul_f32 v94, v251, v94
v_mfma_f32_16x16x32_bf16 v[32:35], v[216:219], a[44:47], v[32:35]
s_nop 0
v_mfma_f32_16x16x32_bf16 v[36:39], v[220:223], a[0:3], v[36:39]
ds_read_b64_tr_b16 v[204:205], v241 offset:0
v_mul_f32 v95, v251, v95
v_mfma_f32_16x16x32_bf16 v[36:39], v[224:227], a[12:15], v[36:39]
s_waitcnt lgkmcnt(1)
ds_read_b64_tr_b16 v[206:207], v241 offset:2048
v_cvt_pk_bf16_f32 v190, v92, v93
v_mfma_f32_16x16x32_bf16 v[36:39], v[228:231], a[24:27], v[36:39]
ds_read_b64_tr_b16 v[208:209], v241 offset:4096
v_cvt_pk_bf16_f32 v191, v94, v95
v_mfma_f32_16x16x32_bf16 v[36:39], v[232:235], a[36:39], v[36:39]
s_nop 0
ds_read_b64_tr_b16 v[210:211], v241 offset:6144
v_mfma_f32_16x16x32_bf16 v[40:43], v[220:223], a[4:7], v[40:43]
ds_read_b64_tr_b16 v[212:213], v241 offset:8192
v_xor_b32 v243, 32, v241
v_mfma_f32_16x16x32_bf16 v[40:43], v[224:227], a[16:19], v[40:43]
ds_read_b64_tr_b16 v[214:215], v241 offset:10240
v_mfma_f32_16x16x32_bf16 v[40:43], v[228:231], a[28:31], v[40:43]
ds_read_b64_tr_b16 v[216:217], v241 offset:12288
v_mfma_f32_16x16x32_bf16 v[40:43], v[232:235], a[40:43], v[40:43]
s_nop 0
v_mfma_f32_16x16x32_bf16 v[44:47], v[220:223], a[8:11], v[44:47]
ds_read_b64_tr_b16 v[218:219], v241 offset:14336
v_mfma_f32_16x16x32_bf16 v[44:47], v[224:227], a[20:23], v[44:47]
v_mfma_f32_16x16x32_bf16 v[44:47], v[228:231], a[32:35], v[44:47]
s_waitcnt lgkmcnt(4)
v_mfma_f32_16x16x32_bf16 v[44:47], v[232:235], a[44:47], v[44:47]
s_nop 0
v_mfma_f32_16x16x32_bf16 v[0:3], v[204:207], v[144:147], v[0:3]
ds_read_b64_tr_b16 v[220:221], v243 offset:0
v_mfma_f32_16x16x32_bf16 v[0:3], v[208:211], v[156:159], v[0:3]
s_waitcnt lgkmcnt(1)
ds_read_b64_tr_b16 v[222:223], v243 offset:2048
v_mfma_f32_16x16x32_bf16 v[0:3], v[212:215], v[168:171], v[0:3]
ds_read_b64_tr_b16 v[224:225], v243 offset:4096
v_mfma_f32_16x16x32_bf16 v[0:3], v[216:219], v[180:183], v[0:3]
s_nop 0
ds_read_b64_tr_b16 v[226:227], v243 offset:6144
v_mfma_f32_16x16x32_bf16 v[4:7], v[204:207], v[148:151], v[4:7]
ds_read_b64_tr_b16 v[228:229], v243 offset:8192
v_xor_b32 v242, 64, v241
v_mfma_f32_16x16x32_bf16 v[4:7], v[208:211], v[160:163], v[4:7]
ds_read_b64_tr_b16 v[230:231], v243 offset:10240
v_mfma_f32_16x16x32_bf16 v[4:7], v[212:215], v[172:175], v[4:7]
ds_read_b64_tr_b16 v[232:233], v243 offset:12288
v_mfma_f32_16x16x32_bf16 v[4:7], v[216:219], v[184:187], v[4:7]
s_nop 0
v_mfma_f32_16x16x32_bf16 v[8:11], v[204:207], v[152:155], v[8:11]
ds_read_b64_tr_b16 v[234:235], v243 offset:14336
v_lshrrev_b32 v48, 4, v244
v_mfma_f32_16x16x32_bf16 v[8:11], v[208:211], v[164:167], v[8:11]
v_lshrrev_b32 v49, 4, v48
v_and_b32 v50, 1, v48
v_mfma_f32_16x16x32_bf16 v[8:11], v[212:215], v[176:179], v[8:11]
s_waitcnt lgkmcnt(4)
v_lshlrev_b32 v50, 4, v50
v_mov_b32 v51, 0x3f80
v_mfma_f32_16x16x32_bf16 v[8:11], v[216:219], v[188:191], v[8:11]
s_nop 0
v_mfma_f32_16x16x32_bf16 v[12:15], v[220:223], v[144:147], v[12:15]
s_mov_b32 s86, 1
ds_read_b64_tr_b16 v[204:205], v242 offset:0
v_lshlrev_b32 v50, v50, v51
v_mfma_f32_16x16x32_bf16 v[12:15], v[224:227], v[156:159], v[12:15]
s_waitcnt lgkmcnt(1)
ds_read_b64_tr_b16 v[206:207], v242 offset:2048
v_bfe_u32 v51, v48, 1, 1
v_mfma_f32_16x16x32_bf16 v[12:15], v[228:231], v[168:171], v[12:15]
s_sub_u32 s100, s86, 1
ds_read_b64_tr_b16 v[208:209], v242 offset:4096
v_bfe_u32 v52, v48, 3, 1
v_mfma_f32_16x16x32_bf16 v[12:15], v[232:235], v[180:183], v[12:15]
s_and_b32 s100, s100, s72
ds_read_b64_tr_b16 v[210:211], v242 offset:6144
v_xor_b32 v243, 96, v241
v_mfma_f32_16x16x32_bf16 v[16:19], v[220:223], v[148:151], v[16:19]
s_mul_i32 s100, s100, 196608
ds_read_b64_tr_b16 v[212:213], v242 offset:8192
v_lshl_add_u32 v51, v52, 1, v51
v_mfma_f32_16x16x32_bf16 v[16:19], v[224:227], v[160:163], v[16:19]
s_add_u32 s87, s68, s100
ds_read_b64_tr_b16 v[214:215], v242 offset:10240
v_bfe_u32 v52, v48, 2, 1
v_mfma_f32_16x16x32_bf16 v[16:19], v[228:231], v[172:175], v[16:19]
s_add_u32 s90, s69, s100
ds_read_b64_tr_b16 v[216:217], v242 offset:12288
v_lshlrev_b32 v52, 1, v52
v_mfma_f32_16x16x32_bf16 v[16:19], v[232:235], v[184:187], v[16:19]
s_add_u32 s91, s90, 0x1000
ds_read_b64_tr_b16 v[218:219], v242 offset:14336
v_add_u32 v53, 1, v52
v_mfma_f32_16x16x32_bf16 v[20:23], v[220:223], v[152:155], v[20:23]
s_add_u32 s88, s88, 256
v_cmp_eq_u32 vcc, v49, v52
v_cmp_eq_u32 s[84:85], v49, v53
v_mfma_f32_16x16x32_bf16 v[20:23], v[224:227], v[164:167], v[20:23]
s_add_u32 s4, s87, 0
v_add_u32 v241, 0xffff0000, v241
v_cndmask_b32 v54, 0, v50, vcc
v_mfma_f32_16x16x32_bf16 v[20:23], v[228:231], v[176:179], v[20:23]
s_waitcnt lgkmcnt(4)
v_cndmask_b32 v55, 0, v50, s[84:85]
v_cmp_eq_u32 vcc, 0, v51
v_mfma_f32_16x16x32_bf16 v[20:23], v[232:235], v[188:191], v[20:23]
s_add_u32 s5, s87, 8192
ds_read_b64_tr_b16 v[220:221], v243 offset:0
v_cndmask_b32 v48, 0, v54, vcc
v_mfma_f32_16x16x32_bf16 v[24:27], v[204:207], v[144:147], v[24:27]
ds_read_b64_tr_b16 v[222:223], v243 offset:2048
v_cndmask_b32 v49, 0, v55, vcc
v_mfma_f32_16x16x32_bf16 v[24:27], v[208:211], v[156:159], v[24:27]
s_waitcnt lgkmcnt(2)
ds_read_b64_tr_b16 v[224:225], v243 offset:4096
v_accvgpr_write_b32 a48, v48
v_mfma_f32_16x16x32_bf16 v[24:27], v[212:215], v[168:171], v[24:27]
ds_read_b64_tr_b16 v[226:227], v243 offset:6144
v_accvgpr_write_b32 a52, v49
v_mfma_f32_16x16x32_bf16 v[24:27], v[216:219], v[180:183], v[24:27]
ds_read_b64_tr_b16 v[228:229], v243 offset:8192
v_cmp_eq_u32 vcc, 1, v51
v_mfma_f32_16x16x32_bf16 v[28:31], v[204:207], v[148:151], v[28:31]
ds_read_b64_tr_b16 v[230:231], v243 offset:10240
v_cndmask_b32 v48, 0, v54, vcc
v_mfma_f32_16x16x32_bf16 v[28:31], v[208:211], v[160:163], v[28:31]
ds_read_b64_tr_b16 v[232:233], v243 offset:12288
v_cndmask_b32 v49, 0, v55, vcc
v_mfma_f32_16x16x32_bf16 v[28:31], v[212:215], v[172:175], v[28:31]
ds_read_b64_tr_b16 v[234:235], v243 offset:14336
v_accvgpr_write_b32 a49, v48
v_mfma_f32_16x16x32_bf16 v[28:31], v[216:219], v[184:187], v[28:31]
v_accvgpr_write_b32 a53, v49
v_cmp_eq_u32 vcc, 2, v51
v_mfma_f32_16x16x32_bf16 v[32:35], v[204:207], v[152:155], v[32:35]
v_mfma_f32_16x16x32_bf16 v[32:35], v[208:211], v[164:167], v[32:35]
v_cndmask_b32 v48, 0, v54, vcc
v_cndmask_b32 v49, 0, v55, vcc
v_mfma_f32_16x16x32_bf16 v[32:35], v[212:215], v[176:179], v[32:35]
s_waitcnt lgkmcnt(4)
v_accvgpr_write_b32 a50, v48
v_accvgpr_write_b32 a54, v49
v_mfma_f32_16x16x32_bf16 v[32:35], v[216:219], v[188:191], v[32:35]
v_cmp_eq_u32 vcc, 3, v51
v_mfma_f32_16x16x32_bf16 v[36:39], v[220:223], v[144:147], v[36:39]
s_waitcnt vmcnt(18) lgkmcnt(0)
v_cndmask_b32 v48, 0, v54, vcc
v_cndmask_b32 v49, 0, v55, vcc
v_mfma_f32_16x16x32_bf16 v[36:39], v[224:227], v[156:159], v[36:39]
s_barrier
ds_read_b64_tr_b16 v[204:205], v241 offset:16384
v_accvgpr_write_b32 a51, v48
v_mfma_f32_16x16x32_bf16 v[36:39], v[228:231], v[168:171], v[36:39]
ds_read_b64_tr_b16 v[206:207], v241 offset:18432
v_accvgpr_write_b32 a55, v49
v_mfma_f32_16x16x32_bf16 v[36:39], v[232:235], v[180:183], v[36:39]
ds_read_b64_tr_b16 v[208:209], v241 offset:20480
v_xor_b32 v243, 32, v241
v_mfma_f32_16x16x32_bf16 v[40:43], v[220:223], v[148:151], v[40:43]
ds_read_b64_tr_b16 v[210:211], v241 offset:22528
v_mfma_f32_16x16x32_bf16 v[40:43], v[224:227], v[160:163], v[40:43]
ds_read_b64_tr_b16 v[212:213], v241 offset:24576
v_mfma_f32_16x16x32_bf16 v[40:43], v[228:231], v[172:175], v[40:43]
ds_read_b64_tr_b16 v[214:215], v241 offset:26624
v_mfma_f32_16x16x32_bf16 v[40:43], v[232:235], v[184:187], v[40:43]
ds_read_b64_tr_b16 v[216:217], v241 offset:28672
v_mfma_f32_16x16x32_bf16 v[44:47], v[220:223], v[152:155], v[44:47]
ds_read_b64_tr_b16 v[218:219], v241 offset:30720
v_mfma_f32_16x16x32_bf16 v[44:47], v[224:227], v[164:167], v[44:47]
v_mfma_f32_16x16x32_bf16 v[44:47], v[228:231], v[176:179], v[44:47]
s_waitcnt lgkmcnt(4)
v_mfma_f32_16x16x32_bf16 v[44:47], v[232:235], v[188:191], v[44:47]
ds_read_b64_tr_b16 v[220:221], v243 offset:16384
v_mfma_f32_16x16x32_bf16 v[48:51], v[204:207], a[144:147], 0
ds_read_b64_tr_b16 v[222:223], v243 offset:18432
v_mfma_f32_16x16x32_bf16 v[48:51], v[208:211], a[156:159], v[48:51]
s_waitcnt lgkmcnt(2)
ds_read_b64_tr_b16 v[224:225], v243 offset:20480
v_mfma_f32_16x16x32_bf16 v[48:51], v[212:215], a[168:171], v[48:51]
ds_read_b64_tr_b16 v[226:227], v243 offset:22528
v_mfma_f32_16x16x32_bf16 v[48:51], v[216:219], a[180:183], v[48:51]
ds_read_b64_tr_b16 v[228:229], v243 offset:24576
v_xor_b32 v242, 64, v241
v_mfma_f32_16x16x32_bf16 v[52:55], v[204:207], a[148:151], 0
ds_read_b64_tr_b16 v[230:231], v243 offset:26624
v_mfma_f32_16x16x32_bf16 v[52:55], v[208:211], a[160:163], v[52:55]
ds_read_b64_tr_b16 v[232:233], v243 offset:28672
v_mfma_f32_16x16x32_bf16 v[52:55], v[212:215], a[172:175], v[52:55]
ds_read_b64_tr_b16 v[234:235], v243 offset:30720
v_mfma_f32_16x16x32_bf16 v[52:55], v[216:219], a[184:187], v[52:55]
v_mfma_f32_16x16x32_bf16 v[56:59], v[204:207], a[152:155], 0
v_cvt_pk_bf16_f32 v0, v0, v1
v_cvt_pk_bf16_f32 v1, v2, v3
v_mfma_f32_16x16x32_bf16 v[56:59], v[208:211], a[164:167], v[56:59]
v_cvt_pk_bf16_f32 v2, v12, v13
v_cvt_pk_bf16_f32 v3, v14, v15
v_mfma_f32_16x16x32_bf16 v[56:59], v[212:215], a[176:179], v[56:59]
s_waitcnt lgkmcnt(4)
buffer_store_dwordx4 v[0:3], v244, s[24:27], s4 offen sc1
v_mfma_f32_16x16x32_bf16 v[56:59], v[216:219], a[188:191], v[56:59]
s_add_u32 s4, s87, 16384
ds_read_b64_tr_b16 v[204:205], v242 offset:16384
v_cvt_pk_bf16_f32 v24, v24, v25
v_mfma_f32_16x16x32_bf16 v[60:63], v[220:223], a[144:147], 0
ds_read_b64_tr_b16 v[206:207], v242 offset:18432
v_cvt_pk_bf16_f32 v25, v26, v27
v_mfma_f32_16x16x32_bf16 v[60:63], v[224:227], a[156:159], v[60:63]
s_waitcnt lgkmcnt(2)
ds_read_b64_tr_b16 v[208:209], v242 offset:20480
v_cvt_pk_bf16_f32 v26, v36, v37
v_mfma_f32_16x16x32_bf16 v[60:63], v[228:231], a[168:171], v[60:63]
ds_read_b64_tr_b16 v[210:211], v242 offset:22528
v_cvt_pk_bf16_f32 v27, v38, v39
v_mfma_f32_16x16x32_bf16 v[60:63], v[232:235], a[180:183], v[60:63]
buffer_store_dwordx4 v[24:27], v244, s[24:27], s5 offen sc1
v_mfma_f32_16x16x32_bf16 v[64:67], v[220:223], a[148:151], 0
s_add_u32 s5, s87, 24576
ds_read_b64_tr_b16 v[212:213], v242 offset:24576
v_cvt_pk_bf16_f32 v4, v4, v5
v_mfma_f32_16x16x32_bf16 v[64:67], v[224:227], a[160:163], v[64:67]
ds_read_b64_tr_b16 v[214:215], v242 offset:26624
v_cvt_pk_bf16_f32 v5, v6, v7
v_mfma_f32_16x16x32_bf16 v[64:67], v[228:231], a[172:175], v[64:67]
ds_read_b64_tr_b16 v[216:217], v242 offset:28672
v_cvt_pk_bf16_f32 v6, v16, v17
v_mfma_f32_16x16x32_bf16 v[64:67], v[232:235], a[184:187], v[64:67]
ds_read_b64_tr_b16 v[218:219], v242 offset:30720
v_cvt_pk_bf16_f32 v7, v18, v19
v_mfma_f32_16x16x32_bf16 v[68:71], v[220:223], a[152:155], 0
buffer_store_dwordx4 v[4:7], v244, s[24:27], s4 offen sc1
v_mfma_f32_16x16x32_bf16 v[68:71], v[224:227], a[164:167], v[68:71]
s_add_u32 s4, s87, 32768
v_xor_b32 v243, 96, v241
v_cvt_pk_bf16_f32 v28, v28, v29
v_mfma_f32_16x16x32_bf16 v[68:71], v[228:231], a[176:179], v[68:71]
s_waitcnt lgkmcnt(4)
v_cvt_pk_bf16_f32 v29, v30, v31
v_cvt_pk_bf16_f32 v30, v40, v41
v_mfma_f32_16x16x32_bf16 v[68:71], v[232:235], a[188:191], v[68:71]
ds_read_b64_tr_b16 v[220:221], v243 offset:16384
v_cvt_pk_bf16_f32 v31, v42, v43
v_mfma_f32_16x16x32_bf16 v[72:75], v[204:207], a[144:147], 0
buffer_store_dwordx4 v[28:31], v244, s[24:27], s5 offen sc1
v_mfma_f32_16x16x32_bf16 v[72:75], v[208:211], a[156:159], v[72:75]
s_waitcnt lgkmcnt(1)
ds_read_b64_tr_b16 v[222:223], v243 offset:18432
v_cvt_pk_bf16_f32 v8, v8, v9
v_mfma_f32_16x16x32_bf16 v[72:75], v[212:215], a[168:171], v[72:75]
s_add_u32 s5, s87, 40960
ds_read_b64_tr_b16 v[224:225], v243 offset:20480
v_cvt_pk_bf16_f32 v9, v10, v11
v_mfma_f32_16x16x32_bf16 v[72:75], v[216:219], a[180:183], v[72:75]
ds_read_b64_tr_b16 v[226:227], v243 offset:22528
v_cvt_pk_bf16_f32 v10, v20, v21
v_mfma_f32_16x16x32_bf16 v[76:79], v[204:207], a[148:151], 0
s_add_u32 s56, s41, s96
ds_read_b64_tr_b16 v[228:229], v243 offset:24576
v_cvt_pk_bf16_f32 v11, v22, v23
v_mfma_f32_16x16x32_bf16 v[76:79], v[208:211], a[160:163], v[76:79]
s_add_u32 s57, s56, s50
buffer_store_dwordx4 v[8:11], v244, s[24:27], s4 offen sc1
v_mfma_f32_16x16x32_bf16 v[76:79], v[212:215], a[172:175], v[76:79]
s_add_u32 s58, s56, s51
ds_read_b64_tr_b16 v[230:231], v243 offset:26624
v_cvt_pk_bf16_f32 v32, v32, v33
v_mfma_f32_16x16x32_bf16 v[76:79], v[216:219], a[184:187], v[76:79]
s_add_u32 s59, s56, s52
ds_read_b64_tr_b16 v[232:233], v243 offset:28672
v_cvt_pk_bf16_f32 v33, v34, v35
v_mfma_f32_16x16x32_bf16 v[80:83], v[204:207], a[152:155], 0
ds_read_b64_tr_b16 v[234:235], v243 offset:30720
v_cvt_pk_bf16_f32 v34, v44, v45
v_cvt_pk_bf16_f32 v35, v46, v47
v_mfma_f32_16x16x32_bf16 v[80:83], v[208:211], a[164:167], v[80:83]
buffer_store_dwordx4 v[32:35], v244, s[24:27], s5 offen sc1
v_mfma_f32_16x16x32_bf16 v[80:83], v[212:215], a[176:179], v[80:83]
s_waitcnt lgkmcnt(4)
v_add_u32 v241, 0x18000, v241
v_mfma_f32_16x16x32_bf16 v[80:83], v[216:219], a[188:191], v[80:83]
s_add_u32 m0, s60, 114688
ds_read_b64_tr_b16 v[204:205], v241 offset:0
v_mfma_f32_16x16x32_bf16 v[84:87], v[220:223], a[144:147], 0
ds_read_b64_tr_b16 v[206:207], v241 offset:2048
v_mfma_f32_16x16x32_bf16 v[84:87], v[224:227], a[156:159], v[84:87]
s_waitcnt lgkmcnt(2)
ds_read_b64_tr_b16 v[208:209], v241 offset:4096
v_mfma_f32_16x16x32_bf16 v[84:87], v[228:231], a[168:171], v[84:87]
ds_read_b64_tr_b16 v[210:211], v241 offset:6144
v_mfma_f32_16x16x32_bf16 v[84:87], v[232:235], a[180:183], v[84:87]
ds_read_b64_tr_b16 v[212:213], v241 offset:8192
v_xor_b32 v243, 32, v241
v_mfma_f32_16x16x32_bf16 v[88:91], v[220:223], a[148:151], 0
ds_read_b64_tr_b16 v[214:215], v241 offset:10240
v_mfma_f32_16x16x32_bf16 v[88:91], v[224:227], a[160:163], v[88:91]
ds_read_b64_tr_b16 v[216:217], v241 offset:12288
v_mfma_f32_16x16x32_bf16 v[88:91], v[228:231], a[172:175], v[88:91]
buffer_load_dwordx4 v246, s[16:19], s56 offen offset:0 lds
v_mfma_f32_16x16x32_bf16 v[88:91], v[232:235], a[184:187], v[88:91]
ds_read_b64_tr_b16 v[218:219], v241 offset:14336
v_mfma_f32_16x16x32_bf16 v[92:95], v[220:223], a[152:155], 0
v_mfma_f32_16x16x32_bf16 v[92:95], v[224:227], a[164:167], v[92:95]
v_mfma_f32_16x16x32_bf16 v[92:95], v[228:231], a[176:179], v[92:95]
s_waitcnt lgkmcnt(4)
buffer_load_dwordx4 v246, s[16:19], s57 offen offset:1024 lds
v_mfma_f32_16x16x32_bf16 v[92:95], v[232:235], a[188:191], v[92:95]
ds_read_b64_tr_b16 v[220:221], v243 offset:0
v_mfma_f32_16x16x32_bf16 v[48:51], v[204:207], a[192:195], v[48:51]
ds_read_b64_tr_b16 v[222:223], v243 offset:2048
v_mfma_f32_16x16x32_bf16 v[48:51], v[208:211], a[204:207], v[48:51]
s_waitcnt lgkmcnt(2)
ds_read_b64_tr_b16 v[224:225], v243 offset:4096
v_mfma_f32_16x16x32_bf16 v[48:51], v[212:215], a[216:219], v[48:51]
ds_read_b64_tr_b16 v[226:227], v243 offset:6144
v_mfma_f32_16x16x32_bf16 v[48:51], v[216:219], a[228:231], v[48:51]
ds_read_b64_tr_b16 v[228:229], v243 offset:8192
v_xor_b32 v242, 64, v241
v_mfma_f32_16x16x32_bf16 v[52:55], v[204:207], a[196:199], v[52:55]
ds_read_b64_tr_b16 v[230:231], v243 offset:10240
v_mfma_f32_16x16x32_bf16 v[52:55], v[208:211], a[208:211], v[52:55]
buffer_load_dwordx4 v246, s[16:19], s58 offen offset:2048 lds
v_mfma_f32_16x16x32_bf16 v[52:55], v[212:215], a[220:223], v[52:55]
ds_read_b64_tr_b16 v[232:233], v243 offset:12288
v_mfma_f32_16x16x32_bf16 v[52:55], v[216:219], a[232:235], v[52:55]
ds_read_b64_tr_b16 v[234:235], v243 offset:14336
v_mfma_f32_16x16x32_bf16 v[56:59], v[204:207], a[200:203], v[56:59]
v_mfma_f32_16x16x32_bf16 v[56:59], v[208:211], a[212:215], v[56:59]
buffer_load_dwordx4 v246, s[16:19], s59 offen offset:3072 lds
v_mfma_f32_16x16x32_bf16 v[56:59], v[212:215], a[224:227], v[56:59]
s_waitcnt lgkmcnt(4)
v_mfma_f32_16x16x32_bf16 v[56:59], v[216:219], a[236:239], v[56:59]
s_add_u32 m0, s60, 65536
ds_read_b64_tr_b16 v[204:205], v242 offset:0
v_mfma_f32_16x16x32_bf16 v[60:63], v[220:223], a[192:195], v[60:63]
s_add_u32 s56, s41, s97
ds_read_b64_tr_b16 v[206:207], v242 offset:2048
v_mfma_f32_16x16x32_bf16 v[60:63], v[224:227], a[204:207], v[60:63]
s_waitcnt lgkmcnt(2)
ds_read_b64_tr_b16 v[208:209], v242 offset:4096
v_mfma_f32_16x16x32_bf16 v[60:63], v[228:231], a[216:219], v[60:63]
s_add_u32 s57, s56, s50
ds_read_b64_tr_b16 v[210:211], v242 offset:6144
v_mfma_f32_16x16x32_bf16 v[60:63], v[232:235], a[228:231], v[60:63]
s_add_u32 s58, s56, s51
ds_read_b64_tr_b16 v[212:213], v242 offset:8192
v_xor_b32 v243, 96, v241
v_mfma_f32_16x16x32_bf16 v[64:67], v[220:223], a[196:199], v[64:67]
s_add_u32 s59, s56, s52
buffer_load_dwordx4 v246, s[16:19], s56 offen offset:0 lds
v_mfma_f32_16x16x32_bf16 v[64:67], v[224:227], a[208:211], v[64:67]
ds_read_b64_tr_b16 v[214:215], v242 offset:10240
v_mfma_f32_16x16x32_bf16 v[64:67], v[228:231], a[220:223], v[64:67]
ds_read_b64_tr_b16 v[216:217], v242 offset:12288
v_mfma_f32_16x16x32_bf16 v[64:67], v[232:235], a[232:235], v[64:67]
ds_read_b64_tr_b16 v[218:219], v242 offset:14336
v_mfma_f32_16x16x32_bf16 v[68:71], v[220:223], a[200:203], v[68:71]
buffer_load_dwordx4 v246, s[16:19], s57 offen offset:1024 lds
v_mfma_f32_16x16x32_bf16 v[68:71], v[224:227], a[212:215], v[68:71]
v_mfma_f32_16x16x32_bf16 v[68:71], v[228:231], a[224:227], v[68:71]
s_waitcnt lgkmcnt(4)
v_mfma_f32_16x16x32_bf16 v[68:71], v[232:235], a[236:239], v[68:71]
ds_read_b64_tr_b16 v[220:221], v243 offset:0
v_mfma_f32_16x16x32_bf16 v[72:75], v[204:207], a[192:195], v[72:75]
ds_read_b64_tr_b16 v[222:223], v243 offset:2048
v_mfma_f32_16x16x32_bf16 v[72:75], v[208:211], a[204:207], v[72:75]
s_waitcnt lgkmcnt(2)
ds_read_b64_tr_b16 v[224:225], v243 offset:4096
v_mfma_f32_16x16x32_bf16 v[72:75], v[212:215], a[216:219], v[72:75]
ds_read_b64_tr_b16 v[226:227], v243 offset:6144
v_mfma_f32_16x16x32_bf16 v[72:75], v[216:219], a[228:231], v[72:75]
buffer_load_dwordx4 v246, s[16:19], s58 offen offset:2048 lds
v_mfma_f32_16x16x32_bf16 v[76:79], v[204:207], a[196:199], v[76:79]
ds_read_b64_tr_b16 v[228:229], v243 offset:8192
v_mfma_f32_16x16x32_bf16 v[76:79], v[208:211], a[208:211], v[76:79]
ds_read_b64_tr_b16 v[230:231], v243 offset:10240
v_mfma_f32_16x16x32_bf16 v[76:79], v[212:215], a[220:223], v[76:79]
ds_read_b64_tr_b16 v[232:233], v243 offset:12288
v_mfma_f32_16x16x32_bf16 v[76:79], v[216:219], a[232:235], v[76:79]
ds_read_b64_tr_b16 v[234:235], v243 offset:14336
v_mfma_f32_16x16x32_bf16 v[80:83], v[204:207], a[200:203], v[80:83]
buffer_load_dwordx4 v246, s[16:19], s59 offen offset:3072 lds
v_mfma_f32_16x16x32_bf16 v[80:83], v[208:211], a[212:215], v[80:83]
s_add_u32 m0, s60, 16384
v_mfma_f32_16x16x32_bf16 v[80:83], v[212:215], a[224:227], v[80:83]
s_waitcnt lgkmcnt(4)
v_mfma_f32_16x16x32_bf16 v[80:83], v[216:219], a[236:239], v[80:83]
s_add_u32 s56, s42, s93
v_mfma_f32_16x16x32_bf16 v[84:87], v[220:223], a[192:195], v[84:87]
s_waitcnt vmcnt(8) lgkmcnt(0)
v_mfma_f32_16x16x32_bf16 v[84:87], v[224:227], a[204:207], v[84:87]
s_barrier
ds_read_b64_tr_b16 v[204:205], v241 offset:49152
v_mfma_f32_16x16x32_bf16 v[84:87], v[228:231], a[216:219], v[84:87]
s_add_u32 s57, s56, s50
buffer_store_dword v244, v245, s[24:27], s88 offen sc1
v_mfma_f32_16x16x32_bf16 v[84:87], v[232:235], a[228:231], v[84:87]
s_add_u32 s58, s56, s51
ds_read_b64_tr_b16 v[206:207], v241 offset:51200
v_xor_b32 v243, 32, v241
v_mfma_f32_16x16x32_bf16 v[88:91], v[220:223], a[196:199], v[88:91]
s_add_u32 s59, s56, s52
ds_read_b64_tr_b16 v[208:209], v241 offset:53248
v_mfma_f32_16x16x32_bf16 v[88:91], v[224:227], a[208:211], v[88:91]
ds_read_b64_tr_b16 v[210:211], v241 offset:55296
v_mfma_f32_16x16x32_bf16 v[88:91], v[228:231], a[220:223], v[88:91]
buffer_load_dwordx4 v246, s[16:19], s56 offen offset:0 lds
v_mfma_f32_16x16x32_bf16 v[88:91], v[232:235], a[232:235], v[88:91]
ds_read_b64_tr_b16 v[212:213], v241 offset:57344
v_mfma_f32_16x16x32_bf16 v[92:95], v[220:223], a[200:203], v[92:95]
ds_read_b64_tr_b16 v[214:215], v241 offset:59392
v_mfma_f32_16x16x32_bf16 v[92:95], v[224:227], a[212:215], v[92:95]
ds_read_b64_tr_b16 v[216:217], v241 offset:61440
v_mfma_f32_16x16x32_bf16 v[92:95], v[228:231], a[224:227], v[92:95]
s_waitcnt lgkmcnt(3)
ds_read_b64_tr_b16 v[218:219], v241 offset:63488
v_mfma_f32_16x16x32_bf16 v[92:95], v[232:235], a[236:239], v[92:95]
buffer_load_dwordx4 v246, s[16:19], s57 offen offset:1024 lds
v_mfma_f32_16x16x32_bf16 v[48:51], v[204:207], a[0:3], v[48:51]
ds_read_b64_tr_b16 v[220:221], v243 offset:49152
v_mfma_f32_16x16x32_bf16 v[48:51], v[208:211], a[12:15], v[48:51]
s_waitcnt lgkmcnt(1)
ds_read_b64_tr_b16 v[222:223], v243 offset:51200
v_mfma_f32_16x16x32_bf16 v[48:51], v[212:215], a[24:27], v[48:51]
ds_read_b64_tr_b16 v[224:225], v243 offset:53248
v_mfma_f32_16x16x32_bf16 v[48:51], v[216:219], a[36:39], v[48:51]
ds_read_b64_tr_b16 v[226:227], v243 offset:55296
v_xor_b32 v242, 64, v241
v_mfma_f32_16x16x32_bf16 v[52:55], v[204:207], a[4:7], v[52:55]
buffer_load_dwordx4 v246, s[16:19], s58 offen offset:2048 lds
v_mfma_f32_16x16x32_bf16 v[52:55], v[208:211], a[16:19], v[52:55]
ds_read_b64_tr_b16 v[228:229], v243 offset:57344
v_mfma_f32_16x16x32_bf16 v[52:55], v[212:215], a[28:31], v[52:55]
ds_read_b64_tr_b16 v[230:231], v243 offset:59392
v_mfma_f32_16x16x32_bf16 v[52:55], v[216:219], a[40:43], v[52:55]
ds_read_b64_tr_b16 v[232:233], v243 offset:61440
v_mfma_f32_16x16x32_bf16 v[56:59], v[204:207], a[8:11], v[56:59]
ds_read_b64_tr_b16 v[234:235], v243 offset:63488
v_mfma_f32_16x16x32_bf16 v[56:59], v[208:211], a[20:23], v[56:59]
buffer_load_dwordx4 v246, s[16:19], s59 offen offset:3072 lds
v_mfma_f32_16x16x32_bf16 v[56:59], v[212:215], a[32:35], v[56:59]
s_waitcnt lgkmcnt(4)
v_mfma_f32_16x16x32_bf16 v[56:59], v[216:219], a[44:47], v[56:59]
s_add_u32 m0, s60, 98304
ds_read_b64_tr_b16 v[204:205], v242 offset:49152
v_mfma_f32_16x16x32_bf16 v[60:63], v[220:223], a[0:3], v[60:63]
s_add_u32 s56, s42, s95
ds_read_b64_tr_b16 v[206:207], v242 offset:51200
v_mfma_f32_16x16x32_bf16 v[60:63], v[224:227], a[12:15], v[60:63]
s_waitcnt lgkmcnt(2)
ds_read_b64_tr_b16 v[208:209], v242 offset:53248
v_mfma_f32_16x16x32_bf16 v[60:63], v[228:231], a[24:27], v[60:63]
s_load_dwordx8 s[8:15], s[82:83], s88
ds_read_b64_tr_b16 v[210:211], v242 offset:55296
v_mfma_f32_16x16x32_bf16 v[60:63], v[232:235], a[36:39], v[60:63]
s_add_u32 s57, s56, s50
buffer_load_dwordx4 v246, s[16:19], s56 offen offset:0 lds
v_mfma_f32_16x16x32_bf16 v[64:67], v[220:223], a[4:7], v[64:67]
s_add_u32 s58, s56, s51
ds_read_b64_tr_b16 v[212:213], v242 offset:57344
v_xor_b32 v243, 96, v241
v_mfma_f32_16x16x32_bf16 v[64:67], v[224:227], a[16:19], v[64:67]
s_add_u32 s59, s56, s52
ds_read_b64_tr_b16 v[214:215], v242 offset:59392
v_mfma_f32_16x16x32_bf16 v[64:67], v[228:231], a[28:31], v[64:67]
ds_read_b64_tr_b16 v[216:217], v242 offset:61440
v_mfma_f32_16x16x32_bf16 v[64:67], v[232:235], a[40:43], v[64:67]
ds_read_b64_tr_b16 v[218:219], v242 offset:63488
v_mfma_f32_16x16x32_bf16 v[68:71], v[220:223], a[8:11], v[68:71]
buffer_load_dwordx4 v246, s[16:19], s57 offen offset:1024 lds
v_mfma_f32_16x16x32_bf16 v[68:71], v[224:227], a[20:23], v[68:71]
v_add_u32 v241, 0xfffe8000, v241
v_mfma_f32_16x16x32_bf16 v[68:71], v[228:231], a[32:35], v[68:71]
s_waitcnt lgkmcnt(4)
v_mfma_f32_16x16x32_bf16 v[68:71], v[232:235], a[44:47], v[68:71]
ds_read_b64_tr_b16 v[220:221], v243 offset:49152
v_mfma_f32_16x16x32_bf16 v[72:75], v[204:207], a[0:3], v[72:75]
ds_read_b64_tr_b16 v[222:223], v243 offset:51200
v_mfma_f32_16x16x32_bf16 v[72:75], v[208:211], a[12:15], v[72:75]
s_waitcnt lgkmcnt(2)
buffer_load_dwordx4 v246, s[16:19], s58 offen offset:2048 lds
v_mfma_f32_16x16x32_bf16 v[72:75], v[212:215], a[24:27], v[72:75]
ds_read_b64_tr_b16 v[224:225], v243 offset:53248
v_mfma_f32_16x16x32_bf16 v[72:75], v[216:219], a[36:39], v[72:75]
ds_read_b64_tr_b16 v[226:227], v243 offset:55296
v_mfma_f32_16x16x32_bf16 v[76:79], v[204:207], a[4:7], v[76:79]
ds_read_b64_tr_b16 v[228:229], v243 offset:57344
v_mfma_f32_16x16x32_bf16 v[76:79], v[208:211], a[16:19], v[76:79]
ds_read_b64_tr_b16 v[230:231], v243 offset:59392
v_mfma_f32_16x16x32_bf16 v[76:79], v[212:215], a[28:31], v[76:79]
buffer_load_dwordx4 v246, s[16:19], s59 offen offset:3072 lds
v_mfma_f32_16x16x32_bf16 v[76:79], v[216:219], a[40:43], v[76:79]
ds_read_b64_tr_b16 v[232:233], v243 offset:61440
v_mfma_f32_16x16x32_bf16 v[80:83], v[204:207], a[8:11], v[80:83]
ds_read_b64_tr_b16 v[234:235], v243 offset:63488
v_mfma_f32_16x16x32_bf16 v[80:83], v[208:211], a[20:23], v[80:83]
v_mfma_f32_16x16x32_bf16 v[80:83], v[212:215], a[32:35], v[80:83]
s_waitcnt lgkmcnt(4)
v_mfma_f32_16x16x32_bf16 v[80:83], v[216:219], a[44:47], v[80:83]
ds_read_b64_tr_b16 v[204:205], v241 offset:32768
v_mfma_f32_16x16x32_bf16 v[84:87], v[220:223], a[0:3], v[84:87]
s_waitcnt lgkmcnt(0)
ds_read_b64_tr_b16 v[206:207], v241 offset:34816
v_mfma_f32_16x16x32_bf16 v[84:87], v[224:227], a[12:15], v[84:87]
s_waitcnt lgkmcnt(2)
ds_read_b64_tr_b16 v[208:209], v241 offset:36864
v_mfma_f32_16x16x32_bf16 v[84:87], v[228:231], a[24:27], v[84:87]
s_and_b32 s8, s8, s9
ds_read_b64_tr_b16 v[210:211], v241 offset:38912
v_mfma_f32_16x16x32_bf16 v[84:87], v[232:235], a[36:39], v[84:87]
s_and_b32 s10, s10, s11
ds_read_b64_tr_b16 v[212:213], v241 offset:40960
v_xor_b32 v243, 32, v241
v_mfma_f32_16x16x32_bf16 v[88:91], v[220:223], a[4:7], v[88:91]
s_and_b32 s12, s12, s13
ds_read_b64_tr_b16 v[214:215], v241 offset:43008
v_mfma_f32_16x16x32_bf16 v[88:91], v[224:227], a[16:19], v[88:91]
s_and_b32 s14, s14, s15
ds_read_b64_tr_b16 v[216:217], v241 offset:45056
v_mfma_f32_16x16x32_bf16 v[88:91], v[228:231], a[28:31], v[88:91]
s_and_b32 s8, s8, s10
ds_read_b64_tr_b16 v[218:219], v241 offset:47104
v_mfma_f32_16x16x32_bf16 v[88:91], v[232:235], a[40:43], v[88:91]
s_and_b32 s12, s12, s14
v_mfma_f32_16x16x32_bf16 v[92:95], v[220:223], a[8:11], v[92:95]
s_and_b32 s8, s8, s12
v_mfma_f32_16x16x32_bf16 v[92:95], v[224:227], a[20:23], v[92:95]
s_bitcmp0_b32 s8, 4
v_mfma_f32_16x16x32_bf16 v[92:95], v[228:231], a[32:35], v[92:95]
s_waitcnt lgkmcnt(4)
v_mfma_f32_16x16x32_bf16 v[92:95], v[232:235], a[44:47], v[92:95]
s_cbranch_scc1 L_spinG1FS
L_backG1FS:
ds_read_b64_tr_b16 v[220:221], v243 offset:32768
v_mfma_f32_16x16x32_bf16 v[48:51], v[204:207], v[144:147], v[48:51]
ds_read_b64_tr_b16 v[222:223], v243 offset:34816
v_mfma_f32_16x16x32_bf16 v[48:51], v[208:211], v[156:159], v[48:51]
s_waitcnt lgkmcnt(2)
buffer_load_dwordx4 v[128:131], v244, s[24:27], s90 offen offset:0 sc1
v_mfma_f32_16x16x32_bf16 v[48:51], v[212:215], v[168:171], v[48:51]
ds_read_b64_tr_b16 v[224:225], v243 offset:36864
v_mfma_f32_16x16x32_bf16 v[48:51], v[216:219], v[180:183], v[48:51]
ds_read_b64_tr_b16 v[226:227], v243 offset:38912
v_xor_b32 v242, 64, v241
v_mfma_f32_16x16x32_bf16 v[52:55], v[204:207], v[148:151], v[52:55]
ds_read_b64_tr_b16 v[228:229], v243 offset:40960
v_mfma_f32_16x16x32_bf16 v[52:55], v[208:211], v[160:163], v[52:55]
buffer_load_dwordx4 v[132:135], v244, s[24:27], s90 offen offset:1024 sc1
v_mfma_f32_16x16x32_bf16 v[52:55], v[212:215], v[172:175], v[52:55]
ds_read_b64_tr_b16 v[230:231], v243 offset:43008
v_mfma_f32_16x16x32_bf16 v[52:55], v[216:219], v[184:187], v[52:55]
ds_read_b64_tr_b16 v[232:233], v243 offset:45056
v_mfma_f32_16x16x32_bf16 v[56:59], v[204:207], v[152:155], v[56:59]
ds_read_b64_tr_b16 v[234:235], v243 offset:47104
v_mfma_f32_16x16x32_bf16 v[56:59], v[208:211], v[164:167], v[56:59]
buffer_load_dwordx4 v[136:139], v244, s[24:27], s90 offen offset:2048 sc1
v_mfma_f32_16x16x32_bf16 v[56:59], v[212:215], v[176:179], v[56:59]
s_waitcnt lgkmcnt(4)
v_mfma_f32_16x16x32_bf16 v[56:59], v[216:219], v[188:191], v[56:59]
ds_read_b64_tr_b16 v[204:205], v242 offset:32768
v_mfma_f32_16x16x32_bf16 v[60:63], v[220:223], v[144:147], v[60:63]
ds_read_b64_tr_b16 v[206:207], v242 offset:34816
v_mfma_f32_16x16x32_bf16 v[60:63], v[224:227], v[156:159], v[60:63]
s_waitcnt lgkmcnt(2)
buffer_load_dwordx4 v[140:143], v244, s[24:27], s90 offen offset:3072 sc1
v_mfma_f32_16x16x32_bf16 v[60:63], v[228:231], v[168:171], v[60:63]
ds_read_b64_tr_b16 v[208:209], v242 offset:36864
v_mfma_f32_16x16x32_bf16 v[60:63], v[232:235], v[180:183], v[60:63]
ds_read_b64_tr_b16 v[210:211], v242 offset:38912
v_xor_b32 v243, 96, v241
v_mfma_f32_16x16x32_bf16 v[64:67], v[220:223], v[148:151], v[64:67]
ds_read_b64_tr_b16 v[212:213], v242 offset:40960
v_mfma_f32_16x16x32_bf16 v[64:67], v[224:227], v[160:163], v[64:67]
buffer_load_dwordx4 v[192:195], v244, s[24:27], s91 offen offset:0 sc1
v_mfma_f32_16x16x32_bf16 v[64:67], v[228:231], v[172:175], v[64:67]
ds_read_b64_tr_b16 v[214:215], v242 offset:43008
v_mfma_f32_16x16x32_bf16 v[64:67], v[232:235], v[184:187], v[64:67]
ds_read_b64_tr_b16 v[216:217], v242 offset:45056
v_mfma_f32_16x16x32_bf16 v[68:71], v[220:223], v[152:155], v[68:71]
ds_read_b64_tr_b16 v[218:219], v242 offset:47104
v_mfma_f32_16x16x32_bf16 v[68:71], v[224:227], v[164:167], v[68:71]
buffer_load_dwordx4 v[196:199], v244, s[24:27], s91 offen offset:1024 sc1
v_mfma_f32_16x16x32_bf16 v[68:71], v[228:231], v[176:179], v[68:71]
s_waitcnt lgkmcnt(4)
v_mfma_f32_16x16x32_bf16 v[68:71], v[232:235], v[188:191], v[68:71]
ds_read_b64_tr_b16 v[220:221], v243 offset:32768
v_mfma_f32_16x16x32_bf16 v[72:75], v[204:207], v[144:147], v[72:75]
ds_read_b64_tr_b16 v[222:223], v243 offset:34816
v_mfma_f32_16x16x32_bf16 v[72:75], v[208:211], v[156:159], v[72:75]
s_waitcnt lgkmcnt(2)
buffer_load_dwordx4 v[200:203], v244, s[24:27], s91 offen offset:2048 sc1
v_mfma_f32_16x16x32_bf16 v[72:75], v[212:215], v[168:171], v[72:75]
ds_read_b64_tr_b16 v[224:225], v243 offset:36864
v_mfma_f32_16x16x32_bf16 v[72:75], v[216:219], v[180:183], v[72:75]
ds_read_b64_tr_b16 v[226:227], v243 offset:38912
v_mfma_f32_16x16x32_bf16 v[76:79], v[204:207], v[148:151], v[76:79]
ds_read_b64_tr_b16 v[228:229], v243 offset:40960
v_mfma_f32_16x16x32_bf16 v[76:79], v[208:211], v[160:163], v[76:79]
buffer_load_dwordx4 v[236:239], v244, s[24:27], s91 offen offset:3072 sc1
v_mfma_f32_16x16x32_bf16 v[76:79], v[212:215], v[172:175], v[76:79]
s_mov_b32 s86, 2
ds_read_b64_tr_b16 v[230:231], v243 offset:43008
v_mfma_f32_16x16x32_bf16 v[76:79], v[216:219], v[184:187], v[76:79]
s_sub_u32 s100, s86, 1
ds_read_b64_tr_b16 v[232:233], v243 offset:45056
v_mfma_f32_16x16x32_bf16 v[80:83], v[204:207], v[152:155], v[80:83]
s_and_b32 s100, s100, s72
ds_read_b64_tr_b16 v[234:235], v243 offset:47104
v_mfma_f32_16x16x32_bf16 v[80:83], v[208:211], v[164:167], v[80:83]
s_mul_i32 s100, s100, 196608
v_mfma_f32_16x16x32_bf16 v[80:83], v[212:215], v[176:179], v[80:83]
s_waitcnt lgkmcnt(4)
v_mfma_f32_16x16x32_bf16 v[80:83], v[216:219], v[188:191], v[80:83]
s_add_u32 s87, s68, s100
v_mfma_f32_16x16x32_bf16 v[84:87], v[220:223], v[144:147], v[84:87]
s_waitcnt vmcnt(31) lgkmcnt(0)
v_mfma_f32_16x16x32_bf16 v[84:87], v[224:227], v[156:159], v[84:87]
s_barrier
ds_read_b64_tr_b16 v[204:205], v241 offset:49152
v_mfma_f32_16x16x32_bf16 v[84:87], v[228:231], v[168:171], v[84:87]
s_add_u32 s90, s69, s100
ds_read_b64_tr_b16 v[206:207], v241 offset:51200
v_mfma_f32_16x16x32_bf16 v[84:87], v[232:235], v[180:183], v[84:87]
s_add_u32 s91, s90, 0x1000
ds_read_b64_tr_b16 v[208:209], v241 offset:53248
v_mfma_f32_16x16x32_bf16 v[88:91], v[220:223], v[148:151], v[88:91]
s_add_u32 s88, s88, 256
ds_read_b64_tr_b16 v[210:211], v241 offset:55296
v_mfma_f32_16x16x32_bf16 v[88:91], v[224:227], v[160:163], v[88:91]
ds_read_b64_tr_b16 v[212:213], v241 offset:57344
v_mfma_f32_16x16x32_bf16 v[88:91], v[228:231], v[172:175], v[88:91]
ds_read_b64_tr_b16 v[214:215], v241 offset:59392
v_mfma_f32_16x16x32_bf16 v[88:91], v[232:235], v[184:187], v[88:91]
ds_read_b64_tr_b16 v[216:217], v241 offset:61440
v_mfma_f32_16x16x32_bf16 v[92:95], v[220:223], v[152:155], v[92:95]
ds_read_b64_tr_b16 v[218:219], v241 offset:63488
v_mfma_f32_16x16x32_bf16 v[92:95], v[224:227], v[164:167], v[92:95]
v_mfma_f32_16x16x32_bf16 v[92:95], v[228:231], v[176:179], v[92:95]
v_mfma_f32_16x16x32_bf16 v[92:95], v[232:235], v[188:191], v[92:95]
s_mov_b32 s40, s42
s_add_u32 s41, s40, 128
s_and_b32 s41, s41, 0x3ff
s_add_u32 s42, s41, 128
s_and_b32 s42, s42, 0x3ff
s_cmp_lt_u32 s86, 8
L_GS:
s_waitcnt lgkmcnt(4)
v_mfma_f32_16x16x32_bf16 v[0:3], v[204:207], a[144:147], 0
s_add_u32 s4, s87, 0
v_xor_b32 v243, 32, v241
v_mfma_f32_16x16x32_bf16 v[0:3], v[208:211], a[156:159], v[0:3]
s_waitcnt lgkmcnt(0)
ds_read_b64_tr_b16 v[220:221], v243 offset:49152
v_mfma_f32_16x16x32_bf16 v[0:3], v[212:215], a[168:171], v[0:3]
s_add_u32 s5, s87, 8192
ds_read_b64_tr_b16 v[222:223], v243 offset:51200
v_mfma_f32_16x16x32_bf16 v[0:3], v[216:219], a[180:183], v[0:3]
ds_read_b64_tr_b16 v[224:225], v243 offset:53248
v_xor_b32 v242, 64, v241
v_mfma_f32_16x16x32_bf16 v[4:7], v[204:207], a[148:151], 0
ds_read_b64_tr_b16 v[226:227], v243 offset:55296
v_mfma_f32_16x16x32_bf16 v[4:7], v[208:211], a[160:163], v[4:7]
ds_read_b64_tr_b16 v[228:229], v243 offset:57344
v_mfma_f32_16x16x32_bf16 v[4:7], v[212:215], a[172:175], v[4:7]
ds_read_b64_tr_b16 v[230:231], v243 offset:59392
v_mfma_f32_16x16x32_bf16 v[4:7], v[216:219], a[184:187], v[4:7]
ds_read_b64_tr_b16 v[232:233], v243 offset:61440
v_mfma_f32_16x16x32_bf16 v[8:11], v[204:207], a[152:155], 0
s_waitcnt vmcnt(0)
ds_read_b64_tr_b16 v[234:235], v243 offset:63488
v_cvt_pk_bf16_f32 v48, v48, v49
v_mfma_f32_16x16x32_bf16 v[8:11], v[208:211], a[164:167], v[8:11]
v_cvt_pk_bf16_f32 v49, v50, v51
v_cvt_pk_bf16_f32 v50, v60, v61
v_mfma_f32_16x16x32_bf16 v[8:11], v[212:215], a[176:179], v[8:11]
s_waitcnt lgkmcnt(4)
v_cvt_pk_bf16_f32 v51, v62, v63
v_cvt_pk_bf16_f32 v72, v72, v73
v_mfma_f32_16x16x32_bf16 v[8:11], v[216:219], a[188:191], v[8:11]
ds_read_b64_tr_b16 v[204:205], v242 offset:49152
v_cvt_pk_bf16_f32 v73, v74, v75
v_mfma_f32_16x16x32_bf16 v[12:15], v[220:223], a[144:147], 0
buffer_store_dwordx4 v[48:51], v244, s[24:27], s4 offen sc1
v_mfma_f32_16x16x32_bf16 v[12:15], v[224:227], a[156:159], v[12:15]
s_waitcnt lgkmcnt(1)
ds_read_b64_tr_b16 v[206:207], v242 offset:51200
v_cvt_pk_bf16_f32 v74, v84, v85
v_mfma_f32_16x16x32_bf16 v[12:15], v[228:231], a[168:171], v[12:15]
s_add_u32 s4, s87, 16384
ds_read_b64_tr_b16 v[208:209], v242 offset:53248
v_cvt_pk_bf16_f32 v75, v86, v87
v_mfma_f32_16x16x32_bf16 v[12:15], v[232:235], a[180:183], v[12:15]
ds_read_b64_tr_b16 v[210:211], v242 offset:55296
v_cvt_pk_bf16_f32 v52, v52, v53
v_mfma_f32_16x16x32_bf16 v[16:19], v[220:223], a[148:151], 0
buffer_store_dwordx4 v[72:75], v244, s[24:27], s5 offen sc1
v_mfma_f32_16x16x32_bf16 v[16:19], v[224:227], a[160:163], v[16:19]
s_add_u32 s5, s87, 24576
ds_read_b64_tr_b16 v[212:213], v242 offset:57344
v_cvt_pk_bf16_f32 v53, v54, v55
v_mfma_f32_16x16x32_bf16 v[16:19], v[228:231], a[172:175], v[16:19]
ds_read_b64_tr_b16 v[214:215], v242 offset:59392
v_cvt_pk_bf16_f32 v54, v64, v65
v_mfma_f32_16x16x32_bf16 v[16:19], v[232:235], a[184:187], v[16:19]
ds_read_b64_tr_b16 v[216:217], v242 offset:61440
v_cvt_pk_bf16_f32 v55, v66, v67
v_mfma_f32_16x16x32_bf16 v[20:23], v[220:223], a[152:155], 0
ds_read_b64_tr_b16 v[218:219], v242 offset:63488
v_xor_b32 v243, 96, v241
v_mfma_f32_16x16x32_bf16 v[20:23], v[224:227], a[164:167], v[20:23]
buffer_store_dwordx4 v[52:55], v244, s[24:27], s4 offen sc1
v_mfma_f32_16x16x32_bf16 v[20:23], v[228:231], a[176:179], v[20:23]
s_waitcnt lgkmcnt(4)
v_cvt_pk_bf16_f32 v76, v76, v77
v_cvt_pk_bf16_f32 v77, v78, v79
v_mfma_f32_16x16x32_bf16 v[20:23], v[232:235], a[188:191], v[20:23]
s_add_u32 s4, s87, 32768
v_cvt_pk_bf16_f32 v78, v88, v89
v_cvt_pk_bf16_f32 v79, v90, v91
v_mfma_f32_16x16x32_bf16 v[24:27], v[204:207], a[144:147], 0
ds_read_b64_tr_b16 v[220:221], v243 offset:49152
v_cvt_pk_bf16_f32 v56, v56, v57
v_mfma_f32_16x16x32_bf16 v[24:27], v[208:211], a[156:159], v[24:27]
s_waitcnt lgkmcnt(1)
buffer_store_dwordx4 v[76:79], v244, s[24:27], s5 offen sc1
ds_read_b64_tr_b16 v[222:223], v243 offset:51200
v_mfma_f32_16x16x32_bf16 v[24:27], v[212:215], a[168:171], v[24:27]
s_add_u32 s5, s87, 40960
ds_read_b64_tr_b16 v[224:225], v243 offset:53248
v_cvt_pk_bf16_f32 v57, v58, v59
v_mfma_f32_16x16x32_bf16 v[24:27], v[216:219], a[180:183], v[24:27]
s_add_u32 s92, s71, s39
ds_read_b64_tr_b16 v[226:227], v243 offset:55296
v_cvt_pk_bf16_f32 v58, v68, v69
v_mfma_f32_16x16x32_bf16 v[28:31], v[204:207], a[148:151], 0
s_add_u32 s56, s40, s96
ds_read_b64_tr_b16 v[228:229], v243 offset:57344
v_cvt_pk_bf16_f32 v59, v70, v71
v_mfma_f32_16x16x32_bf16 v[28:31], v[208:211], a[160:163], v[28:31]
s_add_u32 s57, s56, s50
buffer_store_dwordx4 v[56:59], v244, s[24:27], s4 offen sc1
v_mfma_f32_16x16x32_bf16 v[28:31], v[212:215], a[172:175], v[28:31]
s_add_u32 s58, s56, s51
ds_read_b64_tr_b16 v[230:231], v243 offset:59392
v_cvt_pk_bf16_f32 v80, v80, v81
v_mfma_f32_16x16x32_bf16 v[28:31], v[216:219], a[184:187], v[28:31]
s_add_u32 s59, s56, s52
ds_read_b64_tr_b16 v[232:233], v243 offset:61440
v_cvt_pk_bf16_f32 v81, v82, v83
v_mfma_f32_16x16x32_bf16 v[32:35], v[204:207], a[152:155], 0
s_add_u32 s39, s39, 128
ds_read_b64_tr_b16 v[234:235], v243 offset:63488
v_cvt_pk_bf16_f32 v82, v92, v93
v_cvt_pk_bf16_f32 v83, v94, v95
v_mfma_f32_16x16x32_bf16 v[32:35], v[208:211], a[164:167], v[32:35]
s_and_b32 s39, s39, 0x3ff
buffer_store_dwordx4 v[80:83], v244, s[24:27], s5 offen sc1
v_mfma_f32_16x16x32_bf16 v[32:35], v[212:215], a[176:179], v[32:35]
s_waitcnt lgkmcnt(4)
v_add_u32 v241, 0x10000, v241
v_lshlrev_b32 v249, 16, v128
v_mfma_f32_16x16x32_bf16 v[32:35], v[216:219], a[188:191], v[32:35]
s_add_u32 m0, s60, 147456
ds_read_b64_tr_b16 v[204:205], v241 offset:16384
v_and_b32 v128, s6, v128
v_mfma_f32_16x16x32_bf16 v[36:39], v[220:223], a[144:147], 0
s_add_u32 s86, s86, 1
ds_read_b64_tr_b16 v[206:207], v241 offset:18432
v_lshlrev_b32 v254, 16, v132
v_mfma_f32_16x16x32_bf16 v[36:39], v[224:227], a[156:159], v[36:39]
s_waitcnt lgkmcnt(2)
ds_read_b64_tr_b16 v[208:209], v241 offset:20480
v_and_b32 v132, s6, v132
v_mfma_f32_16x16x32_bf16 v[36:39], v[228:231], a[168:171], v[36:39]
ds_read_b64_tr_b16 v[210:211], v241 offset:22528
v_add_f32 v249, v249, v254
v_mfma_f32_16x16x32_bf16 v[36:39], v[232:235], a[180:183], v[36:39]
ds_read_b64_tr_b16 v[212:213], v241 offset:24576
v_xor_b32 v243, 32, v241
v_mfma_f32_16x16x32_bf16 v[40:43], v[220:223], a[148:151], 0
ds_read_b64_tr_b16 v[214:215], v241 offset:26624
v_add_f32 v128, v128, v132
v_mfma_f32_16x16x32_bf16 v[40:43], v[224:227], a[160:163], v[40:43]
ds_read_b64_tr_b16 v[216:217], v241 offset:28672
v_lshlrev_b32 v255, 16, v136
v_mfma_f32_16x16x32_bf16 v[40:43], v[228:231], a[172:175], v[40:43]
ds_read_b64_tr_b16 v[218:219], v241 offset:30720
v_and_b32 v136, s6, v136
v_mfma_f32_16x16x32_bf16 v[40:43], v[232:235], a[184:187], v[40:43]
buffer_load_dwordx4 v246, s[16:19], s56 offen offset:0 lds
v_mfma_f32_16x16x32_bf16 v[44:47], v[220:223], a[152:155], 0
v_add_f32 v249, v249, v255
v_add_f32 v128, v128, v136
v_mfma_f32_16x16x32_bf16 v[44:47], v[224:227], a[164:167], v[44:47]
v_lshlrev_b32 v254, 16, v140
v_and_b32 v140, s6, v140
v_mfma_f32_16x16x32_bf16 v[44:47], v[228:231], a[176:179], v[44:47]
s_waitcnt lgkmcnt(4)
v_add_f32 v249, v249, v254
v_add_f32 v128, v128, v140
v_mfma_f32_16x16x32_bf16 v[44:47], v[232:235], a[188:191], v[44:47]
ds_read_b64_tr_b16 v[220:221], v243 offset:16384
v_lshlrev_b32 v255, 16, v192
v_mfma_f32_16x16x32_bf16 v[0:3], v[204:207], a[192:195], v[0:3]
ds_read_b64_tr_b16 v[222:223], v243 offset:18432
v_and_b32 v192, s6, v192
v_mfma_f32_16x16x32_bf16 v[0:3], v[208:211], a[204:207], v[0:3]
s_waitcnt lgkmcnt(2)
buffer_load_dwordx4 v246, s[16:19], s57 offen offset:1024 lds
v_mfma_f32_16x16x32_bf16 v[0:3], v[212:215], a[216:219], v[0:3]
ds_read_b64_tr_b16 v[224:225], v243 offset:20480
v_add_f32 v249, v249, v255
v_mfma_f32_16x16x32_bf16 v[0:3], v[216:219], a[228:231], v[0:3]
ds_read_b64_tr_b16 v[226:227], v243 offset:22528
v_xor_b32 v242, 64, v241
v_mfma_f32_16x16x32_bf16 v[4:7], v[204:207], a[196:199], v[4:7]
ds_read_b64_tr_b16 v[228:229], v243 offset:24576
v_add_f32 v128, v128, v192
v_mfma_f32_16x16x32_bf16 v[4:7], v[208:211], a[208:211], v[4:7]
ds_read_b64_tr_b16 v[230:231], v243 offset:26624
v_lshlrev_b32 v254, 16, v196
v_mfma_f32_16x16x32_bf16 v[4:7], v[212:215], a[220:223], v[4:7]
buffer_load_dwordx4 v246, s[16:19], s58 offen offset:2048 lds
v_mfma_f32_16x16x32_bf16 v[4:7], v[216:219], a[232:235], v[4:7]
ds_read_b64_tr_b16 v[232:233], v243 offset:28672
v_and_b32 v196, s6, v196
v_mfma_f32_16x16x32_bf16 v[8:11], v[204:207], a[200:203], v[8:11]
ds_read_b64_tr_b16 v[234:235], v243 offset:30720
v_add_f32 v249, v249, v254
v_mfma_f32_16x16x32_bf16 v[8:11], v[208:211], a[212:215], v[8:11]
v_add_f32 v128, v128, v196
v_lshlrev_b32 v255, 16, v200
v_mfma_f32_16x16x32_bf16 v[8:11], v[212:215], a[224:227], v[8:11]
s_waitcnt lgkmcnt(4)
buffer_load_dwordx4 v246, s[16:19], s59 offen offset:3072 lds
v_mfma_f32_16x16x32_bf16 v[8:11], v[216:219], a[236:239], v[8:11]
s_add_u32 m0, s60, 32768
ds_read_b64_tr_b16 v[204:205], v242 offset:16384
v_and_b32 v200, s6, v200
v_mfma_f32_16x16x32_bf16 v[12:15], v[220:223], a[192:195], v[12:15]
s_add_u32 s56, s40, s97
ds_read_b64_tr_b16 v[206:207], v242 offset:18432
v_add_f32 v249, v249, v255
v_mfma_f32_16x16x32_bf16 v[12:15], v[224:227], a[204:207], v[12:15]
s_waitcnt lgkmcnt(2)
ds_read_b64_tr_b16 v[208:209], v242 offset:20480
v_add_f32 v128, v128, v200
v_mfma_f32_16x16x32_bf16 v[12:15], v[228:231], a[216:219], v[12:15]
s_add_u32 s57, s56, s50
ds_read_b64_tr_b16 v[210:211], v242 offset:22528
v_lshlrev_b32 v254, 16, v236
v_mfma_f32_16x16x32_bf16 v[12:15], v[232:235], a[228:231], v[12:15]
s_add_u32 s58, s56, s51
ds_read_b64_tr_b16 v[212:213], v242 offset:24576
v_xor_b32 v243, 96, v241
v_mfma_f32_16x16x32_bf16 v[16:19], v[220:223], a[196:199], v[16:19]
s_add_u32 s59, s56, s52
buffer_load_dwordx4 v246, s[16:19], s56 offen offset:0 lds
v_mfma_f32_16x16x32_bf16 v[16:19], v[224:227], a[208:211], v[16:19]
ds_read_b64_tr_b16 v[214:215], v242 offset:26624
v_and_b32 v236, s6, v236
v_mfma_f32_16x16x32_bf16 v[16:19], v[228:231], a[220:223], v[16:19]
ds_read_b64_tr_b16 v[216:217], v242 offset:28672
v_add_f32 v249, v249, v254
v_mfma_f32_16x16x32_bf16 v[16:19], v[232:235], a[232:235], v[16:19]
ds_read_b64_tr_b16 v[218:219], v242 offset:30720
v_add_f32 v128, v128, v236
v_mfma_f32_16x16x32_bf16 v[20:23], v[220:223], a[200:203], v[20:23]
buffer_load_dwordx4 v246, s[16:19], s57 offen offset:1024 lds
v_mfma_f32_16x16x32_bf16 v[20:23], v[224:227], a[212:215], v[20:23]
v_cvt_pk_bf16_f32 v128, v249, v128
v_lshlrev_b32 v250, 16, v129
v_mfma_f32_16x16x32_bf16 v[20:23], v[228:231], a[224:227], v[20:23]
s_waitcnt lgkmcnt(4)
v_and_b32 v129, s6, v129
v_lshlrev_b32 v255, 16, v133
v_mfma_f32_16x16x32_bf16 v[20:23], v[232:235], a[236:239], v[20:23]
ds_read_b64_tr_b16 v[220:221], v243 offset:16384
v_and_b32 v133, s6, v133
v_mfma_f32_16x16x32_bf16 v[24:27], v[204:207], a[192:195], v[24:27]
ds_read_b64_tr_b16 v[222:223], v243 offset:18432
v_add_f32 v250, v250, v255
v_mfma_f32_16x16x32_bf16 v[24:27], v[208:211], a[204:207], v[24:27]
s_waitcnt lgkmcnt(2)
ds_read_b64_tr_b16 v[224:225], v243 offset:20480
v_add_f32 v129, v129, v133
v_mfma_f32_16x16x32_bf16 v[24:27], v[212:215], a[216:219], v[24:27]
ds_read_b64_tr_b16 v[226:227], v243 offset:22528
v_lshlrev_b32 v254, 16, v137
v_mfma_f32_16x16x32_bf16 v[24:27], v[216:219], a[228:231], v[24:27]
buffer_load_dwordx4 v246, s[16:19], s58 offen offset:2048 lds
v_mfma_f32_16x16x32_bf16 v[28:31], v[204:207], a[196:199], v[28:31]
ds_read_b64_tr_b16 v[228:229], v243 offset:24576
v_and_b32 v137, s6, v137
v_mfma_f32_16x16x32_bf16 v[28:31], v[208:211], a[208:211], v[28:31]
ds_read_b64_tr_b16 v[230:231], v243 offset:26624
v_add_f32 v250, v250, v254
v_mfma_f32_16x16x32_bf16 v[28:31], v[212:215], a[220:223], v[28:31]
ds_read_b64_tr_b16 v[232:233], v243 offset:28672
v_add_f32 v129, v129, v137
v_mfma_f32_16x16x32_bf16 v[28:31], v[216:219], a[232:235], v[28:31]
ds_read_b64_tr_b16 v[234:235], v243 offset:30720
v_lshlrev_b32 v255, 16, v141
v_mfma_f32_16x16x32_bf16 v[32:35], v[204:207], a[200:203], v[32:35]
buffer_load_dwordx4 v246, s[16:19], s59 offen offset:3072 lds
v_mfma_f32_16x16x32_bf16 v[32:35], v[208:211], a[212:215], v[32:35]
s_add_u32 m0, s60, 49152
v_and_b32 v141, s6, v141
v_add_f32 v250, v250, v255
v_mfma_f32_16x16x32_bf16 v[32:35], v[212:215], a[224:227], v[32:35]
s_waitcnt lgkmcnt(4)
v_add_f32 v129, v129, v141
v_lshlrev_b32 v254, 16, v193
v_mfma_f32_16x16x32_bf16 v[32:35], v[216:219], a[236:239], v[32:35]
s_cmp_ge_u32 s86, 7
v_and_b32 v193, s6, v193
v_add_f32 v250, v250, v254
v_mfma_f32_16x16x32_bf16 v[36:39], v[220:223], a[192:195], v[36:39]
s_waitcnt vmcnt(8) lgkmcnt(0)
v_add_f32 v129, v129, v193
v_lshlrev_b32 v255, 16, v197
v_mfma_f32_16x16x32_bf16 v[36:39], v[224:227], a[204:207], v[36:39]
s_barrier
ds_read_b64_tr_b16 v[204:205], v241 offset:49152
v_and_b32 v197, s6, v197
v_mfma_f32_16x16x32_bf16 v[36:39], v[228:231], a[216:219], v[36:39]
s_cselect_b32 s18, 0, s18
buffer_store_dword v244, v245, s[24:27], s88 offen sc1
v_mfma_f32_16x16x32_bf16 v[36:39], v[232:235], a[228:231], v[36:39]
s_add_u32 s56, s41, s93
ds_read_b64_tr_b16 v[206:207], v241 offset:51200
v_xor_b32 v243, 32, v241
v_mfma_f32_16x16x32_bf16 v[40:43], v[220:223], a[196:199], v[40:43]
s_add_u32 s57, s56, s50
ds_read_b64_tr_b16 v[208:209], v241 offset:53248
v_add_f32 v250, v250, v255
v_mfma_f32_16x16x32_bf16 v[40:43], v[224:227], a[208:211], v[40:43]
s_add_u32 s58, s56, s51
ds_read_b64_tr_b16 v[210:211], v241 offset:55296
v_add_f32 v129, v129, v197
v_mfma_f32_16x16x32_bf16 v[40:43], v[228:231], a[220:223], v[40:43]
s_add_u32 s59, s56, s52
buffer_load_dwordx4 v246, s[16:19], s56 offen offset:0 lds
v_mfma_f32_16x16x32_bf16 v[40:43], v[232:235], a[232:235], v[40:43]
ds_read_b64_tr_b16 v[212:213], v241 offset:57344
v_lshlrev_b32 v254, 16, v201
v_mfma_f32_16x16x32_bf16 v[44:47], v[220:223], a[200:203], v[44:47]
ds_read_b64_tr_b16 v[214:215], v241 offset:59392
v_and_b32 v201, s6, v201
v_mfma_f32_16x16x32_bf16 v[44:47], v[224:227], a[212:215], v[44:47]
ds_read_b64_tr_b16 v[216:217], v241 offset:61440
v_add_f32 v250, v250, v254
v_mfma_f32_16x16x32_bf16 v[44:47], v[228:231], a[224:227], v[44:47]
s_waitcnt lgkmcnt(3)
ds_read_b64_tr_b16 v[218:219], v241 offset:63488
v_add_f32 v129, v129, v201
v_mfma_f32_16x16x32_bf16 v[44:47], v[232:235], a[236:239], v[44:47]
buffer_load_dwordx4 v246, s[16:19], s57 offen offset:1024 lds
v_mfma_f32_16x16x32_bf16 v[0:3], v[204:207], a[0:3], v[0:3]
ds_read_b64_tr_b16 v[220:221], v243 offset:49152
v_lshlrev_b32 v255, 16, v237
v_mfma_f32_16x16x32_bf16 v[0:3], v[208:211], a[12:15], v[0:3]
s_waitcnt lgkmcnt(1)
ds_read_b64_tr_b16 v[222:223], v243 offset:51200
v_and_b32 v237, s6, v237
v_mfma_f32_16x16x32_bf16 v[0:3], v[212:215], a[24:27], v[0:3]
ds_read_b64_tr_b16 v[224:225], v243 offset:53248
v_add_f32 v250, v250, v255
v_mfma_f32_16x16x32_bf16 v[0:3], v[216:219], a[36:39], v[0:3]
ds_read_b64_tr_b16 v[226:227], v243 offset:55296
v_xor_b32 v242, 64, v241
v_mfma_f32_16x16x32_bf16 v[4:7], v[204:207], a[4:7], v[4:7]
buffer_load_dwordx4 v246, s[16:19], s58 offen offset:2048 lds
v_mfma_f32_16x16x32_bf16 v[4:7], v[208:211], a[16:19], v[4:7]
ds_read_b64_tr_b16 v[228:229], v243 offset:57344
v_add_f32 v129, v129, v237
v_mfma_f32_16x16x32_bf16 v[4:7], v[212:215], a[28:31], v[4:7]
ds_read_b64_tr_b16 v[230:231], v243 offset:59392
v_cvt_pk_bf16_f32 v129, v250, v129
v_mfma_f32_16x16x32_bf16 v[4:7], v[216:219], a[40:43], v[4:7]
ds_read_b64_tr_b16 v[232:233], v243 offset:61440
v_lshlrev_b32 v251, 16, v130
v_mfma_f32_16x16x32_bf16 v[8:11], v[204:207], a[8:11], v[8:11]
ds_read_b64_tr_b16 v[234:235], v243 offset:63488
v_and_b32 v130, s6, v130
v_mfma_f32_16x16x32_bf16 v[8:11], v[208:211], a[20:23], v[8:11]
buffer_load_dwordx4 v246, s[16:19], s59 offen offset:3072 lds
v_mfma_f32_16x16x32_bf16 v[8:11], v[212:215], a[32:35], v[8:11]
s_waitcnt lgkmcnt(4)
v_lshlrev_b32 v254, 16, v134
v_and_b32 v134, s6, v134
v_mfma_f32_16x16x32_bf16 v[8:11], v[216:219], a[44:47], v[8:11]
s_add_u32 m0, s60, 81920
ds_read_b64_tr_b16 v[204:205], v242 offset:49152
v_add_f32 v251, v251, v254
v_mfma_f32_16x16x32_bf16 v[12:15], v[220:223], a[0:3], v[12:15]
s_add_u32 s56, s41, s95
ds_read_b64_tr_b16 v[206:207], v242 offset:51200
v_add_f32 v130, v130, v134
v_mfma_f32_16x16x32_bf16 v[12:15], v[224:227], a[12:15], v[12:15]
s_waitcnt lgkmcnt(2)
ds_read_b64_tr_b16 v[208:209], v242 offset:53248
v_lshlrev_b32 v255, 16, v138
v_mfma_f32_16x16x32_bf16 v[12:15], v[228:231], a[24:27], v[12:15]
s_load_dwordx8 s[8:15], s[82:83], s88
ds_read_b64_tr_b16 v[210:211], v242 offset:55296
v_and_b32 v138, s6, v138
v_mfma_f32_16x16x32_bf16 v[12:15], v[232:235], a[36:39], v[12:15]
s_add_u32 s57, s56, s50
buffer_load_dwordx4 v246, s[16:19], s56 offen offset:0 lds
v_mfma_f32_16x16x32_bf16 v[16:19], v[220:223], a[4:7], v[16:19]
s_add_u32 s58, s56, s51
ds_read_b64_tr_b16 v[212:213], v242 offset:57344
v_xor_b32 v243, 96, v241
v_mfma_f32_16x16x32_bf16 v[16:19], v[224:227], a[16:19], v[16:19]
s_add_u32 s59, s56, s52
ds_read_b64_tr_b16 v[214:215], v242 offset:59392
v_add_f32 v251, v251, v255
v_mfma_f32_16x16x32_bf16 v[16:19], v[228:231], a[28:31], v[16:19]
ds_read_b64_tr_b16 v[216:217], v242 offset:61440
v_add_f32 v130, v130, v138
v_mfma_f32_16x16x32_bf16 v[16:19], v[232:235], a[40:43], v[16:19]
ds_read_b64_tr_b16 v[218:219], v242 offset:63488
v_lshlrev_b32 v254, 16, v142
v_mfma_f32_16x16x32_bf16 v[20:23], v[220:223], a[8:11], v[20:23]
buffer_load_dwordx4 v246, s[16:19], s57 offen offset:1024 lds
v_mfma_f32_16x16x32_bf16 v[20:23], v[224:227], a[20:23], v[20:23]
v_and_b32 v142, s6, v142
v_add_f32 v251, v251, v254
v_mfma_f32_16x16x32_bf16 v[20:23], v[228:231], a[32:35], v[20:23]
s_waitcnt lgkmcnt(4)
v_add_f32 v130, v130, v142
v_lshlrev_b32 v255, 16, v194
v_mfma_f32_16x16x32_bf16 v[20:23], v[232:235], a[44:47], v[20:23]
ds_read_b64_tr_b16 v[220:221], v243 offset:49152
v_and_b32 v194, s6, v194
v_mfma_f32_16x16x32_bf16 v[24:27], v[204:207], a[0:3], v[24:27]
ds_read_b64_tr_b16 v[222:223], v243 offset:51200
v_add_f32 v251, v251, v255
v_mfma_f32_16x16x32_bf16 v[24:27], v[208:211], a[12:15], v[24:27]
s_waitcnt lgkmcnt(2)
buffer_load_dwordx4 v246, s[16:19], s58 offen offset:2048 lds
v_mfma_f32_16x16x32_bf16 v[24:27], v[212:215], a[24:27], v[24:27]
ds_read_b64_tr_b16 v[224:225], v243 offset:53248
v_add_f32 v130, v130, v194
v_mfma_f32_16x16x32_bf16 v[24:27], v[216:219], a[36:39], v[24:27]
ds_read_b64_tr_b16 v[226:227], v243 offset:55296
v_lshlrev_b32 v254, 16, v198
v_mfma_f32_16x16x32_bf16 v[28:31], v[204:207], a[4:7], v[28:31]
ds_read_b64_tr_b16 v[228:229], v243 offset:57344
v_and_b32 v198, s6, v198
v_mfma_f32_16x16x32_bf16 v[28:31], v[208:211], a[16:19], v[28:31]
ds_read_b64_tr_b16 v[230:231], v243 offset:59392
v_add_f32 v251, v251, v254
v_mfma_f32_16x16x32_bf16 v[28:31], v[212:215], a[28:31], v[28:31]
buffer_load_dwordx4 v246, s[16:19], s59 offen offset:3072 lds
v_mfma_f32_16x16x32_bf16 v[28:31], v[216:219], a[40:43], v[28:31]
ds_read_b64_tr_b16 v[232:233], v243 offset:61440
v_add_f32 v130, v130, v198
v_mfma_f32_16x16x32_bf16 v[32:35], v[204:207], a[8:11], v[32:35]
ds_read_b64_tr_b16 v[234:235], v243 offset:63488
v_lshlrev_b32 v255, 16, v202
v_mfma_f32_16x16x32_bf16 v[32:35], v[208:211], a[20:23], v[32:35]
v_and_b32 v202, s6, v202
v_add_f32 v251, v251, v255
v_mfma_f32_16x16x32_bf16 v[32:35], v[212:215], a[32:35], v[32:35]
s_waitcnt lgkmcnt(4)
v_add_f32 v130, v130, v202
v_lshlrev_b32 v254, 16, v238
v_mfma_f32_16x16x32_bf16 v[32:35], v[216:219], a[44:47], v[32:35]
ds_read_b64_tr_b16 v[204:205], v241 offset:0
v_and_b32 v238, s6, v238
v_mfma_f32_16x16x32_bf16 v[36:39], v[220:223], a[0:3], v[36:39]
s_waitcnt lgkmcnt(0)
ds_read_b64_tr_b16 v[206:207], v241 offset:2048
v_add_f32 v251, v251, v254
v_mfma_f32_16x16x32_bf16 v[36:39], v[224:227], a[12:15], v[36:39]
s_waitcnt lgkmcnt(2)
ds_read_b64_tr_b16 v[208:209], v241 offset:4096
v_add_f32 v130, v130, v238
v_mfma_f32_16x16x32_bf16 v[36:39], v[228:231], a[24:27], v[36:39]
s_and_b32 s8, s8, s9
ds_read_b64_tr_b16 v[210:211], v241 offset:6144
v_cvt_pk_bf16_f32 v130, v251, v130
v_mfma_f32_16x16x32_bf16 v[36:39], v[232:235], a[36:39], v[36:39]
s_and_b32 s10, s10, s11
ds_read_b64_tr_b16 v[212:213], v241 offset:8192
v_xor_b32 v243, 32, v241
v_mfma_f32_16x16x32_bf16 v[40:43], v[220:223], a[4:7], v[40:43]
s_and_b32 s12, s12, s13
ds_read_b64_tr_b16 v[214:215], v241 offset:10240
v_lshlrev_b32 v253, 16, v131
v_mfma_f32_16x16x32_bf16 v[40:43], v[224:227], a[16:19], v[40:43]
s_and_b32 s14, s14, s15
ds_read_b64_tr_b16 v[216:217], v241 offset:12288
v_and_b32 v131, s6, v131
v_mfma_f32_16x16x32_bf16 v[40:43], v[228:231], a[28:31], v[40:43]
s_and_b32 s8, s8, s10
ds_read_b64_tr_b16 v[218:219], v241 offset:14336
v_lshlrev_b32 v255, 16, v135
v_mfma_f32_16x16x32_bf16 v[40:43], v[232:235], a[40:43], v[40:43]
s_and_b32 s12, s12, s14
v_and_b32 v135, s6, v135
v_add_f32 v253, v253, v255
v_mfma_f32_16x16x32_bf16 v[44:47], v[220:223], a[8:11], v[44:47]
s_and_b32 s8, s8, s12
v_add_f32 v131, v131, v135
v_lshlrev_b32 v254, 16, v139
v_mfma_f32_16x16x32_bf16 v[44:47], v[224:227], a[20:23], v[44:47]
s_bitcmp0_b32 s8, 4
v_and_b32 v139, s6, v139
v_add_f32 v253, v253, v254
v_mfma_f32_16x16x32_bf16 v[44:47], v[228:231], a[32:35], v[44:47]
s_waitcnt lgkmcnt(4)
v_add_f32 v131, v131, v139
v_lshlrev_b32 v255, 16, v143
v_mfma_f32_16x16x32_bf16 v[44:47], v[232:235], a[44:47], v[44:47]
s_cbranch_scc1 L_spinG0S
L_backG0S:
ds_read_b64_tr_b16 v[220:221], v243 offset:0
v_and_b32 v143, s6, v143
v_mfma_f32_16x16x32_bf16 v[0:3], v[204:207], v[144:147], v[0:3]
ds_read_b64_tr_b16 v[222:223], v243 offset:2048
v_add_f32 v253, v253, v255
v_mfma_f32_16x16x32_bf16 v[0:3], v[208:211], v[156:159], v[0:3]
s_waitcnt lgkmcnt(2)
buffer_load_dwordx4 v[96:99], v244, s[24:27], s90 offen offset:0 sc1
v_mfma_f32_16x16x32_bf16 v[0:3], v[212:215], v[168:171], v[0:3]
ds_read_b64_tr_b16 v[224:225], v243 offset:4096
v_add_f32 v131, v131, v143
v_mfma_f32_16x16x32_bf16 v[0:3], v[216:219], v[180:183], v[0:3]
ds_read_b64_tr_b16 v[226:227], v243 offset:6144
v_xor_b32 v242, 64, v241
v_mfma_f32_16x16x32_bf16 v[4:7], v[204:207], v[148:151], v[4:7]
ds_read_b64_tr_b16 v[228:229], v243 offset:8192
v_lshlrev_b32 v254, 16, v195
v_mfma_f32_16x16x32_bf16 v[4:7], v[208:211], v[160:163], v[4:7]
buffer_load_dwordx4 v[100:103], v244, s[24:27], s90 offen offset:1024 sc1
v_mfma_f32_16x16x32_bf16 v[4:7], v[212:215], v[172:175], v[4:7]
ds_read_b64_tr_b16 v[230:231], v243 offset:10240
v_and_b32 v195, s6, v195
v_mfma_f32_16x16x32_bf16 v[4:7], v[216:219], v[184:187], v[4:7]
ds_read_b64_tr_b16 v[232:233], v243 offset:12288
v_add_f32 v253, v253, v254
v_mfma_f32_16x16x32_bf16 v[8:11], v[204:207], v[152:155], v[8:11]
ds_read_b64_tr_b16 v[234:235], v243 offset:14336
v_add_f32 v131, v131, v195
v_mfma_f32_16x16x32_bf16 v[8:11], v[208:211], v[164:167], v[8:11]
buffer_load_dwordx4 v[104:107], v244, s[24:27], s90 offen offset:2048 sc1
v_mfma_f32_16x16x32_bf16 v[8:11], v[212:215], v[176:179], v[8:11]
s_waitcnt lgkmcnt(4)
v_lshlrev_b32 v255, 16, v199
v_and_b32 v199, s6, v199
v_mfma_f32_16x16x32_bf16 v[8:11], v[216:219], v[188:191], v[8:11]
ds_read_b64_tr_b16 v[204:205], v242 offset:0
v_add_f32 v253, v253, v255
v_mfma_f32_16x16x32_bf16 v[12:15], v[220:223], v[144:147], v[12:15]
ds_read_b64_tr_b16 v[206:207], v242 offset:2048
v_add_f32 v131, v131, v199
v_mfma_f32_16x16x32_bf16 v[12:15], v[224:227], v[156:159], v[12:15]
s_waitcnt lgkmcnt(2)
buffer_load_dwordx4 v[108:111], v244, s[24:27], s90 offen offset:3072 sc1
v_mfma_f32_16x16x32_bf16 v[12:15], v[228:231], v[168:171], v[12:15]
ds_read_b64_tr_b16 v[208:209], v242 offset:4096
v_lshlrev_b32 v254, 16, v203
v_mfma_f32_16x16x32_bf16 v[12:15], v[232:235], v[180:183], v[12:15]
ds_read_b64_tr_b16 v[210:211], v242 offset:6144
v_xor_b32 v243, 96, v241
v_mfma_f32_16x16x32_bf16 v[16:19], v[220:223], v[148:151], v[16:19]
ds_read_b64_tr_b16 v[212:213], v242 offset:8192
v_and_b32 v203, s6, v203
v_mfma_f32_16x16x32_bf16 v[16:19], v[224:227], v[160:163], v[16:19]
buffer_load_dwordx4 v[112:115], v244, s[24:27], s91 offen offset:0 sc1
v_mfma_f32_16x16x32_bf16 v[16:19], v[228:231], v[172:175], v[16:19]
ds_read_b64_tr_b16 v[214:215], v242 offset:10240
v_add_f32 v253, v253, v254
v_mfma_f32_16x16x32_bf16 v[16:19], v[232:235], v[184:187], v[16:19]
ds_read_b64_tr_b16 v[216:217], v242 offset:12288
v_add_f32 v131, v131, v203
v_mfma_f32_16x16x32_bf16 v[20:23], v[220:223], v[152:155], v[20:23]
ds_read_b64_tr_b16 v[218:219], v242 offset:14336
v_add_u32 v241, 0xffff0000, v241
v_mfma_f32_16x16x32_bf16 v[20:23], v[224:227], v[164:167], v[20:23]
buffer_load_dwordx4 v[116:119], v244, s[24:27], s91 offen offset:1024 sc1
v_mfma_f32_16x16x32_bf16 v[20:23], v[228:231], v[176:179], v[20:23]
s_waitcnt lgkmcnt(4)
v_lshlrev_b32 v255, 16, v239
v_and_b32 v239, s6, v239
v_mfma_f32_16x16x32_bf16 v[20:23], v[232:235], v[188:191], v[20:23]
ds_read_b64_tr_b16 v[220:221], v243 offset:0
v_add_f32 v253, v253, v255
v_mfma_f32_16x16x32_bf16 v[24:27], v[204:207], v[144:147], v[24:27]
ds_read_b64_tr_b16 v[222:223], v243 offset:2048
v_add_f32 v131, v131, v239
v_mfma_f32_16x16x32_bf16 v[24:27], v[208:211], v[156:159], v[24:27]
s_waitcnt lgkmcnt(2)
buffer_load_dwordx4 v[120:123], v244, s[24:27], s91 offen offset:2048 sc1
v_mfma_f32_16x16x32_bf16 v[24:27], v[212:215], v[168:171], v[24:27]
ds_read_b64_tr_b16 v[224:225], v243 offset:4096
v_cvt_pk_bf16_f32 v131, v253, v131
v_mfma_f32_16x16x32_bf16 v[24:27], v[216:219], v[180:183], v[24:27]
ds_read_b64_tr_b16 v[226:227], v243 offset:6144
v_mfma_f32_16x16x32_bf16 v[28:31], v[204:207], v[148:151], v[28:31]
ds_read_b64_tr_b16 v[228:229], v243 offset:8192
v_mfma_f32_16x16x32_bf16 v[28:31], v[208:211], v[160:163], v[28:31]
buffer_load_dwordx4 v[124:127], v244, s[24:27], s91 offen offset:3072 sc1
v_mfma_f32_16x16x32_bf16 v[28:31], v[212:215], v[172:175], v[28:31]
s_sub_u32 s100, s86, 1
ds_read_b64_tr_b16 v[230:231], v243 offset:10240
v_mfma_f32_16x16x32_bf16 v[28:31], v[216:219], v[184:187], v[28:31]
s_and_b32 s100, s100, s72
ds_read_b64_tr_b16 v[232:233], v243 offset:12288
v_mfma_f32_16x16x32_bf16 v[32:35], v[204:207], v[152:155], v[32:35]
s_mul_i32 s100, s100, 196608
ds_read_b64_tr_b16 v[234:235], v243 offset:14336
v_mfma_f32_16x16x32_bf16 v[32:35], v[208:211], v[164:167], v[32:35]
s_add_u32 s87, s68, s100
v_permlane32_swap_b32 v128, v130
v_mfma_f32_16x16x32_bf16 v[32:35], v[212:215], v[176:179], v[32:35]
s_waitcnt lgkmcnt(4)
v_permlane32_swap_b32 v129, v131
v_mfma_f32_16x16x32_bf16 v[32:35], v[216:219], v[188:191], v[32:35]
s_add_u32 s90, s69, s100
v_permlane16_swap_b32 v128, v130
v_mfma_f32_16x16x32_bf16 v[36:39], v[220:223], v[144:147], v[36:39]
s_waitcnt vmcnt(39) lgkmcnt(0)
v_permlane16_swap_b32 v129, v131
v_mfma_f32_16x16x32_bf16 v[36:39], v[224:227], v[156:159], v[36:39]
s_barrier
ds_read_b64_tr_b16 v[204:205], v241 offset:16384
v_mfma_f32_16x16x32_bf16 v[36:39], v[228:231], v[168:171], v[36:39]
s_add_u32 s91, s90, 0x1000
ds_read_b64_tr_b16 v[206:207], v241 offset:18432
v_mfma_f32_16x16x32_bf16 v[36:39], v[232:235], v[180:183], v[36:39]
s_add_u32 s88, s88, 256
ds_read_b64_tr_b16 v[208:209], v241 offset:20480
v_xor_b32 v243, 32, v241
v_mfma_f32_16x16x32_bf16 v[40:43], v[220:223], v[148:151], v[40:43]
s_add_u32 s4, s87, 0
ds_read_b64_tr_b16 v[210:211], v241 offset:22528
v_mfma_f32_16x16x32_bf16 v[40:43], v[224:227], v[160:163], v[40:43]
s_add_u32 s5, s87, 8192
ds_read_b64_tr_b16 v[212:213], v241 offset:24576
v_mfma_f32_16x16x32_bf16 v[40:43], v[228:231], v[172:175], v[40:43]
ds_read_b64_tr_b16 v[214:215], v241 offset:26624
v_mfma_f32_16x16x32_bf16 v[40:43], v[232:235], v[184:187], v[40:43]
buffer_store_dwordx4 v[128:131], v248, s[28:31], s92 offen
v_mfma_f32_16x16x32_bf16 v[44:47], v[220:223], v[152:155], v[44:47]
ds_read_b64_tr_b16 v[216:217], v241 offset:28672
v_mfma_f32_16x16x32_bf16 v[44:47], v[224:227], v[164:167], v[44:47]
ds_read_b64_tr_b16 v[218:219], v241 offset:30720
v_mfma_f32_16x16x32_bf16 v[44:47], v[228:231], v[176:179], v[44:47]
s_waitcnt lgkmcnt(4)
v_mfma_f32_16x16x32_bf16 v[44:47], v[232:235], v[188:191], v[44:47]
ds_read_b64_tr_b16 v[220:221], v243 offset:16384
v_mfma_f32_16x16x32_bf16 v[48:51], v[204:207], a[144:147], 0
ds_read_b64_tr_b16 v[222:223], v243 offset:18432
v_mfma_f32_16x16x32_bf16 v[48:51], v[208:211], a[156:159], v[48:51]
s_waitcnt lgkmcnt(2)
ds_read_b64_tr_b16 v[224:225], v243 offset:20480
v_mfma_f32_16x16x32_bf16 v[48:51], v[212:215], a[168:171], v[48:51]
ds_read_b64_tr_b16 v[226:227], v243 offset:22528
v_mfma_f32_16x16x32_bf16 v[48:51], v[216:219], a[180:183], v[48:51]
ds_read_b64_tr_b16 v[228:229], v243 offset:24576
v_xor_b32 v242, 64, v241
v_mfma_f32_16x16x32_bf16 v[52:55], v[204:207], a[148:151], 0
ds_read_b64_tr_b16 v[230:231], v243 offset:26624
v_mfma_f32_16x16x32_bf16 v[52:55], v[208:211], a[160:163], v[52:55]
ds_read_b64_tr_b16 v[232:233], v243 offset:28672
v_mfma_f32_16x16x32_bf16 v[52:55], v[212:215], a[172:175], v[52:55]
ds_read_b64_tr_b16 v[234:235], v243 offset:30720
v_mfma_f32_16x16x32_bf16 v[52:55], v[216:219], a[184:187], v[52:55]
v_mfma_f32_16x16x32_bf16 v[56:59], v[204:207], a[152:155], 0
s_waitcnt vmcnt(1)
v_cvt_pk_bf16_f32 v0, v0, v1
v_cvt_pk_bf16_f32 v1, v2, v3
v_mfma_f32_16x16x32_bf16 v[56:59], v[208:211], a[164:167], v[56:59]
v_cvt_pk_bf16_f32 v2, v12, v13
v_cvt_pk_bf16_f32 v3, v14, v15
v_mfma_f32_16x16x32_bf16 v[56:59], v[212:215], a[176:179], v[56:59]
s_waitcnt lgkmcnt(4)
buffer_store_dwordx4 v[0:3], v244, s[24:27], s4 offen sc1
v_mfma_f32_16x16x32_bf16 v[56:59], v[216:219], a[188:191], v[56:59]
s_add_u32 s4, s87, 16384
ds_read_b64_tr_b16 v[204:205], v242 offset:16384
v_cvt_pk_bf16_f32 v24, v24, v25
v_mfma_f32_16x16x32_bf16 v[60:63], v[220:223], a[144:147], 0
ds_read_b64_tr_b16 v[206:207], v242 offset:18432
v_cvt_pk_bf16_f32 v25, v26, v27
v_mfma_f32_16x16x32_bf16 v[60:63], v[224:227], a[156:159], v[60:63]
s_waitcnt lgkmcnt(2)
ds_read_b64_tr_b16 v[208:209], v242 offset:20480
v_cvt_pk_bf16_f32 v26, v36, v37
v_mfma_f32_16x16x32_bf16 v[60:63], v[228:231], a[168:171], v[60:63]
ds_read_b64_tr_b16 v[210:211], v242 offset:22528
v_cvt_pk_bf16_f32 v27, v38, v39
v_mfma_f32_16x16x32_bf16 v[60:63], v[232:235], a[180:183], v[60:63]
buffer_store_dwordx4 v[24:27], v244, s[24:27], s5 offen sc1
v_mfma_f32_16x16x32_bf16 v[64:67], v[220:223], a[148:151], 0
s_add_u32 s5, s87, 24576
ds_read_b64_tr_b16 v[212:213], v242 offset:24576
v_cvt_pk_bf16_f32 v4, v4, v5
v_mfma_f32_16x16x32_bf16 v[64:67], v[224:227], a[160:163], v[64:67]
ds_read_b64_tr_b16 v[214:215], v242 offset:26624
v_cvt_pk_bf16_f32 v5, v6, v7
v_mfma_f32_16x16x32_bf16 v[64:67], v[228:231], a[172:175], v[64:67]
ds_read_b64_tr_b16 v[216:217], v242 offset:28672
v_cvt_pk_bf16_f32 v6, v16, v17
v_mfma_f32_16x16x32_bf16 v[64:67], v[232:235], a[184:187], v[64:67]
ds_read_b64_tr_b16 v[218:219], v242 offset:30720
v_cvt_pk_bf16_f32 v7, v18, v19
v_mfma_f32_16x16x32_bf16 v[68:71], v[220:223], a[152:155], 0
buffer_store_dwordx4 v[4:7], v244, s[24:27], s4 offen sc1
v_mfma_f32_16x16x32_bf16 v[68:71], v[224:227], a[164:167], v[68:71]
s_add_u32 s4, s87, 32768
v_xor_b32 v243, 96, v241
v_cvt_pk_bf16_f32 v28, v28, v29
v_mfma_f32_16x16x32_bf16 v[68:71], v[228:231], a[176:179], v[68:71]
s_waitcnt lgkmcnt(4)
v_cvt_pk_bf16_f32 v29, v30, v31
v_cvt_pk_bf16_f32 v30, v40, v41
v_mfma_f32_16x16x32_bf16 v[68:71], v[232:235], a[188:191], v[68:71]
ds_read_b64_tr_b16 v[220:221], v243 offset:16384
v_cvt_pk_bf16_f32 v31, v42, v43
v_mfma_f32_16x16x32_bf16 v[72:75], v[204:207], a[144:147], 0
buffer_store_dwordx4 v[28:31], v244, s[24:27], s5 offen sc1
v_mfma_f32_16x16x32_bf16 v[72:75], v[208:211], a[156:159], v[72:75]
s_waitcnt lgkmcnt(1)
ds_read_b64_tr_b16 v[222:223], v243 offset:18432
v_cvt_pk_bf16_f32 v8, v8, v9
v_mfma_f32_16x16x32_bf16 v[72:75], v[212:215], a[168:171], v[72:75]
s_add_u32 s5, s87, 40960
ds_read_b64_tr_b16 v[224:225], v243 offset:20480
v_cvt_pk_bf16_f32 v9, v10, v11
v_mfma_f32_16x16x32_bf16 v[72:75], v[216:219], a[180:183], v[72:75]
s_add_u32 s92, s71, s39
ds_read_b64_tr_b16 v[226:227], v243 offset:22528
v_cvt_pk_bf16_f32 v10, v20, v21
v_mfma_f32_16x16x32_bf16 v[76:79], v[204:207], a[148:151], 0
s_add_u32 s56, s41, s96
ds_read_b64_tr_b16 v[228:229], v243 offset:24576
v_cvt_pk_bf16_f32 v11, v22, v23
v_mfma_f32_16x16x32_bf16 v[76:79], v[208:211], a[160:163], v[76:79]
s_add_u32 s57, s56, s50
buffer_store_dwordx4 v[8:11], v244, s[24:27], s4 offen sc1
v_mfma_f32_16x16x32_bf16 v[76:79], v[212:215], a[172:175], v[76:79]
s_add_u32 s58, s56, s51
ds_read_b64_tr_b16 v[230:231], v243 offset:26624
v_cvt_pk_bf16_f32 v32, v32, v33
v_mfma_f32_16x16x32_bf16 v[76:79], v[216:219], a[184:187], v[76:79]
s_add_u32 s59, s56, s52
ds_read_b64_tr_b16 v[232:233], v243 offset:28672
v_cvt_pk_bf16_f32 v33, v34, v35
v_mfma_f32_16x16x32_bf16 v[80:83], v[204:207], a[152:155], 0
s_add_u32 s39, s39, 128
ds_read_b64_tr_b16 v[234:235], v243 offset:30720
v_cvt_pk_bf16_f32 v34, v44, v45
v_cvt_pk_bf16_f32 v35, v46, v47
v_mfma_f32_16x16x32_bf16 v[80:83], v[208:211], a[164:167], v[80:83]
s_and_b32 s39, s39, 0x3ff
buffer_store_dwordx4 v[32:35], v244, s[24:27], s5 offen sc1
v_mfma_f32_16x16x32_bf16 v[80:83], v[212:215], a[176:179], v[80:83]
s_waitcnt lgkmcnt(4)
v_add_u32 v241, 0x18000, v241
v_lshlrev_b32 v249, 16, v96
v_mfma_f32_16x16x32_bf16 v[80:83], v[216:219], a[188:191], v[80:83]
s_add_u32 m0, s60, 114688
ds_read_b64_tr_b16 v[204:205], v241 offset:0
v_and_b32 v96, s6, v96
v_mfma_f32_16x16x32_bf16 v[84:87], v[220:223], a[144:147], 0
s_add_u32 s86, s86, 1
ds_read_b64_tr_b16 v[206:207], v241 offset:2048
v_lshlrev_b32 v254, 16, v100
v_mfma_f32_16x16x32_bf16 v[84:87], v[224:227], a[156:159], v[84:87]
s_waitcnt lgkmcnt(2)
ds_read_b64_tr_b16 v[208:209], v241 offset:4096
v_and_b32 v100, s6, v100
v_mfma_f32_16x16x32_bf16 v[84:87], v[228:231], a[168:171], v[84:87]
ds_read_b64_tr_b16 v[210:211], v241 offset:6144
v_add_f32 v249, v249, v254
v_mfma_f32_16x16x32_bf16 v[84:87], v[232:235], a[180:183], v[84:87]
ds_read_b64_tr_b16 v[212:213], v241 offset:8192
v_xor_b32 v243, 32, v241
v_mfma_f32_16x16x32_bf16 v[88:91], v[220:223], a[148:151], 0
ds_read_b64_tr_b16 v[214:215], v241 offset:10240
v_add_f32 v96, v96, v100
v_mfma_f32_16x16x32_bf16 v[88:91], v[224:227], a[160:163], v[88:91]
ds_read_b64_tr_b16 v[216:217], v241 offset:12288
v_lshlrev_b32 v255, 16, v104
v_mfma_f32_16x16x32_bf16 v[88:91], v[228:231], a[172:175], v[88:91]
ds_read_b64_tr_b16 v[218:219], v241 offset:14336
v_and_b32 v104, s6, v104
v_mfma_f32_16x16x32_bf16 v[88:91], v[232:235], a[184:187], v[88:91]
buffer_load_dwordx4 v246, s[16:19], s56 offen offset:0 lds
v_mfma_f32_16x16x32_bf16 v[92:95], v[220:223], a[152:155], 0
v_add_f32 v249, v249, v255
v_add_f32 v96, v96, v104
v_mfma_f32_16x16x32_bf16 v[92:95], v[224:227], a[164:167], v[92:95]
v_lshlrev_b32 v254, 16, v108
v_and_b32 v108, s6, v108
v_mfma_f32_16x16x32_bf16 v[92:95], v[228:231], a[176:179], v[92:95]
s_waitcnt lgkmcnt(4)
v_add_f32 v249, v249, v254
v_add_f32 v96, v96, v108
v_mfma_f32_16x16x32_bf16 v[92:95], v[232:235], a[188:191], v[92:95]
ds_read_b64_tr_b16 v[220:221], v243 offset:0
v_lshlrev_b32 v255, 16, v112
v_mfma_f32_16x16x32_bf16 v[48:51], v[204:207], a[192:195], v[48:51]
ds_read_b64_tr_b16 v[222:223], v243 offset:2048
v_and_b32 v112, s6, v112
v_mfma_f32_16x16x32_bf16 v[48:51], v[208:211], a[204:207], v[48:51]
s_waitcnt lgkmcnt(2)
buffer_load_dwordx4 v246, s[16:19], s57 offen offset:1024 lds
v_mfma_f32_16x16x32_bf16 v[48:51], v[212:215], a[216:219], v[48:51]
ds_read_b64_tr_b16 v[224:225], v243 offset:4096
v_add_f32 v249, v249, v255
v_mfma_f32_16x16x32_bf16 v[48:51], v[216:219], a[228:231], v[48:51]
ds_read_b64_tr_b16 v[226:227], v243 offset:6144
v_xor_b32 v242, 64, v241
v_mfma_f32_16x16x32_bf16 v[52:55], v[204:207], a[196:199], v[52:55]
ds_read_b64_tr_b16 v[228:229], v243 offset:8192
v_add_f32 v96, v96, v112
v_mfma_f32_16x16x32_bf16 v[52:55], v[208:211], a[208:211], v[52:55]
ds_read_b64_tr_b16 v[230:231], v243 offset:10240
v_lshlrev_b32 v254, 16, v116
v_mfma_f32_16x16x32_bf16 v[52:55], v[212:215], a[220:223], v[52:55]
buffer_load_dwordx4 v246, s[16:19], s58 offen offset:2048 lds
v_mfma_f32_16x16x32_bf16 v[52:55], v[216:219], a[232:235], v[52:55]
ds_read_b64_tr_b16 v[232:233], v243 offset:12288
v_and_b32 v116, s6, v116
v_mfma_f32_16x16x32_bf16 v[56:59], v[204:207], a[200:203], v[56:59]
ds_read_b64_tr_b16 v[234:235], v243 offset:14336
v_add_f32 v249, v249, v254
v_mfma_f32_16x16x32_bf16 v[56:59], v[208:211], a[212:215], v[56:59]
v_add_f32 v96, v96, v116
v_lshlrev_b32 v255, 16, v120
v_mfma_f32_16x16x32_bf16 v[56:59], v[212:215], a[224:227], v[56:59]
s_waitcnt lgkmcnt(4)
buffer_load_dwordx4 v246, s[16:19], s59 offen offset:3072 lds
v_mfma_f32_16x16x32_bf16 v[56:59], v[216:219], a[236:239], v[56:59]
s_add_u32 m0, s60, 65536
ds_read_b64_tr_b16 v[204:205], v242 offset:0
v_and_b32 v120, s6, v120
v_mfma_f32_16x16x32_bf16 v[60:63], v[220:223], a[192:195], v[60:63]
s_add_u32 s56, s41, s97
ds_read_b64_tr_b16 v[206:207], v242 offset:2048
v_add_f32 v249, v249, v255
v_mfma_f32_16x16x32_bf16 v[60:63], v[224:227], a[204:207], v[60:63]
s_waitcnt lgkmcnt(2)
ds_read_b64_tr_b16 v[208:209], v242 offset:4096
v_add_f32 v96, v96, v120
v_mfma_f32_16x16x32_bf16 v[60:63], v[228:231], a[216:219], v[60:63]
s_add_u32 s57, s56, s50
ds_read_b64_tr_b16 v[210:211], v242 offset:6144
v_lshlrev_b32 v254, 16, v124
v_mfma_f32_16x16x32_bf16 v[60:63], v[232:235], a[228:231], v[60:63]
s_add_u32 s58, s56, s51
ds_read_b64_tr_b16 v[212:213], v242 offset:8192
v_xor_b32 v243, 96, v241
v_mfma_f32_16x16x32_bf16 v[64:67], v[220:223], a[196:199], v[64:67]
s_add_u32 s59, s56, s52
buffer_load_dwordx4 v246, s[16:19], s56 offen offset:0 lds
v_mfma_f32_16x16x32_bf16 v[64:67], v[224:227], a[208:211], v[64:67]
ds_read_b64_tr_b16 v[214:215], v242 offset:10240
v_and_b32 v124, s6, v124
v_mfma_f32_16x16x32_bf16 v[64:67], v[228:231], a[220:223], v[64:67]
ds_read_b64_tr_b16 v[216:217], v242 offset:12288
v_add_f32 v249, v249, v254
v_mfma_f32_16x16x32_bf16 v[64:67], v[232:235], a[232:235], v[64:67]
ds_read_b64_tr_b16 v[218:219], v242 offset:14336
v_add_f32 v96, v96, v124
v_mfma_f32_16x16x32_bf16 v[68:71], v[220:223], a[200:203], v[68:71]
buffer_load_dwordx4 v246, s[16:19], s57 offen offset:1024 lds
v_mfma_f32_16x16x32_bf16 v[68:71], v[224:227], a[212:215], v[68:71]
v_cvt_pk_bf16_f32 v96, v249, v96
v_lshlrev_b32 v250, 16, v97
v_mfma_f32_16x16x32_bf16 v[68:71], v[228:231], a[224:227], v[68:71]
s_waitcnt lgkmcnt(4)
v_and_b32 v97, s6, v97
v_lshlrev_b32 v255, 16, v101
v_mfma_f32_16x16x32_bf16 v[68:71], v[232:235], a[236:239], v[68:71]
ds_read_b64_tr_b16 v[220:221], v243 offset:0
v_and_b32 v101, s6, v101
v_mfma_f32_16x16x32_bf16 v[72:75], v[204:207], a[192:195], v[72:75]
ds_read_b64_tr_b16 v[222:223], v243 offset:2048
v_add_f32 v250, v250, v255
v_mfma_f32_16x16x32_bf16 v[72:75], v[208:211], a[204:207], v[72:75]
s_waitcnt lgkmcnt(2)
ds_read_b64_tr_b16 v[224:225], v243 offset:4096
v_add_f32 v97, v97, v101
v_mfma_f32_16x16x32_bf16 v[72:75], v[212:215], a[216:219], v[72:75]
ds_read_b64_tr_b16 v[226:227], v243 offset:6144
v_lshlrev_b32 v254, 16, v105
v_mfma_f32_16x16x32_bf16 v[72:75], v[216:219], a[228:231], v[72:75]
buffer_load_dwordx4 v246, s[16:19], s58 offen offset:2048 lds
v_mfma_f32_16x16x32_bf16 v[76:79], v[204:207], a[196:199], v[76:79]
ds_read_b64_tr_b16 v[228:229], v243 offset:8192
v_and_b32 v105, s6, v105
v_mfma_f32_16x16x32_bf16 v[76:79], v[208:211], a[208:211], v[76:79]
ds_read_b64_tr_b16 v[230:231], v243 offset:10240
v_add_f32 v250, v250, v254
v_mfma_f32_16x16x32_bf16 v[76:79], v[212:215], a[220:223], v[76:79]
ds_read_b64_tr_b16 v[232:233], v243 offset:12288
v_add_f32 v97, v97, v105
v_mfma_f32_16x16x32_bf16 v[76:79], v[216:219], a[232:235], v[76:79]
ds_read_b64_tr_b16 v[234:235], v243 offset:14336
v_lshlrev_b32 v255, 16, v109
v_mfma_f32_16x16x32_bf16 v[80:83], v[204:207], a[200:203], v[80:83]
buffer_load_dwordx4 v246, s[16:19], s59 offen offset:3072 lds
v_mfma_f32_16x16x32_bf16 v[80:83], v[208:211], a[212:215], v[80:83]
s_add_u32 m0, s60, 16384
v_and_b32 v109, s6, v109
v_add_f32 v250, v250, v255
v_mfma_f32_16x16x32_bf16 v[80:83], v[212:215], a[224:227], v[80:83]
s_waitcnt lgkmcnt(4)
v_add_f32 v97, v97, v109
v_lshlrev_b32 v254, 16, v113
v_mfma_f32_16x16x32_bf16 v[80:83], v[216:219], a[236:239], v[80:83]
s_add_u32 s56, s42, s93
v_and_b32 v113, s6, v113
v_add_f32 v250, v250, v254
v_mfma_f32_16x16x32_bf16 v[84:87], v[220:223], a[192:195], v[84:87]
s_waitcnt vmcnt(8) lgkmcnt(0)
v_add_f32 v97, v97, v113
v_lshlrev_b32 v255, 16, v117
v_mfma_f32_16x16x32_bf16 v[84:87], v[224:227], a[204:207], v[84:87]
s_barrier
ds_read_b64_tr_b16 v[204:205], v241 offset:49152
v_and_b32 v117, s6, v117
v_mfma_f32_16x16x32_bf16 v[84:87], v[228:231], a[216:219], v[84:87]
s_add_u32 s57, s56, s50
buffer_store_dword v244, v245, s[24:27], s88 offen sc1
v_mfma_f32_16x16x32_bf16 v[84:87], v[232:235], a[228:231], v[84:87]
s_add_u32 s58, s56, s51
ds_read_b64_tr_b16 v[206:207], v241 offset:51200
v_xor_b32 v243, 32, v241
v_mfma_f32_16x16x32_bf16 v[88:91], v[220:223], a[196:199], v[88:91]
s_add_u32 s59, s56, s52
ds_read_b64_tr_b16 v[208:209], v241 offset:53248
v_add_f32 v250, v250, v255
v_mfma_f32_16x16x32_bf16 v[88:91], v[224:227], a[208:211], v[88:91]
ds_read_b64_tr_b16 v[210:211], v241 offset:55296
v_add_f32 v97, v97, v117
v_mfma_f32_16x16x32_bf16 v[88:91], v[228:231], a[220:223], v[88:91]
buffer_load_dwordx4 v246, s[16:19], s56 offen offset:0 lds
v_mfma_f32_16x16x32_bf16 v[88:91], v[232:235], a[232:235], v[88:91]
ds_read_b64_tr_b16 v[212:213], v241 offset:57344
v_lshlrev_b32 v254, 16, v121
v_mfma_f32_16x16x32_bf16 v[92:95], v[220:223], a[200:203], v[92:95]
ds_read_b64_tr_b16 v[214:215], v241 offset:59392
v_and_b32 v121, s6, v121
v_mfma_f32_16x16x32_bf16 v[92:95], v[224:227], a[212:215], v[92:95]
ds_read_b64_tr_b16 v[216:217], v241 offset:61440
v_add_f32 v250, v250, v254
v_mfma_f32_16x16x32_bf16 v[92:95], v[228:231], a[224:227], v[92:95]
s_waitcnt lgkmcnt(3)
ds_read_b64_tr_b16 v[218:219], v241 offset:63488
v_add_f32 v97, v97, v121
v_mfma_f32_16x16x32_bf16 v[92:95], v[232:235], a[236:239], v[92:95]
buffer_load_dwordx4 v246, s[16:19], s57 offen offset:1024 lds
v_mfma_f32_16x16x32_bf16 v[48:51], v[204:207], a[0:3], v[48:51]
ds_read_b64_tr_b16 v[220:221], v243 offset:49152
v_lshlrev_b32 v255, 16, v125
v_mfma_f32_16x16x32_bf16 v[48:51], v[208:211], a[12:15], v[48:51]
s_waitcnt lgkmcnt(1)
ds_read_b64_tr_b16 v[222:223], v243 offset:51200
v_and_b32 v125, s6, v125
v_mfma_f32_16x16x32_bf16 v[48:51], v[212:215], a[24:27], v[48:51]
ds_read_b64_tr_b16 v[224:225], v243 offset:53248
v_add_f32 v250, v250, v255
v_mfma_f32_16x16x32_bf16 v[48:51], v[216:219], a[36:39], v[48:51]
ds_read_b64_tr_b16 v[226:227], v243 offset:55296
v_xor_b32 v242, 64, v241
v_mfma_f32_16x16x32_bf16 v[52:55], v[204:207], a[4:7], v[52:55]
buffer_load_dwordx4 v246, s[16:19], s58 offen offset:2048 lds
v_mfma_f32_16x16x32_bf16 v[52:55], v[208:211], a[16:19], v[52:55]
ds_read_b64_tr_b16 v[228:229], v243 offset:57344
v_add_f32 v97, v97, v125
v_mfma_f32_16x16x32_bf16 v[52:55], v[212:215], a[28:31], v[52:55]
ds_read_b64_tr_b16 v[230:231], v243 offset:59392
v_cvt_pk_bf16_f32 v97, v250, v97
v_mfma_f32_16x16x32_bf16 v[52:55], v[216:219], a[40:43], v[52:55]
ds_read_b64_tr_b16 v[232:233], v243 offset:61440
v_lshlrev_b32 v251, 16, v98
v_mfma_f32_16x16x32_bf16 v[56:59], v[204:207], a[8:11], v[56:59]
ds_read_b64_tr_b16 v[234:235], v243 offset:63488
v_and_b32 v98, s6, v98
v_mfma_f32_16x16x32_bf16 v[56:59], v[208:211], a[20:23], v[56:59]
buffer_load_dwordx4 v246, s[16:19], s59 offen offset:3072 lds
v_mfma_f32_16x16x32_bf16 v[56:59], v[212:215], a[32:35], v[56:59]
s_waitcnt lgkmcnt(4)
v_lshlrev_b32 v254, 16, v102
v_and_b32 v102, s6, v102
v_mfma_f32_16x16x32_bf16 v[56:59], v[216:219], a[44:47], v[56:59]
s_add_u32 m0, s60, 98304
ds_read_b64_tr_b16 v[204:205], v242 offset:49152
v_add_f32 v251, v251, v254
v_mfma_f32_16x16x32_bf16 v[60:63], v[220:223], a[0:3], v[60:63]
s_add_u32 s56, s42, s95
ds_read_b64_tr_b16 v[206:207], v242 offset:51200
v_add_f32 v98, v98, v102
v_mfma_f32_16x16x32_bf16 v[60:63], v[224:227], a[12:15], v[60:63]
s_waitcnt lgkmcnt(2)
ds_read_b64_tr_b16 v[208:209], v242 offset:53248
v_lshlrev_b32 v255, 16, v106
v_mfma_f32_16x16x32_bf16 v[60:63], v[228:231], a[24:27], v[60:63]
s_load_dwordx8 s[8:15], s[82:83], s88
ds_read_b64_tr_b16 v[210:211], v242 offset:55296
v_and_b32 v106, s6, v106
v_mfma_f32_16x16x32_bf16 v[60:63], v[232:235], a[36:39], v[60:63]
s_add_u32 s57, s56, s50
buffer_load_dwordx4 v246, s[16:19], s56 offen offset:0 lds
v_mfma_f32_16x16x32_bf16 v[64:67], v[220:223], a[4:7], v[64:67]
s_add_u32 s58, s56, s51
ds_read_b64_tr_b16 v[212:213], v242 offset:57344
v_xor_b32 v243, 96, v241
v_mfma_f32_16x16x32_bf16 v[64:67], v[224:227], a[16:19], v[64:67]
s_add_u32 s59, s56, s52
ds_read_b64_tr_b16 v[214:215], v242 offset:59392
v_add_f32 v251, v251, v255
v_mfma_f32_16x16x32_bf16 v[64:67], v[228:231], a[28:31], v[64:67]
ds_read_b64_tr_b16 v[216:217], v242 offset:61440
v_add_f32 v98, v98, v106
v_mfma_f32_16x16x32_bf16 v[64:67], v[232:235], a[40:43], v[64:67]
ds_read_b64_tr_b16 v[218:219], v242 offset:63488
v_lshlrev_b32 v254, 16, v110
v_mfma_f32_16x16x32_bf16 v[68:71], v[220:223], a[8:11], v[68:71]
buffer_load_dwordx4 v246, s[16:19], s57 offen offset:1024 lds
v_mfma_f32_16x16x32_bf16 v[68:71], v[224:227], a[20:23], v[68:71]
v_add_u32 v241, 0xfffe8000, v241
v_and_b32 v110, s6, v110
v_mfma_f32_16x16x32_bf16 v[68:71], v[228:231], a[32:35], v[68:71]
s_waitcnt lgkmcnt(4)
v_add_f32 v251, v251, v254
v_add_f32 v98, v98, v110
v_mfma_f32_16x16x32_bf16 v[68:71], v[232:235], a[44:47], v[68:71]
ds_read_b64_tr_b16 v[220:221], v243 offset:49152
v_lshlrev_b32 v255, 16, v114
v_mfma_f32_16x16x32_bf16 v[72:75], v[204:207], a[0:3], v[72:75]
ds_read_b64_tr_b16 v[222:223], v243 offset:51200
v_and_b32 v114, s6, v114
v_mfma_f32_16x16x32_bf16 v[72:75], v[208:211], a[12:15], v[72:75]
s_waitcnt lgkmcnt(2)
buffer_load_dwordx4 v246, s[16:19], s58 offen offset:2048 lds
v_mfma_f32_16x16x32_bf16 v[72:75], v[212:215], a[24:27], v[72:75]
ds_read_b64_tr_b16 v[224:225], v243 offset:53248
v_add_f32 v251, v251, v255
v_mfma_f32_16x16x32_bf16 v[72:75], v[216:219], a[36:39], v[72:75]
ds_read_b64_tr_b16 v[226:227], v243 offset:55296
v_add_f32 v98, v98, v114
v_mfma_f32_16x16x32_bf16 v[76:79], v[204:207], a[4:7], v[76:79]
ds_read_b64_tr_b16 v[228:229], v243 offset:57344
v_lshlrev_b32 v254, 16, v118
v_mfma_f32_16x16x32_bf16 v[76:79], v[208:211], a[16:19], v[76:79]
ds_read_b64_tr_b16 v[230:231], v243 offset:59392
v_and_b32 v118, s6, v118
v_mfma_f32_16x16x32_bf16 v[76:79], v[212:215], a[28:31], v[76:79]
buffer_load_dwordx4 v246, s[16:19], s59 offen offset:3072 lds
v_mfma_f32_16x16x32_bf16 v[76:79], v[216:219], a[40:43], v[76:79]
ds_read_b64_tr_b16 v[232:233], v243 offset:61440
v_add_f32 v251, v251, v254
v_mfma_f32_16x16x32_bf16 v[80:83], v[204:207], a[8:11], v[80:83]
ds_read_b64_tr_b16 v[234:235], v243 offset:63488
v_add_f32 v98, v98, v118
v_mfma_f32_16x16x32_bf16 v[80:83], v[208:211], a[20:23], v[80:83]
v_lshlrev_b32 v255, 16, v122
v_and_b32 v122, s6, v122
v_mfma_f32_16x16x32_bf16 v[80:83], v[212:215], a[32:35], v[80:83]
s_waitcnt lgkmcnt(4)
v_add_f32 v251, v251, v255
v_add_f32 v98, v98, v122
v_mfma_f32_16x16x32_bf16 v[80:83], v[216:219], a[44:47], v[80:83]
ds_read_b64_tr_b16 v[204:205], v241 offset:32768
v_lshlrev_b32 v254, 16, v126
v_mfma_f32_16x16x32_bf16 v[84:87], v[220:223], a[0:3], v[84:87]
s_waitcnt lgkmcnt(0)
ds_read_b64_tr_b16 v[206:207], v241 offset:34816
v_and_b32 v126, s6, v126
v_mfma_f32_16x16x32_bf16 v[84:87], v[224:227], a[12:15], v[84:87]
s_waitcnt lgkmcnt(2)
ds_read_b64_tr_b16 v[208:209], v241 offset:36864
v_add_f32 v251, v251, v254
v_mfma_f32_16x16x32_bf16 v[84:87], v[228:231], a[24:27], v[84:87]
s_and_b32 s8, s8, s9
ds_read_b64_tr_b16 v[210:211], v241 offset:38912
v_add_f32 v98, v98, v126
v_mfma_f32_16x16x32_bf16 v[84:87], v[232:235], a[36:39], v[84:87]
s_and_b32 s10, s10, s11
ds_read_b64_tr_b16 v[212:213], v241 offset:40960
v_xor_b32 v243, 32, v241
v_mfma_f32_16x16x32_bf16 v[88:91], v[220:223], a[4:7], v[88:91]
s_and_b32 s12, s12, s13
ds_read_b64_tr_b16 v[214:215], v241 offset:43008
v_cvt_pk_bf16_f32 v98, v251, v98
v_mfma_f32_16x16x32_bf16 v[88:91], v[224:227], a[16:19], v[88:91]
s_and_b32 s14, s14, s15
ds_read_b64_tr_b16 v[216:217], v241 offset:45056
v_lshlrev_b32 v253, 16, v99
v_mfma_f32_16x16x32_bf16 v[88:91], v[228:231], a[28:31], v[88:91]
s_and_b32 s8, s8, s10
ds_read_b64_tr_b16 v[218:219], v241 offset:47104
v_and_b32 v99, s6, v99
v_mfma_f32_16x16x32_bf16 v[88:91], v[232:235], a[40:43], v[88:91]
s_and_b32 s12, s12, s14
v_lshlrev_b32 v255, 16, v103
v_and_b32 v103, s6, v103
v_mfma_f32_16x16x32_bf16 v[92:95], v[220:223], a[8:11], v[92:95]
s_and_b32 s8, s8, s12
v_add_f32 v253, v253, v255
v_add_f32 v99, v99, v103
v_mfma_f32_16x16x32_bf16 v[92:95], v[224:227], a[20:23], v[92:95]
s_bitcmp0_b32 s8, 4
v_lshlrev_b32 v254, 16, v107
v_and_b32 v107, s6, v107
v_mfma_f32_16x16x32_bf16 v[92:95], v[228:231], a[32:35], v[92:95]
s_waitcnt lgkmcnt(4)
v_add_f32 v253, v253, v254
v_add_f32 v99, v99, v107
v_mfma_f32_16x16x32_bf16 v[92:95], v[232:235], a[44:47], v[92:95]
s_cbranch_scc1 L_spinG1S
L_backG1S:
ds_read_b64_tr_b16 v[220:221], v243 offset:32768
v_lshlrev_b32 v255, 16, v111
v_mfma_f32_16x16x32_bf16 v[48:51], v[204:207], v[144:147], v[48:51]
ds_read_b64_tr_b16 v[222:223], v243 offset:34816
v_and_b32 v111, s6, v111
v_mfma_f32_16x16x32_bf16 v[48:51], v[208:211], v[156:159], v[48:51]
s_waitcnt lgkmcnt(2)
buffer_load_dwordx4 v[128:131], v244, s[24:27], s90 offen offset:0 sc1
v_mfma_f32_16x16x32_bf16 v[48:51], v[212:215], v[168:171], v[48:51]
ds_read_b64_tr_b16 v[224:225], v243 offset:36864
v_add_f32 v253, v253, v255
v_mfma_f32_16x16x32_bf16 v[48:51], v[216:219], v[180:183], v[48:51]
ds_read_b64_tr_b16 v[226:227], v243 offset:38912
v_xor_b32 v242, 64, v241
v_mfma_f32_16x16x32_bf16 v[52:55], v[204:207], v[148:151], v[52:55]
ds_read_b64_tr_b16 v[228:229], v243 offset:40960
v_add_f32 v99, v99, v111
v_mfma_f32_16x16x32_bf16 v[52:55], v[208:211], v[160:163], v[52:55]
buffer_load_dwordx4 v[132:135], v244, s[24:27], s90 offen offset:1024 sc1
v_mfma_f32_16x16x32_bf16 v[52:55], v[212:215], v[172:175], v[52:55]
ds_read_b64_tr_b16 v[230:231], v243 offset:43008
v_lshlrev_b32 v254, 16, v115
v_mfma_f32_16x16x32_bf16 v[52:55], v[216:219], v[184:187], v[52:55]
ds_read_b64_tr_b16 v[232:233], v243 offset:45056
v_and_b32 v115, s6, v115
v_mfma_f32_16x16x32_bf16 v[56:59], v[204:207], v[152:155], v[56:59]
ds_read_b64_tr_b16 v[234:235], v243 offset:47104
v_add_f32 v253, v253, v254
v_mfma_f32_16x16x32_bf16 v[56:59], v[208:211], v[164:167], v[56:59]
buffer_load_dwordx4 v[136:139], v244, s[24:27], s90 offen offset:2048 sc1
v_mfma_f32_16x16x32_bf16 v[56:59], v[212:215], v[176:179], v[56:59]
s_waitcnt lgkmcnt(4)
v_add_f32 v99, v99, v115
v_lshlrev_b32 v255, 16, v119
v_mfma_f32_16x16x32_bf16 v[56:59], v[216:219], v[188:191], v[56:59]
ds_read_b64_tr_b16 v[204:205], v242 offset:32768
v_and_b32 v119, s6, v119
v_mfma_f32_16x16x32_bf16 v[60:63], v[220:223], v[144:147], v[60:63]
ds_read_b64_tr_b16 v[206:207], v242 offset:34816
v_add_f32 v253, v253, v255
v_mfma_f32_16x16x32_bf16 v[60:63], v[224:227], v[156:159], v[60:63]
s_waitcnt lgkmcnt(2)
buffer_load_dwordx4 v[140:143], v244, s[24:27], s90 offen offset:3072 sc1
v_mfma_f32_16x16x32_bf16 v[60:63], v[228:231], v[168:171], v[60:63]
ds_read_b64_tr_b16 v[208:209], v242 offset:36864
v_add_f32 v99, v99, v119
v_mfma_f32_16x16x32_bf16 v[60:63], v[232:235], v[180:183], v[60:63]
ds_read_b64_tr_b16 v[210:211], v242 offset:38912
v_xor_b32 v243, 96, v241
v_mfma_f32_16x16x32_bf16 v[64:67], v[220:223], v[148:151], v[64:67]
ds_read_b64_tr_b16 v[212:213], v242 offset:40960
v_lshlrev_b32 v254, 16, v123
v_mfma_f32_16x16x32_bf16 v[64:67], v[224:227], v[160:163], v[64:67]
buffer_load_dwordx4 v[192:195], v244, s[24:27], s91 offen offset:0 sc1
v_mfma_f32_16x16x32_bf16 v[64:67], v[228:231], v[172:175], v[64:67]
ds_read_b64_tr_b16 v[214:215], v242 offset:43008
v_and_b32 v123, s6, v123
v_mfma_f32_16x16x32_bf16 v[64:67], v[232:235], v[184:187], v[64:67]
ds_read_b64_tr_b16 v[216:217], v242 offset:45056
v_add_f32 v253, v253, v254
v_mfma_f32_16x16x32_bf16 v[68:71], v[220:223], v[152:155], v[68:71]
ds_read_b64_tr_b16 v[218:219], v242 offset:47104
v_add_f32 v99, v99, v123
v_mfma_f32_16x16x32_bf16 v[68:71], v[224:227], v[164:167], v[68:71]
buffer_load_dwordx4 v[196:199], v244, s[24:27], s91 offen offset:1024 sc1
v_mfma_f32_16x16x32_bf16 v[68:71], v[228:231], v[176:179], v[68:71]
s_waitcnt lgkmcnt(4)
v_lshlrev_b32 v255, 16, v127
v_and_b32 v127, s6, v127
v_mfma_f32_16x16x32_bf16 v[68:71], v[232:235], v[188:191], v[68:71]
ds_read_b64_tr_b16 v[220:221], v243 offset:32768
v_add_f32 v253, v253, v255
v_mfma_f32_16x16x32_bf16 v[72:75], v[204:207], v[144:147], v[72:75]
ds_read_b64_tr_b16 v[222:223], v243 offset:34816
v_add_f32 v99, v99, v127
v_mfma_f32_16x16x32_bf16 v[72:75], v[208:211], v[156:159], v[72:75]
s_waitcnt lgkmcnt(2)
buffer_load_dwordx4 v[200:203], v244, s[24:27], s91 offen offset:2048 sc1
v_mfma_f32_16x16x32_bf16 v[72:75], v[212:215], v[168:171], v[72:75]
ds_read_b64_tr_b16 v[224:225], v243 offset:36864
v_cvt_pk_bf16_f32 v99, v253, v99
v_mfma_f32_16x16x32_bf16 v[72:75], v[216:219], v[180:183], v[72:75]
ds_read_b64_tr_b16 v[226:227], v243 offset:38912
v_mfma_f32_16x16x32_bf16 v[76:79], v[204:207], v[148:151], v[76:79]
ds_read_b64_tr_b16 v[228:229], v243 offset:40960
v_mfma_f32_16x16x32_bf16 v[76:79], v[208:211], v[160:163], v[76:79]
buffer_load_dwordx4 v[236:239], v244, s[24:27], s91 offen offset:3072 sc1
v_mfma_f32_16x16x32_bf16 v[76:79], v[212:215], v[172:175], v[76:79]
s_sub_u32 s100, s86, 1
ds_read_b64_tr_b16 v[230:231], v243 offset:43008
v_mfma_f32_16x16x32_bf16 v[76:79], v[216:219], v[184:187], v[76:79]
s_and_b32 s100, s100, s72
ds_read_b64_tr_b16 v[232:233], v243 offset:45056
v_mfma_f32_16x16x32_bf16 v[80:83], v[204:207], v[152:155], v[80:83]
s_mul_i32 s100, s100, 196608
ds_read_b64_tr_b16 v[234:235], v243 offset:47104
v_mfma_f32_16x16x32_bf16 v[80:83], v[208:211], v[164:167], v[80:83]
s_add_u32 s87, s68, s100
v_permlane32_swap_b32 v96, v98
v_mfma_f32_16x16x32_bf16 v[80:83], v[212:215], v[176:179], v[80:83]
s_waitcnt lgkmcnt(4)
v_permlane32_swap_b32 v97, v99
v_mfma_f32_16x16x32_bf16 v[80:83], v[216:219], v[188:191], v[80:83]
s_add_u32 s90, s69, s100
v_permlane16_swap_b32 v96, v98
v_mfma_f32_16x16x32_bf16 v[84:87], v[220:223], v[144:147], v[84:87]
s_waitcnt vmcnt(40) lgkmcnt(0)
v_permlane16_swap_b32 v97, v99
v_mfma_f32_16x16x32_bf16 v[84:87], v[224:227], v[156:159], v[84:87]
s_barrier
ds_read_b64_tr_b16 v[204:205], v241 offset:49152
v_mfma_f32_16x16x32_bf16 v[84:87], v[228:231], v[168:171], v[84:87]
s_add_u32 s91, s90, 0x1000
ds_read_b64_tr_b16 v[206:207], v241 offset:51200
v_mfma_f32_16x16x32_bf16 v[84:87], v[232:235], v[180:183], v[84:87]
s_add_u32 s88, s88, 256
ds_read_b64_tr_b16 v[208:209], v241 offset:53248
v_mfma_f32_16x16x32_bf16 v[88:91], v[220:223], v[148:151], v[88:91]
ds_read_b64_tr_b16 v[210:211], v241 offset:55296
v_mfma_f32_16x16x32_bf16 v[88:91], v[224:227], v[160:163], v[88:91]
ds_read_b64_tr_b16 v[212:213], v241 offset:57344
v_mfma_f32_16x16x32_bf16 v[88:91], v[228:231], v[172:175], v[88:91]
ds_read_b64_tr_b16 v[214:215], v241 offset:59392
v_mfma_f32_16x16x32_bf16 v[88:91], v[232:235], v[184:187], v[88:91]
buffer_store_dwordx4 v[96:99], v248, s[28:31], s92 offen
v_mfma_f32_16x16x32_bf16 v[92:95], v[220:223], v[152:155], v[92:95]
ds_read_b64_tr_b16 v[216:217], v241 offset:61440
v_mfma_f32_16x16x32_bf16 v[92:95], v[224:227], v[164:167], v[92:95]
ds_read_b64_tr_b16 v[218:219], v241 offset:63488
v_mfma_f32_16x16x32_bf16 v[92:95], v[228:231], v[176:179], v[92:95]
v_mfma_f32_16x16x32_bf16 v[92:95], v[232:235], v[188:191], v[92:95]
s_mov_b32 s40, s42
s_add_u32 s41, s40, 128
s_and_b32 s41, s41, 0x3ff
s_add_u32 s42, s41, 128
s_and_b32 s42, s42, 0x3ff
s_cmp_lt_u32 s86, 8
s_cbranch_scc1 L_GS
s_add_u32 s92, s71, s39
s_add_u32 s39, s39, 128
s_and_b32 s39, s39, 0x3ff
s_add_u32 s86, s86, 1
s_nop 1
v_cvt_pk_bf16_f32 v48, v48, v49
v_cvt_pk_bf16_f32 v49, v50, v51
v_cvt_pk_bf16_f32 v50, v60, v61
v_cvt_pk_bf16_f32 v51, v62, v63
s_add_u32 s4, s87, 0
buffer_store_dwordx4 v[48:51], v244, s[24:27], s4 offen sc1
v_cvt_pk_bf16_f32 v72, v72, v73
v_cvt_pk_bf16_f32 v73, v74, v75
v_cvt_pk_bf16_f32 v74, v84, v85
v_cvt_pk_bf16_f32 v75, v86, v87
s_add_u32 s5, s87, 8192
buffer_store_dwordx4 v[72:75], v244, s[24:27], s5 offen sc1
v_cvt_pk_bf16_f32 v52, v52, v53
v_cvt_pk_bf16_f32 v53, v54, v55
v_cvt_pk_bf16_f32 v54, v64, v65
v_cvt_pk_bf16_f32 v55, v66, v67
s_add_u32 s4, s87, 16384
buffer_store_dwordx4 v[52:55], v244, s[24:27], s4 offen sc1
v_cvt_pk_bf16_f32 v76, v76, v77
v_cvt_pk_bf16_f32 v77, v78, v79
v_cvt_pk_bf16_f32 v78, v88, v89
v_cvt_pk_bf16_f32 v79, v90, v91
s_add_u32 s5, s87, 24576
buffer_store_dwordx4 v[76:79], v244, s[24:27], s5 offen sc1
v_cvt_pk_bf16_f32 v56, v56, v57
v_cvt_pk_bf16_f32 v57, v58, v59
v_cvt_pk_bf16_f32 v58, v68, v69
v_cvt_pk_bf16_f32 v59, v70, v71
s_add_u32 s4, s87, 32768
buffer_store_dwordx4 v[56:59], v244, s[24:27], s4 offen sc1
v_cvt_pk_bf16_f32 v80, v80, v81
v_cvt_pk_bf16_f32 v81, v82, v83
v_cvt_pk_bf16_f32 v82, v92, v93
v_cvt_pk_bf16_f32 v83, v94, v95
s_add_u32 s5, s87, 40960
buffer_store_dwordx4 v[80:83], v244, s[24:27], s5 offen sc1
s_waitcnt vmcnt(14)
v_mfma_f32_16x16x32_bf16 v[220:223], a[48:51], v[128:131], 0
v_mfma_f32_16x16x32_bf16 v[224:227], a[52:55], v[128:131], 0
s_waitcnt vmcnt(13)
v_mfma_f32_16x16x32_bf16 v[220:223], a[48:51], v[132:135], v[220:223]
v_mfma_f32_16x16x32_bf16 v[224:227], a[52:55], v[132:135], v[224:227]
s_waitcnt vmcnt(12)
v_mfma_f32_16x16x32_bf16 v[220:223], a[48:51], v[136:139], v[220:223]
v_mfma_f32_16x16x32_bf16 v[224:227], a[52:55], v[136:139], v[224:227]
s_waitcnt vmcnt(11)
v_mfma_f32_16x16x32_bf16 v[220:223], a[48:51], v[140:143], v[220:223]
v_mfma_f32_16x16x32_bf16 v[224:227], a[52:55], v[140:143], v[224:227]
s_waitcnt vmcnt(10)
v_mfma_f32_16x16x32_bf16 v[220:223], a[48:51], v[192:195], v[220:223]
v_mfma_f32_16x16x32_bf16 v[224:227], a[52:55], v[192:195], v[224:227]
s_waitcnt vmcnt(9)
v_mfma_f32_16x16x32_bf16 v[220:223], a[48:51], v[196:199], v[220:223]
v_mfma_f32_16x16x32_bf16 v[224:227], a[52:55], v[196:199], v[224:227]
s_waitcnt vmcnt(8)
v_mfma_f32_16x16x32_bf16 v[220:223], a[48:51], v[200:203], v[220:223]
v_mfma_f32_16x16x32_bf16 v[224:227], a[52:55], v[200:203], v[224:227]
s_waitcnt vmcnt(7)
v_mfma_f32_16x16x32_bf16 v[220:223], a[48:51], v[236:239], v[220:223]
v_mfma_f32_16x16x32_bf16 v[224:227], a[52:55], v[236:239], v[224:227]
s_nop 7
v_cvt_pk_bf16_f32 v232, v220, v221
v_cvt_pk_bf16_f32 v233, v222, v223
v_cvt_pk_bf16_f32 v234, v224, v225
v_cvt_pk_bf16_f32 v235, v226, v227
buffer_store_dwordx4 v[232:235], v248, s[28:31], s92 offen
s_waitcnt vmcnt(1)
s_barrier
buffer_store_dword v244, v245, s[24:27], s88 offen sc1
s_branch L_spinUS
L_backUS:
buffer_load_dwordx4 v[96:99], v244, s[24:27], s90 offen offset:0 sc1
buffer_load_dwordx4 v[100:103], v244, s[24:27], s90 offen offset:1024 sc1
buffer_load_dwordx4 v[104:107], v244, s[24:27], s90 offen offset:2048 sc1
buffer_load_dwordx4 v[108:111], v244, s[24:27], s90 offen offset:3072 sc1
buffer_load_dwordx4 v[112:115], v244, s[24:27], s91 offen offset:0 sc1
buffer_load_dwordx4 v[116:119], v244, s[24:27], s91 offen offset:1024 sc1
buffer_load_dwordx4 v[120:123], v244, s[24:27], s91 offen offset:2048 sc1
buffer_load_dwordx4 v[124:127], v244, s[24:27], s91 offen offset:3072 sc1
s_add_u32 s92, s71, s39
s_waitcnt vmcnt(7)
v_mfma_f32_16x16x32_bf16 v[220:223], a[48:51], v[96:99], 0
v_mfma_f32_16x16x32_bf16 v[224:227], a[52:55], v[96:99], 0
s_waitcnt vmcnt(6)
v_mfma_f32_16x16x32_bf16 v[220:223], a[48:51], v[100:103], v[220:223]
v_mfma_f32_16x16x32_bf16 v[224:227], a[52:55], v[100:103], v[224:227]
s_waitcnt vmcnt(5)
v_mfma_f32_16x16x32_bf16 v[220:223], a[48:51], v[104:107], v[220:223]
v_mfma_f32_16x16x32_bf16 v[224:227], a[52:55], v[104:107], v[224:227]
s_waitcnt vmcnt(4)
v_mfma_f32_16x16x32_bf16 v[220:223], a[48:51], v[108:111], v[220:223]
v_mfma_f32_16x16x32_bf16 v[224:227], a[52:55], v[108:111], v[224:227]
s_waitcnt vmcnt(3)
v_mfma_f32_16x16x32_bf16 v[220:223], a[48:51], v[112:115], v[220:223]
v_mfma_f32_16x16x32_bf16 v[224:227], a[52:55], v[112:115], v[224:227]
s_waitcnt vmcnt(2)
v_mfma_f32_16x16x32_bf16 v[220:223], a[48:51], v[116:119], v[220:223]
v_mfma_f32_16x16x32_bf16 v[224:227], a[52:55], v[116:119], v[224:227]
s_waitcnt vmcnt(1)
v_mfma_f32_16x16x32_bf16 v[220:223], a[48:51], v[120:123], v[220:223]
v_mfma_f32_16x16x32_bf16 v[224:227], a[52:55], v[120:123], v[224:227]
s_waitcnt vmcnt(0)
v_mfma_f32_16x16x32_bf16 v[220:223], a[48:51], v[124:127], v[220:223]
v_mfma_f32_16x16x32_bf16 v[224:227], a[52:55], v[124:127], v[224:227]
s_nop 7
v_cvt_pk_bf16_f32 v228, v220, v221
v_cvt_pk_bf16_f32 v229, v222, v223
v_cvt_pk_bf16_f32 v230, v224, v225
v_cvt_pk_bf16_f32 v231, v226, v227
buffer_store_dwordx4 v[228:231], v248, s[28:31], s92 offen
s_endpgm
L_spinG0S:
s_mov_b32 s3, 0
L_spinG0S_l:
buffer_load_dword v247, v240, s[24:27], s88 offen sc1
s_add_u32 s3, s3, 1
s_waitcnt vmcnt(0)
v_cmp_ne_u32 vcc, s89, v247
s_cmp_gt_u32 s3, 0x10000
s_cbranch_scc1 L_backG0S
s_nop 2
s_cbranch_vccnz L_spinG0S_l
s_branch L_backG0S
L_spinG1S:
s_mov_b32 s3, 0
L_spinG1S_l:
buffer_load_dword v247, v240, s[24:27], s88 offen sc1
s_add_u32 s3, s3, 1
s_waitcnt vmcnt(0)
v_cmp_ne_u32 vcc, s89, v247
s_cmp_gt_u32 s3, 0x10000
s_cbranch_scc1 L_backG1S
s_nop 2
s_cbranch_vccnz L_spinG1S_l
s_branch L_backG1S
L_spinG1FS:
s_mov_b32 s3, 0
L_spinG1FS_l:
buffer_load_dword v247, v240, s[24:27], s88 offen sc1
s_add_u32 s3, s3, 1
s_waitcnt vmcnt(0)
v_cmp_ne_u32 vcc, s89, v247
s_cmp_gt_u32 s3, 0x10000
s_cbranch_scc1 L_backG1FS
s_nop 2
s_cbranch_vccnz L_spinG1FS_l
s_branch L_backG1FS
L_spinUS:
s_mov_b32 s3, 0
L_spinUS_l:
buffer_load_dword v247, v240, s[24:27], s88 offen sc1
s_add_u32 s3, s3, 1
s_waitcnt vmcnt(0)
v_cmp_ne_u32 vcc, s89, v247
s_cmp_gt_u32 s3, 0x10000
s_cbranch_scc1 L_backUS
s_nop 2
s_cbranch_vccnz L_spinUS_l
s_branch L_backUS
L_spinD:
s_add_u32 s3, s3, 1
s_cmp_gt_u32 s3, 0x10000
s_cbranch_scc1 L_backD
s_lshl_b32 s100, s64, 2
buffer_load_dword v252, off, s[32:35], s100 sc1
s_waitcnt vmcnt(0)
s_branch L_chkD
L_slow:
s_waitcnt vmcnt(0) lgkmcnt(0)
s_nop 7
v_mbcnt_lo_u32_b32 v255, -1, 0
v_mbcnt_hi_u32_b32 v255, -1, v255
v_and_b32 v254, 15, v255
v_lshrrev_b32 v255, 4, v255
v_lshlrev_b32 v184, 8, v254
v_lshl_add_u32 v184, v255, 4, v184
s_and_b32 s4, s49, 128
s_xor_b32 s5, s4, 128
v_add_u32 v187, s5, v184
v_add_u32 v184, s4, v184
v_lshlrev_b32 v185, 10, v255
v_lshl_add_u32 v185, v254, 1, v185
v_add_u32 v186, 0x1000, v185
s_add_u32 s4, s98, s61
s_and_b32 s4, s4, 3
s_lshl_b32 s4, s4, 17
s_mov_b32 s10, 0x80000
s_mov_b32 s14, 0x80000
s_add_u32 s5, s4, 0x20000
s_mov_b32 s6, s4
v_mov_b32 v180, 0xff800000
v_mov_b32 v181, 0xff800000
v_mov_b32 v182, 0xff800000
L_slow1:
buffer_load_dwordx4 v[204:207], v184, s[8:11], s6 offen offset:0
buffer_load_dwordx4 v[208:211], v184, s[8:11], s6 offen offset:64
buffer_load_dwordx4 v[212:215], v187, s[8:11], s6 offen offset:0
buffer_load_dwordx4 v[216:219], v187, s[8:11], s6 offen offset:64
s_waitcnt vmcnt(0)
v_mfma_f32_16x16x32_bf16 v[192:195], v[204:207], v[96:99], 0
v_mfma_f32_16x16x32_bf16 v[192:195], v[208:211], v[108:111], v[192:195]
v_mfma_f32_16x16x32_bf16 v[192:195], v[212:215], v[120:123], v[192:195]
v_mfma_f32_16x16x32_bf16 v[192:195], v[216:219], v[132:135], v[192:195]
v_mfma_f32_16x16x32_bf16 v[196:199], v[204:207], v[100:103], 0
v_mfma_f32_16x16x32_bf16 v[196:199], v[208:211], v[112:115], v[196:199]
v_mfma_f32_16x16x32_bf16 v[196:199], v[212:215], v[124:127], v[196:199]
v_mfma_f32_16x16x32_bf16 v[196:199], v[216:219], v[136:139], v[196:199]
v_mfma_f32_16x16x32_bf16 v[200:203], v[204:207], v[104:107], 0
v_mfma_f32_16x16x32_bf16 v[200:203], v[208:211], v[116:119], v[200:203]
v_mfma_f32_16x16x32_bf16 v[200:203], v[212:215], v[128:131], v[200:203]
v_mfma_f32_16x16x32_bf16 v[200:203], v[216:219], v[140:143], v[200:203]
s_nop 9
v_max3_f32 v180, v180, v192, v193
v_max3_f32 v180, v180, v194, v195
v_max3_f32 v181, v181, v196, v197
v_max3_f32 v181, v181, v198, v199
v_max3_f32 v182, v182, v200, v201
v_max3_f32 v182, v182, v202, v203
s_add_u32 s6, s6, 0x1000
s_cmp_lt_u32 s6, s5
s_cbranch_scc1 L_slow1
v_mov_b32 v254, v180
s_nop 1
v_permlane32_swap_b32 v254, v180
s_nop 1
v_max_f32 v180, v254, v180
v_mov_b32 v254, v180
s_nop 1
v_permlane16_swap_b32 v254, v180
s_nop 1
v_max_f32 v180, v254, v180
v_sub_f32 v168, 0, v180
v_sub_f32 v169, 0, v180
v_sub_f32 v170, 0, v180
v_sub_f32 v171, 0, v180
v_mov_b32 v254, v181
s_nop 1
v_permlane32_swap_b32 v254, v181
s_nop 1
v_max_f32 v181, v254, v181
v_mov_b32 v254, v181
s_nop 1
v_permlane16_swap_b32 v254, v181
s_nop 1
v_max_f32 v181, v254, v181
v_sub_f32 v172, 0, v181
v_sub_f32 v173, 0, v181
v_sub_f32 v174, 0, v181
v_sub_f32 v175, 0, v181
v_mov_b32 v254, v182
s_nop 1
v_permlane32_swap_b32 v254, v182
s_nop 1
v_max_f32 v182, v254, v182
v_mov_b32 v254, v182
s_nop 1
v_permlane16_swap_b32 v254, v182
s_nop 1
v_max_f32 v182, v254, v182
v_sub_f32 v176, 0, v182
v_sub_f32 v177, 0, v182
v_sub_f32 v178, 0, v182
v_sub_f32 v179, 0, v182
v_mov_b32 v0, 0
v_mov_b32 v1, 0
v_mov_b32 v2, 0
v_mov_b32 v3, 0
v_mov_b32 v4, 0
v_mov_b32 v5, 0
v_mov_b32 v6, 0
v_mov_b32 v7, 0
v_mov_b32 v8, 0
v_mov_b32 v9, 0
v_mov_b32 v10, 0
v_mov_b32 v11, 0
v_mov_b32 v12, 0
v_mov_b32 v13, 0
v_mov_b32 v14, 0
v_mov_b32 v15, 0
v_mov_b32 v16, 0
v_mov_b32 v17, 0
v_mov_b32 v18, 0
v_mov_b32 v19, 0
v_mov_b32 v20, 0
v_mov_b32 v21, 0
v_mov_b32 v22, 0
v_mov_b32 v23, 0
v_mov_b32 v24, 0
v_mov_b32 v25, 0
v_mov_b32 v26, 0
v_mov_b32 v27, 0
v_mov_b32 v28, 0
v_mov_b32 v29, 0
v_mov_b32 v30, 0
v_mov_b32 v31, 0
v_mov_b32 v32, 0
v_mov_b32 v33, 0
v_mov_b32 v34, 0
v_mov_b32 v35, 0
v_mov_b32 v36, 0
v_mov_b32 v37, 0
v_mov_b32 v38, 0
v_mov_b32 v39, 0
v_mov_b32 v40, 0
v_mov_b32 v41, 0
v_mov_b32 v42, 0
v_mov_b32 v43, 0
v_mov_b32 v44, 0
v_mov_b32 v45, 0
v_mov_b32 v46, 0
v_mov_b32 v47, 0
v_mov_b32 v48, 0
v_mov_b32 v49, 0
v_mov_b32 v50, 0
v_mov_b32 v51, 0
v_mov_b32 v52, 0
v_mov_b32 v53, 0
v_mov_b32 v54, 0
v_mov_b32 v55, 0
v_mov_b32 v56, 0
v_mov_b32 v57, 0
v_mov_b32 v58, 0
v_mov_b32 v59, 0
v_mov_b32 v60, 0
v_mov_b32 v61, 0
v_mov_b32 v62, 0
v_mov_b32 v63, 0
v_mov_b32 v64, 0
v_mov_b32 v65, 0
v_mov_b32 v66, 0
v_mov_b32 v67, 0
v_mov_b32 v68, 0
v_mov_b32 v69, 0
v_mov_b32 v70, 0
v_mov_b32 v71, 0
v_mov_b32 v72, 0
v_mov_b32 v73, 0
v_mov_b32 v74, 0
v_mov_b32 v75, 0
v_mov_b32 v76, 0
v_mov_b32 v77, 0
v_mov_b32 v78, 0
v_mov_b32 v79, 0
v_mov_b32 v80, 0
v_mov_b32 v81, 0
v_mov_b32 v82, 0
v_mov_b32 v83, 0
v_mov_b32 v84, 0
v_mov_b32 v85, 0
v_mov_b32 v86, 0
v_mov_b32 v87, 0
v_mov_b32 v88, 0
v_mov_b32 v89, 0
v_mov_b32 v90, 0
v_mov_b32 v91, 0
v_mov_b32 v92, 0
v_mov_b32 v93, 0
v_mov_b32 v94, 0
v_mov_b32 v95, 0
v_accvgpr_write_b32 a240, 0
v_accvgpr_write_b32 a241, 0
v_accvgpr_write_b32 a242, 0
v_accvgpr_write_b32 a243, 0
v_accvgpr_write_b32 a244, 0
v_accvgpr_write_b32 a245, 0
v_accvgpr_write_b32 a246, 0
v_accvgpr_write_b32 a247, 0
v_accvgpr_write_b32 a248, 0
v_accvgpr_write_b32 a249, 0
v_accvgpr_write_b32 a250, 0
v_accvgpr_write_b32 a251, 0
s_mov_b32 s6, s4
L_slow2:
buffer_load_dwordx4 v[204:207], v184, s[8:11], s6 offen offset:0
buffer_load_dwordx4 v[208:211], v184, s[8:11], s6 offen offset:64
buffer_load_dwordx4 v[212:215], v187, s[8:11], s6 offen offset:0
buffer_load_dwordx4 v[216:219], v187, s[8:11], s6 offen offset:64
s_waitcnt vmcnt(0)
v_mfma_f32_16x16x32_bf16 v[192:195], v[204:207], v[96:99], v[168:171]
v_mfma_f32_16x16x32_bf16 v[192:195], v[208:211], v[108:111], v[192:195]
v_mfma_f32_16x16x32_bf16 v[192:195], v[212:215], v[120:123], v[192:195]
v_mfma_f32_16x16x32_bf16 v[192:195], v[216:219], v[132:135], v[192:195]
v_mfma_f32_16x16x32_bf16 v[196:199], v[204:207], v[100:103], v[172:175]
v_mfma_f32_16x16x32_bf16 v[196:199], v[208:211], v[112:115], v[196:199]
v_mfma_f32_16x16x32_bf16 v[196:199], v[212:215], v[124:127], v[196:199]
v_mfma_f32_16x16x32_bf16 v[196:199], v[216:219], v[136:139], v[196:199]
v_mfma_f32_16x16x32_bf16 v[200:203], v[204:207], v[104:107], v[176:179]
v_mfma_f32_16x16x32_bf16 v[200:203], v[208:211], v[116:119], v[200:203]
v_mfma_f32_16x16x32_bf16 v[200:203], v[212:215], v[128:131], v[200:203]
v_mfma_f32_16x16x32_bf16 v[200:203], v[216:219], v[140:143], v[200:203]
s_nop 9
v_exp_f32 v192, v192
v_exp_f32 v193, v193
v_exp_f32 v194, v194
v_exp_f32 v195, v195
v_exp_f32 v196, v196
v_exp_f32 v197, v197
v_exp_f32 v198, v198
v_exp_f32 v199, v199
v_exp_f32 v200, v200
v_exp_f32 v201, v201
v_exp_f32 v202, v202
v_exp_f32 v203, v203
s_nop 0
v_cvt_pk_bf16_f32 v144, v192, v193
v_cvt_pk_bf16_f32 v145, v194, v195
v_cvt_pk_bf16_f32 v148, v196, v197
v_cvt_pk_bf16_f32 v149, v198, v199
v_cvt_pk_bf16_f32 v152, v200, v201
v_cvt_pk_bf16_f32 v153, v202, v203
s_mov_b32 s7, s6
s_add_u32 s6, s6, 0x1000
buffer_load_dwordx4 v[204:207], v184, s[8:11], s6 offen offset:0
buffer_load_dwordx4 v[208:211], v184, s[8:11], s6 offen offset:64
buffer_load_dwordx4 v[212:215], v187, s[8:11], s6 offen offset:0
buffer_load_dwordx4 v[216:219], v187, s[8:11], s6 offen offset:64
s_waitcnt vmcnt(0)
v_mfma_f32_16x16x32_bf16 v[192:195], v[204:207], v[96:99], v[168:171]
v_mfma_f32_16x16x32_bf16 v[192:195], v[208:211], v[108:111], v[192:195]
v_mfma_f32_16x16x32_bf16 v[192:195], v[212:215], v[120:123], v[192:195]
v_mfma_f32_16x16x32_bf16 v[192:195], v[216:219], v[132:135], v[192:195]
v_mfma_f32_16x16x32_bf16 v[196:199], v[204:207], v[100:103], v[172:175]
v_mfma_f32_16x16x32_bf16 v[196:199], v[208:211], v[112:115], v[196:199]
v_mfma_f32_16x16x32_bf16 v[196:199], v[212:215], v[124:127], v[196:199]
v_mfma_f32_16x16x32_bf16 v[196:199], v[216:219], v[136:139], v[196:199]
v_mfma_f32_16x16x32_bf16 v[200:203], v[204:207], v[104:107], v[176:179]
v_mfma_f32_16x16x32_bf16 v[200:203], v[208:211], v[116:119], v[200:203]
v_mfma_f32_16x16x32_bf16 v[200:203], v[212:215], v[128:131], v[200:203]
v_mfma_f32_16x16x32_bf16 v[200:203], v[216:219], v[140:143], v[200:203]
s_nop 9
v_exp_f32 v192, v192
v_exp_f32 v193, v193
v_exp_f32 v194, v194
v_exp_f32 v195, v195
v_exp_f32 v196, v196
v_exp_f32 v197, v197
v_exp_f32 v198, v198
v_exp_f32 v199, v199
v_exp_f32 v200, v200
v_exp_f32 v201, v201
v_exp_f32 v202, v202
v_exp_f32 v203, v203
s_nop 0
v_cvt_pk_bf16_f32 v146, v192, v193
v_cvt_pk_bf16_f32 v147, v194, v195
v_cvt_pk_bf16_f32 v150, v196, v197
v_cvt_pk_bf16_f32 v151, v198, v199
v_cvt_pk_bf16_f32 v154, v200, v201
v_cvt_pk_bf16_f32 v155, v202, v203
buffer_load_ushort v204, v185, s[12:15], s7 offen offset:0
buffer_load_ushort v205, v185, s[12:15], s7 offen offset:256
buffer_load_ushort v206, v185, s[12:15], s7 offen offset:512
buffer_load_ushort v207, v185, s[12:15], s7 offen offset:768
buffer_load_ushort v208, v186, s[12:15], s7 offen offset:0
buffer_load_ushort v209, v186, s[12:15], s7 offen offset:256
buffer_load_ushort v210, v186, s[12:15], s7 offen offset:512
buffer_load_ushort v211, v186, s[12:15], s7 offen offset:768
s_waitcnt vmcnt(0)
v_lshl_or_b32 v220, v205, 16, v204
v_lshl_or_b32 v221, v207, 16, v206
v_lshl_or_b32 v222, v209, 16, v208
v_lshl_or_b32 v223, v211, 16, v210
s_nop 1
v_mfma_f32_16x16x32_bf16 v[0:3], v[220:223], v[144:147], v[0:3]
v_mfma_f32_16x16x32_bf16 v[4:7], v[220:223], v[148:151], v[4:7]
v_mfma_f32_16x16x32_bf16 v[8:11], v[220:223], v[152:155], v[8:11]
buffer_load_ushort v204, v185, s[12:15], s7 offen offset:32
buffer_load_ushort v205, v185, s[12:15], s7 offen offset:288
buffer_load_ushort v206, v185, s[12:15], s7 offen offset:544
buffer_load_ushort v207, v185, s[12:15], s7 offen offset:800
buffer_load_ushort v208, v186, s[12:15], s7 offen offset:32
buffer_load_ushort v209, v186, s[12:15], s7 offen offset:288
buffer_load_ushort v210, v186, s[12:15], s7 offen offset:544
buffer_load_ushort v211, v186, s[12:15], s7 offen offset:800
s_waitcnt vmcnt(0)
v_lshl_or_b32 v220, v205, 16, v204
v_lshl_or_b32 v221, v207, 16, v206
v_lshl_or_b32 v222, v209, 16, v208
v_lshl_or_b32 v223, v211, 16, v210
s_nop 1
v_mfma_f32_16x16x32_bf16 v[12:15], v[220:223], v[144:147], v[12:15]
v_mfma_f32_16x16x32_bf16 v[16:19], v[220:223], v[148:151], v[16:19]
v_mfma_f32_16x16x32_bf16 v[20:23], v[220:223], v[152:155], v[20:23]
buffer_load_ushort v204, v185, s[12:15], s7 offen offset:64
buffer_load_ushort v205, v185, s[12:15], s7 offen offset:320
buffer_load_ushort v206, v185, s[12:15], s7 offen offset:576
buffer_load_ushort v207, v185, s[12:15], s7 offen offset:832
buffer_load_ushort v208, v186, s[12:15], s7 offen offset:64
buffer_load_ushort v209, v186, s[12:15], s7 offen offset:320
buffer_load_ushort v210, v186, s[12:15], s7 offen offset:576
buffer_load_ushort v211, v186, s[12:15], s7 offen offset:832
s_waitcnt vmcnt(0)
v_lshl_or_b32 v220, v205, 16, v204
v_lshl_or_b32 v221, v207, 16, v206
v_lshl_or_b32 v222, v209, 16, v208
v_lshl_or_b32 v223, v211, 16, v210
s_nop 1
v_mfma_f32_16x16x32_bf16 v[24:27], v[220:223], v[144:147], v[24:27]
v_mfma_f32_16x16x32_bf16 v[28:31], v[220:223], v[148:151], v[28:31]
v_mfma_f32_16x16x32_bf16 v[32:35], v[220:223], v[152:155], v[32:35]
buffer_load_ushort v204, v185, s[12:15], s7 offen offset:96
buffer_load_ushort v205, v185, s[12:15], s7 offen offset:352
buffer_load_ushort v206, v185, s[12:15], s7 offen offset:608
buffer_load_ushort v207, v185, s[12:15], s7 offen offset:864
buffer_load_ushort v208, v186, s[12:15], s7 offen offset:96
buffer_load_ushort v209, v186, s[12:15], s7 offen offset:352
buffer_load_ushort v210, v186, s[12:15], s7 offen offset:608
buffer_load_ushort v211, v186, s[12:15], s7 offen offset:864
s_waitcnt vmcnt(0)
v_lshl_or_b32 v220, v205, 16, v204
v_lshl_or_b32 v221, v207, 16, v206
v_lshl_or_b32 v222, v209, 16, v208
v_lshl_or_b32 v223, v211, 16, v210
s_nop 1
v_mfma_f32_16x16x32_bf16 v[36:39], v[220:223], v[144:147], v[36:39]
v_mfma_f32_16x16x32_bf16 v[40:43], v[220:223], v[148:151], v[40:43]
v_mfma_f32_16x16x32_bf16 v[44:47], v[220:223], v[152:155], v[44:47]
buffer_load_ushort v204, v185, s[12:15], s7 offen offset:128
buffer_load_ushort v205, v185, s[12:15], s7 offen offset:384
buffer_load_ushort v206, v185, s[12:15], s7 offen offset:640
buffer_load_ushort v207, v185, s[12:15], s7 offen offset:896
buffer_load_ushort v208, v186, s[12:15], s7 offen offset:128
buffer_load_ushort v209, v186, s[12:15], s7 offen offset:384
buffer_load_ushort v210, v186, s[12:15], s7 offen offset:640
buffer_load_ushort v211, v186, s[12:15], s7 offen offset:896
s_waitcnt vmcnt(0)
v_lshl_or_b32 v220, v205, 16, v204
v_lshl_or_b32 v221, v207, 16, v206
v_lshl_or_b32 v222, v209, 16, v208
v_lshl_or_b32 v223, v211, 16, v210
s_nop 1
v_mfma_f32_16x16x32_bf16 v[48:51], v[220:223], v[144:147], v[48:51]
v_mfma_f32_16x16x32_bf16 v[52:55], v[220:223], v[148:151], v[52:55]
v_mfma_f32_16x16x32_bf16 v[56:59], v[220:223], v[152:155], v[56:59]
buffer_load_ushort v204, v185, s[12:15], s7 offen offset:160
buffer_load_ushort v205, v185, s[12:15], s7 offen offset:416
buffer_load_ushort v206, v185, s[12:15], s7 offen offset:672
buffer_load_ushort v207, v185, s[12:15], s7 offen offset:928
buffer_load_ushort v208, v186, s[12:15], s7 offen offset:160
buffer_load_ushort v209, v186, s[12:15], s7 offen offset:416
buffer_load_ushort v210, v186, s[12:15], s7 offen offset:672
buffer_load_ushort v211, v186, s[12:15], s7 offen offset:928
s_waitcnt vmcnt(0)
v_lshl_or_b32 v220, v205, 16, v204
v_lshl_or_b32 v221, v207, 16, v206
v_lshl_or_b32 v222, v209, 16, v208
v_lshl_or_b32 v223, v211, 16, v210
s_nop 1
v_mfma_f32_16x16x32_bf16 v[60:63], v[220:223], v[144:147], v[60:63]
v_mfma_f32_16x16x32_bf16 v[64:67], v[220:223], v[148:151], v[64:67]
v_mfma_f32_16x16x32_bf16 v[68:71], v[220:223], v[152:155], v[68:71]
buffer_load_ushort v204, v185, s[12:15], s7 offen offset:192
buffer_load_ushort v205, v185, s[12:15], s7 offen offset:448
buffer_load_ushort v206, v185, s[12:15], s7 offen offset:704
buffer_load_ushort v207, v185, s[12:15], s7 offen offset:960
buffer_load_ushort v208, v186, s[12:15], s7 offen offset:192
buffer_load_ushort v209, v186, s[12:15], s7 offen offset:448
buffer_load_ushort v210, v186, s[12:15], s7 offen offset:704
buffer_load_ushort v211, v186, s[12:15], s7 offen offset:960
s_waitcnt vmcnt(0)
v_lshl_or_b32 v220, v205, 16, v204
v_lshl_or_b32 v221, v207, 16, v206
v_lshl_or_b32 v222, v209, 16, v208
v_lshl_or_b32 v223, v211, 16, v210
s_nop 1
v_mfma_f32_16x16x32_bf16 v[72:75], v[220:223], v[144:147], v[72:75]
v_mfma_f32_16x16x32_bf16 v[76:79], v[220:223], v[148:151], v[76:79]
v_mfma_f32_16x16x32_bf16 v[80:83], v[220:223], v[152:155], v[80:83]
buffer_load_ushort v204, v185, s[12:15], s7 offen offset:224
buffer_load_ushort v205, v185, s[12:15], s7 offen offset:480
buffer_load_ushort v206, v185, s[12:15], s7 offen offset:736
buffer_load_ushort v207, v185, s[12:15], s7 offen offset:992
buffer_load_ushort v208, v186, s[12:15], s7 offen offset:224
buffer_load_ushort v209, v186, s[12:15], s7 offen offset:480
buffer_load_ushort v210, v186, s[12:15], s7 offen offset:736
buffer_load_ushort v211, v186, s[12:15], s7 offen offset:992
s_waitcnt vmcnt(0)
v_lshl_or_b32 v220, v205, 16, v204
v_lshl_or_b32 v221, v207, 16, v206
v_lshl_or_b32 v222, v209, 16, v208
v_lshl_or_b32 v223, v211, 16, v210
s_nop 1
v_mfma_f32_16x16x32_bf16 v[84:87], v[220:223], v[144:147], v[84:87]
v_mfma_f32_16x16x32_bf16 v[88:91], v[220:223], v[148:151], v[88:91]
v_mfma_f32_16x16x32_bf16 v[92:95], v[220:223], v[152:155], v[92:95]
v_mfma_f32_16x16x32_bf16 a[240:243], a[252:255], v[144:147], a[240:243]
v_mfma_f32_16x16x32_bf16 a[244:247], a[252:255], v[148:151], a[244:247]
v_mfma_f32_16x16x32_bf16 a[248:251], a[252:255], v[152:155], a[248:251]
s_add_u32 s6, s6, 0x1000
s_cmp_lt_u32 s6, s5
s_cbranch_scc1 L_slow2
s_nop 9
v_accvgpr_read_b32 v249, a240
v_accvgpr_read_b32 v250, a244
v_accvgpr_read_b32 v251, a248
v_rcp_f32 v249, v249
v_rcp_f32 v250, v250
v_rcp_f32 v251, v251
s_nop 0
v_mul_f32 v0, v249, v0
v_mul_f32 v1, v249, v1
v_mul_f32 v2, v249, v2
v_mul_f32 v3, v249, v3
v_cvt_pk_bf16_f32 v144, v0, v1
v_cvt_pk_bf16_f32 v145, v2, v3
v_mul_f32 v12, v249, v12
v_mul_f32 v13, v249, v13
v_mul_f32 v14, v249, v14
v_mul_f32 v15, v249, v15
v_cvt_pk_bf16_f32 v146, v12, v13
v_cvt_pk_bf16_f32 v147, v14, v15
v_mul_f32 v4, v250, v4
v_mul_f32 v5, v250, v5
v_mul_f32 v6, v250, v6
v_mul_f32 v7, v250, v7
v_cvt_pk_bf16_f32 v148, v4, v5
v_cvt_pk_bf16_f32 v149, v6, v7
v_mul_f32 v16, v250, v16
v_mul_f32 v17, v250, v17
v_mul_f32 v18, v250, v18
v_mul_f32 v19, v250, v19
v_cvt_pk_bf16_f32 v150, v16, v17
v_cvt_pk_bf16_f32 v151, v18, v19
v_mul_f32 v8, v251, v8
v_mul_f32 v9, v251, v9
v_mul_f32 v10, v251, v10
ds_read_b64_tr_b16 v[204:205], v241 offset:49152
ds_read_b64_tr_b16 v[206:207], v241 offset:51200
ds_read_b64_tr_b16 v[208:209], v241 offset:53248
ds_read_b64_tr_b16 v[210:211], v241 offset:55296
ds_read_b64_tr_b16 v[212:213], v241 offset:57344
ds_read_b64_tr_b16 v[214:215], v241 offset:59392
ds_read_b64_tr_b16 v[216:217], v241 offset:61440
ds_read_b64_tr_b16 v[218:219], v241 offset:63488
s_waitcnt lgkmcnt(0)
s_branch L_join
s_endpgm
.section .rodata,"a"
.p2align 6
.amdhsa_kernel standalone__mha_block_cached__near_ridge_kernel
  .amdhsa_next_free_vgpr 512
  .amdhsa_next_free_sgpr 102
  .amdhsa_accum_offset 256
  .amdhsa_group_segment_fixed_size 0
  .amdhsa_kernarg_size 64
  .amdhsa_user_sgpr_count 2
  .amdhsa_user_sgpr_kernarg_segment_ptr 1
  .amdhsa_system_sgpr_workgroup_id_x 1
.end_amdhsa_kernel
```
